```python
import torch

def _softmax(x, axis=-1):
    return torch.softmax(x, dim=axis)

def _gelu(x):
    return torch.nn.functional.gelu(x, approximate='tanh')

def _silu(x):
    return torch.nn.functional.silu(x)

def _sigmoid(x):
    return torch.sigmoid(x)

def _layernorm(x, axis=-1, eps=1e-05):
    m = x.mean(dim=axis, keepdim=True)
    v = x.var(dim=axis, keepdim=True, unbiased=False)
    return (x - m) / torch.sqrt(v + eps)

def _scatter_add(tgt, idx, src, axis=0):
    return tgt.clone().index_add_(axis, idx, src)

def _segment_sum(src, seg, n):
    out = torch.zeros((n,) + src.shape[1:], dtype=src.dtype)
    return out.index_add_(0, seg, src)

def _pad(x, pw):
    flat = tuple((v for pair in reversed(pw) for v in pair))
    return torch.nn.functional.pad(x, flat)
kernel_name = 'interleave_layers__memory_aug_recurrent_mem_tr__glu_gated_geglu__prompt'

def setup_inputs():

    _w = lambda a: (lambda t: t.to(torch.bfloat16) if t.is_floating_point() else t)(torch.as_tensor(a))

    def _A_setup():
        B, S, Dm = (1, 2048, 512)
        H, Dh = (32, 128)
        M, seg = (8, 32)
        seg = min(seg, S)
        S = S // seg * seg
        return {'x': _w((lambda *s: torch.randn(*s, dtype=torch.bfloat16) * 0.05)(B, S, Dm)), 'mem0': _w((lambda *s: torch.randn(*s, dtype=torch.bfloat16) * 0.4)(B, M, Dm)), 'Wq': _w((lambda *s: torch.randn(*s, dtype=torch.bfloat16) * 0.8)(Dm, H, Dh) * Dm ** (-0.5)), 'Wk': _w((lambda *s: torch.randn(*s, dtype=torch.bfloat16) * 0.8)(Dm, H, Dh) * Dm ** (-0.5)), 'Wv': _w((lambda *s: torch.randn(*s, dtype=torch.bfloat16) * 0.4)(Dm, H, Dh) * Dm ** (-0.5)), 'Wo': _w((lambda *s: torch.randn(*s, dtype=torch.bfloat16) * 0.4)(H, Dh, Dm) * (H * Dh) ** (-0.5)), 'seg_len': seg}
    _A_in = _A_setup()

    def _B_setup():
        B, S, Dm, Df = (1, 2048, 512, 1792)
        return {'x': _w((lambda *s: torch.randn(*s, dtype=torch.bfloat16) * 0.05)(B, S, Dm)), 'w_gate': _w((lambda *s: torch.randn(*s, dtype=torch.bfloat16) * 0.4)(Dm, Df) * Dm ** (-0.5)), 'w_up': _w((lambda *s: torch.randn(*s, dtype=torch.bfloat16) * 0.4)(Dm, Df) * Dm ** (-0.5)), 'w_down': _w((lambda *s: torch.randn(*s, dtype=torch.bfloat16) * 0.4)(Df, Dm) * Df ** (-0.5))}
    _B_in = _B_setup()
    return {'A_x': _A_in['x'], 'A_mem0': _A_in['mem0'], 'A_Wq': _A_in['Wq'], 'A_Wk': _A_in['Wk'], 'A_Wv': _A_in['Wv'], 'A_Wo': _A_in['Wo'], 'A_seg_len': _A_in['seg_len'], 'B_x': _B_in['x'], 'B_w_gate': _B_in['w_gate'], 'B_w_up': _B_in['w_up'], 'B_w_down': _B_in['w_down']}

def reference(A_x, A_mem0, A_Wq, A_Wk, A_Wv, A_Wo, A_seg_len, B_x, B_w_gate, B_w_up, B_w_down):

    def _A_ref(x, mem0, Wq, Wk, Wv, Wo, seg_len):
        B, S, Dm = x.shape
        H, Dh = (Wq.shape[1], Wq.shape[2])
        M = mem0.shape[1]
        scale = Dh ** (-0.5)
        n_seg = S // seg_len
        L = M + seg_len
        idx = torch.arange(L)
        mask = (idx[:, None] < M) | (idx[:, None] >= idx[None, :])
        mem = mem0
        outs = []
        for s in range(n_seg):
            xs = x[:, s * seg_len:(s + 1) * seg_len, :].clone()
            h = torch.concatenate([mem, xs], axis=1)
            q = torch.einsum('btd,dhe->bhte', h, Wq)
            k = torch.einsum('btd,dhe->bhte', h, Wk)
            v = torch.einsum('btd,dhe->bhte', h, Wv)
            scores = torch.einsum('bhqe,bhke->bhqk', q, k) * scale
            scores = torch.where(mask[None, None], scores, -1000000000.0)
            p = _softmax(scores, axis=-1)
            o = torch.einsum('bhqk,bhke->bhqe', p, v)
            o = torch.einsum('bhte,hed->btd', o, Wo)
            mem = o[:, :M, :].clone()
            outs.append(o[:, M:, :])
        return torch.concatenate(outs, axis=1)

    def _B_ref(x, w_gate, w_up, w_down):
        g = torch.einsum('bsd,df->bsf', x, w_gate)
        u = torch.einsum('bsd,df->bsf', x, w_up)
        h = _gelu(g) * u
        return torch.einsum('bsf,fd->bsd', h, w_down)
    x = A_x
    x = x + _A_ref(_layernorm(x, axis=-1), A_mem0, A_Wq, A_Wk, A_Wv, A_Wo, A_seg_len)
    x = x + _B_ref(_layernorm(x, axis=-1), B_w_gate, B_w_up, B_w_down)
    x = x + _A_ref(_layernorm(x, axis=-1), A_mem0, A_Wq, A_Wk, A_Wv, A_Wo, A_seg_len)
    x = x + _B_ref(_layernorm(x, axis=-1), B_w_gate, B_w_up, B_w_down)
    return x
```

```asm
; @launch grid=(256,1,1) block=(256,1,1) lds=163840
.amdgcn_target "amdgcn-amd-amdhsa--gfx950"
.text
.globl interleave_layers__memory_aug_recurrent_mem_tr__glu_gated_geglu__prompt_kernel
.p2align 8
.type interleave_layers__memory_aug_recurrent_mem_tr__glu_gated_geglu__prompt_kernel,@function
interleave_layers__memory_aug_recurrent_mem_tr__glu_gated_geglu__prompt_kernel:
  s_cmp_ge_u32 s2, 256
  s_cbranch_scc1 END
  s_load_dwordx16 s[16:31], s[0:1], 0
  s_load_dwordx8 s[32:39], s[0:1], 64
  s_load_dwordx4 s[40:43], s[0:1], 96
  v_lshrrev_b32 v2, 6, v0
  v_and_b32 v0, 63, v0
  v_readfirstlane_b32 s44, v2
  v_lshlrev_b32 v1, 4, v0
  s_getreg_b32 s50, hwreg(HW_REG_XCC_ID)
  s_and_b32 s50, s50, 0xf
  s_mov_b32 s46, 0
  s_mov_b32 s47, 0
  s_mov_b32 s49, 0
  s_lshl_b32 s48, s44, 15
  s_waitcnt lgkmcnt(0)
  s_mov_b32 s4, s42
  s_and_b32 s5, s43, 0xffff
  s_mov_b32 s6, 0x10000000
  s_mov_b32 s7, 0x20000
  s_mov_b32 s12, s40
  s_and_b32 s13, s41, 0xffff
  s_mov_b32 s14, 256
  s_mov_b32 s15, 0x20000
  s_mov_b32 s8, s16
  s_and_b32 s9, s17, 0xffff
  s_mov_b32 s10, 0x200000
  s_mov_b32 s11, 0x20000
  v_mov_b32 v4, -1
  v_mov_b32 v8, 0
  v_mov_b32 v5, -1
  v_mov_b32 v9, 0
  v_mov_b32 v6, -1
  v_mov_b32 v10, 0
  v_mov_b32 v7, -1
  v_mov_b32 v11, 0
  s_lshl_b32 s92, s2, 13
  s_lshl_b32 s93, s44, 11
  s_add_u32 s92, s92, s93
  s_add_u32 s92, s92, 0x200000
  buffer_store_dwordx4 v[4:7], v1, s[4:7], s92 offen sc1
  buffer_store_dwordx4 v[4:7], v1, s[4:7], s92 offen offset:1024 sc1
  s_lshl_b32 s92, s2, 14
  s_lshl_b32 s93, s44, 12
  s_add_u32 s92, s92, s93
  s_add_u32 s92, s92, 0xc000000
  buffer_store_dwordx4 v[8:11], v1, s[4:7], s92 offen offset:0 sc1
  buffer_store_dwordx4 v[8:11], v1, s[4:7], s92 offen offset:1024 sc1
  buffer_store_dwordx4 v[8:11], v1, s[4:7], s92 offen offset:2048 sc1
  buffer_store_dwordx4 v[8:11], v1, s[4:7], s92 offen offset:3072 sc1
  s_cmp_lg_u32 s44, 2
  s_cbranch_scc1 pi_2
  s_lshl_b32 s92, s2, 8
  s_add_u32 s92, s92, 0x40000
  s_mov_b64 exec, 0xffff
  buffer_store_dwordx4 v[4:7], v1, s[4:7], s92 offen sc1
  s_mov_b64 exec, 3
  s_lshl_b32 s92, s2, 5
  buffer_store_dwordx4 v[8:11], v1, s[4:7], s92 offen sc1
  s_mov_b64 exec, -1
pi_2:
  v_mov_b32 v12, 163328
  s_waitcnt vmcnt(0)
  s_barrier
  s_cmp_lg_u32 s44, 3
  s_cbranch_scc1 pi_4
  s_getpc_b64 s[52:53]
PCREF:
  s_bfe_u32 s54, s2, 0x40003
  s_lshl_b32 s54, s54, 13
  v_lshlrev_b32 v13, 7, v0
  v_add_u32 v13, s54, v13
  v_min_u32 v13, END-PCREF, v13
  global_load_dword v14, v13, s[52:53]
pi_4:
  s_cmp_lg_u32 s44, 0
  s_cbranch_scc1 pi_3
  s_min_u32 s51, s50, 8
  s_lshl_b32 s52, s51, 3
  s_cmp_eq_u32 s51, 0
  s_cselect_b32 s52, 128, s52
  v_mov_b32 v2, s52
  v_mov_b32 v3, 1
  s_mov_b64 exec, 1
  buffer_atomic_add v3, v2, s[12:15], 0 offen sc0
  v_mov_b32 v4, s51
  ds_write_b32 v12, v4 offset:4
  s_waitcnt vmcnt(0)
  ds_write_b32 v12, v3
  s_mov_b64 exec, -1
  s_waitcnt lgkmcnt(0)
pi_3:
  s_barrier
  ds_read2_b32 v[2:3], v12 offset0:0 offset1:1
  s_waitcnt lgkmcnt(0)
  v_readfirstlane_b32 s51, v2
  v_readfirstlane_b32 s50, v3
  s_nop 0
  s_lshl_b32 s45, s50, 5
  s_add_u32 s45, s45, s51
  s_mov_b32 s92, 0
  s_cmp_ge_u32 s45, 64
  s_cselect_b32 s92, 0x0, s92
  s_cmp_ge_u32 s45, 160
  s_cselect_b32 s92, 0x0, s92
  s_cmp_ge_u32 s45, 192
  s_cselect_b32 s92, 0x0, s92
  s_cmp_ge_u32 s45, 204
  s_cselect_b32 s92, 0x30, s92
  s_cmp_ge_u32 s45, 208
  s_cselect_b32 s92, 0x0, s92
  s_cmp_ge_u32 s45, 224
  s_cselect_b32 s92, 0x0, s92
  s_cmp_ge_u32 s45, 252
  s_cselect_b32 s92, 0xffffffd0, s92
  s_add_u32 s45, s45, s92
  s_cmp_ge_u32 s51, 32
  s_cselect_b32 s45, 255, s45
  s_cmp_ge_u32 s50, 8
  s_cselect_b32 s45, 255, s45
DISPATCH:
  s_cmp_lt_u32 s45, 64
  s_cbranch_scc1 ROLE_CHAIN
  s_cmp_lt_u32 s45, 160
  s_cbranch_scc1 ROLE_H
  s_cmp_lt_u32 s45, 192
  s_cbranch_scc1 ROLE_W
  s_cmp_lt_u32 s45, 208
  s_cbranch_scc1 ROLE_ATT
  s_cmp_lt_u32 s45, 224
  s_cbranch_scc1 ROLE_F2
  s_cmp_lt_u32 s45, 252
  s_cbranch_scc1 ROLE_F1
  s_cmp_lg_u32 s46, 0
  s_cbranch_scc1 cen_5
  v_mov_b32 v4, 163328
  s_cmp_lg_u32 s44, 0
  s_cbranch_scc1 cen_6
  v_min_u32 v5, 9, v0
  v_lshlrev_b32 v5, 3, v5
  s_mov_b32 s92, 128
  v_writelane_b32 v5, s92, 0
cen_7:
  buffer_load_dword v2, v5, s[12:15], 0 offen sc1
  s_mov_b32 s92, 0
  s_waitcnt vmcnt(0)
  v_readlane_b32 s93, v2, 0
  s_nop 0
  s_add_u32 s92, s92, s93
  v_readlane_b32 s93, v2, 1
  s_nop 0
  s_add_u32 s92, s92, s93
  v_readlane_b32 s93, v2, 2
  s_nop 0
  s_add_u32 s92, s92, s93
  v_readlane_b32 s93, v2, 3
  s_nop 0
  s_add_u32 s92, s92, s93
  v_readlane_b32 s93, v2, 4
  s_nop 0
  s_add_u32 s92, s92, s93
  v_readlane_b32 s93, v2, 5
  s_nop 0
  s_add_u32 s92, s92, s93
  v_readlane_b32 s93, v2, 6
  s_nop 0
  s_add_u32 s92, s92, s93
  v_readlane_b32 s93, v2, 7
  s_nop 0
  s_add_u32 s92, s92, s93
  v_readlane_b32 s93, v2, 8
  s_nop 0
  s_add_u32 s92, s92, s93
  s_cmp_eq_u32 s92, 256
  s_cbranch_scc1 cen_8
  s_add_u32 s47, s47, 1
  s_mov_b32 s49, 1
  s_cmp_gt_u32 s47, 131072
  s_cbranch_scc1 TIMEOUT
  s_sleep 4
  s_branch cen_7
cen_8:
  v_cmp_ne_u32 vcc, 32, v2
  ds_read2_b32 v[6:7], v4 offset0:0 offset1:1
  s_and_b32 s94, vcc_lo, 0xff
  s_waitcnt lgkmcnt(0)
  v_readfirstlane_b32 s92, v6
  v_readfirstlane_b32 s95, v7
  v_readlane_b32 s93, v2, 0
  s_cmp_gt_u32 s95, 0
  s_cselect_b32 s93, s93, 0
  s_add_u32 s92, s92, s93
  v_readlane_b32 s93, v2, 1
  s_cmp_gt_u32 s95, 1
  s_cselect_b32 s93, s93, 0
  s_add_u32 s92, s92, s93
  v_readlane_b32 s93, v2, 2
  s_cmp_gt_u32 s95, 2
  s_cselect_b32 s93, s93, 0
  s_add_u32 s92, s92, s93
  v_readlane_b32 s93, v2, 3
  s_cmp_gt_u32 s95, 3
  s_cselect_b32 s93, s93, 0
  s_add_u32 s92, s92, s93
  v_readlane_b32 s93, v2, 4
  s_cmp_gt_u32 s95, 4
  s_cselect_b32 s93, s93, 0
  s_add_u32 s92, s92, s93
  v_readlane_b32 s93, v2, 5
  s_cmp_gt_u32 s95, 5
  s_cselect_b32 s93, s93, 0
  s_add_u32 s92, s92, s93
  v_readlane_b32 s93, v2, 6
  s_cmp_gt_u32 s95, 6
  s_cselect_b32 s93, s93, 0
  s_add_u32 s92, s92, s93
  v_readlane_b32 s93, v2, 7
  s_cmp_gt_u32 s95, 7
  s_cselect_b32 s93, s93, 0
  s_add_u32 s92, s92, s93
  v_mov_b32 v2, s92
  v_mov_b32 v3, s94
  ds_write2_b32 v4, v2, v3 offset0:2 offset1:3
cen_6:
  s_waitcnt lgkmcnt(0)
  s_barrier
  ds_read2_b32 v[2:3], v4 offset0:2 offset1:3
  s_waitcnt lgkmcnt(0)
  v_readfirstlane_b32 s92, v2
  v_readfirstlane_b32 s93, v3
  s_nop 0
  s_cmp_eq_u32 s93, 0
  s_cbranch_scc1 cen_5
  s_mov_b32 s46, 1
  s_mov_b32 s45, s92
  s_branch DISPATCH
cen_5:
  s_branch END
ROLE_CHAIN:
  s_lshr_b32 s50, s45, 5
  s_and_b32 s51, s45, 31
  s_lshl_b32 s52, s51, 8
  s_lshl_b32 s92, s44, 6
  s_add_u32 s52, s52, s92
  s_lshl_b32 s53, s51, 17
  s_lshl_b32 s92, s44, 8
  s_add_u32 s53, s53, s92
  v_min_u32 v43, 9, v0
  v_lshlrev_b32 v43, 3, v43
  s_mov_b32 s92, 128
  v_writelane_b32 v43, s92, 0
  s_mov_b32 s76, s18
  s_and_b32 s77, s19, 0xffff
  s_mov_b32 s78, 8192
  s_mov_b32 s79, 0x20000
  v_lshrrev_b32 v46, 4, v0
  v_lshlrev_b32 v46, 11, v46
  v_and_b32 v47, 1, v0
  v_lshl_add_u32 v46, v47, 10, v46
  v_bfe_u32 v47, v0, 2, 1
  v_lshl_add_u32 v46, v47, 6, v46
  v_bfe_u32 v47, v0, 1, 1
  v_lshl_add_u32 v46, v47, 3, v46
  s_lshr_b32 s80, s51, 2
  s_lshl_b32 s80, s80, 7
  s_and_b32 s93, s51, 3
  s_lshl_b32 s93, s93, 4
  s_add_u32 s80, s80, s93
  s_cmp_lg_u32 s44, 0
  s_cbranch_scc1 cl_10
  s_mov_b32 s72, 151552
  s_mov_b32 s73, 149504
  s_mov_b32 s74, 153600
  s_xor_b32 s75, s51, 1
  s_lshl_b32 s75, s75, 8
  s_add_u32 s75, s75, 0
  v_lshlrev_b32 v40, 13, v0
  v_lshrrev_b32 v21, 4, v0
  v_bfe_u32 v22, v0, 2, 2
  v_and_b32 v23, 3, v0
  v_lshrrev_b32 v24, 1, v21
  v_lshlrev_b32 v17, 4, v24
  v_lshrrev_b32 v24, 1, v22
  v_lshl_add_u32 v17, v24, 3, v17
  v_and_b32 v24, 1, v21
  v_lshl_add_u32 v17, v24, 2, v17
  v_and_b32 v24, 1, v22
  v_add_u32 v17, v17, v24
  v_lshlrev_b32 v17, 6, v17
  v_lshl_add_u32 v17, v23, 3, v17
  v_add_u32 v17, s48, v17
  v_lshrrev_b32 v24, 1, v22
  v_lshlrev_b32 v18, 5, v24
  v_and_b32 v24, 1, v22
  v_add_u32 v18, v18, v24
  v_and_b32 v24, 1, v21
  v_lshl_add_u32 v18, v24, 4, v18
  v_lshrrev_b32 v24, 1, v21
  v_lshl_add_u32 v18, v24, 2, v18
  v_lshlrev_b32 v18, 6, v18
  v_lshl_add_u32 v18, v23, 4, v18
  v_add_u32 v18, s48, v18
  v_add_u32 v21, s48, v1
  s_mov_b32 s8, s20
  s_and_b32 s9, s21, 0xffff
  s_mov_b32 s10, 0x400000
  s_mov_b32 s11, 0x20000
  s_mov_b32 s92, 8192
  v_lshrrev_b32 v16, 2, v0
  v_mul_lo_u32 v16, v16, s92
  v_lshl_add_u32 v16, v23, 4, v16
  s_add_u32 m0, s48, 0
  s_add_u32 s92, s52, 0x0
  buffer_load_dwordx4 v16, s[8:11], s92 offen offset:0 lds
  s_add_u32 s92, s52, 0x1fc00
  buffer_load_dwordx4 v16, s[8:11], s92 offen offset:1024 lds
  s_add_u32 s92, s52, 0x3f800
  buffer_load_dwordx4 v16, s[8:11], s92 offen offset:2048 lds
  s_add_u32 s92, s52, 0x5f400
  buffer_load_dwordx4 v16, s[8:11], s92 offen offset:3072 lds
  s_add_u32 m0, s48, 4096
  s_add_u32 s92, s52, 0x80000
  buffer_load_dwordx4 v16, s[8:11], s92 offen offset:0 lds
  s_add_u32 s92, s52, 0x9fc00
  buffer_load_dwordx4 v16, s[8:11], s92 offen offset:1024 lds
  s_add_u32 s92, s52, 0xbf800
  buffer_load_dwordx4 v16, s[8:11], s92 offen offset:2048 lds
  s_add_u32 s92, s52, 0xdf400
  buffer_load_dwordx4 v16, s[8:11], s92 offen offset:3072 lds
  s_add_u32 m0, s48, 8192
  s_add_u32 s92, s52, 0x100000
  buffer_load_dwordx4 v16, s[8:11], s92 offen offset:0 lds
  s_add_u32 s92, s52, 0x11fc00
  buffer_load_dwordx4 v16, s[8:11], s92 offen offset:1024 lds
  s_add_u32 s92, s52, 0x13f800
  buffer_load_dwordx4 v16, s[8:11], s92 offen offset:2048 lds
  s_add_u32 s92, s52, 0x15f400
  buffer_load_dwordx4 v16, s[8:11], s92 offen offset:3072 lds
  s_add_u32 m0, s48, 12288
  s_add_u32 s92, s52, 0x180000
  buffer_load_dwordx4 v16, s[8:11], s92 offen offset:0 lds
  s_add_u32 s92, s52, 0x19fc00
  buffer_load_dwordx4 v16, s[8:11], s92 offen offset:1024 lds
  s_add_u32 s92, s52, 0x1bf800
  buffer_load_dwordx4 v16, s[8:11], s92 offen offset:2048 lds
  s_add_u32 s92, s52, 0x1df400
  buffer_load_dwordx4 v16, s[8:11], s92 offen offset:3072 lds
  s_add_u32 m0, s48, 16384
  s_add_u32 s92, s52, 0x300000
  buffer_load_dwordx4 v16, s[8:11], s92 offen offset:0 lds
  s_add_u32 s92, s52, 0x31fc00
  buffer_load_dwordx4 v16, s[8:11], s92 offen offset:1024 lds
  s_add_u32 s92, s52, 0x33f800
  buffer_load_dwordx4 v16, s[8:11], s92 offen offset:2048 lds
  s_add_u32 s92, s52, 0x35f400
  buffer_load_dwordx4 v16, s[8:11], s92 offen offset:3072 lds
  s_add_u32 m0, s48, 20480
  s_add_u32 s92, s52, 0x380000
  buffer_load_dwordx4 v16, s[8:11], s92 offen offset:0 lds
  s_add_u32 s92, s52, 0x39fc00
  buffer_load_dwordx4 v16, s[8:11], s92 offen offset:1024 lds
  s_add_u32 s92, s52, 0x3bf800
  buffer_load_dwordx4 v16, s[8:11], s92 offen offset:2048 lds
  s_add_u32 s92, s52, 0x3df400
  buffer_load_dwordx4 v16, s[8:11], s92 offen offset:3072 lds
  s_mov_b32 s8, s22
  s_and_b32 s9, s23, 0xffff
  s_mov_b32 s10, 0x400000
  s_mov_b32 s11, 0x20000
  s_add_u32 m0, s48, 24576
  s_add_u32 s92, s52, 0x0
  buffer_load_dwordx4 v16, s[8:11], s92 offen offset:0 lds
  s_add_u32 s92, s52, 0x1fc00
  buffer_load_dwordx4 v16, s[8:11], s92 offen offset:1024 lds
  s_add_u32 s92, s52, 0x3f800
  buffer_load_dwordx4 v16, s[8:11], s92 offen offset:2048 lds
  s_add_u32 s92, s52, 0x5f400
  buffer_load_dwordx4 v16, s[8:11], s92 offen offset:3072 lds
  s_add_u32 m0, s48, 28672
  s_add_u32 s92, s52, 0x80000
  buffer_load_dwordx4 v16, s[8:11], s92 offen offset:0 lds
  s_add_u32 s92, s52, 0x9fc00
  buffer_load_dwordx4 v16, s[8:11], s92 offen offset:1024 lds
  s_add_u32 s92, s52, 0xbf800
  buffer_load_dwordx4 v16, s[8:11], s92 offen offset:2048 lds
  s_add_u32 s92, s52, 0xdf400
  buffer_load_dwordx4 v16, s[8:11], s92 offen offset:3072 lds
  s_waitcnt vmcnt(28)
  ds_read_b64_tr_b16 a[64:65], v17 offset:0
  ds_read_b64_tr_b16 a[66:67], v17 offset:128
  ds_read_b64_tr_b16 a[72:73], v17 offset:32
  ds_read_b64_tr_b16 a[74:75], v17 offset:160
  ds_read_b64_tr_b16 a[68:69], v17 offset:2048
  ds_read_b64_tr_b16 a[70:71], v17 offset:2176
  ds_read_b64_tr_b16 a[76:77], v17 offset:2080
  ds_read_b64_tr_b16 a[78:79], v17 offset:2208
  s_waitcnt lgkmcnt(0)
  s_add_u32 m0, s48, 0
  s_add_u32 s92, s52, 0x100000
  buffer_load_dwordx4 v16, s[8:11], s92 offen offset:0 lds
  s_add_u32 s92, s52, 0x11fc00
  buffer_load_dwordx4 v16, s[8:11], s92 offen offset:1024 lds
  s_add_u32 s92, s52, 0x13f800
  buffer_load_dwordx4 v16, s[8:11], s92 offen offset:2048 lds
  s_add_u32 s92, s52, 0x15f400
  buffer_load_dwordx4 v16, s[8:11], s92 offen offset:3072 lds
  s_waitcnt vmcnt(28)
  ds_read_b64_tr_b16 a[80:81], v17 offset:4096
  ds_read_b64_tr_b16 a[82:83], v17 offset:4224
  ds_read_b64_tr_b16 a[88:89], v17 offset:4128
  ds_read_b64_tr_b16 a[90:91], v17 offset:4256
  ds_read_b64_tr_b16 a[84:85], v17 offset:6144
  ds_read_b64_tr_b16 a[86:87], v17 offset:6272
  ds_read_b64_tr_b16 a[92:93], v17 offset:6176
  ds_read_b64_tr_b16 a[94:95], v17 offset:6304
  s_waitcnt lgkmcnt(0)
  s_add_u32 m0, s48, 4096
  s_add_u32 s92, s52, 0x180000
  buffer_load_dwordx4 v16, s[8:11], s92 offen offset:0 lds
  s_add_u32 s92, s52, 0x19fc00
  buffer_load_dwordx4 v16, s[8:11], s92 offen offset:1024 lds
  s_add_u32 s92, s52, 0x1bf800
  buffer_load_dwordx4 v16, s[8:11], s92 offen offset:2048 lds
  s_add_u32 s92, s52, 0x1df400
  buffer_load_dwordx4 v16, s[8:11], s92 offen offset:3072 lds
  s_waitcnt vmcnt(28)
  ds_read_b64_tr_b16 a[0:1], v17 offset:8192
  ds_read_b64_tr_b16 a[2:3], v17 offset:8320
  ds_read_b64_tr_b16 a[8:9], v17 offset:8224
  ds_read_b64_tr_b16 a[10:11], v17 offset:8352
  ds_read_b64_tr_b16 a[4:5], v17 offset:10240
  ds_read_b64_tr_b16 a[6:7], v17 offset:10368
  ds_read_b64_tr_b16 a[12:13], v17 offset:10272
  ds_read_b64_tr_b16 a[14:15], v17 offset:10400
  s_waitcnt lgkmcnt(0)
  s_add_u32 m0, s48, 8192
  s_add_u32 s92, s52, 0x300000
  buffer_load_dwordx4 v16, s[8:11], s92 offen offset:0 lds
  s_add_u32 s92, s52, 0x31fc00
  buffer_load_dwordx4 v16, s[8:11], s92 offen offset:1024 lds
  s_add_u32 s92, s52, 0x33f800
  buffer_load_dwordx4 v16, s[8:11], s92 offen offset:2048 lds
  s_add_u32 s92, s52, 0x35f400
  buffer_load_dwordx4 v16, s[8:11], s92 offen offset:3072 lds
  s_waitcnt vmcnt(28)
  ds_read_b64_tr_b16 a[16:17], v17 offset:12288
  ds_read_b64_tr_b16 a[18:19], v17 offset:12416
  ds_read_b64_tr_b16 a[24:25], v17 offset:12320
  ds_read_b64_tr_b16 a[26:27], v17 offset:12448
  ds_read_b64_tr_b16 a[20:21], v17 offset:14336
  ds_read_b64_tr_b16 a[22:23], v17 offset:14464
  ds_read_b64_tr_b16 a[28:29], v17 offset:14368
  ds_read_b64_tr_b16 a[30:31], v17 offset:14496
  s_waitcnt lgkmcnt(0)
  s_add_u32 m0, s48, 12288
  s_add_u32 s92, s52, 0x380000
  buffer_load_dwordx4 v16, s[8:11], s92 offen offset:0 lds
  s_add_u32 s92, s52, 0x39fc00
  buffer_load_dwordx4 v16, s[8:11], s92 offen offset:1024 lds
  s_add_u32 s92, s52, 0x3bf800
  buffer_load_dwordx4 v16, s[8:11], s92 offen offset:2048 lds
  s_add_u32 s92, s52, 0x3df400
  buffer_load_dwordx4 v16, s[8:11], s92 offen offset:3072 lds
  s_waitcnt vmcnt(28)
  ds_read_b64_tr_b16 a[32:33], v17 offset:16384
  ds_read_b64_tr_b16 a[34:35], v17 offset:16512
  ds_read_b64_tr_b16 a[40:41], v17 offset:16416
  ds_read_b64_tr_b16 a[42:43], v17 offset:16544
  ds_read_b64_tr_b16 a[36:37], v17 offset:18432
  ds_read_b64_tr_b16 a[38:39], v17 offset:18560
  ds_read_b64_tr_b16 a[44:45], v17 offset:18464
  ds_read_b64_tr_b16 a[46:47], v17 offset:18592
  s_waitcnt lgkmcnt(0)
  s_mov_b32 s8, s24
  s_and_b32 s9, s25, 0xffff
  s_mov_b32 s10, 0x400000
  s_mov_b32 s11, 0x20000
  s_add_u32 m0, s48, 16384
  s_add_u32 s92, s52, 0x0
  buffer_load_dwordx4 v16, s[8:11], s92 offen offset:0 lds
  s_add_u32 s92, s52, 0x1fc00
  buffer_load_dwordx4 v16, s[8:11], s92 offen offset:1024 lds
  s_add_u32 s92, s52, 0x3f800
  buffer_load_dwordx4 v16, s[8:11], s92 offen offset:2048 lds
  s_add_u32 s92, s52, 0x5f400
  buffer_load_dwordx4 v16, s[8:11], s92 offen offset:3072 lds
  s_waitcnt vmcnt(28)
  ds_read_b64_tr_b16 a[48:49], v17 offset:20480
  ds_read_b64_tr_b16 a[50:51], v17 offset:20608
  ds_read_b64_tr_b16 a[56:57], v17 offset:20512
  ds_read_b64_tr_b16 a[58:59], v17 offset:20640
  ds_read_b64_tr_b16 a[52:53], v17 offset:22528
  ds_read_b64_tr_b16 a[54:55], v17 offset:22656
  ds_read_b64_tr_b16 a[60:61], v17 offset:22560
  ds_read_b64_tr_b16 a[62:63], v17 offset:22688
  s_waitcnt lgkmcnt(0)
  s_add_u32 m0, s48, 20480
  s_add_u32 s92, s52, 0x80000
  buffer_load_dwordx4 v16, s[8:11], s92 offen offset:0 lds
  s_add_u32 s92, s52, 0x9fc00
  buffer_load_dwordx4 v16, s[8:11], s92 offen offset:1024 lds
  s_add_u32 s92, s52, 0xbf800
  buffer_load_dwordx4 v16, s[8:11], s92 offen offset:2048 lds
  s_add_u32 s92, s52, 0xdf400
  buffer_load_dwordx4 v16, s[8:11], s92 offen offset:3072 lds
  s_waitcnt vmcnt(28)
  ds_read_b64_tr_b16 a[160:161], v17 offset:24576
  ds_read_b64_tr_b16 a[162:163], v17 offset:24704
  ds_read_b64_tr_b16 a[168:169], v17 offset:24608
  ds_read_b64_tr_b16 a[170:171], v17 offset:24736
  ds_read_b64_tr_b16 a[164:165], v17 offset:26624
  ds_read_b64_tr_b16 a[166:167], v17 offset:26752
  ds_read_b64_tr_b16 a[172:173], v17 offset:26656
  ds_read_b64_tr_b16 a[174:175], v17 offset:26784
  s_waitcnt lgkmcnt(0)
  s_add_u32 m0, s48, 24576
  s_add_u32 s92, s52, 0x100000
  buffer_load_dwordx4 v16, s[8:11], s92 offen offset:0 lds
  s_add_u32 s92, s52, 0x11fc00
  buffer_load_dwordx4 v16, s[8:11], s92 offen offset:1024 lds
  s_add_u32 s92, s52, 0x13f800
  buffer_load_dwordx4 v16, s[8:11], s92 offen offset:2048 lds
  s_add_u32 s92, s52, 0x15f400
  buffer_load_dwordx4 v16, s[8:11], s92 offen offset:3072 lds
  s_waitcnt vmcnt(28)
  ds_read_b64_tr_b16 a[176:177], v17 offset:28672
  ds_read_b64_tr_b16 a[178:179], v17 offset:28800
  ds_read_b64_tr_b16 a[184:185], v17 offset:28704
  ds_read_b64_tr_b16 a[186:187], v17 offset:28832
  ds_read_b64_tr_b16 a[180:181], v17 offset:30720
  ds_read_b64_tr_b16 a[182:183], v17 offset:30848
  ds_read_b64_tr_b16 a[188:189], v17 offset:30752
  ds_read_b64_tr_b16 a[190:191], v17 offset:30880
  s_waitcnt lgkmcnt(0)
  s_add_u32 m0, s48, 28672
  s_add_u32 s92, s52, 0x180000
  buffer_load_dwordx4 v16, s[8:11], s92 offen offset:0 lds
  s_add_u32 s92, s52, 0x19fc00
  buffer_load_dwordx4 v16, s[8:11], s92 offen offset:1024 lds
  s_add_u32 s92, s52, 0x1bf800
  buffer_load_dwordx4 v16, s[8:11], s92 offen offset:2048 lds
  s_add_u32 s92, s52, 0x1df400
  buffer_load_dwordx4 v16, s[8:11], s92 offen offset:3072 lds
  s_waitcnt vmcnt(28)
  ds_read_b64_tr_b16 a[96:97], v17 offset:0
  ds_read_b64_tr_b16 a[98:99], v17 offset:128
  ds_read_b64_tr_b16 a[104:105], v17 offset:32
  ds_read_b64_tr_b16 a[106:107], v17 offset:160
  ds_read_b64_tr_b16 a[100:101], v17 offset:2048
  ds_read_b64_tr_b16 a[102:103], v17 offset:2176
  ds_read_b64_tr_b16 a[108:109], v17 offset:2080
  ds_read_b64_tr_b16 a[110:111], v17 offset:2208
  s_waitcnt lgkmcnt(0)
  s_add_u32 m0, s48, 0
  s_add_u32 s92, s52, 0x300000
  buffer_load_dwordx4 v16, s[8:11], s92 offen offset:0 lds
  s_add_u32 s92, s52, 0x31fc00
  buffer_load_dwordx4 v16, s[8:11], s92 offen offset:1024 lds
  s_add_u32 s92, s52, 0x33f800
  buffer_load_dwordx4 v16, s[8:11], s92 offen offset:2048 lds
  s_add_u32 s92, s52, 0x35f400
  buffer_load_dwordx4 v16, s[8:11], s92 offen offset:3072 lds
  s_waitcnt vmcnt(28)
  ds_read_b64_tr_b16 a[112:113], v17 offset:4096
  ds_read_b64_tr_b16 a[114:115], v17 offset:4224
  ds_read_b64_tr_b16 a[120:121], v17 offset:4128
  ds_read_b64_tr_b16 a[122:123], v17 offset:4256
  ds_read_b64_tr_b16 a[116:117], v17 offset:6144
  ds_read_b64_tr_b16 a[118:119], v17 offset:6272
  ds_read_b64_tr_b16 a[124:125], v17 offset:6176
  ds_read_b64_tr_b16 a[126:127], v17 offset:6304
  s_waitcnt lgkmcnt(0)
  s_add_u32 m0, s48, 4096
  s_add_u32 s92, s52, 0x380000
  buffer_load_dwordx4 v16, s[8:11], s92 offen offset:0 lds
  s_add_u32 s92, s52, 0x39fc00
  buffer_load_dwordx4 v16, s[8:11], s92 offen offset:1024 lds
  s_add_u32 s92, s52, 0x3bf800
  buffer_load_dwordx4 v16, s[8:11], s92 offen offset:2048 lds
  s_add_u32 s92, s52, 0x3df400
  buffer_load_dwordx4 v16, s[8:11], s92 offen offset:3072 lds
  s_waitcnt vmcnt(28)
  ds_read_b64_tr_b16 a[128:129], v17 offset:8192
  ds_read_b64_tr_b16 a[130:131], v17 offset:8320
  ds_read_b64_tr_b16 a[136:137], v17 offset:8224
  ds_read_b64_tr_b16 a[138:139], v17 offset:8352
  ds_read_b64_tr_b16 a[132:133], v17 offset:10240
  ds_read_b64_tr_b16 a[134:135], v17 offset:10368
  ds_read_b64_tr_b16 a[140:141], v17 offset:10272
  ds_read_b64_tr_b16 a[142:143], v17 offset:10400
  s_waitcnt lgkmcnt(0)
  s_mov_b32 s8, s26
  s_and_b32 s9, s27, 0xffff
  s_mov_b32 s10, 0x400000
  s_mov_b32 s11, 0x20000
  s_mov_b32 s92, 1024
  v_lshrrev_b32 v16, 2, v0
  v_mul_lo_u32 v16, v16, s92
  v_lshl_add_u32 v16, v23, 4, v16
  s_add_u32 m0, s48, 8192
  s_add_u32 s92, s53, 0x80
  buffer_load_dwordx4 v16, s[8:11], s92 offen offset:0 lds
  s_add_u32 s92, s53, 0x3c80
  buffer_load_dwordx4 v16, s[8:11], s92 offen offset:1024 lds
  s_add_u32 s92, s53, 0x7880
  buffer_load_dwordx4 v16, s[8:11], s92 offen offset:2048 lds
  s_add_u32 s92, s53, 0xb480
  buffer_load_dwordx4 v16, s[8:11], s92 offen offset:3072 lds
  s_waitcnt vmcnt(28)
  ds_read_b64_tr_b16 a[144:145], v17 offset:12288
  ds_read_b64_tr_b16 a[146:147], v17 offset:12416
  ds_read_b64_tr_b16 a[152:153], v17 offset:12320
  ds_read_b64_tr_b16 a[154:155], v17 offset:12448
  ds_read_b64_tr_b16 a[148:149], v17 offset:14336
  ds_read_b64_tr_b16 a[150:151], v17 offset:14464
  ds_read_b64_tr_b16 a[156:157], v17 offset:14368
  ds_read_b64_tr_b16 a[158:159], v17 offset:14496
  s_waitcnt lgkmcnt(0)
  s_add_u32 m0, s48, 12288
  s_add_u32 s92, s53, 0xc0
  buffer_load_dwordx4 v16, s[8:11], s92 offen offset:0 lds
  s_add_u32 s92, s53, 0x3cc0
  buffer_load_dwordx4 v16, s[8:11], s92 offen offset:1024 lds
  s_add_u32 s92, s53, 0x78c0
  buffer_load_dwordx4 v16, s[8:11], s92 offen offset:2048 lds
  s_add_u32 s92, s53, 0xb4c0
  buffer_load_dwordx4 v16, s[8:11], s92 offen offset:3072 lds
  s_waitcnt vmcnt(28)
  ds_read_b64_tr_b16 v[128:129], v17 offset:16384
  ds_read_b64_tr_b16 v[130:131], v17 offset:16512
  ds_read_b64_tr_b16 v[136:137], v17 offset:16416
  ds_read_b64_tr_b16 v[138:139], v17 offset:16544
  ds_read_b64_tr_b16 v[132:133], v17 offset:18432
  ds_read_b64_tr_b16 v[134:135], v17 offset:18560
  ds_read_b64_tr_b16 v[140:141], v17 offset:18464
  ds_read_b64_tr_b16 v[142:143], v17 offset:18592
  s_waitcnt lgkmcnt(0)
  s_add_u32 m0, s48, 16384
  s_add_u32 s92, s53, 0x10080
  buffer_load_dwordx4 v16, s[8:11], s92 offen offset:0 lds
  s_add_u32 s92, s53, 0x13c80
  buffer_load_dwordx4 v16, s[8:11], s92 offen offset:1024 lds
  s_add_u32 s92, s53, 0x17880
  buffer_load_dwordx4 v16, s[8:11], s92 offen offset:2048 lds
  s_add_u32 s92, s53, 0x1b480
  buffer_load_dwordx4 v16, s[8:11], s92 offen offset:3072 lds
  s_waitcnt vmcnt(28)
  ds_read_b64_tr_b16 v[144:145], v17 offset:20480
  ds_read_b64_tr_b16 v[146:147], v17 offset:20608
  ds_read_b64_tr_b16 v[152:153], v17 offset:20512
  ds_read_b64_tr_b16 v[154:155], v17 offset:20640
  ds_read_b64_tr_b16 v[148:149], v17 offset:22528
  ds_read_b64_tr_b16 v[150:151], v17 offset:22656
  ds_read_b64_tr_b16 v[156:157], v17 offset:22560
  ds_read_b64_tr_b16 v[158:159], v17 offset:22688
  s_waitcnt lgkmcnt(0)
  s_add_u32 m0, s48, 20480
  s_add_u32 s92, s53, 0x100c0
  buffer_load_dwordx4 v16, s[8:11], s92 offen offset:0 lds
  s_add_u32 s92, s53, 0x13cc0
  buffer_load_dwordx4 v16, s[8:11], s92 offen offset:1024 lds
  s_add_u32 s92, s53, 0x178c0
  buffer_load_dwordx4 v16, s[8:11], s92 offen offset:2048 lds
  s_add_u32 s92, s53, 0x1b4c0
  buffer_load_dwordx4 v16, s[8:11], s92 offen offset:3072 lds
  s_waitcnt vmcnt(28)
  ds_read_b64_tr_b16 a[192:193], v17 offset:24576
  ds_read_b64_tr_b16 a[194:195], v17 offset:24704
  ds_read_b64_tr_b16 a[200:201], v17 offset:24608
  ds_read_b64_tr_b16 a[202:203], v17 offset:24736
  ds_read_b64_tr_b16 a[196:197], v17 offset:26624
  ds_read_b64_tr_b16 a[198:199], v17 offset:26752
  ds_read_b64_tr_b16 a[204:205], v17 offset:26656
  ds_read_b64_tr_b16 a[206:207], v17 offset:26784
  s_waitcnt lgkmcnt(0)
  s_add_u32 m0, s48, 24576
  s_add_u32 s92, s53, 0x40
  buffer_load_dwordx4 v16, s[8:11], s92 offen offset:0 lds
  s_add_u32 s92, s53, 0x3c40
  buffer_load_dwordx4 v16, s[8:11], s92 offen offset:1024 lds
  s_add_u32 s92, s53, 0x7840
  buffer_load_dwordx4 v16, s[8:11], s92 offen offset:2048 lds
  s_add_u32 s92, s53, 0xb440
  buffer_load_dwordx4 v16, s[8:11], s92 offen offset:3072 lds
  s_waitcnt vmcnt(28)
  ds_read_b64_tr_b16 a[208:209], v17 offset:28672
  ds_read_b64_tr_b16 a[210:211], v17 offset:28800
  ds_read_b64_tr_b16 a[216:217], v17 offset:28704
  ds_read_b64_tr_b16 a[218:219], v17 offset:28832
  ds_read_b64_tr_b16 a[212:213], v17 offset:30720
  ds_read_b64_tr_b16 a[214:215], v17 offset:30848
  ds_read_b64_tr_b16 a[220:221], v17 offset:30752
  ds_read_b64_tr_b16 a[222:223], v17 offset:30880
  s_waitcnt lgkmcnt(0)
  s_add_u32 m0, s48, 28672
  s_add_u32 s92, s53, 0x10040
  buffer_load_dwordx4 v16, s[8:11], s92 offen offset:0 lds
  s_add_u32 s92, s53, 0x13c40
  buffer_load_dwordx4 v16, s[8:11], s92 offen offset:1024 lds
  s_add_u32 s92, s53, 0x17840
  buffer_load_dwordx4 v16, s[8:11], s92 offen offset:2048 lds
  s_add_u32 s92, s53, 0x1b440
  buffer_load_dwordx4 v16, s[8:11], s92 offen offset:3072 lds
  s_waitcnt vmcnt(28)
  ds_read_b64_tr_b16 a[224:225], v17 offset:0
  ds_read_b64_tr_b16 a[226:227], v17 offset:128
  ds_read_b64_tr_b16 a[232:233], v17 offset:32
  ds_read_b64_tr_b16 a[234:235], v17 offset:160
  ds_read_b64_tr_b16 a[228:229], v17 offset:2048
  ds_read_b64_tr_b16 a[230:231], v17 offset:2176
  ds_read_b64_tr_b16 a[236:237], v17 offset:2080
  ds_read_b64_tr_b16 a[238:239], v17 offset:2208
  s_waitcnt lgkmcnt(0)
  s_mov_b32 s8, s20
  s_and_b32 s9, s21, 0xffff
  s_mov_b32 s10, 0x400000
  s_mov_b32 s11, 0x20000
  s_mov_b32 s92, 8192
  v_lshrrev_b32 v16, 2, v0
  v_mul_lo_u32 v16, v16, s92
  v_lshl_add_u32 v16, v23, 4, v16
  s_add_u32 m0, s48, 0
  s_add_u32 s92, s52, 0x200000
  buffer_load_dwordx4 v16, s[8:11], s92 offen offset:0 lds
  s_add_u32 s92, s52, 0x21fc00
  buffer_load_dwordx4 v16, s[8:11], s92 offen offset:1024 lds
  s_add_u32 s92, s52, 0x23f800
  buffer_load_dwordx4 v16, s[8:11], s92 offen offset:2048 lds
  s_add_u32 s92, s52, 0x25f400
  buffer_load_dwordx4 v16, s[8:11], s92 offen offset:3072 lds
  s_waitcnt vmcnt(28)
  ds_read_b64_tr_b16 a[240:241], v17 offset:4096
  ds_read_b64_tr_b16 a[242:243], v17 offset:4224
  ds_read_b64_tr_b16 a[248:249], v17 offset:4128
  ds_read_b64_tr_b16 a[250:251], v17 offset:4256
  ds_read_b64_tr_b16 a[244:245], v17 offset:6144
  ds_read_b64_tr_b16 a[246:247], v17 offset:6272
  ds_read_b64_tr_b16 a[252:253], v17 offset:6176
  ds_read_b64_tr_b16 a[254:255], v17 offset:6304
  s_waitcnt lgkmcnt(0)
  s_add_u32 m0, s48, 4096
  s_add_u32 s92, s52, 0x280000
  buffer_load_dwordx4 v16, s[8:11], s92 offen offset:0 lds
  s_add_u32 s92, s52, 0x29fc00
  buffer_load_dwordx4 v16, s[8:11], s92 offen offset:1024 lds
  s_add_u32 s92, s52, 0x2bf800
  buffer_load_dwordx4 v16, s[8:11], s92 offen offset:2048 lds
  s_add_u32 s92, s52, 0x2df400
  buffer_load_dwordx4 v16, s[8:11], s92 offen offset:3072 lds
  s_waitcnt vmcnt(28)
  ds_read_b64_tr_b16 v[192:193], v18 offset:8192
  ds_read_b64_tr_b16 v[194:195], v18 offset:8320
  ds_read_b64_tr_b16 v[200:201], v18 offset:8200
  ds_read_b64_tr_b16 v[202:203], v18 offset:8328
  ds_read_b64_tr_b16 v[196:197], v18 offset:8704
  ds_read_b64_tr_b16 v[198:199], v18 offset:8832
  ds_read_b64_tr_b16 v[204:205], v18 offset:8712
  ds_read_b64_tr_b16 v[206:207], v18 offset:8840
  s_waitcnt lgkmcnt(0)
  s_mov_b32 s8, s22
  s_and_b32 s9, s23, 0xffff
  s_mov_b32 s10, 0x400000
  s_mov_b32 s11, 0x20000
  s_add_u32 m0, s48, 8192
  s_add_u32 s92, s52, 0x200000
  buffer_load_dwordx4 v16, s[8:11], s92 offen offset:0 lds
  s_add_u32 s92, s52, 0x21fc00
  buffer_load_dwordx4 v16, s[8:11], s92 offen offset:1024 lds
  s_add_u32 s92, s52, 0x23f800
  buffer_load_dwordx4 v16, s[8:11], s92 offen offset:2048 lds
  s_add_u32 s92, s52, 0x25f400
  buffer_load_dwordx4 v16, s[8:11], s92 offen offset:3072 lds
  buffer_load_dword v42, v43, s[12:15], 0 offen sc1
  buffer_load_dwordx2 v[44:45], v46, s[76:79], s80 offen
  s_waitcnt vmcnt(30)
  ds_read_b64_tr_b16 v[224:225], v18 offset:12288
  ds_read_b64_tr_b16 v[226:227], v18 offset:12416
  ds_read_b64_tr_b16 v[232:233], v18 offset:12296
  ds_read_b64_tr_b16 v[234:235], v18 offset:12424
  ds_read_b64_tr_b16 v[228:229], v18 offset:12800
  ds_read_b64_tr_b16 v[230:231], v18 offset:12928
  ds_read_b64_tr_b16 v[236:237], v18 offset:12808
  ds_read_b64_tr_b16 v[238:239], v18 offset:12936
  s_waitcnt lgkmcnt(0)
  s_add_u32 m0, s48, 12288
  s_add_u32 s92, s52, 0x280000
  buffer_load_dwordx4 v16, s[8:11], s92 offen offset:0 lds
  s_add_u32 s92, s52, 0x29fc00
  buffer_load_dwordx4 v16, s[8:11], s92 offen offset:1024 lds
  s_add_u32 s92, s52, 0x2bf800
  buffer_load_dwordx4 v16, s[8:11], s92 offen offset:2048 lds
  s_add_u32 s92, s52, 0x2df400
  buffer_load_dwordx4 v16, s[8:11], s92 offen offset:3072 lds
  s_waitcnt vmcnt(30)
  ds_read_b64_tr_b16 v[208:209], v18 offset:16384
  ds_read_b64_tr_b16 v[210:211], v18 offset:16512
  ds_read_b64_tr_b16 v[216:217], v18 offset:16392
  ds_read_b64_tr_b16 v[218:219], v18 offset:16520
  ds_read_b64_tr_b16 v[212:213], v18 offset:16896
  ds_read_b64_tr_b16 v[214:215], v18 offset:17024
  ds_read_b64_tr_b16 v[220:221], v18 offset:16904
  ds_read_b64_tr_b16 v[222:223], v18 offset:17032
  s_waitcnt lgkmcnt(0)
  s_mov_b32 s8, s24
  s_and_b32 s9, s25, 0xffff
  s_mov_b32 s10, 0x400000
  s_mov_b32 s11, 0x20000
  s_add_u32 m0, s48, 16384
  s_add_u32 s92, s52, 0x200000
  buffer_load_dwordx4 v16, s[8:11], s92 offen offset:0 lds
  s_add_u32 s92, s52, 0x21fc00
  buffer_load_dwordx4 v16, s[8:11], s92 offen offset:1024 lds
  s_add_u32 s92, s52, 0x23f800
  buffer_load_dwordx4 v16, s[8:11], s92 offen offset:2048 lds
  s_add_u32 s92, s52, 0x25f400
  buffer_load_dwordx4 v16, s[8:11], s92 offen offset:3072 lds
  s_waitcnt vmcnt(30)
  ds_read_b64_tr_b16 v[240:241], v18 offset:20480
  ds_read_b64_tr_b16 v[242:243], v18 offset:20608
  ds_read_b64_tr_b16 v[248:249], v18 offset:20488
  ds_read_b64_tr_b16 v[250:251], v18 offset:20616
  ds_read_b64_tr_b16 v[244:245], v18 offset:20992
  ds_read_b64_tr_b16 v[246:247], v18 offset:21120
  ds_read_b64_tr_b16 v[252:253], v18 offset:21000
  ds_read_b64_tr_b16 v[254:255], v18 offset:21128
  s_waitcnt lgkmcnt(0)
  s_add_u32 m0, s48, 20480
  s_add_u32 s92, s52, 0x280000
  buffer_load_dwordx4 v16, s[8:11], s92 offen offset:0 lds
  s_add_u32 s92, s52, 0x29fc00
  buffer_load_dwordx4 v16, s[8:11], s92 offen offset:1024 lds
  s_add_u32 s92, s52, 0x2bf800
  buffer_load_dwordx4 v16, s[8:11], s92 offen offset:2048 lds
  s_add_u32 s92, s52, 0x2df400
  buffer_load_dwordx4 v16, s[8:11], s92 offen offset:3072 lds
  s_waitcnt vmcnt(30)
  ds_read_b64_tr_b16 v[160:161], v18 offset:24576
  ds_read_b64_tr_b16 v[162:163], v18 offset:24704
  ds_read_b64_tr_b16 v[168:169], v18 offset:24584
  ds_read_b64_tr_b16 v[170:171], v18 offset:24712
  ds_read_b64_tr_b16 v[164:165], v18 offset:25088
  ds_read_b64_tr_b16 v[166:167], v18 offset:25216
  ds_read_b64_tr_b16 v[172:173], v18 offset:25096
  ds_read_b64_tr_b16 v[174:175], v18 offset:25224
  s_waitcnt lgkmcnt(0)
  s_mov_b32 s8, s26
  s_and_b32 s9, s27, 0xffff
  s_mov_b32 s10, 0x400000
  s_mov_b32 s11, 0x20000
  s_mov_b32 s92, 1024
  v_lshrrev_b32 v16, 2, v0
  v_mul_lo_u32 v16, v16, s92
  v_lshl_add_u32 v16, v23, 4, v16
  s_add_u32 m0, s48, 24576
  s_add_u32 s92, s53, 0x0
  buffer_load_dwordx4 v16, s[8:11], s92 offen offset:0 lds
  s_add_u32 s92, s53, 0x3c00
  buffer_load_dwordx4 v16, s[8:11], s92 offen offset:1024 lds
  s_add_u32 s92, s53, 0x7800
  buffer_load_dwordx4 v16, s[8:11], s92 offen offset:2048 lds
  s_add_u32 s92, s53, 0xb400
  buffer_load_dwordx4 v16, s[8:11], s92 offen offset:3072 lds
  s_waitcnt vmcnt(30)
  ds_read_b64_tr_b16 v[176:177], v18 offset:28672
  ds_read_b64_tr_b16 v[178:179], v18 offset:28800
  ds_read_b64_tr_b16 v[184:185], v18 offset:28680
  ds_read_b64_tr_b16 v[186:187], v18 offset:28808
  ds_read_b64_tr_b16 v[180:181], v18 offset:29184
  ds_read_b64_tr_b16 v[182:183], v18 offset:29312
  ds_read_b64_tr_b16 v[188:189], v18 offset:29192
  ds_read_b64_tr_b16 v[190:191], v18 offset:29320
  s_waitcnt lgkmcnt(0)
  s_add_u32 m0, s48, 28672
  s_add_u32 s92, s53, 0x10000
  buffer_load_dwordx4 v16, s[8:11], s92 offen offset:0 lds
  s_add_u32 s92, s53, 0x13c00
  buffer_load_dwordx4 v16, s[8:11], s92 offen offset:1024 lds
  s_add_u32 s92, s53, 0x17800
  buffer_load_dwordx4 v16, s[8:11], s92 offen offset:2048 lds
  s_add_u32 s92, s53, 0x1b400
  buffer_load_dwordx4 v16, s[8:11], s92 offen offset:3072 lds
  s_waitcnt vmcnt(30)
  ds_read_b64_tr_b16 v[24:25], v17 offset:0
  ds_read_b64_tr_b16 v[26:27], v17 offset:128
  ds_read_b64_tr_b16 v[32:33], v17 offset:32
  ds_read_b64_tr_b16 v[34:35], v17 offset:160
  ds_read_b64_tr_b16 v[28:29], v17 offset:2048
  ds_read_b64_tr_b16 v[30:31], v17 offset:2176
  ds_read_b64_tr_b16 v[36:37], v17 offset:2080
  ds_read_b64_tr_b16 v[38:39], v17 offset:2208
  s_waitcnt lgkmcnt(0)
  ds_write_b128 v21, v[24:27] offset:0
  ds_write_b128 v21, v[28:31] offset:1024
  ds_write_b128 v21, v[32:35] offset:2048
  ds_write_b128 v21, v[36:39] offset:3072
  s_waitcnt vmcnt(26)
  ds_read_b64_tr_b16 v[24:25], v17 offset:4096
  ds_read_b64_tr_b16 v[26:27], v17 offset:4224
  ds_read_b64_tr_b16 v[32:33], v17 offset:4128
  ds_read_b64_tr_b16 v[34:35], v17 offset:4256
  ds_read_b64_tr_b16 v[28:29], v17 offset:6144
  ds_read_b64_tr_b16 v[30:31], v17 offset:6272
  ds_read_b64_tr_b16 v[36:37], v17 offset:6176
  ds_read_b64_tr_b16 v[38:39], v17 offset:6304
  s_waitcnt lgkmcnt(0)
  ds_write_b128 v21, v[24:27] offset:4096
  ds_write_b128 v21, v[28:31] offset:5120
  ds_write_b128 v21, v[32:35] offset:6144
  ds_write_b128 v21, v[36:39] offset:7168
  s_waitcnt vmcnt(22)
  ds_read_b64_tr_b16 v[24:25], v17 offset:8192
  ds_read_b64_tr_b16 v[26:27], v17 offset:8320
  ds_read_b64_tr_b16 v[32:33], v17 offset:8224
  ds_read_b64_tr_b16 v[34:35], v17 offset:8352
  ds_read_b64_tr_b16 v[28:29], v17 offset:10240
  ds_read_b64_tr_b16 v[30:31], v17 offset:10368
  ds_read_b64_tr_b16 v[36:37], v17 offset:10272
  ds_read_b64_tr_b16 v[38:39], v17 offset:10400
  s_waitcnt lgkmcnt(0)
  ds_write_b128 v21, v[24:27] offset:8192
  ds_write_b128 v21, v[28:31] offset:9216
  ds_write_b128 v21, v[32:35] offset:10240
  ds_write_b128 v21, v[36:39] offset:11264
  s_waitcnt vmcnt(16)
  ds_read_b64_tr_b16 v[24:25], v17 offset:12288
  ds_read_b64_tr_b16 v[26:27], v17 offset:12416
  ds_read_b64_tr_b16 v[32:33], v17 offset:12320
  ds_read_b64_tr_b16 v[34:35], v17 offset:12448
  ds_read_b64_tr_b16 v[28:29], v17 offset:14336
  ds_read_b64_tr_b16 v[30:31], v17 offset:14464
  ds_read_b64_tr_b16 v[36:37], v17 offset:14368
  ds_read_b64_tr_b16 v[38:39], v17 offset:14496
  s_waitcnt lgkmcnt(0)
  ds_write_b128 v21, v[24:27] offset:12288
  ds_write_b128 v21, v[28:31] offset:13312
  ds_write_b128 v21, v[32:35] offset:14336
  ds_write_b128 v21, v[36:39] offset:15360
  s_waitcnt vmcnt(12)
  ds_read_b64_tr_b16 v[24:25], v17 offset:16384
  ds_read_b64_tr_b16 v[26:27], v17 offset:16512
  ds_read_b64_tr_b16 v[32:33], v17 offset:16416
  ds_read_b64_tr_b16 v[34:35], v17 offset:16544
  ds_read_b64_tr_b16 v[28:29], v17 offset:18432
  ds_read_b64_tr_b16 v[30:31], v17 offset:18560
  ds_read_b64_tr_b16 v[36:37], v17 offset:18464
  ds_read_b64_tr_b16 v[38:39], v17 offset:18592
  s_waitcnt lgkmcnt(0)
  ds_write_b128 v21, v[24:27] offset:16384
  ds_write_b128 v21, v[28:31] offset:17408
  ds_write_b128 v21, v[32:35] offset:18432
  ds_write_b128 v21, v[36:39] offset:19456
  s_waitcnt vmcnt(8)
  ds_read_b64_tr_b16 v[24:25], v17 offset:20480
  ds_read_b64_tr_b16 v[26:27], v17 offset:20608
  ds_read_b64_tr_b16 v[32:33], v17 offset:20512
  ds_read_b64_tr_b16 v[34:35], v17 offset:20640
  ds_read_b64_tr_b16 v[28:29], v17 offset:22528
  ds_read_b64_tr_b16 v[30:31], v17 offset:22656
  ds_read_b64_tr_b16 v[36:37], v17 offset:22560
  ds_read_b64_tr_b16 v[38:39], v17 offset:22688
  s_waitcnt lgkmcnt(0)
  ds_write_b128 v21, v[24:27] offset:20480
  ds_write_b128 v21, v[28:31] offset:21504
  ds_write_b128 v21, v[32:35] offset:22528
  ds_write_b128 v21, v[36:39] offset:23552
  s_waitcnt vmcnt(4)
  ds_read_b64_tr_b16 v[24:25], v18 offset:24576
  ds_read_b64_tr_b16 v[26:27], v18 offset:24704
  ds_read_b64_tr_b16 v[32:33], v18 offset:24584
  ds_read_b64_tr_b16 v[34:35], v18 offset:24712
  ds_read_b64_tr_b16 v[28:29], v18 offset:25088
  ds_read_b64_tr_b16 v[30:31], v18 offset:25216
  ds_read_b64_tr_b16 v[36:37], v18 offset:25096
  ds_read_b64_tr_b16 v[38:39], v18 offset:25224
  s_waitcnt lgkmcnt(0)
  ds_write_b128 v21, v[24:27] offset:24576
  ds_write_b128 v21, v[28:31] offset:25600
  ds_write_b128 v21, v[32:35] offset:26624
  ds_write_b128 v21, v[36:39] offset:27648
  s_waitcnt vmcnt(0)
  ds_read_b64_tr_b16 v[24:25], v18 offset:28672
  ds_read_b64_tr_b16 v[26:27], v18 offset:28800
  ds_read_b64_tr_b16 v[32:33], v18 offset:28680
  ds_read_b64_tr_b16 v[34:35], v18 offset:28808
  ds_read_b64_tr_b16 v[28:29], v18 offset:29184
  ds_read_b64_tr_b16 v[30:31], v18 offset:29312
  ds_read_b64_tr_b16 v[36:37], v18 offset:29192
  ds_read_b64_tr_b16 v[38:39], v18 offset:29320
  s_waitcnt lgkmcnt(0)
  ds_write_b128 v21, v[24:27] offset:28672
  ds_write_b128 v21, v[28:31] offset:29696
  ds_write_b128 v21, v[32:35] offset:30720
  ds_write_b128 v21, v[36:39] offset:31744
  s_waitcnt lgkmcnt(0)
  s_branch cld_9
cl_10:
  s_cmp_lg_u32 s44, 1
  s_cbranch_scc1 cl_395
  s_mov_b32 s72, 151552
  s_mov_b32 s73, 147456
  s_mov_b32 s74, 153600
  s_xor_b32 s75, s51, 1
  s_lshl_b32 s75, s75, 8
  s_add_u32 s75, s75, 0
  v_lshlrev_b32 v40, 13, v0
  v_lshrrev_b32 v21, 4, v0
  v_bfe_u32 v22, v0, 2, 2
  v_and_b32 v23, 3, v0
  v_lshrrev_b32 v24, 1, v21
  v_lshlrev_b32 v17, 4, v24
  v_lshrrev_b32 v24, 1, v22
  v_lshl_add_u32 v17, v24, 3, v17
  v_and_b32 v24, 1, v21
  v_lshl_add_u32 v17, v24, 2, v17
  v_and_b32 v24, 1, v22
  v_add_u32 v17, v17, v24
  v_lshlrev_b32 v17, 6, v17
  v_lshl_add_u32 v17, v23, 3, v17
  v_add_u32 v17, s48, v17
  v_lshrrev_b32 v24, 1, v22
  v_lshlrev_b32 v18, 5, v24
  v_and_b32 v24, 1, v22
  v_add_u32 v18, v18, v24
  v_and_b32 v24, 1, v21
  v_lshl_add_u32 v18, v24, 4, v18
  v_lshrrev_b32 v24, 1, v21
  v_lshl_add_u32 v18, v24, 2, v18
  v_lshlrev_b32 v18, 6, v18
  v_lshl_add_u32 v18, v23, 4, v18
  v_add_u32 v18, s48, v18
  v_add_u32 v21, s48, v1
  s_mov_b32 s8, s20
  s_and_b32 s9, s21, 0xffff
  s_mov_b32 s10, 0x400000
  s_mov_b32 s11, 0x20000
  s_mov_b32 s92, 8192
  v_lshrrev_b32 v16, 2, v0
  v_mul_lo_u32 v16, v16, s92
  v_lshl_add_u32 v16, v23, 4, v16
  s_add_u32 m0, s48, 0
  s_add_u32 s92, s52, 0x0
  buffer_load_dwordx4 v16, s[8:11], s92 offen offset:0 lds
  s_add_u32 s92, s52, 0x1fc00
  buffer_load_dwordx4 v16, s[8:11], s92 offen offset:1024 lds
  s_add_u32 s92, s52, 0x3f800
  buffer_load_dwordx4 v16, s[8:11], s92 offen offset:2048 lds
  s_add_u32 s92, s52, 0x5f400
  buffer_load_dwordx4 v16, s[8:11], s92 offen offset:3072 lds
  s_add_u32 m0, s48, 4096
  s_add_u32 s92, s52, 0x80000
  buffer_load_dwordx4 v16, s[8:11], s92 offen offset:0 lds
  s_add_u32 s92, s52, 0x9fc00
  buffer_load_dwordx4 v16, s[8:11], s92 offen offset:1024 lds
  s_add_u32 s92, s52, 0xbf800
  buffer_load_dwordx4 v16, s[8:11], s92 offen offset:2048 lds
  s_add_u32 s92, s52, 0xdf400
  buffer_load_dwordx4 v16, s[8:11], s92 offen offset:3072 lds
  s_add_u32 m0, s48, 8192
  s_add_u32 s92, s52, 0x100000
  buffer_load_dwordx4 v16, s[8:11], s92 offen offset:0 lds
  s_add_u32 s92, s52, 0x11fc00
  buffer_load_dwordx4 v16, s[8:11], s92 offen offset:1024 lds
  s_add_u32 s92, s52, 0x13f800
  buffer_load_dwordx4 v16, s[8:11], s92 offen offset:2048 lds
  s_add_u32 s92, s52, 0x15f400
  buffer_load_dwordx4 v16, s[8:11], s92 offen offset:3072 lds
  s_add_u32 m0, s48, 12288
  s_add_u32 s92, s52, 0x180000
  buffer_load_dwordx4 v16, s[8:11], s92 offen offset:0 lds
  s_add_u32 s92, s52, 0x19fc00
  buffer_load_dwordx4 v16, s[8:11], s92 offen offset:1024 lds
  s_add_u32 s92, s52, 0x1bf800
  buffer_load_dwordx4 v16, s[8:11], s92 offen offset:2048 lds
  s_add_u32 s92, s52, 0x1df400
  buffer_load_dwordx4 v16, s[8:11], s92 offen offset:3072 lds
  s_add_u32 m0, s48, 16384
  s_add_u32 s92, s52, 0x300000
  buffer_load_dwordx4 v16, s[8:11], s92 offen offset:0 lds
  s_add_u32 s92, s52, 0x31fc00
  buffer_load_dwordx4 v16, s[8:11], s92 offen offset:1024 lds
  s_add_u32 s92, s52, 0x33f800
  buffer_load_dwordx4 v16, s[8:11], s92 offen offset:2048 lds
  s_add_u32 s92, s52, 0x35f400
  buffer_load_dwordx4 v16, s[8:11], s92 offen offset:3072 lds
  s_add_u32 m0, s48, 20480
  s_add_u32 s92, s52, 0x380000
  buffer_load_dwordx4 v16, s[8:11], s92 offen offset:0 lds
  s_add_u32 s92, s52, 0x39fc00
  buffer_load_dwordx4 v16, s[8:11], s92 offen offset:1024 lds
  s_add_u32 s92, s52, 0x3bf800
  buffer_load_dwordx4 v16, s[8:11], s92 offen offset:2048 lds
  s_add_u32 s92, s52, 0x3df400
  buffer_load_dwordx4 v16, s[8:11], s92 offen offset:3072 lds
  s_mov_b32 s8, s22
  s_and_b32 s9, s23, 0xffff
  s_mov_b32 s10, 0x400000
  s_mov_b32 s11, 0x20000
  s_add_u32 m0, s48, 24576
  s_add_u32 s92, s52, 0x0
  buffer_load_dwordx4 v16, s[8:11], s92 offen offset:0 lds
  s_add_u32 s92, s52, 0x1fc00
  buffer_load_dwordx4 v16, s[8:11], s92 offen offset:1024 lds
  s_add_u32 s92, s52, 0x3f800
  buffer_load_dwordx4 v16, s[8:11], s92 offen offset:2048 lds
  s_add_u32 s92, s52, 0x5f400
  buffer_load_dwordx4 v16, s[8:11], s92 offen offset:3072 lds
  s_add_u32 m0, s48, 28672
  s_add_u32 s92, s52, 0x80000
  buffer_load_dwordx4 v16, s[8:11], s92 offen offset:0 lds
  s_add_u32 s92, s52, 0x9fc00
  buffer_load_dwordx4 v16, s[8:11], s92 offen offset:1024 lds
  s_add_u32 s92, s52, 0xbf800
  buffer_load_dwordx4 v16, s[8:11], s92 offen offset:2048 lds
  s_add_u32 s92, s52, 0xdf400
  buffer_load_dwordx4 v16, s[8:11], s92 offen offset:3072 lds
  s_waitcnt vmcnt(28)
  ds_read_b64_tr_b16 a[0:1], v17 offset:0
  ds_read_b64_tr_b16 a[2:3], v17 offset:128
  ds_read_b64_tr_b16 a[8:9], v17 offset:32
  ds_read_b64_tr_b16 a[10:11], v17 offset:160
  ds_read_b64_tr_b16 a[4:5], v17 offset:2048
  ds_read_b64_tr_b16 a[6:7], v17 offset:2176
  ds_read_b64_tr_b16 a[12:13], v17 offset:2080
  ds_read_b64_tr_b16 a[14:15], v17 offset:2208
  s_waitcnt lgkmcnt(0)
  s_add_u32 m0, s48, 0
  s_add_u32 s92, s52, 0x100000
  buffer_load_dwordx4 v16, s[8:11], s92 offen offset:0 lds
  s_add_u32 s92, s52, 0x11fc00
  buffer_load_dwordx4 v16, s[8:11], s92 offen offset:1024 lds
  s_add_u32 s92, s52, 0x13f800
  buffer_load_dwordx4 v16, s[8:11], s92 offen offset:2048 lds
  s_add_u32 s92, s52, 0x15f400
  buffer_load_dwordx4 v16, s[8:11], s92 offen offset:3072 lds
  s_waitcnt vmcnt(28)
  ds_read_b64_tr_b16 a[16:17], v17 offset:4096
  ds_read_b64_tr_b16 a[18:19], v17 offset:4224
  ds_read_b64_tr_b16 a[24:25], v17 offset:4128
  ds_read_b64_tr_b16 a[26:27], v17 offset:4256
  ds_read_b64_tr_b16 a[20:21], v17 offset:6144
  ds_read_b64_tr_b16 a[22:23], v17 offset:6272
  ds_read_b64_tr_b16 a[28:29], v17 offset:6176
  ds_read_b64_tr_b16 a[30:31], v17 offset:6304
  s_waitcnt lgkmcnt(0)
  s_add_u32 m0, s48, 4096
  s_add_u32 s92, s52, 0x180000
  buffer_load_dwordx4 v16, s[8:11], s92 offen offset:0 lds
  s_add_u32 s92, s52, 0x19fc00
  buffer_load_dwordx4 v16, s[8:11], s92 offen offset:1024 lds
  s_add_u32 s92, s52, 0x1bf800
  buffer_load_dwordx4 v16, s[8:11], s92 offen offset:2048 lds
  s_add_u32 s92, s52, 0x1df400
  buffer_load_dwordx4 v16, s[8:11], s92 offen offset:3072 lds
  s_waitcnt vmcnt(28)
  ds_read_b64_tr_b16 a[64:65], v17 offset:8192
  ds_read_b64_tr_b16 a[66:67], v17 offset:8320
  ds_read_b64_tr_b16 a[72:73], v17 offset:8224
  ds_read_b64_tr_b16 a[74:75], v17 offset:8352
  ds_read_b64_tr_b16 a[68:69], v17 offset:10240
  ds_read_b64_tr_b16 a[70:71], v17 offset:10368
  ds_read_b64_tr_b16 a[76:77], v17 offset:10272
  ds_read_b64_tr_b16 a[78:79], v17 offset:10400
  s_waitcnt lgkmcnt(0)
  s_add_u32 m0, s48, 8192
  s_add_u32 s92, s52, 0x300000
  buffer_load_dwordx4 v16, s[8:11], s92 offen offset:0 lds
  s_add_u32 s92, s52, 0x31fc00
  buffer_load_dwordx4 v16, s[8:11], s92 offen offset:1024 lds
  s_add_u32 s92, s52, 0x33f800
  buffer_load_dwordx4 v16, s[8:11], s92 offen offset:2048 lds
  s_add_u32 s92, s52, 0x35f400
  buffer_load_dwordx4 v16, s[8:11], s92 offen offset:3072 lds
  s_waitcnt vmcnt(28)
  ds_read_b64_tr_b16 a[80:81], v17 offset:12288
  ds_read_b64_tr_b16 a[82:83], v17 offset:12416
  ds_read_b64_tr_b16 a[88:89], v17 offset:12320
  ds_read_b64_tr_b16 a[90:91], v17 offset:12448
  ds_read_b64_tr_b16 a[84:85], v17 offset:14336
  ds_read_b64_tr_b16 a[86:87], v17 offset:14464
  ds_read_b64_tr_b16 a[92:93], v17 offset:14368
  ds_read_b64_tr_b16 a[94:95], v17 offset:14496
  s_waitcnt lgkmcnt(0)
  s_add_u32 m0, s48, 12288
  s_add_u32 s92, s52, 0x380000
  buffer_load_dwordx4 v16, s[8:11], s92 offen offset:0 lds
  s_add_u32 s92, s52, 0x39fc00
  buffer_load_dwordx4 v16, s[8:11], s92 offen offset:1024 lds
  s_add_u32 s92, s52, 0x3bf800
  buffer_load_dwordx4 v16, s[8:11], s92 offen offset:2048 lds
  s_add_u32 s92, s52, 0x3df400
  buffer_load_dwordx4 v16, s[8:11], s92 offen offset:3072 lds
  s_waitcnt vmcnt(28)
  ds_read_b64_tr_b16 a[32:33], v17 offset:16384
  ds_read_b64_tr_b16 a[34:35], v17 offset:16512
  ds_read_b64_tr_b16 a[40:41], v17 offset:16416
  ds_read_b64_tr_b16 a[42:43], v17 offset:16544
  ds_read_b64_tr_b16 a[36:37], v17 offset:18432
  ds_read_b64_tr_b16 a[38:39], v17 offset:18560
  ds_read_b64_tr_b16 a[44:45], v17 offset:18464
  ds_read_b64_tr_b16 a[46:47], v17 offset:18592
  s_waitcnt lgkmcnt(0)
  s_mov_b32 s8, s24
  s_and_b32 s9, s25, 0xffff
  s_mov_b32 s10, 0x400000
  s_mov_b32 s11, 0x20000
  s_add_u32 m0, s48, 16384
  s_add_u32 s92, s52, 0x0
  buffer_load_dwordx4 v16, s[8:11], s92 offen offset:0 lds
  s_add_u32 s92, s52, 0x1fc00
  buffer_load_dwordx4 v16, s[8:11], s92 offen offset:1024 lds
  s_add_u32 s92, s52, 0x3f800
  buffer_load_dwordx4 v16, s[8:11], s92 offen offset:2048 lds
  s_add_u32 s92, s52, 0x5f400
  buffer_load_dwordx4 v16, s[8:11], s92 offen offset:3072 lds
  s_waitcnt vmcnt(28)
  ds_read_b64_tr_b16 a[48:49], v17 offset:20480
  ds_read_b64_tr_b16 a[50:51], v17 offset:20608
  ds_read_b64_tr_b16 a[56:57], v17 offset:20512
  ds_read_b64_tr_b16 a[58:59], v17 offset:20640
  ds_read_b64_tr_b16 a[52:53], v17 offset:22528
  ds_read_b64_tr_b16 a[54:55], v17 offset:22656
  ds_read_b64_tr_b16 a[60:61], v17 offset:22560
  ds_read_b64_tr_b16 a[62:63], v17 offset:22688
  s_waitcnt lgkmcnt(0)
  s_add_u32 m0, s48, 20480
  s_add_u32 s92, s52, 0x80000
  buffer_load_dwordx4 v16, s[8:11], s92 offen offset:0 lds
  s_add_u32 s92, s52, 0x9fc00
  buffer_load_dwordx4 v16, s[8:11], s92 offen offset:1024 lds
  s_add_u32 s92, s52, 0xbf800
  buffer_load_dwordx4 v16, s[8:11], s92 offen offset:2048 lds
  s_add_u32 s92, s52, 0xdf400
  buffer_load_dwordx4 v16, s[8:11], s92 offen offset:3072 lds
  s_waitcnt vmcnt(28)
  ds_read_b64_tr_b16 a[96:97], v17 offset:24576
  ds_read_b64_tr_b16 a[98:99], v17 offset:24704
  ds_read_b64_tr_b16 a[104:105], v17 offset:24608
  ds_read_b64_tr_b16 a[106:107], v17 offset:24736
  ds_read_b64_tr_b16 a[100:101], v17 offset:26624
  ds_read_b64_tr_b16 a[102:103], v17 offset:26752
  ds_read_b64_tr_b16 a[108:109], v17 offset:26656
  ds_read_b64_tr_b16 a[110:111], v17 offset:26784
  s_waitcnt lgkmcnt(0)
  s_add_u32 m0, s48, 24576
  s_add_u32 s92, s52, 0x100000
  buffer_load_dwordx4 v16, s[8:11], s92 offen offset:0 lds
  s_add_u32 s92, s52, 0x11fc00
  buffer_load_dwordx4 v16, s[8:11], s92 offen offset:1024 lds
  s_add_u32 s92, s52, 0x13f800
  buffer_load_dwordx4 v16, s[8:11], s92 offen offset:2048 lds
  s_add_u32 s92, s52, 0x15f400
  buffer_load_dwordx4 v16, s[8:11], s92 offen offset:3072 lds
  s_waitcnt vmcnt(28)
  ds_read_b64_tr_b16 a[112:113], v17 offset:28672
  ds_read_b64_tr_b16 a[114:115], v17 offset:28800
  ds_read_b64_tr_b16 a[120:121], v17 offset:28704
  ds_read_b64_tr_b16 a[122:123], v17 offset:28832
  ds_read_b64_tr_b16 a[116:117], v17 offset:30720
  ds_read_b64_tr_b16 a[118:119], v17 offset:30848
  ds_read_b64_tr_b16 a[124:125], v17 offset:30752
  ds_read_b64_tr_b16 a[126:127], v17 offset:30880
  s_waitcnt lgkmcnt(0)
  s_add_u32 m0, s48, 28672
  s_add_u32 s92, s52, 0x180000
  buffer_load_dwordx4 v16, s[8:11], s92 offen offset:0 lds
  s_add_u32 s92, s52, 0x19fc00
  buffer_load_dwordx4 v16, s[8:11], s92 offen offset:1024 lds
  s_add_u32 s92, s52, 0x1bf800
  buffer_load_dwordx4 v16, s[8:11], s92 offen offset:2048 lds
  s_add_u32 s92, s52, 0x1df400
  buffer_load_dwordx4 v16, s[8:11], s92 offen offset:3072 lds
  s_waitcnt vmcnt(28)
  ds_read_b64_tr_b16 a[160:161], v17 offset:0
  ds_read_b64_tr_b16 a[162:163], v17 offset:128
  ds_read_b64_tr_b16 a[168:169], v17 offset:32
  ds_read_b64_tr_b16 a[170:171], v17 offset:160
  ds_read_b64_tr_b16 a[164:165], v17 offset:2048
  ds_read_b64_tr_b16 a[166:167], v17 offset:2176
  ds_read_b64_tr_b16 a[172:173], v17 offset:2080
  ds_read_b64_tr_b16 a[174:175], v17 offset:2208
  s_waitcnt lgkmcnt(0)
  s_add_u32 m0, s48, 0
  s_add_u32 s92, s52, 0x300000
  buffer_load_dwordx4 v16, s[8:11], s92 offen offset:0 lds
  s_add_u32 s92, s52, 0x31fc00
  buffer_load_dwordx4 v16, s[8:11], s92 offen offset:1024 lds
  s_add_u32 s92, s52, 0x33f800
  buffer_load_dwordx4 v16, s[8:11], s92 offen offset:2048 lds
  s_add_u32 s92, s52, 0x35f400
  buffer_load_dwordx4 v16, s[8:11], s92 offen offset:3072 lds
  s_waitcnt vmcnt(28)
  ds_read_b64_tr_b16 a[176:177], v17 offset:4096
  ds_read_b64_tr_b16 a[178:179], v17 offset:4224
  ds_read_b64_tr_b16 a[184:185], v17 offset:4128
  ds_read_b64_tr_b16 a[186:187], v17 offset:4256
  ds_read_b64_tr_b16 a[180:181], v17 offset:6144
  ds_read_b64_tr_b16 a[182:183], v17 offset:6272
  ds_read_b64_tr_b16 a[188:189], v17 offset:6176
  ds_read_b64_tr_b16 a[190:191], v17 offset:6304
  s_waitcnt lgkmcnt(0)
  s_add_u32 m0, s48, 4096
  s_add_u32 s92, s52, 0x380000
  buffer_load_dwordx4 v16, s[8:11], s92 offen offset:0 lds
  s_add_u32 s92, s52, 0x39fc00
  buffer_load_dwordx4 v16, s[8:11], s92 offen offset:1024 lds
  s_add_u32 s92, s52, 0x3bf800
  buffer_load_dwordx4 v16, s[8:11], s92 offen offset:2048 lds
  s_add_u32 s92, s52, 0x3df400
  buffer_load_dwordx4 v16, s[8:11], s92 offen offset:3072 lds
  s_waitcnt vmcnt(28)
  ds_read_b64_tr_b16 a[128:129], v17 offset:8192
  ds_read_b64_tr_b16 a[130:131], v17 offset:8320
  ds_read_b64_tr_b16 a[136:137], v17 offset:8224
  ds_read_b64_tr_b16 a[138:139], v17 offset:8352
  ds_read_b64_tr_b16 a[132:133], v17 offset:10240
  ds_read_b64_tr_b16 a[134:135], v17 offset:10368
  ds_read_b64_tr_b16 a[140:141], v17 offset:10272
  ds_read_b64_tr_b16 a[142:143], v17 offset:10400
  s_waitcnt lgkmcnt(0)
  s_mov_b32 s8, s26
  s_and_b32 s9, s27, 0xffff
  s_mov_b32 s10, 0x400000
  s_mov_b32 s11, 0x20000
  s_mov_b32 s92, 1024
  v_lshrrev_b32 v16, 2, v0
  v_mul_lo_u32 v16, v16, s92
  v_lshl_add_u32 v16, v23, 4, v16
  s_add_u32 m0, s48, 8192
  s_add_u32 s92, s53, 0x80
  buffer_load_dwordx4 v16, s[8:11], s92 offen offset:0 lds
  s_add_u32 s92, s53, 0x3c80
  buffer_load_dwordx4 v16, s[8:11], s92 offen offset:1024 lds
  s_add_u32 s92, s53, 0x7880
  buffer_load_dwordx4 v16, s[8:11], s92 offen offset:2048 lds
  s_add_u32 s92, s53, 0xb480
  buffer_load_dwordx4 v16, s[8:11], s92 offen offset:3072 lds
  s_waitcnt vmcnt(28)
  ds_read_b64_tr_b16 a[144:145], v17 offset:12288
  ds_read_b64_tr_b16 a[146:147], v17 offset:12416
  ds_read_b64_tr_b16 a[152:153], v17 offset:12320
  ds_read_b64_tr_b16 a[154:155], v17 offset:12448
  ds_read_b64_tr_b16 a[148:149], v17 offset:14336
  ds_read_b64_tr_b16 a[150:151], v17 offset:14464
  ds_read_b64_tr_b16 a[156:157], v17 offset:14368
  ds_read_b64_tr_b16 a[158:159], v17 offset:14496
  s_waitcnt lgkmcnt(0)
  s_add_u32 m0, s48, 12288
  s_add_u32 s92, s53, 0xc0
  buffer_load_dwordx4 v16, s[8:11], s92 offen offset:0 lds
  s_add_u32 s92, s53, 0x3cc0
  buffer_load_dwordx4 v16, s[8:11], s92 offen offset:1024 lds
  s_add_u32 s92, s53, 0x78c0
  buffer_load_dwordx4 v16, s[8:11], s92 offen offset:2048 lds
  s_add_u32 s92, s53, 0xb4c0
  buffer_load_dwordx4 v16, s[8:11], s92 offen offset:3072 lds
  s_waitcnt vmcnt(28)
  ds_read_b64_tr_b16 a[192:193], v17 offset:16384
  ds_read_b64_tr_b16 a[194:195], v17 offset:16512
  ds_read_b64_tr_b16 a[200:201], v17 offset:16416
  ds_read_b64_tr_b16 a[202:203], v17 offset:16544
  ds_read_b64_tr_b16 a[196:197], v17 offset:18432
  ds_read_b64_tr_b16 a[198:199], v17 offset:18560
  ds_read_b64_tr_b16 a[204:205], v17 offset:18464
  ds_read_b64_tr_b16 a[206:207], v17 offset:18592
  s_waitcnt lgkmcnt(0)
  s_add_u32 m0, s48, 16384
  s_add_u32 s92, s53, 0x10080
  buffer_load_dwordx4 v16, s[8:11], s92 offen offset:0 lds
  s_add_u32 s92, s53, 0x13c80
  buffer_load_dwordx4 v16, s[8:11], s92 offen offset:1024 lds
  s_add_u32 s92, s53, 0x17880
  buffer_load_dwordx4 v16, s[8:11], s92 offen offset:2048 lds
  s_add_u32 s92, s53, 0x1b480
  buffer_load_dwordx4 v16, s[8:11], s92 offen offset:3072 lds
  s_waitcnt vmcnt(28)
  ds_read_b64_tr_b16 a[208:209], v17 offset:20480
  ds_read_b64_tr_b16 a[210:211], v17 offset:20608
  ds_read_b64_tr_b16 a[216:217], v17 offset:20512
  ds_read_b64_tr_b16 a[218:219], v17 offset:20640
  ds_read_b64_tr_b16 a[212:213], v17 offset:22528
  ds_read_b64_tr_b16 a[214:215], v17 offset:22656
  ds_read_b64_tr_b16 a[220:221], v17 offset:22560
  ds_read_b64_tr_b16 a[222:223], v17 offset:22688
  s_waitcnt lgkmcnt(0)
  s_add_u32 m0, s48, 20480
  s_add_u32 s92, s53, 0x100c0
  buffer_load_dwordx4 v16, s[8:11], s92 offen offset:0 lds
  s_add_u32 s92, s53, 0x13cc0
  buffer_load_dwordx4 v16, s[8:11], s92 offen offset:1024 lds
  s_add_u32 s92, s53, 0x178c0
  buffer_load_dwordx4 v16, s[8:11], s92 offen offset:2048 lds
  s_add_u32 s92, s53, 0x1b4c0
  buffer_load_dwordx4 v16, s[8:11], s92 offen offset:3072 lds
  s_waitcnt vmcnt(28)
  ds_read_b64_tr_b16 v[128:129], v17 offset:24576
  ds_read_b64_tr_b16 v[130:131], v17 offset:24704
  ds_read_b64_tr_b16 v[136:137], v17 offset:24608
  ds_read_b64_tr_b16 v[138:139], v17 offset:24736
  ds_read_b64_tr_b16 v[132:133], v17 offset:26624
  ds_read_b64_tr_b16 v[134:135], v17 offset:26752
  ds_read_b64_tr_b16 v[140:141], v17 offset:26656
  ds_read_b64_tr_b16 v[142:143], v17 offset:26784
  s_waitcnt lgkmcnt(0)
  s_add_u32 m0, s48, 24576
  s_add_u32 s92, s53, 0x40
  buffer_load_dwordx4 v16, s[8:11], s92 offen offset:0 lds
  s_add_u32 s92, s53, 0x3c40
  buffer_load_dwordx4 v16, s[8:11], s92 offen offset:1024 lds
  s_add_u32 s92, s53, 0x7840
  buffer_load_dwordx4 v16, s[8:11], s92 offen offset:2048 lds
  s_add_u32 s92, s53, 0xb440
  buffer_load_dwordx4 v16, s[8:11], s92 offen offset:3072 lds
  s_waitcnt vmcnt(28)
  ds_read_b64_tr_b16 v[144:145], v17 offset:28672
  ds_read_b64_tr_b16 v[146:147], v17 offset:28800
  ds_read_b64_tr_b16 v[152:153], v17 offset:28704
  ds_read_b64_tr_b16 v[154:155], v17 offset:28832
  ds_read_b64_tr_b16 v[148:149], v17 offset:30720
  ds_read_b64_tr_b16 v[150:151], v17 offset:30848
  ds_read_b64_tr_b16 v[156:157], v17 offset:30752
  ds_read_b64_tr_b16 v[158:159], v17 offset:30880
  s_waitcnt lgkmcnt(0)
  s_add_u32 m0, s48, 28672
  s_add_u32 s92, s53, 0x10040
  buffer_load_dwordx4 v16, s[8:11], s92 offen offset:0 lds
  s_add_u32 s92, s53, 0x13c40
  buffer_load_dwordx4 v16, s[8:11], s92 offen offset:1024 lds
  s_add_u32 s92, s53, 0x17840
  buffer_load_dwordx4 v16, s[8:11], s92 offen offset:2048 lds
  s_add_u32 s92, s53, 0x1b440
  buffer_load_dwordx4 v16, s[8:11], s92 offen offset:3072 lds
  s_waitcnt vmcnt(28)
  ds_read_b64_tr_b16 a[224:225], v17 offset:0
  ds_read_b64_tr_b16 a[226:227], v17 offset:128
  ds_read_b64_tr_b16 a[232:233], v17 offset:32
  ds_read_b64_tr_b16 a[234:235], v17 offset:160
  ds_read_b64_tr_b16 a[228:229], v17 offset:2048
  ds_read_b64_tr_b16 a[230:231], v17 offset:2176
  ds_read_b64_tr_b16 a[236:237], v17 offset:2080
  ds_read_b64_tr_b16 a[238:239], v17 offset:2208
  s_waitcnt lgkmcnt(0)
  s_mov_b32 s8, s20
  s_and_b32 s9, s21, 0xffff
  s_mov_b32 s10, 0x400000
  s_mov_b32 s11, 0x20000
  s_mov_b32 s92, 8192
  v_lshrrev_b32 v16, 2, v0
  v_mul_lo_u32 v16, v16, s92
  v_lshl_add_u32 v16, v23, 4, v16
  s_add_u32 m0, s48, 0
  s_add_u32 s92, s52, 0x200000
  buffer_load_dwordx4 v16, s[8:11], s92 offen offset:0 lds
  s_add_u32 s92, s52, 0x21fc00
  buffer_load_dwordx4 v16, s[8:11], s92 offen offset:1024 lds
  s_add_u32 s92, s52, 0x23f800
  buffer_load_dwordx4 v16, s[8:11], s92 offen offset:2048 lds
  s_add_u32 s92, s52, 0x25f400
  buffer_load_dwordx4 v16, s[8:11], s92 offen offset:3072 lds
  s_waitcnt vmcnt(28)
  ds_read_b64_tr_b16 a[240:241], v17 offset:4096
  ds_read_b64_tr_b16 a[242:243], v17 offset:4224
  ds_read_b64_tr_b16 a[248:249], v17 offset:4128
  ds_read_b64_tr_b16 a[250:251], v17 offset:4256
  ds_read_b64_tr_b16 a[244:245], v17 offset:6144
  ds_read_b64_tr_b16 a[246:247], v17 offset:6272
  ds_read_b64_tr_b16 a[252:253], v17 offset:6176
  ds_read_b64_tr_b16 a[254:255], v17 offset:6304
  s_waitcnt lgkmcnt(0)
  s_add_u32 m0, s48, 4096
  s_add_u32 s92, s52, 0x280000
  buffer_load_dwordx4 v16, s[8:11], s92 offen offset:0 lds
  s_add_u32 s92, s52, 0x29fc00
  buffer_load_dwordx4 v16, s[8:11], s92 offen offset:1024 lds
  s_add_u32 s92, s52, 0x2bf800
  buffer_load_dwordx4 v16, s[8:11], s92 offen offset:2048 lds
  s_add_u32 s92, s52, 0x2df400
  buffer_load_dwordx4 v16, s[8:11], s92 offen offset:3072 lds
  s_waitcnt vmcnt(28)
  ds_read_b64_tr_b16 v[192:193], v18 offset:8192
  ds_read_b64_tr_b16 v[194:195], v18 offset:8320
  ds_read_b64_tr_b16 v[200:201], v18 offset:8200
  ds_read_b64_tr_b16 v[202:203], v18 offset:8328
  ds_read_b64_tr_b16 v[196:197], v18 offset:8704
  ds_read_b64_tr_b16 v[198:199], v18 offset:8832
  ds_read_b64_tr_b16 v[204:205], v18 offset:8712
  ds_read_b64_tr_b16 v[206:207], v18 offset:8840
  s_waitcnt lgkmcnt(0)
  s_mov_b32 s8, s22
  s_and_b32 s9, s23, 0xffff
  s_mov_b32 s10, 0x400000
  s_mov_b32 s11, 0x20000
  s_add_u32 m0, s48, 8192
  s_add_u32 s92, s52, 0x200000
  buffer_load_dwordx4 v16, s[8:11], s92 offen offset:0 lds
  s_add_u32 s92, s52, 0x21fc00
  buffer_load_dwordx4 v16, s[8:11], s92 offen offset:1024 lds
  s_add_u32 s92, s52, 0x23f800
  buffer_load_dwordx4 v16, s[8:11], s92 offen offset:2048 lds
  s_add_u32 s92, s52, 0x25f400
  buffer_load_dwordx4 v16, s[8:11], s92 offen offset:3072 lds
  buffer_load_dword v42, v43, s[12:15], 0 offen sc1
  buffer_load_dwordx2 v[44:45], v46, s[76:79], s80 offen
  s_waitcnt vmcnt(30)
  ds_read_b64_tr_b16 v[224:225], v18 offset:12288
  ds_read_b64_tr_b16 v[226:227], v18 offset:12416
  ds_read_b64_tr_b16 v[232:233], v18 offset:12296
  ds_read_b64_tr_b16 v[234:235], v18 offset:12424
  ds_read_b64_tr_b16 v[228:229], v18 offset:12800
  ds_read_b64_tr_b16 v[230:231], v18 offset:12928
  ds_read_b64_tr_b16 v[236:237], v18 offset:12808
  ds_read_b64_tr_b16 v[238:239], v18 offset:12936
  s_waitcnt lgkmcnt(0)
  s_add_u32 m0, s48, 12288
  s_add_u32 s92, s52, 0x280000
  buffer_load_dwordx4 v16, s[8:11], s92 offen offset:0 lds
  s_add_u32 s92, s52, 0x29fc00
  buffer_load_dwordx4 v16, s[8:11], s92 offen offset:1024 lds
  s_add_u32 s92, s52, 0x2bf800
  buffer_load_dwordx4 v16, s[8:11], s92 offen offset:2048 lds
  s_add_u32 s92, s52, 0x2df400
  buffer_load_dwordx4 v16, s[8:11], s92 offen offset:3072 lds
  s_waitcnt vmcnt(30)
  ds_read_b64_tr_b16 v[208:209], v18 offset:16384
  ds_read_b64_tr_b16 v[210:211], v18 offset:16512
  ds_read_b64_tr_b16 v[216:217], v18 offset:16392
  ds_read_b64_tr_b16 v[218:219], v18 offset:16520
  ds_read_b64_tr_b16 v[212:213], v18 offset:16896
  ds_read_b64_tr_b16 v[214:215], v18 offset:17024
  ds_read_b64_tr_b16 v[220:221], v18 offset:16904
  ds_read_b64_tr_b16 v[222:223], v18 offset:17032
  s_waitcnt lgkmcnt(0)
  s_mov_b32 s8, s24
  s_and_b32 s9, s25, 0xffff
  s_mov_b32 s10, 0x400000
  s_mov_b32 s11, 0x20000
  s_add_u32 m0, s48, 16384
  s_add_u32 s92, s52, 0x200000
  buffer_load_dwordx4 v16, s[8:11], s92 offen offset:0 lds
  s_add_u32 s92, s52, 0x21fc00
  buffer_load_dwordx4 v16, s[8:11], s92 offen offset:1024 lds
  s_add_u32 s92, s52, 0x23f800
  buffer_load_dwordx4 v16, s[8:11], s92 offen offset:2048 lds
  s_add_u32 s92, s52, 0x25f400
  buffer_load_dwordx4 v16, s[8:11], s92 offen offset:3072 lds
  s_waitcnt vmcnt(30)
  ds_read_b64_tr_b16 v[240:241], v18 offset:20480
  ds_read_b64_tr_b16 v[242:243], v18 offset:20608
  ds_read_b64_tr_b16 v[248:249], v18 offset:20488
  ds_read_b64_tr_b16 v[250:251], v18 offset:20616
  ds_read_b64_tr_b16 v[244:245], v18 offset:20992
  ds_read_b64_tr_b16 v[246:247], v18 offset:21120
  ds_read_b64_tr_b16 v[252:253], v18 offset:21000
  ds_read_b64_tr_b16 v[254:255], v18 offset:21128
  s_waitcnt lgkmcnt(0)
  s_add_u32 m0, s48, 20480
  s_add_u32 s92, s52, 0x280000
  buffer_load_dwordx4 v16, s[8:11], s92 offen offset:0 lds
  s_add_u32 s92, s52, 0x29fc00
  buffer_load_dwordx4 v16, s[8:11], s92 offen offset:1024 lds
  s_add_u32 s92, s52, 0x2bf800
  buffer_load_dwordx4 v16, s[8:11], s92 offen offset:2048 lds
  s_add_u32 s92, s52, 0x2df400
  buffer_load_dwordx4 v16, s[8:11], s92 offen offset:3072 lds
  s_waitcnt vmcnt(30)
  ds_read_b64_tr_b16 v[160:161], v18 offset:24576
  ds_read_b64_tr_b16 v[162:163], v18 offset:24704
  ds_read_b64_tr_b16 v[168:169], v18 offset:24584
  ds_read_b64_tr_b16 v[170:171], v18 offset:24712
  ds_read_b64_tr_b16 v[164:165], v18 offset:25088
  ds_read_b64_tr_b16 v[166:167], v18 offset:25216
  ds_read_b64_tr_b16 v[172:173], v18 offset:25096
  ds_read_b64_tr_b16 v[174:175], v18 offset:25224
  s_waitcnt lgkmcnt(0)
  s_mov_b32 s8, s26
  s_and_b32 s9, s27, 0xffff
  s_mov_b32 s10, 0x400000
  s_mov_b32 s11, 0x20000
  s_mov_b32 s92, 1024
  v_lshrrev_b32 v16, 2, v0
  v_mul_lo_u32 v16, v16, s92
  v_lshl_add_u32 v16, v23, 4, v16
  s_add_u32 m0, s48, 24576
  s_add_u32 s92, s53, 0x0
  buffer_load_dwordx4 v16, s[8:11], s92 offen offset:0 lds
  s_add_u32 s92, s53, 0x3c00
  buffer_load_dwordx4 v16, s[8:11], s92 offen offset:1024 lds
  s_add_u32 s92, s53, 0x7800
  buffer_load_dwordx4 v16, s[8:11], s92 offen offset:2048 lds
  s_add_u32 s92, s53, 0xb400
  buffer_load_dwordx4 v16, s[8:11], s92 offen offset:3072 lds
  s_waitcnt vmcnt(30)
  ds_read_b64_tr_b16 v[176:177], v18 offset:28672
  ds_read_b64_tr_b16 v[178:179], v18 offset:28800
  ds_read_b64_tr_b16 v[184:185], v18 offset:28680
  ds_read_b64_tr_b16 v[186:187], v18 offset:28808
  ds_read_b64_tr_b16 v[180:181], v18 offset:29184
  ds_read_b64_tr_b16 v[182:183], v18 offset:29312
  ds_read_b64_tr_b16 v[188:189], v18 offset:29192
  ds_read_b64_tr_b16 v[190:191], v18 offset:29320
  s_waitcnt lgkmcnt(0)
  s_add_u32 m0, s48, 28672
  s_add_u32 s92, s53, 0x10000
  buffer_load_dwordx4 v16, s[8:11], s92 offen offset:0 lds
  s_add_u32 s92, s53, 0x13c00
  buffer_load_dwordx4 v16, s[8:11], s92 offen offset:1024 lds
  s_add_u32 s92, s53, 0x17800
  buffer_load_dwordx4 v16, s[8:11], s92 offen offset:2048 lds
  s_add_u32 s92, s53, 0x1b400
  buffer_load_dwordx4 v16, s[8:11], s92 offen offset:3072 lds
  s_waitcnt vmcnt(30)
  ds_read_b64_tr_b16 v[24:25], v17 offset:0
  ds_read_b64_tr_b16 v[26:27], v17 offset:128
  ds_read_b64_tr_b16 v[32:33], v17 offset:32
  ds_read_b64_tr_b16 v[34:35], v17 offset:160
  ds_read_b64_tr_b16 v[28:29], v17 offset:2048
  ds_read_b64_tr_b16 v[30:31], v17 offset:2176
  ds_read_b64_tr_b16 v[36:37], v17 offset:2080
  ds_read_b64_tr_b16 v[38:39], v17 offset:2208
  s_waitcnt lgkmcnt(0)
  ds_write_b128 v21, v[24:27] offset:0
  ds_write_b128 v21, v[28:31] offset:1024
  ds_write_b128 v21, v[32:35] offset:2048
  ds_write_b128 v21, v[36:39] offset:3072
  s_waitcnt vmcnt(26)
  ds_read_b64_tr_b16 v[24:25], v17 offset:4096
  ds_read_b64_tr_b16 v[26:27], v17 offset:4224
  ds_read_b64_tr_b16 v[32:33], v17 offset:4128
  ds_read_b64_tr_b16 v[34:35], v17 offset:4256
  ds_read_b64_tr_b16 v[28:29], v17 offset:6144
  ds_read_b64_tr_b16 v[30:31], v17 offset:6272
  ds_read_b64_tr_b16 v[36:37], v17 offset:6176
  ds_read_b64_tr_b16 v[38:39], v17 offset:6304
  s_waitcnt lgkmcnt(0)
  ds_write_b128 v21, v[24:27] offset:4096
  ds_write_b128 v21, v[28:31] offset:5120
  ds_write_b128 v21, v[32:35] offset:6144
  ds_write_b128 v21, v[36:39] offset:7168
  s_waitcnt vmcnt(22)
  ds_read_b64_tr_b16 v[24:25], v17 offset:8192
  ds_read_b64_tr_b16 v[26:27], v17 offset:8320
  ds_read_b64_tr_b16 v[32:33], v17 offset:8224
  ds_read_b64_tr_b16 v[34:35], v17 offset:8352
  ds_read_b64_tr_b16 v[28:29], v17 offset:10240
  ds_read_b64_tr_b16 v[30:31], v17 offset:10368
  ds_read_b64_tr_b16 v[36:37], v17 offset:10272
  ds_read_b64_tr_b16 v[38:39], v17 offset:10400
  s_waitcnt lgkmcnt(0)
  ds_write_b128 v21, v[24:27] offset:8192
  ds_write_b128 v21, v[28:31] offset:9216
  ds_write_b128 v21, v[32:35] offset:10240
  ds_write_b128 v21, v[36:39] offset:11264
  s_waitcnt vmcnt(16)
  ds_read_b64_tr_b16 v[24:25], v17 offset:12288
  ds_read_b64_tr_b16 v[26:27], v17 offset:12416
  ds_read_b64_tr_b16 v[32:33], v17 offset:12320
  ds_read_b64_tr_b16 v[34:35], v17 offset:12448
  ds_read_b64_tr_b16 v[28:29], v17 offset:14336
  ds_read_b64_tr_b16 v[30:31], v17 offset:14464
  ds_read_b64_tr_b16 v[36:37], v17 offset:14368
  ds_read_b64_tr_b16 v[38:39], v17 offset:14496
  s_waitcnt lgkmcnt(0)
  ds_write_b128 v21, v[24:27] offset:12288
  ds_write_b128 v21, v[28:31] offset:13312
  ds_write_b128 v21, v[32:35] offset:14336
  ds_write_b128 v21, v[36:39] offset:15360
  s_waitcnt vmcnt(12)
  ds_read_b64_tr_b16 v[24:25], v17 offset:16384
  ds_read_b64_tr_b16 v[26:27], v17 offset:16512
  ds_read_b64_tr_b16 v[32:33], v17 offset:16416
  ds_read_b64_tr_b16 v[34:35], v17 offset:16544
  ds_read_b64_tr_b16 v[28:29], v17 offset:18432
  ds_read_b64_tr_b16 v[30:31], v17 offset:18560
  ds_read_b64_tr_b16 v[36:37], v17 offset:18464
  ds_read_b64_tr_b16 v[38:39], v17 offset:18592
  s_waitcnt lgkmcnt(0)
  ds_write_b128 v21, v[24:27] offset:16384
  ds_write_b128 v21, v[28:31] offset:17408
  ds_write_b128 v21, v[32:35] offset:18432
  ds_write_b128 v21, v[36:39] offset:19456
  s_waitcnt vmcnt(8)
  ds_read_b64_tr_b16 v[24:25], v17 offset:20480
  ds_read_b64_tr_b16 v[26:27], v17 offset:20608
  ds_read_b64_tr_b16 v[32:33], v17 offset:20512
  ds_read_b64_tr_b16 v[34:35], v17 offset:20640
  ds_read_b64_tr_b16 v[28:29], v17 offset:22528
  ds_read_b64_tr_b16 v[30:31], v17 offset:22656
  ds_read_b64_tr_b16 v[36:37], v17 offset:22560
  ds_read_b64_tr_b16 v[38:39], v17 offset:22688
  s_waitcnt lgkmcnt(0)
  ds_write_b128 v21, v[24:27] offset:20480
  ds_write_b128 v21, v[28:31] offset:21504
  ds_write_b128 v21, v[32:35] offset:22528
  ds_write_b128 v21, v[36:39] offset:23552
  s_waitcnt vmcnt(4)
  ds_read_b64_tr_b16 v[24:25], v18 offset:24576
  ds_read_b64_tr_b16 v[26:27], v18 offset:24704
  ds_read_b64_tr_b16 v[32:33], v18 offset:24584
  ds_read_b64_tr_b16 v[34:35], v18 offset:24712
  ds_read_b64_tr_b16 v[28:29], v18 offset:25088
  ds_read_b64_tr_b16 v[30:31], v18 offset:25216
  ds_read_b64_tr_b16 v[36:37], v18 offset:25096
  ds_read_b64_tr_b16 v[38:39], v18 offset:25224
  s_waitcnt lgkmcnt(0)
  ds_write_b128 v21, v[24:27] offset:24576
  ds_write_b128 v21, v[28:31] offset:25600
  ds_write_b128 v21, v[32:35] offset:26624
  ds_write_b128 v21, v[36:39] offset:27648
  s_waitcnt vmcnt(0)
  ds_read_b64_tr_b16 v[24:25], v18 offset:28672
  ds_read_b64_tr_b16 v[26:27], v18 offset:28800
  ds_read_b64_tr_b16 v[32:33], v18 offset:28680
  ds_read_b64_tr_b16 v[34:35], v18 offset:28808
  ds_read_b64_tr_b16 v[28:29], v18 offset:29184
  ds_read_b64_tr_b16 v[30:31], v18 offset:29312
  ds_read_b64_tr_b16 v[36:37], v18 offset:29192
  ds_read_b64_tr_b16 v[38:39], v18 offset:29320
  s_waitcnt lgkmcnt(0)
  ds_write_b128 v21, v[24:27] offset:28672
  ds_write_b128 v21, v[28:31] offset:29696
  ds_write_b128 v21, v[32:35] offset:30720
  ds_write_b128 v21, v[36:39] offset:31744
  s_waitcnt lgkmcnt(0)
  s_branch cld_9
cl_395:
  s_cmp_lg_u32 s44, 2
  s_cbranch_scc1 cl_780
  s_mov_b32 s72, 147456
  s_mov_b32 s73, 153600
  s_mov_b32 s74, 149504
  s_xor_b32 s75, s51, 1
  s_lshl_b32 s75, s75, 8
  s_add_u32 s75, s75, 128
  v_lshlrev_b32 v40, 13, v0
  v_lshrrev_b32 v21, 4, v0
  v_bfe_u32 v22, v0, 2, 2
  v_and_b32 v23, 3, v0
  v_lshrrev_b32 v24, 1, v21
  v_lshlrev_b32 v17, 4, v24
  v_lshrrev_b32 v24, 1, v22
  v_lshl_add_u32 v17, v24, 3, v17
  v_and_b32 v24, 1, v21
  v_lshl_add_u32 v17, v24, 2, v17
  v_and_b32 v24, 1, v22
  v_add_u32 v17, v17, v24
  v_lshlrev_b32 v17, 6, v17
  v_lshl_add_u32 v17, v23, 3, v17
  v_add_u32 v17, s48, v17
  v_lshrrev_b32 v24, 1, v22
  v_lshlrev_b32 v18, 5, v24
  v_and_b32 v24, 1, v22
  v_add_u32 v18, v18, v24
  v_and_b32 v24, 1, v21
  v_lshl_add_u32 v18, v24, 4, v18
  v_lshrrev_b32 v24, 1, v21
  v_lshl_add_u32 v18, v24, 2, v18
  v_lshlrev_b32 v18, 6, v18
  v_lshl_add_u32 v18, v23, 4, v18
  v_add_u32 v18, s48, v18
  v_add_u32 v21, s48, v1
  s_mov_b32 s8, s20
  s_and_b32 s9, s21, 0xffff
  s_mov_b32 s10, 0x400000
  s_mov_b32 s11, 0x20000
  s_mov_b32 s92, 8192
  v_lshrrev_b32 v16, 2, v0
  v_mul_lo_u32 v16, v16, s92
  v_lshl_add_u32 v16, v23, 4, v16
  s_add_u32 m0, s48, 0
  s_add_u32 s92, s52, 0x100000
  buffer_load_dwordx4 v16, s[8:11], s92 offen offset:0 lds
  s_add_u32 s92, s52, 0x11fc00
  buffer_load_dwordx4 v16, s[8:11], s92 offen offset:1024 lds
  s_add_u32 s92, s52, 0x13f800
  buffer_load_dwordx4 v16, s[8:11], s92 offen offset:2048 lds
  s_add_u32 s92, s52, 0x15f400
  buffer_load_dwordx4 v16, s[8:11], s92 offen offset:3072 lds
  s_add_u32 m0, s48, 4096
  s_add_u32 s92, s52, 0x180000
  buffer_load_dwordx4 v16, s[8:11], s92 offen offset:0 lds
  s_add_u32 s92, s52, 0x19fc00
  buffer_load_dwordx4 v16, s[8:11], s92 offen offset:1024 lds
  s_add_u32 s92, s52, 0x1bf800
  buffer_load_dwordx4 v16, s[8:11], s92 offen offset:2048 lds
  s_add_u32 s92, s52, 0x1df400
  buffer_load_dwordx4 v16, s[8:11], s92 offen offset:3072 lds
  s_add_u32 m0, s48, 8192
  s_add_u32 s92, s52, 0x200000
  buffer_load_dwordx4 v16, s[8:11], s92 offen offset:0 lds
  s_add_u32 s92, s52, 0x21fc00
  buffer_load_dwordx4 v16, s[8:11], s92 offen offset:1024 lds
  s_add_u32 s92, s52, 0x23f800
  buffer_load_dwordx4 v16, s[8:11], s92 offen offset:2048 lds
  s_add_u32 s92, s52, 0x25f400
  buffer_load_dwordx4 v16, s[8:11], s92 offen offset:3072 lds
  s_add_u32 m0, s48, 12288
  s_add_u32 s92, s52, 0x280000
  buffer_load_dwordx4 v16, s[8:11], s92 offen offset:0 lds
  s_add_u32 s92, s52, 0x29fc00
  buffer_load_dwordx4 v16, s[8:11], s92 offen offset:1024 lds
  s_add_u32 s92, s52, 0x2bf800
  buffer_load_dwordx4 v16, s[8:11], s92 offen offset:2048 lds
  s_add_u32 s92, s52, 0x2df400
  buffer_load_dwordx4 v16, s[8:11], s92 offen offset:3072 lds
  s_add_u32 m0, s48, 16384
  s_add_u32 s92, s52, 0x300000
  buffer_load_dwordx4 v16, s[8:11], s92 offen offset:0 lds
  s_add_u32 s92, s52, 0x31fc00
  buffer_load_dwordx4 v16, s[8:11], s92 offen offset:1024 lds
  s_add_u32 s92, s52, 0x33f800
  buffer_load_dwordx4 v16, s[8:11], s92 offen offset:2048 lds
  s_add_u32 s92, s52, 0x35f400
  buffer_load_dwordx4 v16, s[8:11], s92 offen offset:3072 lds
  s_add_u32 m0, s48, 20480
  s_add_u32 s92, s52, 0x380000
  buffer_load_dwordx4 v16, s[8:11], s92 offen offset:0 lds
  s_add_u32 s92, s52, 0x39fc00
  buffer_load_dwordx4 v16, s[8:11], s92 offen offset:1024 lds
  s_add_u32 s92, s52, 0x3bf800
  buffer_load_dwordx4 v16, s[8:11], s92 offen offset:2048 lds
  s_add_u32 s92, s52, 0x3df400
  buffer_load_dwordx4 v16, s[8:11], s92 offen offset:3072 lds
  s_mov_b32 s8, s22
  s_and_b32 s9, s23, 0xffff
  s_mov_b32 s10, 0x400000
  s_mov_b32 s11, 0x20000
  s_add_u32 m0, s48, 24576
  s_add_u32 s92, s52, 0x100000
  buffer_load_dwordx4 v16, s[8:11], s92 offen offset:0 lds
  s_add_u32 s92, s52, 0x11fc00
  buffer_load_dwordx4 v16, s[8:11], s92 offen offset:1024 lds
  s_add_u32 s92, s52, 0x13f800
  buffer_load_dwordx4 v16, s[8:11], s92 offen offset:2048 lds
  s_add_u32 s92, s52, 0x15f400
  buffer_load_dwordx4 v16, s[8:11], s92 offen offset:3072 lds
  s_add_u32 m0, s48, 28672
  s_add_u32 s92, s52, 0x180000
  buffer_load_dwordx4 v16, s[8:11], s92 offen offset:0 lds
  s_add_u32 s92, s52, 0x19fc00
  buffer_load_dwordx4 v16, s[8:11], s92 offen offset:1024 lds
  s_add_u32 s92, s52, 0x1bf800
  buffer_load_dwordx4 v16, s[8:11], s92 offen offset:2048 lds
  s_add_u32 s92, s52, 0x1df400
  buffer_load_dwordx4 v16, s[8:11], s92 offen offset:3072 lds
  s_waitcnt vmcnt(28)
  ds_read_b64_tr_b16 a[32:33], v17 offset:0
  ds_read_b64_tr_b16 a[34:35], v17 offset:128
  ds_read_b64_tr_b16 a[40:41], v17 offset:32
  ds_read_b64_tr_b16 a[42:43], v17 offset:160
  ds_read_b64_tr_b16 a[36:37], v17 offset:2048
  ds_read_b64_tr_b16 a[38:39], v17 offset:2176
  ds_read_b64_tr_b16 a[44:45], v17 offset:2080
  ds_read_b64_tr_b16 a[46:47], v17 offset:2208
  s_waitcnt lgkmcnt(0)
  s_add_u32 m0, s48, 0
  s_add_u32 s92, s52, 0x200000
  buffer_load_dwordx4 v16, s[8:11], s92 offen offset:0 lds
  s_add_u32 s92, s52, 0x21fc00
  buffer_load_dwordx4 v16, s[8:11], s92 offen offset:1024 lds
  s_add_u32 s92, s52, 0x23f800
  buffer_load_dwordx4 v16, s[8:11], s92 offen offset:2048 lds
  s_add_u32 s92, s52, 0x25f400
  buffer_load_dwordx4 v16, s[8:11], s92 offen offset:3072 lds
  s_waitcnt vmcnt(28)
  ds_read_b64_tr_b16 a[48:49], v17 offset:4096
  ds_read_b64_tr_b16 a[50:51], v17 offset:4224
  ds_read_b64_tr_b16 a[56:57], v17 offset:4128
  ds_read_b64_tr_b16 a[58:59], v17 offset:4256
  ds_read_b64_tr_b16 a[52:53], v17 offset:6144
  ds_read_b64_tr_b16 a[54:55], v17 offset:6272
  ds_read_b64_tr_b16 a[60:61], v17 offset:6176
  ds_read_b64_tr_b16 a[62:63], v17 offset:6304
  s_waitcnt lgkmcnt(0)
  s_add_u32 m0, s48, 4096
  s_add_u32 s92, s52, 0x280000
  buffer_load_dwordx4 v16, s[8:11], s92 offen offset:0 lds
  s_add_u32 s92, s52, 0x29fc00
  buffer_load_dwordx4 v16, s[8:11], s92 offen offset:1024 lds
  s_add_u32 s92, s52, 0x2bf800
  buffer_load_dwordx4 v16, s[8:11], s92 offen offset:2048 lds
  s_add_u32 s92, s52, 0x2df400
  buffer_load_dwordx4 v16, s[8:11], s92 offen offset:3072 lds
  s_waitcnt vmcnt(28)
  ds_read_b64_tr_b16 a[64:65], v17 offset:8192
  ds_read_b64_tr_b16 a[66:67], v17 offset:8320
  ds_read_b64_tr_b16 a[72:73], v17 offset:8224
  ds_read_b64_tr_b16 a[74:75], v17 offset:8352
  ds_read_b64_tr_b16 a[68:69], v17 offset:10240
  ds_read_b64_tr_b16 a[70:71], v17 offset:10368
  ds_read_b64_tr_b16 a[76:77], v17 offset:10272
  ds_read_b64_tr_b16 a[78:79], v17 offset:10400
  s_waitcnt lgkmcnt(0)
  s_add_u32 m0, s48, 8192
  s_add_u32 s92, s52, 0x300000
  buffer_load_dwordx4 v16, s[8:11], s92 offen offset:0 lds
  s_add_u32 s92, s52, 0x31fc00
  buffer_load_dwordx4 v16, s[8:11], s92 offen offset:1024 lds
  s_add_u32 s92, s52, 0x33f800
  buffer_load_dwordx4 v16, s[8:11], s92 offen offset:2048 lds
  s_add_u32 s92, s52, 0x35f400
  buffer_load_dwordx4 v16, s[8:11], s92 offen offset:3072 lds
  s_waitcnt vmcnt(28)
  ds_read_b64_tr_b16 a[80:81], v17 offset:12288
  ds_read_b64_tr_b16 a[82:83], v17 offset:12416
  ds_read_b64_tr_b16 a[88:89], v17 offset:12320
  ds_read_b64_tr_b16 a[90:91], v17 offset:12448
  ds_read_b64_tr_b16 a[84:85], v17 offset:14336
  ds_read_b64_tr_b16 a[86:87], v17 offset:14464
  ds_read_b64_tr_b16 a[92:93], v17 offset:14368
  ds_read_b64_tr_b16 a[94:95], v17 offset:14496
  s_waitcnt lgkmcnt(0)
  s_add_u32 m0, s48, 12288
  s_add_u32 s92, s52, 0x380000
  buffer_load_dwordx4 v16, s[8:11], s92 offen offset:0 lds
  s_add_u32 s92, s52, 0x39fc00
  buffer_load_dwordx4 v16, s[8:11], s92 offen offset:1024 lds
  s_add_u32 s92, s52, 0x3bf800
  buffer_load_dwordx4 v16, s[8:11], s92 offen offset:2048 lds
  s_add_u32 s92, s52, 0x3df400
  buffer_load_dwordx4 v16, s[8:11], s92 offen offset:3072 lds
  s_waitcnt vmcnt(28)
  ds_read_b64_tr_b16 a[0:1], v17 offset:16384
  ds_read_b64_tr_b16 a[2:3], v17 offset:16512
  ds_read_b64_tr_b16 a[8:9], v17 offset:16416
  ds_read_b64_tr_b16 a[10:11], v17 offset:16544
  ds_read_b64_tr_b16 a[4:5], v17 offset:18432
  ds_read_b64_tr_b16 a[6:7], v17 offset:18560
  ds_read_b64_tr_b16 a[12:13], v17 offset:18464
  ds_read_b64_tr_b16 a[14:15], v17 offset:18592
  s_waitcnt lgkmcnt(0)
  s_mov_b32 s8, s24
  s_and_b32 s9, s25, 0xffff
  s_mov_b32 s10, 0x400000
  s_mov_b32 s11, 0x20000
  s_add_u32 m0, s48, 16384
  s_add_u32 s92, s52, 0x100000
  buffer_load_dwordx4 v16, s[8:11], s92 offen offset:0 lds
  s_add_u32 s92, s52, 0x11fc00
  buffer_load_dwordx4 v16, s[8:11], s92 offen offset:1024 lds
  s_add_u32 s92, s52, 0x13f800
  buffer_load_dwordx4 v16, s[8:11], s92 offen offset:2048 lds
  s_add_u32 s92, s52, 0x15f400
  buffer_load_dwordx4 v16, s[8:11], s92 offen offset:3072 lds
  s_waitcnt vmcnt(28)
  ds_read_b64_tr_b16 a[16:17], v17 offset:20480
  ds_read_b64_tr_b16 a[18:19], v17 offset:20608
  ds_read_b64_tr_b16 a[24:25], v17 offset:20512
  ds_read_b64_tr_b16 a[26:27], v17 offset:20640
  ds_read_b64_tr_b16 a[20:21], v17 offset:22528
  ds_read_b64_tr_b16 a[22:23], v17 offset:22656
  ds_read_b64_tr_b16 a[28:29], v17 offset:22560
  ds_read_b64_tr_b16 a[30:31], v17 offset:22688
  s_waitcnt lgkmcnt(0)
  s_add_u32 m0, s48, 20480
  s_add_u32 s92, s52, 0x180000
  buffer_load_dwordx4 v16, s[8:11], s92 offen offset:0 lds
  s_add_u32 s92, s52, 0x19fc00
  buffer_load_dwordx4 v16, s[8:11], s92 offen offset:1024 lds
  s_add_u32 s92, s52, 0x1bf800
  buffer_load_dwordx4 v16, s[8:11], s92 offen offset:2048 lds
  s_add_u32 s92, s52, 0x1df400
  buffer_load_dwordx4 v16, s[8:11], s92 offen offset:3072 lds
  s_waitcnt vmcnt(28)
  ds_read_b64_tr_b16 a[128:129], v17 offset:24576
  ds_read_b64_tr_b16 a[130:131], v17 offset:24704
  ds_read_b64_tr_b16 a[136:137], v17 offset:24608
  ds_read_b64_tr_b16 a[138:139], v17 offset:24736
  ds_read_b64_tr_b16 a[132:133], v17 offset:26624
  ds_read_b64_tr_b16 a[134:135], v17 offset:26752
  ds_read_b64_tr_b16 a[140:141], v17 offset:26656
  ds_read_b64_tr_b16 a[142:143], v17 offset:26784
  s_waitcnt lgkmcnt(0)
  s_add_u32 m0, s48, 24576
  s_add_u32 s92, s52, 0x200000
  buffer_load_dwordx4 v16, s[8:11], s92 offen offset:0 lds
  s_add_u32 s92, s52, 0x21fc00
  buffer_load_dwordx4 v16, s[8:11], s92 offen offset:1024 lds
  s_add_u32 s92, s52, 0x23f800
  buffer_load_dwordx4 v16, s[8:11], s92 offen offset:2048 lds
  s_add_u32 s92, s52, 0x25f400
  buffer_load_dwordx4 v16, s[8:11], s92 offen offset:3072 lds
  s_waitcnt vmcnt(28)
  ds_read_b64_tr_b16 a[144:145], v17 offset:28672
  ds_read_b64_tr_b16 a[146:147], v17 offset:28800
  ds_read_b64_tr_b16 a[152:153], v17 offset:28704
  ds_read_b64_tr_b16 a[154:155], v17 offset:28832
  ds_read_b64_tr_b16 a[148:149], v17 offset:30720
  ds_read_b64_tr_b16 a[150:151], v17 offset:30848
  ds_read_b64_tr_b16 a[156:157], v17 offset:30752
  ds_read_b64_tr_b16 a[158:159], v17 offset:30880
  s_waitcnt lgkmcnt(0)
  s_add_u32 m0, s48, 28672
  s_add_u32 s92, s52, 0x280000
  buffer_load_dwordx4 v16, s[8:11], s92 offen offset:0 lds
  s_add_u32 s92, s52, 0x29fc00
  buffer_load_dwordx4 v16, s[8:11], s92 offen offset:1024 lds
  s_add_u32 s92, s52, 0x2bf800
  buffer_load_dwordx4 v16, s[8:11], s92 offen offset:2048 lds
  s_add_u32 s92, s52, 0x2df400
  buffer_load_dwordx4 v16, s[8:11], s92 offen offset:3072 lds
  s_waitcnt vmcnt(28)
  ds_read_b64_tr_b16 a[160:161], v17 offset:0
  ds_read_b64_tr_b16 a[162:163], v17 offset:128
  ds_read_b64_tr_b16 a[168:169], v17 offset:32
  ds_read_b64_tr_b16 a[170:171], v17 offset:160
  ds_read_b64_tr_b16 a[164:165], v17 offset:2048
  ds_read_b64_tr_b16 a[166:167], v17 offset:2176
  ds_read_b64_tr_b16 a[172:173], v17 offset:2080
  ds_read_b64_tr_b16 a[174:175], v17 offset:2208
  s_waitcnt lgkmcnt(0)
  s_add_u32 m0, s48, 0
  s_add_u32 s92, s52, 0x300000
  buffer_load_dwordx4 v16, s[8:11], s92 offen offset:0 lds
  s_add_u32 s92, s52, 0x31fc00
  buffer_load_dwordx4 v16, s[8:11], s92 offen offset:1024 lds
  s_add_u32 s92, s52, 0x33f800
  buffer_load_dwordx4 v16, s[8:11], s92 offen offset:2048 lds
  s_add_u32 s92, s52, 0x35f400
  buffer_load_dwordx4 v16, s[8:11], s92 offen offset:3072 lds
  s_waitcnt vmcnt(28)
  ds_read_b64_tr_b16 a[176:177], v17 offset:4096
  ds_read_b64_tr_b16 a[178:179], v17 offset:4224
  ds_read_b64_tr_b16 a[184:185], v17 offset:4128
  ds_read_b64_tr_b16 a[186:187], v17 offset:4256
  ds_read_b64_tr_b16 a[180:181], v17 offset:6144
  ds_read_b64_tr_b16 a[182:183], v17 offset:6272
  ds_read_b64_tr_b16 a[188:189], v17 offset:6176
  ds_read_b64_tr_b16 a[190:191], v17 offset:6304
  s_waitcnt lgkmcnt(0)
  s_add_u32 m0, s48, 4096
  s_add_u32 s92, s52, 0x380000
  buffer_load_dwordx4 v16, s[8:11], s92 offen offset:0 lds
  s_add_u32 s92, s52, 0x39fc00
  buffer_load_dwordx4 v16, s[8:11], s92 offen offset:1024 lds
  s_add_u32 s92, s52, 0x3bf800
  buffer_load_dwordx4 v16, s[8:11], s92 offen offset:2048 lds
  s_add_u32 s92, s52, 0x3df400
  buffer_load_dwordx4 v16, s[8:11], s92 offen offset:3072 lds
  s_waitcnt vmcnt(28)
  ds_read_b64_tr_b16 a[96:97], v17 offset:8192
  ds_read_b64_tr_b16 a[98:99], v17 offset:8320
  ds_read_b64_tr_b16 a[104:105], v17 offset:8224
  ds_read_b64_tr_b16 a[106:107], v17 offset:8352
  ds_read_b64_tr_b16 a[100:101], v17 offset:10240
  ds_read_b64_tr_b16 a[102:103], v17 offset:10368
  ds_read_b64_tr_b16 a[108:109], v17 offset:10272
  ds_read_b64_tr_b16 a[110:111], v17 offset:10400
  s_waitcnt lgkmcnt(0)
  s_mov_b32 s8, s26
  s_and_b32 s9, s27, 0xffff
  s_mov_b32 s10, 0x400000
  s_mov_b32 s11, 0x20000
  s_mov_b32 s92, 1024
  v_lshrrev_b32 v16, 2, v0
  v_mul_lo_u32 v16, v16, s92
  v_lshl_add_u32 v16, v23, 4, v16
  s_add_u32 m0, s48, 8192
  s_add_u32 s92, s53, 0x80
  buffer_load_dwordx4 v16, s[8:11], s92 offen offset:0 lds
  s_add_u32 s92, s53, 0x3c80
  buffer_load_dwordx4 v16, s[8:11], s92 offen offset:1024 lds
  s_add_u32 s92, s53, 0x7880
  buffer_load_dwordx4 v16, s[8:11], s92 offen offset:2048 lds
  s_add_u32 s92, s53, 0xb480
  buffer_load_dwordx4 v16, s[8:11], s92 offen offset:3072 lds
  s_waitcnt vmcnt(28)
  ds_read_b64_tr_b16 a[112:113], v17 offset:12288
  ds_read_b64_tr_b16 a[114:115], v17 offset:12416
  ds_read_b64_tr_b16 a[120:121], v17 offset:12320
  ds_read_b64_tr_b16 a[122:123], v17 offset:12448
  ds_read_b64_tr_b16 a[116:117], v17 offset:14336
  ds_read_b64_tr_b16 a[118:119], v17 offset:14464
  ds_read_b64_tr_b16 a[124:125], v17 offset:14368
  ds_read_b64_tr_b16 a[126:127], v17 offset:14496
  s_waitcnt lgkmcnt(0)
  s_add_u32 m0, s48, 12288
  s_add_u32 s92, s53, 0xc0
  buffer_load_dwordx4 v16, s[8:11], s92 offen offset:0 lds
  s_add_u32 s92, s53, 0x3cc0
  buffer_load_dwordx4 v16, s[8:11], s92 offen offset:1024 lds
  s_add_u32 s92, s53, 0x78c0
  buffer_load_dwordx4 v16, s[8:11], s92 offen offset:2048 lds
  s_add_u32 s92, s53, 0xb4c0
  buffer_load_dwordx4 v16, s[8:11], s92 offen offset:3072 lds
  s_waitcnt vmcnt(28)
  ds_read_b64_tr_b16 a[224:225], v17 offset:16384
  ds_read_b64_tr_b16 a[226:227], v17 offset:16512
  ds_read_b64_tr_b16 a[232:233], v17 offset:16416
  ds_read_b64_tr_b16 a[234:235], v17 offset:16544
  ds_read_b64_tr_b16 a[228:229], v17 offset:18432
  ds_read_b64_tr_b16 a[230:231], v17 offset:18560
  ds_read_b64_tr_b16 a[236:237], v17 offset:18464
  ds_read_b64_tr_b16 a[238:239], v17 offset:18592
  s_waitcnt lgkmcnt(0)
  s_add_u32 m0, s48, 16384
  s_add_u32 s92, s53, 0x10080
  buffer_load_dwordx4 v16, s[8:11], s92 offen offset:0 lds
  s_add_u32 s92, s53, 0x13c80
  buffer_load_dwordx4 v16, s[8:11], s92 offen offset:1024 lds
  s_add_u32 s92, s53, 0x17880
  buffer_load_dwordx4 v16, s[8:11], s92 offen offset:2048 lds
  s_add_u32 s92, s53, 0x1b480
  buffer_load_dwordx4 v16, s[8:11], s92 offen offset:3072 lds
  s_waitcnt vmcnt(28)
  ds_read_b64_tr_b16 a[240:241], v17 offset:20480
  ds_read_b64_tr_b16 a[242:243], v17 offset:20608
  ds_read_b64_tr_b16 a[248:249], v17 offset:20512
  ds_read_b64_tr_b16 a[250:251], v17 offset:20640
  ds_read_b64_tr_b16 a[244:245], v17 offset:22528
  ds_read_b64_tr_b16 a[246:247], v17 offset:22656
  ds_read_b64_tr_b16 a[252:253], v17 offset:22560
  ds_read_b64_tr_b16 a[254:255], v17 offset:22688
  s_waitcnt lgkmcnt(0)
  s_add_u32 m0, s48, 20480
  s_add_u32 s92, s53, 0x100c0
  buffer_load_dwordx4 v16, s[8:11], s92 offen offset:0 lds
  s_add_u32 s92, s53, 0x13cc0
  buffer_load_dwordx4 v16, s[8:11], s92 offen offset:1024 lds
  s_add_u32 s92, s53, 0x178c0
  buffer_load_dwordx4 v16, s[8:11], s92 offen offset:2048 lds
  s_add_u32 s92, s53, 0x1b4c0
  buffer_load_dwordx4 v16, s[8:11], s92 offen offset:3072 lds
  s_waitcnt vmcnt(28)
  ds_read_b64_tr_b16 v[128:129], v17 offset:24576
  ds_read_b64_tr_b16 v[130:131], v17 offset:24704
  ds_read_b64_tr_b16 v[136:137], v17 offset:24608
  ds_read_b64_tr_b16 v[138:139], v17 offset:24736
  ds_read_b64_tr_b16 v[132:133], v17 offset:26624
  ds_read_b64_tr_b16 v[134:135], v17 offset:26752
  ds_read_b64_tr_b16 v[140:141], v17 offset:26656
  ds_read_b64_tr_b16 v[142:143], v17 offset:26784
  s_waitcnt lgkmcnt(0)
  s_add_u32 m0, s48, 24576
  s_add_u32 s92, s53, 0x40
  buffer_load_dwordx4 v16, s[8:11], s92 offen offset:0 lds
  s_add_u32 s92, s53, 0x3c40
  buffer_load_dwordx4 v16, s[8:11], s92 offen offset:1024 lds
  s_add_u32 s92, s53, 0x7840
  buffer_load_dwordx4 v16, s[8:11], s92 offen offset:2048 lds
  s_add_u32 s92, s53, 0xb440
  buffer_load_dwordx4 v16, s[8:11], s92 offen offset:3072 lds
  s_waitcnt vmcnt(28)
  ds_read_b64_tr_b16 v[144:145], v17 offset:28672
  ds_read_b64_tr_b16 v[146:147], v17 offset:28800
  ds_read_b64_tr_b16 v[152:153], v17 offset:28704
  ds_read_b64_tr_b16 v[154:155], v17 offset:28832
  ds_read_b64_tr_b16 v[148:149], v17 offset:30720
  ds_read_b64_tr_b16 v[150:151], v17 offset:30848
  ds_read_b64_tr_b16 v[156:157], v17 offset:30752
  ds_read_b64_tr_b16 v[158:159], v17 offset:30880
  s_waitcnt lgkmcnt(0)
  s_add_u32 m0, s48, 28672
  s_add_u32 s92, s53, 0x10040
  buffer_load_dwordx4 v16, s[8:11], s92 offen offset:0 lds
  s_add_u32 s92, s53, 0x13c40
  buffer_load_dwordx4 v16, s[8:11], s92 offen offset:1024 lds
  s_add_u32 s92, s53, 0x17840
  buffer_load_dwordx4 v16, s[8:11], s92 offen offset:2048 lds
  s_add_u32 s92, s53, 0x1b440
  buffer_load_dwordx4 v16, s[8:11], s92 offen offset:3072 lds
  s_waitcnt vmcnt(28)
  ds_read_b64_tr_b16 a[192:193], v17 offset:0
  ds_read_b64_tr_b16 a[194:195], v17 offset:128
  ds_read_b64_tr_b16 a[200:201], v17 offset:32
  ds_read_b64_tr_b16 a[202:203], v17 offset:160
  ds_read_b64_tr_b16 a[196:197], v17 offset:2048
  ds_read_b64_tr_b16 a[198:199], v17 offset:2176
  ds_read_b64_tr_b16 a[204:205], v17 offset:2080
  ds_read_b64_tr_b16 a[206:207], v17 offset:2208
  s_waitcnt lgkmcnt(0)
  s_mov_b32 s8, s20
  s_and_b32 s9, s21, 0xffff
  s_mov_b32 s10, 0x400000
  s_mov_b32 s11, 0x20000
  s_mov_b32 s92, 8192
  v_lshrrev_b32 v16, 2, v0
  v_mul_lo_u32 v16, v16, s92
  v_lshl_add_u32 v16, v23, 4, v16
  s_add_u32 m0, s48, 0
  s_add_u32 s92, s52, 0x0
  buffer_load_dwordx4 v16, s[8:11], s92 offen offset:0 lds
  s_add_u32 s92, s52, 0x1fc00
  buffer_load_dwordx4 v16, s[8:11], s92 offen offset:1024 lds
  s_add_u32 s92, s52, 0x3f800
  buffer_load_dwordx4 v16, s[8:11], s92 offen offset:2048 lds
  s_add_u32 s92, s52, 0x5f400
  buffer_load_dwordx4 v16, s[8:11], s92 offen offset:3072 lds
  s_waitcnt vmcnt(28)
  ds_read_b64_tr_b16 a[208:209], v17 offset:4096
  ds_read_b64_tr_b16 a[210:211], v17 offset:4224
  ds_read_b64_tr_b16 a[216:217], v17 offset:4128
  ds_read_b64_tr_b16 a[218:219], v17 offset:4256
  ds_read_b64_tr_b16 a[212:213], v17 offset:6144
  ds_read_b64_tr_b16 a[214:215], v17 offset:6272
  ds_read_b64_tr_b16 a[220:221], v17 offset:6176
  ds_read_b64_tr_b16 a[222:223], v17 offset:6304
  s_waitcnt lgkmcnt(0)
  s_add_u32 m0, s48, 4096
  s_add_u32 s92, s52, 0x80000
  buffer_load_dwordx4 v16, s[8:11], s92 offen offset:0 lds
  s_add_u32 s92, s52, 0x9fc00
  buffer_load_dwordx4 v16, s[8:11], s92 offen offset:1024 lds
  s_add_u32 s92, s52, 0xbf800
  buffer_load_dwordx4 v16, s[8:11], s92 offen offset:2048 lds
  s_add_u32 s92, s52, 0xdf400
  buffer_load_dwordx4 v16, s[8:11], s92 offen offset:3072 lds
  s_waitcnt vmcnt(28)
  ds_read_b64_tr_b16 v[192:193], v18 offset:8192
  ds_read_b64_tr_b16 v[194:195], v18 offset:8320
  ds_read_b64_tr_b16 v[200:201], v18 offset:8200
  ds_read_b64_tr_b16 v[202:203], v18 offset:8328
  ds_read_b64_tr_b16 v[196:197], v18 offset:8704
  ds_read_b64_tr_b16 v[198:199], v18 offset:8832
  ds_read_b64_tr_b16 v[204:205], v18 offset:8712
  ds_read_b64_tr_b16 v[206:207], v18 offset:8840
  s_waitcnt lgkmcnt(0)
  s_mov_b32 s8, s22
  s_and_b32 s9, s23, 0xffff
  s_mov_b32 s10, 0x400000
  s_mov_b32 s11, 0x20000
  s_add_u32 m0, s48, 8192
  s_add_u32 s92, s52, 0x0
  buffer_load_dwordx4 v16, s[8:11], s92 offen offset:0 lds
  s_add_u32 s92, s52, 0x1fc00
  buffer_load_dwordx4 v16, s[8:11], s92 offen offset:1024 lds
  s_add_u32 s92, s52, 0x3f800
  buffer_load_dwordx4 v16, s[8:11], s92 offen offset:2048 lds
  s_add_u32 s92, s52, 0x5f400
  buffer_load_dwordx4 v16, s[8:11], s92 offen offset:3072 lds
  buffer_load_dword v42, v43, s[12:15], 0 offen sc1
  buffer_load_dwordx2 v[44:45], v46, s[76:79], s80 offen
  s_waitcnt vmcnt(30)
  ds_read_b64_tr_b16 v[224:225], v18 offset:12288
  ds_read_b64_tr_b16 v[226:227], v18 offset:12416
  ds_read_b64_tr_b16 v[232:233], v18 offset:12296
  ds_read_b64_tr_b16 v[234:235], v18 offset:12424
  ds_read_b64_tr_b16 v[228:229], v18 offset:12800
  ds_read_b64_tr_b16 v[230:231], v18 offset:12928
  ds_read_b64_tr_b16 v[236:237], v18 offset:12808
  ds_read_b64_tr_b16 v[238:239], v18 offset:12936
  s_waitcnt lgkmcnt(0)
  s_add_u32 m0, s48, 12288
  s_add_u32 s92, s52, 0x80000
  buffer_load_dwordx4 v16, s[8:11], s92 offen offset:0 lds
  s_add_u32 s92, s52, 0x9fc00
  buffer_load_dwordx4 v16, s[8:11], s92 offen offset:1024 lds
  s_add_u32 s92, s52, 0xbf800
  buffer_load_dwordx4 v16, s[8:11], s92 offen offset:2048 lds
  s_add_u32 s92, s52, 0xdf400
  buffer_load_dwordx4 v16, s[8:11], s92 offen offset:3072 lds
  s_waitcnt vmcnt(30)
  ds_read_b64_tr_b16 v[208:209], v18 offset:16384
  ds_read_b64_tr_b16 v[210:211], v18 offset:16512
  ds_read_b64_tr_b16 v[216:217], v18 offset:16392
  ds_read_b64_tr_b16 v[218:219], v18 offset:16520
  ds_read_b64_tr_b16 v[212:213], v18 offset:16896
  ds_read_b64_tr_b16 v[214:215], v18 offset:17024
  ds_read_b64_tr_b16 v[220:221], v18 offset:16904
  ds_read_b64_tr_b16 v[222:223], v18 offset:17032
  s_waitcnt lgkmcnt(0)
  s_mov_b32 s8, s24
  s_and_b32 s9, s25, 0xffff
  s_mov_b32 s10, 0x400000
  s_mov_b32 s11, 0x20000
  s_add_u32 m0, s48, 16384
  s_add_u32 s92, s52, 0x0
  buffer_load_dwordx4 v16, s[8:11], s92 offen offset:0 lds
  s_add_u32 s92, s52, 0x1fc00
  buffer_load_dwordx4 v16, s[8:11], s92 offen offset:1024 lds
  s_add_u32 s92, s52, 0x3f800
  buffer_load_dwordx4 v16, s[8:11], s92 offen offset:2048 lds
  s_add_u32 s92, s52, 0x5f400
  buffer_load_dwordx4 v16, s[8:11], s92 offen offset:3072 lds
  s_waitcnt vmcnt(30)
  ds_read_b64_tr_b16 v[240:241], v18 offset:20480
  ds_read_b64_tr_b16 v[242:243], v18 offset:20608
  ds_read_b64_tr_b16 v[248:249], v18 offset:20488
  ds_read_b64_tr_b16 v[250:251], v18 offset:20616
  ds_read_b64_tr_b16 v[244:245], v18 offset:20992
  ds_read_b64_tr_b16 v[246:247], v18 offset:21120
  ds_read_b64_tr_b16 v[252:253], v18 offset:21000
  ds_read_b64_tr_b16 v[254:255], v18 offset:21128
  s_waitcnt lgkmcnt(0)
  s_add_u32 m0, s48, 20480
  s_add_u32 s92, s52, 0x80000
  buffer_load_dwordx4 v16, s[8:11], s92 offen offset:0 lds
  s_add_u32 s92, s52, 0x9fc00
  buffer_load_dwordx4 v16, s[8:11], s92 offen offset:1024 lds
  s_add_u32 s92, s52, 0xbf800
  buffer_load_dwordx4 v16, s[8:11], s92 offen offset:2048 lds
  s_add_u32 s92, s52, 0xdf400
  buffer_load_dwordx4 v16, s[8:11], s92 offen offset:3072 lds
  s_waitcnt vmcnt(30)
  ds_read_b64_tr_b16 v[160:161], v18 offset:24576
  ds_read_b64_tr_b16 v[162:163], v18 offset:24704
  ds_read_b64_tr_b16 v[168:169], v18 offset:24584
  ds_read_b64_tr_b16 v[170:171], v18 offset:24712
  ds_read_b64_tr_b16 v[164:165], v18 offset:25088
  ds_read_b64_tr_b16 v[166:167], v18 offset:25216
  ds_read_b64_tr_b16 v[172:173], v18 offset:25096
  ds_read_b64_tr_b16 v[174:175], v18 offset:25224
  s_waitcnt lgkmcnt(0)
  s_mov_b32 s8, s26
  s_and_b32 s9, s27, 0xffff
  s_mov_b32 s10, 0x400000
  s_mov_b32 s11, 0x20000
  s_mov_b32 s92, 1024
  v_lshrrev_b32 v16, 2, v0
  v_mul_lo_u32 v16, v16, s92
  v_lshl_add_u32 v16, v23, 4, v16
  s_add_u32 m0, s48, 24576
  s_add_u32 s92, s53, 0x0
  buffer_load_dwordx4 v16, s[8:11], s92 offen offset:0 lds
  s_add_u32 s92, s53, 0x3c00
  buffer_load_dwordx4 v16, s[8:11], s92 offen offset:1024 lds
  s_add_u32 s92, s53, 0x7800
  buffer_load_dwordx4 v16, s[8:11], s92 offen offset:2048 lds
  s_add_u32 s92, s53, 0xb400
  buffer_load_dwordx4 v16, s[8:11], s92 offen offset:3072 lds
  s_waitcnt vmcnt(30)
  ds_read_b64_tr_b16 v[176:177], v18 offset:28672
  ds_read_b64_tr_b16 v[178:179], v18 offset:28800
  ds_read_b64_tr_b16 v[184:185], v18 offset:28680
  ds_read_b64_tr_b16 v[186:187], v18 offset:28808
  ds_read_b64_tr_b16 v[180:181], v18 offset:29184
  ds_read_b64_tr_b16 v[182:183], v18 offset:29312
  ds_read_b64_tr_b16 v[188:189], v18 offset:29192
  ds_read_b64_tr_b16 v[190:191], v18 offset:29320
  s_waitcnt lgkmcnt(0)
  s_add_u32 m0, s48, 28672
  s_add_u32 s92, s53, 0x10000
  buffer_load_dwordx4 v16, s[8:11], s92 offen offset:0 lds
  s_add_u32 s92, s53, 0x13c00
  buffer_load_dwordx4 v16, s[8:11], s92 offen offset:1024 lds
  s_add_u32 s92, s53, 0x17800
  buffer_load_dwordx4 v16, s[8:11], s92 offen offset:2048 lds
  s_add_u32 s92, s53, 0x1b400
  buffer_load_dwordx4 v16, s[8:11], s92 offen offset:3072 lds
  s_waitcnt vmcnt(30)
  ds_read_b64_tr_b16 v[24:25], v17 offset:0
  ds_read_b64_tr_b16 v[26:27], v17 offset:128
  ds_read_b64_tr_b16 v[32:33], v17 offset:32
  ds_read_b64_tr_b16 v[34:35], v17 offset:160
  ds_read_b64_tr_b16 v[28:29], v17 offset:2048
  ds_read_b64_tr_b16 v[30:31], v17 offset:2176
  ds_read_b64_tr_b16 v[36:37], v17 offset:2080
  ds_read_b64_tr_b16 v[38:39], v17 offset:2208
  s_waitcnt lgkmcnt(0)
  ds_write_b128 v21, v[24:27] offset:0
  ds_write_b128 v21, v[28:31] offset:1024
  ds_write_b128 v21, v[32:35] offset:2048
  ds_write_b128 v21, v[36:39] offset:3072
  s_waitcnt vmcnt(26)
  ds_read_b64_tr_b16 v[24:25], v17 offset:4096
  ds_read_b64_tr_b16 v[26:27], v17 offset:4224
  ds_read_b64_tr_b16 v[32:33], v17 offset:4128
  ds_read_b64_tr_b16 v[34:35], v17 offset:4256
  ds_read_b64_tr_b16 v[28:29], v17 offset:6144
  ds_read_b64_tr_b16 v[30:31], v17 offset:6272
  ds_read_b64_tr_b16 v[36:37], v17 offset:6176
  ds_read_b64_tr_b16 v[38:39], v17 offset:6304
  s_waitcnt lgkmcnt(0)
  ds_write_b128 v21, v[24:27] offset:4096
  ds_write_b128 v21, v[28:31] offset:5120
  ds_write_b128 v21, v[32:35] offset:6144
  ds_write_b128 v21, v[36:39] offset:7168
  s_waitcnt vmcnt(22)
  ds_read_b64_tr_b16 v[24:25], v17 offset:8192
  ds_read_b64_tr_b16 v[26:27], v17 offset:8320
  ds_read_b64_tr_b16 v[32:33], v17 offset:8224
  ds_read_b64_tr_b16 v[34:35], v17 offset:8352
  ds_read_b64_tr_b16 v[28:29], v17 offset:10240
  ds_read_b64_tr_b16 v[30:31], v17 offset:10368
  ds_read_b64_tr_b16 v[36:37], v17 offset:10272
  ds_read_b64_tr_b16 v[38:39], v17 offset:10400
  s_waitcnt lgkmcnt(0)
  ds_write_b128 v21, v[24:27] offset:8192
  ds_write_b128 v21, v[28:31] offset:9216
  ds_write_b128 v21, v[32:35] offset:10240
  ds_write_b128 v21, v[36:39] offset:11264
  s_waitcnt vmcnt(16)
  ds_read_b64_tr_b16 v[24:25], v17 offset:12288
  ds_read_b64_tr_b16 v[26:27], v17 offset:12416
  ds_read_b64_tr_b16 v[32:33], v17 offset:12320
  ds_read_b64_tr_b16 v[34:35], v17 offset:12448
  ds_read_b64_tr_b16 v[28:29], v17 offset:14336
  ds_read_b64_tr_b16 v[30:31], v17 offset:14464
  ds_read_b64_tr_b16 v[36:37], v17 offset:14368
  ds_read_b64_tr_b16 v[38:39], v17 offset:14496
  s_waitcnt lgkmcnt(0)
  ds_write_b128 v21, v[24:27] offset:12288
  ds_write_b128 v21, v[28:31] offset:13312
  ds_write_b128 v21, v[32:35] offset:14336
  ds_write_b128 v21, v[36:39] offset:15360
  s_waitcnt vmcnt(12)
  ds_read_b64_tr_b16 v[24:25], v17 offset:16384
  ds_read_b64_tr_b16 v[26:27], v17 offset:16512
  ds_read_b64_tr_b16 v[32:33], v17 offset:16416
  ds_read_b64_tr_b16 v[34:35], v17 offset:16544
  ds_read_b64_tr_b16 v[28:29], v17 offset:18432
  ds_read_b64_tr_b16 v[30:31], v17 offset:18560
  ds_read_b64_tr_b16 v[36:37], v17 offset:18464
  ds_read_b64_tr_b16 v[38:39], v17 offset:18592
  s_waitcnt lgkmcnt(0)
  ds_write_b128 v21, v[24:27] offset:16384
  ds_write_b128 v21, v[28:31] offset:17408
  ds_write_b128 v21, v[32:35] offset:18432
  ds_write_b128 v21, v[36:39] offset:19456
  s_waitcnt vmcnt(8)
  ds_read_b64_tr_b16 v[24:25], v17 offset:20480
  ds_read_b64_tr_b16 v[26:27], v17 offset:20608
  ds_read_b64_tr_b16 v[32:33], v17 offset:20512
  ds_read_b64_tr_b16 v[34:35], v17 offset:20640
  ds_read_b64_tr_b16 v[28:29], v17 offset:22528
  ds_read_b64_tr_b16 v[30:31], v17 offset:22656
  ds_read_b64_tr_b16 v[36:37], v17 offset:22560
  ds_read_b64_tr_b16 v[38:39], v17 offset:22688
  s_waitcnt lgkmcnt(0)
  ds_write_b128 v21, v[24:27] offset:20480
  ds_write_b128 v21, v[28:31] offset:21504
  ds_write_b128 v21, v[32:35] offset:22528
  ds_write_b128 v21, v[36:39] offset:23552
  s_waitcnt vmcnt(4)
  ds_read_b64_tr_b16 v[24:25], v18 offset:24576
  ds_read_b64_tr_b16 v[26:27], v18 offset:24704
  ds_read_b64_tr_b16 v[32:33], v18 offset:24584
  ds_read_b64_tr_b16 v[34:35], v18 offset:24712
  ds_read_b64_tr_b16 v[28:29], v18 offset:25088
  ds_read_b64_tr_b16 v[30:31], v18 offset:25216
  ds_read_b64_tr_b16 v[36:37], v18 offset:25096
  ds_read_b64_tr_b16 v[38:39], v18 offset:25224
  s_waitcnt lgkmcnt(0)
  ds_write_b128 v21, v[24:27] offset:24576
  ds_write_b128 v21, v[28:31] offset:25600
  ds_write_b128 v21, v[32:35] offset:26624
  ds_write_b128 v21, v[36:39] offset:27648
  s_waitcnt vmcnt(0)
  ds_read_b64_tr_b16 v[24:25], v18 offset:28672
  ds_read_b64_tr_b16 v[26:27], v18 offset:28800
  ds_read_b64_tr_b16 v[32:33], v18 offset:28680
  ds_read_b64_tr_b16 v[34:35], v18 offset:28808
  ds_read_b64_tr_b16 v[28:29], v18 offset:29184
  ds_read_b64_tr_b16 v[30:31], v18 offset:29312
  ds_read_b64_tr_b16 v[36:37], v18 offset:29192
  ds_read_b64_tr_b16 v[38:39], v18 offset:29320
  s_waitcnt lgkmcnt(0)
  ds_write_b128 v21, v[24:27] offset:28672
  ds_write_b128 v21, v[28:31] offset:29696
  ds_write_b128 v21, v[32:35] offset:30720
  ds_write_b128 v21, v[36:39] offset:31744
  s_waitcnt lgkmcnt(0)
  s_branch cld_9
cl_780:
  s_mov_b32 s72, 147456
  s_mov_b32 s73, 151552
  s_mov_b32 s74, 149504
  s_xor_b32 s75, s51, 1
  s_lshl_b32 s75, s75, 8
  s_add_u32 s75, s75, 128
  v_lshlrev_b32 v40, 13, v0
  v_lshrrev_b32 v21, 4, v0
  v_bfe_u32 v22, v0, 2, 2
  v_and_b32 v23, 3, v0
  v_lshrrev_b32 v24, 1, v21
  v_lshlrev_b32 v17, 4, v24
  v_lshrrev_b32 v24, 1, v22
  v_lshl_add_u32 v17, v24, 3, v17
  v_and_b32 v24, 1, v21
  v_lshl_add_u32 v17, v24, 2, v17
  v_and_b32 v24, 1, v22
  v_add_u32 v17, v17, v24
  v_lshlrev_b32 v17, 6, v17
  v_lshl_add_u32 v17, v23, 3, v17
  v_add_u32 v17, s48, v17
  v_lshrrev_b32 v24, 1, v22
  v_lshlrev_b32 v18, 5, v24
  v_and_b32 v24, 1, v22
  v_add_u32 v18, v18, v24
  v_and_b32 v24, 1, v21
  v_lshl_add_u32 v18, v24, 4, v18
  v_lshrrev_b32 v24, 1, v21
  v_lshl_add_u32 v18, v24, 2, v18
  v_lshlrev_b32 v18, 6, v18
  v_lshl_add_u32 v18, v23, 4, v18
  v_add_u32 v18, s48, v18
  v_add_u32 v21, s48, v1
  s_mov_b32 s8, s20
  s_and_b32 s9, s21, 0xffff
  s_mov_b32 s10, 0x400000
  s_mov_b32 s11, 0x20000
  s_mov_b32 s92, 8192
  v_lshrrev_b32 v16, 2, v0
  v_mul_lo_u32 v16, v16, s92
  v_lshl_add_u32 v16, v23, 4, v16
  s_add_u32 m0, s48, 0
  s_add_u32 s92, s52, 0x100000
  buffer_load_dwordx4 v16, s[8:11], s92 offen offset:0 lds
  s_add_u32 s92, s52, 0x11fc00
  buffer_load_dwordx4 v16, s[8:11], s92 offen offset:1024 lds
  s_add_u32 s92, s52, 0x13f800
  buffer_load_dwordx4 v16, s[8:11], s92 offen offset:2048 lds
  s_add_u32 s92, s52, 0x15f400
  buffer_load_dwordx4 v16, s[8:11], s92 offen offset:3072 lds
  s_add_u32 m0, s48, 4096
  s_add_u32 s92, s52, 0x180000
  buffer_load_dwordx4 v16, s[8:11], s92 offen offset:0 lds
  s_add_u32 s92, s52, 0x19fc00
  buffer_load_dwordx4 v16, s[8:11], s92 offen offset:1024 lds
  s_add_u32 s92, s52, 0x1bf800
  buffer_load_dwordx4 v16, s[8:11], s92 offen offset:2048 lds
  s_add_u32 s92, s52, 0x1df400
  buffer_load_dwordx4 v16, s[8:11], s92 offen offset:3072 lds
  s_add_u32 m0, s48, 8192
  s_add_u32 s92, s52, 0x200000
  buffer_load_dwordx4 v16, s[8:11], s92 offen offset:0 lds
  s_add_u32 s92, s52, 0x21fc00
  buffer_load_dwordx4 v16, s[8:11], s92 offen offset:1024 lds
  s_add_u32 s92, s52, 0x23f800
  buffer_load_dwordx4 v16, s[8:11], s92 offen offset:2048 lds
  s_add_u32 s92, s52, 0x25f400
  buffer_load_dwordx4 v16, s[8:11], s92 offen offset:3072 lds
  s_add_u32 m0, s48, 12288
  s_add_u32 s92, s52, 0x280000
  buffer_load_dwordx4 v16, s[8:11], s92 offen offset:0 lds
  s_add_u32 s92, s52, 0x29fc00
  buffer_load_dwordx4 v16, s[8:11], s92 offen offset:1024 lds
  s_add_u32 s92, s52, 0x2bf800
  buffer_load_dwordx4 v16, s[8:11], s92 offen offset:2048 lds
  s_add_u32 s92, s52, 0x2df400
  buffer_load_dwordx4 v16, s[8:11], s92 offen offset:3072 lds
  s_add_u32 m0, s48, 16384
  s_add_u32 s92, s52, 0x300000
  buffer_load_dwordx4 v16, s[8:11], s92 offen offset:0 lds
  s_add_u32 s92, s52, 0x31fc00
  buffer_load_dwordx4 v16, s[8:11], s92 offen offset:1024 lds
  s_add_u32 s92, s52, 0x33f800
  buffer_load_dwordx4 v16, s[8:11], s92 offen offset:2048 lds
  s_add_u32 s92, s52, 0x35f400
  buffer_load_dwordx4 v16, s[8:11], s92 offen offset:3072 lds
  s_add_u32 m0, s48, 20480
  s_add_u32 s92, s52, 0x380000
  buffer_load_dwordx4 v16, s[8:11], s92 offen offset:0 lds
  s_add_u32 s92, s52, 0x39fc00
  buffer_load_dwordx4 v16, s[8:11], s92 offen offset:1024 lds
  s_add_u32 s92, s52, 0x3bf800
  buffer_load_dwordx4 v16, s[8:11], s92 offen offset:2048 lds
  s_add_u32 s92, s52, 0x3df400
  buffer_load_dwordx4 v16, s[8:11], s92 offen offset:3072 lds
  s_mov_b32 s8, s22
  s_and_b32 s9, s23, 0xffff
  s_mov_b32 s10, 0x400000
  s_mov_b32 s11, 0x20000
  s_add_u32 m0, s48, 24576
  s_add_u32 s92, s52, 0x100000
  buffer_load_dwordx4 v16, s[8:11], s92 offen offset:0 lds
  s_add_u32 s92, s52, 0x11fc00
  buffer_load_dwordx4 v16, s[8:11], s92 offen offset:1024 lds
  s_add_u32 s92, s52, 0x13f800
  buffer_load_dwordx4 v16, s[8:11], s92 offen offset:2048 lds
  s_add_u32 s92, s52, 0x15f400
  buffer_load_dwordx4 v16, s[8:11], s92 offen offset:3072 lds
  s_add_u32 m0, s48, 28672
  s_add_u32 s92, s52, 0x180000
  buffer_load_dwordx4 v16, s[8:11], s92 offen offset:0 lds
  s_add_u32 s92, s52, 0x19fc00
  buffer_load_dwordx4 v16, s[8:11], s92 offen offset:1024 lds
  s_add_u32 s92, s52, 0x1bf800
  buffer_load_dwordx4 v16, s[8:11], s92 offen offset:2048 lds
  s_add_u32 s92, s52, 0x1df400
  buffer_load_dwordx4 v16, s[8:11], s92 offen offset:3072 lds
  s_waitcnt vmcnt(28)
  ds_read_b64_tr_b16 a[32:33], v17 offset:0
  ds_read_b64_tr_b16 a[34:35], v17 offset:128
  ds_read_b64_tr_b16 a[40:41], v17 offset:32
  ds_read_b64_tr_b16 a[42:43], v17 offset:160
  ds_read_b64_tr_b16 a[36:37], v17 offset:2048
  ds_read_b64_tr_b16 a[38:39], v17 offset:2176
  ds_read_b64_tr_b16 a[44:45], v17 offset:2080
  ds_read_b64_tr_b16 a[46:47], v17 offset:2208
  s_waitcnt lgkmcnt(0)
  s_add_u32 m0, s48, 0
  s_add_u32 s92, s52, 0x200000
  buffer_load_dwordx4 v16, s[8:11], s92 offen offset:0 lds
  s_add_u32 s92, s52, 0x21fc00
  buffer_load_dwordx4 v16, s[8:11], s92 offen offset:1024 lds
  s_add_u32 s92, s52, 0x23f800
  buffer_load_dwordx4 v16, s[8:11], s92 offen offset:2048 lds
  s_add_u32 s92, s52, 0x25f400
  buffer_load_dwordx4 v16, s[8:11], s92 offen offset:3072 lds
  s_waitcnt vmcnt(28)
  ds_read_b64_tr_b16 a[48:49], v17 offset:4096
  ds_read_b64_tr_b16 a[50:51], v17 offset:4224
  ds_read_b64_tr_b16 a[56:57], v17 offset:4128
  ds_read_b64_tr_b16 a[58:59], v17 offset:4256
  ds_read_b64_tr_b16 a[52:53], v17 offset:6144
  ds_read_b64_tr_b16 a[54:55], v17 offset:6272
  ds_read_b64_tr_b16 a[60:61], v17 offset:6176
  ds_read_b64_tr_b16 a[62:63], v17 offset:6304
  s_waitcnt lgkmcnt(0)
  s_add_u32 m0, s48, 4096
  s_add_u32 s92, s52, 0x280000
  buffer_load_dwordx4 v16, s[8:11], s92 offen offset:0 lds
  s_add_u32 s92, s52, 0x29fc00
  buffer_load_dwordx4 v16, s[8:11], s92 offen offset:1024 lds
  s_add_u32 s92, s52, 0x2bf800
  buffer_load_dwordx4 v16, s[8:11], s92 offen offset:2048 lds
  s_add_u32 s92, s52, 0x2df400
  buffer_load_dwordx4 v16, s[8:11], s92 offen offset:3072 lds
  s_waitcnt vmcnt(28)
  ds_read_b64_tr_b16 a[0:1], v17 offset:8192
  ds_read_b64_tr_b16 a[2:3], v17 offset:8320
  ds_read_b64_tr_b16 a[8:9], v17 offset:8224
  ds_read_b64_tr_b16 a[10:11], v17 offset:8352
  ds_read_b64_tr_b16 a[4:5], v17 offset:10240
  ds_read_b64_tr_b16 a[6:7], v17 offset:10368
  ds_read_b64_tr_b16 a[12:13], v17 offset:10272
  ds_read_b64_tr_b16 a[14:15], v17 offset:10400
  s_waitcnt lgkmcnt(0)
  s_add_u32 m0, s48, 8192
  s_add_u32 s92, s52, 0x300000
  buffer_load_dwordx4 v16, s[8:11], s92 offen offset:0 lds
  s_add_u32 s92, s52, 0x31fc00
  buffer_load_dwordx4 v16, s[8:11], s92 offen offset:1024 lds
  s_add_u32 s92, s52, 0x33f800
  buffer_load_dwordx4 v16, s[8:11], s92 offen offset:2048 lds
  s_add_u32 s92, s52, 0x35f400
  buffer_load_dwordx4 v16, s[8:11], s92 offen offset:3072 lds
  s_waitcnt vmcnt(28)
  ds_read_b64_tr_b16 a[16:17], v17 offset:12288
  ds_read_b64_tr_b16 a[18:19], v17 offset:12416
  ds_read_b64_tr_b16 a[24:25], v17 offset:12320
  ds_read_b64_tr_b16 a[26:27], v17 offset:12448
  ds_read_b64_tr_b16 a[20:21], v17 offset:14336
  ds_read_b64_tr_b16 a[22:23], v17 offset:14464
  ds_read_b64_tr_b16 a[28:29], v17 offset:14368
  ds_read_b64_tr_b16 a[30:31], v17 offset:14496
  s_waitcnt lgkmcnt(0)
  s_add_u32 m0, s48, 12288
  s_add_u32 s92, s52, 0x380000
  buffer_load_dwordx4 v16, s[8:11], s92 offen offset:0 lds
  s_add_u32 s92, s52, 0x39fc00
  buffer_load_dwordx4 v16, s[8:11], s92 offen offset:1024 lds
  s_add_u32 s92, s52, 0x3bf800
  buffer_load_dwordx4 v16, s[8:11], s92 offen offset:2048 lds
  s_add_u32 s92, s52, 0x3df400
  buffer_load_dwordx4 v16, s[8:11], s92 offen offset:3072 lds
  s_waitcnt vmcnt(28)
  ds_read_b64_tr_b16 a[64:65], v17 offset:16384
  ds_read_b64_tr_b16 a[66:67], v17 offset:16512
  ds_read_b64_tr_b16 a[72:73], v17 offset:16416
  ds_read_b64_tr_b16 a[74:75], v17 offset:16544
  ds_read_b64_tr_b16 a[68:69], v17 offset:18432
  ds_read_b64_tr_b16 a[70:71], v17 offset:18560
  ds_read_b64_tr_b16 a[76:77], v17 offset:18464
  ds_read_b64_tr_b16 a[78:79], v17 offset:18592
  s_waitcnt lgkmcnt(0)
  s_mov_b32 s8, s24
  s_and_b32 s9, s25, 0xffff
  s_mov_b32 s10, 0x400000
  s_mov_b32 s11, 0x20000
  s_add_u32 m0, s48, 16384
  s_add_u32 s92, s52, 0x100000
  buffer_load_dwordx4 v16, s[8:11], s92 offen offset:0 lds
  s_add_u32 s92, s52, 0x11fc00
  buffer_load_dwordx4 v16, s[8:11], s92 offen offset:1024 lds
  s_add_u32 s92, s52, 0x13f800
  buffer_load_dwordx4 v16, s[8:11], s92 offen offset:2048 lds
  s_add_u32 s92, s52, 0x15f400
  buffer_load_dwordx4 v16, s[8:11], s92 offen offset:3072 lds
  s_waitcnt vmcnt(28)
  ds_read_b64_tr_b16 a[80:81], v17 offset:20480
  ds_read_b64_tr_b16 a[82:83], v17 offset:20608
  ds_read_b64_tr_b16 a[88:89], v17 offset:20512
  ds_read_b64_tr_b16 a[90:91], v17 offset:20640
  ds_read_b64_tr_b16 a[84:85], v17 offset:22528
  ds_read_b64_tr_b16 a[86:87], v17 offset:22656
  ds_read_b64_tr_b16 a[92:93], v17 offset:22560
  ds_read_b64_tr_b16 a[94:95], v17 offset:22688
  s_waitcnt lgkmcnt(0)
  s_add_u32 m0, s48, 20480
  s_add_u32 s92, s52, 0x180000
  buffer_load_dwordx4 v16, s[8:11], s92 offen offset:0 lds
  s_add_u32 s92, s52, 0x19fc00
  buffer_load_dwordx4 v16, s[8:11], s92 offen offset:1024 lds
  s_add_u32 s92, s52, 0x1bf800
  buffer_load_dwordx4 v16, s[8:11], s92 offen offset:2048 lds
  s_add_u32 s92, s52, 0x1df400
  buffer_load_dwordx4 v16, s[8:11], s92 offen offset:3072 lds
  s_waitcnt vmcnt(28)
  ds_read_b64_tr_b16 a[128:129], v17 offset:24576
  ds_read_b64_tr_b16 a[130:131], v17 offset:24704
  ds_read_b64_tr_b16 a[136:137], v17 offset:24608
  ds_read_b64_tr_b16 a[138:139], v17 offset:24736
  ds_read_b64_tr_b16 a[132:133], v17 offset:26624
  ds_read_b64_tr_b16 a[134:135], v17 offset:26752
  ds_read_b64_tr_b16 a[140:141], v17 offset:26656
  ds_read_b64_tr_b16 a[142:143], v17 offset:26784
  s_waitcnt lgkmcnt(0)
  s_add_u32 m0, s48, 24576
  s_add_u32 s92, s52, 0x200000
  buffer_load_dwordx4 v16, s[8:11], s92 offen offset:0 lds
  s_add_u32 s92, s52, 0x21fc00
  buffer_load_dwordx4 v16, s[8:11], s92 offen offset:1024 lds
  s_add_u32 s92, s52, 0x23f800
  buffer_load_dwordx4 v16, s[8:11], s92 offen offset:2048 lds
  s_add_u32 s92, s52, 0x25f400
  buffer_load_dwordx4 v16, s[8:11], s92 offen offset:3072 lds
  s_waitcnt vmcnt(28)
  ds_read_b64_tr_b16 a[144:145], v17 offset:28672
  ds_read_b64_tr_b16 a[146:147], v17 offset:28800
  ds_read_b64_tr_b16 a[152:153], v17 offset:28704
  ds_read_b64_tr_b16 a[154:155], v17 offset:28832
  ds_read_b64_tr_b16 a[148:149], v17 offset:30720
  ds_read_b64_tr_b16 a[150:151], v17 offset:30848
  ds_read_b64_tr_b16 a[156:157], v17 offset:30752
  ds_read_b64_tr_b16 a[158:159], v17 offset:30880
  s_waitcnt lgkmcnt(0)
  s_add_u32 m0, s48, 28672
  s_add_u32 s92, s52, 0x280000
  buffer_load_dwordx4 v16, s[8:11], s92 offen offset:0 lds
  s_add_u32 s92, s52, 0x29fc00
  buffer_load_dwordx4 v16, s[8:11], s92 offen offset:1024 lds
  s_add_u32 s92, s52, 0x2bf800
  buffer_load_dwordx4 v16, s[8:11], s92 offen offset:2048 lds
  s_add_u32 s92, s52, 0x2df400
  buffer_load_dwordx4 v16, s[8:11], s92 offen offset:3072 lds
  s_waitcnt vmcnt(28)
  ds_read_b64_tr_b16 a[96:97], v17 offset:0
  ds_read_b64_tr_b16 a[98:99], v17 offset:128
  ds_read_b64_tr_b16 a[104:105], v17 offset:32
  ds_read_b64_tr_b16 a[106:107], v17 offset:160
  ds_read_b64_tr_b16 a[100:101], v17 offset:2048
  ds_read_b64_tr_b16 a[102:103], v17 offset:2176
  ds_read_b64_tr_b16 a[108:109], v17 offset:2080
  ds_read_b64_tr_b16 a[110:111], v17 offset:2208
  s_waitcnt lgkmcnt(0)
  s_add_u32 m0, s48, 0
  s_add_u32 s92, s52, 0x300000
  buffer_load_dwordx4 v16, s[8:11], s92 offen offset:0 lds
  s_add_u32 s92, s52, 0x31fc00
  buffer_load_dwordx4 v16, s[8:11], s92 offen offset:1024 lds
  s_add_u32 s92, s52, 0x33f800
  buffer_load_dwordx4 v16, s[8:11], s92 offen offset:2048 lds
  s_add_u32 s92, s52, 0x35f400
  buffer_load_dwordx4 v16, s[8:11], s92 offen offset:3072 lds
  s_waitcnt vmcnt(28)
  ds_read_b64_tr_b16 a[112:113], v17 offset:4096
  ds_read_b64_tr_b16 a[114:115], v17 offset:4224
  ds_read_b64_tr_b16 a[120:121], v17 offset:4128
  ds_read_b64_tr_b16 a[122:123], v17 offset:4256
  ds_read_b64_tr_b16 a[116:117], v17 offset:6144
  ds_read_b64_tr_b16 a[118:119], v17 offset:6272
  ds_read_b64_tr_b16 a[124:125], v17 offset:6176
  ds_read_b64_tr_b16 a[126:127], v17 offset:6304
  s_waitcnt lgkmcnt(0)
  s_add_u32 m0, s48, 4096
  s_add_u32 s92, s52, 0x380000
  buffer_load_dwordx4 v16, s[8:11], s92 offen offset:0 lds
  s_add_u32 s92, s52, 0x39fc00
  buffer_load_dwordx4 v16, s[8:11], s92 offen offset:1024 lds
  s_add_u32 s92, s52, 0x3bf800
  buffer_load_dwordx4 v16, s[8:11], s92 offen offset:2048 lds
  s_add_u32 s92, s52, 0x3df400
  buffer_load_dwordx4 v16, s[8:11], s92 offen offset:3072 lds
  s_waitcnt vmcnt(28)
  ds_read_b64_tr_b16 a[160:161], v17 offset:8192
  ds_read_b64_tr_b16 a[162:163], v17 offset:8320
  ds_read_b64_tr_b16 a[168:169], v17 offset:8224
  ds_read_b64_tr_b16 a[170:171], v17 offset:8352
  ds_read_b64_tr_b16 a[164:165], v17 offset:10240
  ds_read_b64_tr_b16 a[166:167], v17 offset:10368
  ds_read_b64_tr_b16 a[172:173], v17 offset:10272
  ds_read_b64_tr_b16 a[174:175], v17 offset:10400
  s_waitcnt lgkmcnt(0)
  s_mov_b32 s8, s26
  s_and_b32 s9, s27, 0xffff
  s_mov_b32 s10, 0x400000
  s_mov_b32 s11, 0x20000
  s_mov_b32 s92, 1024
  v_lshrrev_b32 v16, 2, v0
  v_mul_lo_u32 v16, v16, s92
  v_lshl_add_u32 v16, v23, 4, v16
  s_add_u32 m0, s48, 8192
  s_add_u32 s92, s53, 0x80
  buffer_load_dwordx4 v16, s[8:11], s92 offen offset:0 lds
  s_add_u32 s92, s53, 0x3c80
  buffer_load_dwordx4 v16, s[8:11], s92 offen offset:1024 lds
  s_add_u32 s92, s53, 0x7880
  buffer_load_dwordx4 v16, s[8:11], s92 offen offset:2048 lds
  s_add_u32 s92, s53, 0xb480
  buffer_load_dwordx4 v16, s[8:11], s92 offen offset:3072 lds
  s_waitcnt vmcnt(28)
  ds_read_b64_tr_b16 a[176:177], v17 offset:12288
  ds_read_b64_tr_b16 a[178:179], v17 offset:12416
  ds_read_b64_tr_b16 a[184:185], v17 offset:12320
  ds_read_b64_tr_b16 a[186:187], v17 offset:12448
  ds_read_b64_tr_b16 a[180:181], v17 offset:14336
  ds_read_b64_tr_b16 a[182:183], v17 offset:14464
  ds_read_b64_tr_b16 a[188:189], v17 offset:14368
  ds_read_b64_tr_b16 a[190:191], v17 offset:14496
  s_waitcnt lgkmcnt(0)
  s_add_u32 m0, s48, 12288
  s_add_u32 s92, s53, 0xc0
  buffer_load_dwordx4 v16, s[8:11], s92 offen offset:0 lds
  s_add_u32 s92, s53, 0x3cc0
  buffer_load_dwordx4 v16, s[8:11], s92 offen offset:1024 lds
  s_add_u32 s92, s53, 0x78c0
  buffer_load_dwordx4 v16, s[8:11], s92 offen offset:2048 lds
  s_add_u32 s92, s53, 0xb4c0
  buffer_load_dwordx4 v16, s[8:11], s92 offen offset:3072 lds
  s_waitcnt vmcnt(28)
  ds_read_b64_tr_b16 a[224:225], v17 offset:16384
  ds_read_b64_tr_b16 a[226:227], v17 offset:16512
  ds_read_b64_tr_b16 a[232:233], v17 offset:16416
  ds_read_b64_tr_b16 a[234:235], v17 offset:16544
  ds_read_b64_tr_b16 a[228:229], v17 offset:18432
  ds_read_b64_tr_b16 a[230:231], v17 offset:18560
  ds_read_b64_tr_b16 a[236:237], v17 offset:18464
  ds_read_b64_tr_b16 a[238:239], v17 offset:18592
  s_waitcnt lgkmcnt(0)
  s_add_u32 m0, s48, 16384
  s_add_u32 s92, s53, 0x10080
  buffer_load_dwordx4 v16, s[8:11], s92 offen offset:0 lds
  s_add_u32 s92, s53, 0x13c80
  buffer_load_dwordx4 v16, s[8:11], s92 offen offset:1024 lds
  s_add_u32 s92, s53, 0x17880
  buffer_load_dwordx4 v16, s[8:11], s92 offen offset:2048 lds
  s_add_u32 s92, s53, 0x1b480
  buffer_load_dwordx4 v16, s[8:11], s92 offen offset:3072 lds
  s_waitcnt vmcnt(28)
  ds_read_b64_tr_b16 a[240:241], v17 offset:20480
  ds_read_b64_tr_b16 a[242:243], v17 offset:20608
  ds_read_b64_tr_b16 a[248:249], v17 offset:20512
  ds_read_b64_tr_b16 a[250:251], v17 offset:20640
  ds_read_b64_tr_b16 a[244:245], v17 offset:22528
  ds_read_b64_tr_b16 a[246:247], v17 offset:22656
  ds_read_b64_tr_b16 a[252:253], v17 offset:22560
  ds_read_b64_tr_b16 a[254:255], v17 offset:22688
  s_waitcnt lgkmcnt(0)
  s_add_u32 m0, s48, 20480
  s_add_u32 s92, s53, 0x100c0
  buffer_load_dwordx4 v16, s[8:11], s92 offen offset:0 lds
  s_add_u32 s92, s53, 0x13cc0
  buffer_load_dwordx4 v16, s[8:11], s92 offen offset:1024 lds
  s_add_u32 s92, s53, 0x178c0
  buffer_load_dwordx4 v16, s[8:11], s92 offen offset:2048 lds
  s_add_u32 s92, s53, 0x1b4c0
  buffer_load_dwordx4 v16, s[8:11], s92 offen offset:3072 lds
  s_waitcnt vmcnt(28)
  ds_read_b64_tr_b16 a[192:193], v17 offset:24576
  ds_read_b64_tr_b16 a[194:195], v17 offset:24704
  ds_read_b64_tr_b16 a[200:201], v17 offset:24608
  ds_read_b64_tr_b16 a[202:203], v17 offset:24736
  ds_read_b64_tr_b16 a[196:197], v17 offset:26624
  ds_read_b64_tr_b16 a[198:199], v17 offset:26752
  ds_read_b64_tr_b16 a[204:205], v17 offset:26656
  ds_read_b64_tr_b16 a[206:207], v17 offset:26784
  s_waitcnt lgkmcnt(0)
  s_add_u32 m0, s48, 24576
  s_add_u32 s92, s53, 0x40
  buffer_load_dwordx4 v16, s[8:11], s92 offen offset:0 lds
  s_add_u32 s92, s53, 0x3c40
  buffer_load_dwordx4 v16, s[8:11], s92 offen offset:1024 lds
  s_add_u32 s92, s53, 0x7840
  buffer_load_dwordx4 v16, s[8:11], s92 offen offset:2048 lds
  s_add_u32 s92, s53, 0xb440
  buffer_load_dwordx4 v16, s[8:11], s92 offen offset:3072 lds
  s_waitcnt vmcnt(28)
  ds_read_b64_tr_b16 a[208:209], v17 offset:28672
  ds_read_b64_tr_b16 a[210:211], v17 offset:28800
  ds_read_b64_tr_b16 a[216:217], v17 offset:28704
  ds_read_b64_tr_b16 a[218:219], v17 offset:28832
  ds_read_b64_tr_b16 a[212:213], v17 offset:30720
  ds_read_b64_tr_b16 a[214:215], v17 offset:30848
  ds_read_b64_tr_b16 a[220:221], v17 offset:30752
  ds_read_b64_tr_b16 a[222:223], v17 offset:30880
  s_waitcnt lgkmcnt(0)
  s_add_u32 m0, s48, 28672
  s_add_u32 s92, s53, 0x10040
  buffer_load_dwordx4 v16, s[8:11], s92 offen offset:0 lds
  s_add_u32 s92, s53, 0x13c40
  buffer_load_dwordx4 v16, s[8:11], s92 offen offset:1024 lds
  s_add_u32 s92, s53, 0x17840
  buffer_load_dwordx4 v16, s[8:11], s92 offen offset:2048 lds
  s_add_u32 s92, s53, 0x1b440
  buffer_load_dwordx4 v16, s[8:11], s92 offen offset:3072 lds
  s_waitcnt vmcnt(28)
  ds_read_b64_tr_b16 v[128:129], v17 offset:0
  ds_read_b64_tr_b16 v[130:131], v17 offset:128
  ds_read_b64_tr_b16 v[136:137], v17 offset:32
  ds_read_b64_tr_b16 v[138:139], v17 offset:160
  ds_read_b64_tr_b16 v[132:133], v17 offset:2048
  ds_read_b64_tr_b16 v[134:135], v17 offset:2176
  ds_read_b64_tr_b16 v[140:141], v17 offset:2080
  ds_read_b64_tr_b16 v[142:143], v17 offset:2208
  s_waitcnt lgkmcnt(0)
  s_mov_b32 s8, s20
  s_and_b32 s9, s21, 0xffff
  s_mov_b32 s10, 0x400000
  s_mov_b32 s11, 0x20000
  s_mov_b32 s92, 8192
  v_lshrrev_b32 v16, 2, v0
  v_mul_lo_u32 v16, v16, s92
  v_lshl_add_u32 v16, v23, 4, v16
  s_add_u32 m0, s48, 0
  s_add_u32 s92, s52, 0x0
  buffer_load_dwordx4 v16, s[8:11], s92 offen offset:0 lds
  s_add_u32 s92, s52, 0x1fc00
  buffer_load_dwordx4 v16, s[8:11], s92 offen offset:1024 lds
  s_add_u32 s92, s52, 0x3f800
  buffer_load_dwordx4 v16, s[8:11], s92 offen offset:2048 lds
  s_add_u32 s92, s52, 0x5f400
  buffer_load_dwordx4 v16, s[8:11], s92 offen offset:3072 lds
  s_waitcnt vmcnt(28)
  ds_read_b64_tr_b16 v[144:145], v17 offset:4096
  ds_read_b64_tr_b16 v[146:147], v17 offset:4224
  ds_read_b64_tr_b16 v[152:153], v17 offset:4128
  ds_read_b64_tr_b16 v[154:155], v17 offset:4256
  ds_read_b64_tr_b16 v[148:149], v17 offset:6144
  ds_read_b64_tr_b16 v[150:151], v17 offset:6272
  ds_read_b64_tr_b16 v[156:157], v17 offset:6176
  ds_read_b64_tr_b16 v[158:159], v17 offset:6304
  s_waitcnt lgkmcnt(0)
  s_add_u32 m0, s48, 4096
  s_add_u32 s92, s52, 0x80000
  buffer_load_dwordx4 v16, s[8:11], s92 offen offset:0 lds
  s_add_u32 s92, s52, 0x9fc00
  buffer_load_dwordx4 v16, s[8:11], s92 offen offset:1024 lds
  s_add_u32 s92, s52, 0xbf800
  buffer_load_dwordx4 v16, s[8:11], s92 offen offset:2048 lds
  s_add_u32 s92, s52, 0xdf400
  buffer_load_dwordx4 v16, s[8:11], s92 offen offset:3072 lds
  s_waitcnt vmcnt(28)
  ds_read_b64_tr_b16 v[192:193], v18 offset:8192
  ds_read_b64_tr_b16 v[194:195], v18 offset:8320
  ds_read_b64_tr_b16 v[200:201], v18 offset:8200
  ds_read_b64_tr_b16 v[202:203], v18 offset:8328
  ds_read_b64_tr_b16 v[196:197], v18 offset:8704
  ds_read_b64_tr_b16 v[198:199], v18 offset:8832
  ds_read_b64_tr_b16 v[204:205], v18 offset:8712
  ds_read_b64_tr_b16 v[206:207], v18 offset:8840
  s_waitcnt lgkmcnt(0)
  s_mov_b32 s8, s22
  s_and_b32 s9, s23, 0xffff
  s_mov_b32 s10, 0x400000
  s_mov_b32 s11, 0x20000
  s_add_u32 m0, s48, 8192
  s_add_u32 s92, s52, 0x0
  buffer_load_dwordx4 v16, s[8:11], s92 offen offset:0 lds
  s_add_u32 s92, s52, 0x1fc00
  buffer_load_dwordx4 v16, s[8:11], s92 offen offset:1024 lds
  s_add_u32 s92, s52, 0x3f800
  buffer_load_dwordx4 v16, s[8:11], s92 offen offset:2048 lds
  s_add_u32 s92, s52, 0x5f400
  buffer_load_dwordx4 v16, s[8:11], s92 offen offset:3072 lds
  buffer_load_dword v42, v43, s[12:15], 0 offen sc1
  buffer_load_dwordx2 v[44:45], v46, s[76:79], s80 offen
  s_waitcnt vmcnt(30)
  ds_read_b64_tr_b16 v[224:225], v18 offset:12288
  ds_read_b64_tr_b16 v[226:227], v18 offset:12416
  ds_read_b64_tr_b16 v[232:233], v18 offset:12296
  ds_read_b64_tr_b16 v[234:235], v18 offset:12424
  ds_read_b64_tr_b16 v[228:229], v18 offset:12800
  ds_read_b64_tr_b16 v[230:231], v18 offset:12928
  ds_read_b64_tr_b16 v[236:237], v18 offset:12808
  ds_read_b64_tr_b16 v[238:239], v18 offset:12936
  s_waitcnt lgkmcnt(0)
  s_add_u32 m0, s48, 12288
  s_add_u32 s92, s52, 0x80000
  buffer_load_dwordx4 v16, s[8:11], s92 offen offset:0 lds
  s_add_u32 s92, s52, 0x9fc00
  buffer_load_dwordx4 v16, s[8:11], s92 offen offset:1024 lds
  s_add_u32 s92, s52, 0xbf800
  buffer_load_dwordx4 v16, s[8:11], s92 offen offset:2048 lds
  s_add_u32 s92, s52, 0xdf400
  buffer_load_dwordx4 v16, s[8:11], s92 offen offset:3072 lds
  s_waitcnt vmcnt(30)
  ds_read_b64_tr_b16 v[208:209], v18 offset:16384
  ds_read_b64_tr_b16 v[210:211], v18 offset:16512
  ds_read_b64_tr_b16 v[216:217], v18 offset:16392
  ds_read_b64_tr_b16 v[218:219], v18 offset:16520
  ds_read_b64_tr_b16 v[212:213], v18 offset:16896
  ds_read_b64_tr_b16 v[214:215], v18 offset:17024
  ds_read_b64_tr_b16 v[220:221], v18 offset:16904
  ds_read_b64_tr_b16 v[222:223], v18 offset:17032
  s_waitcnt lgkmcnt(0)
  s_mov_b32 s8, s24
  s_and_b32 s9, s25, 0xffff
  s_mov_b32 s10, 0x400000
  s_mov_b32 s11, 0x20000
  s_add_u32 m0, s48, 16384
  s_add_u32 s92, s52, 0x0
  buffer_load_dwordx4 v16, s[8:11], s92 offen offset:0 lds
  s_add_u32 s92, s52, 0x1fc00
  buffer_load_dwordx4 v16, s[8:11], s92 offen offset:1024 lds
  s_add_u32 s92, s52, 0x3f800
  buffer_load_dwordx4 v16, s[8:11], s92 offen offset:2048 lds
  s_add_u32 s92, s52, 0x5f400
  buffer_load_dwordx4 v16, s[8:11], s92 offen offset:3072 lds
  s_waitcnt vmcnt(30)
  ds_read_b64_tr_b16 v[240:241], v18 offset:20480
  ds_read_b64_tr_b16 v[242:243], v18 offset:20608
  ds_read_b64_tr_b16 v[248:249], v18 offset:20488
  ds_read_b64_tr_b16 v[250:251], v18 offset:20616
  ds_read_b64_tr_b16 v[244:245], v18 offset:20992
  ds_read_b64_tr_b16 v[246:247], v18 offset:21120
  ds_read_b64_tr_b16 v[252:253], v18 offset:21000
  ds_read_b64_tr_b16 v[254:255], v18 offset:21128
  s_waitcnt lgkmcnt(0)
  s_add_u32 m0, s48, 20480
  s_add_u32 s92, s52, 0x80000
  buffer_load_dwordx4 v16, s[8:11], s92 offen offset:0 lds
  s_add_u32 s92, s52, 0x9fc00
  buffer_load_dwordx4 v16, s[8:11], s92 offen offset:1024 lds
  s_add_u32 s92, s52, 0xbf800
  buffer_load_dwordx4 v16, s[8:11], s92 offen offset:2048 lds
  s_add_u32 s92, s52, 0xdf400
  buffer_load_dwordx4 v16, s[8:11], s92 offen offset:3072 lds
  s_waitcnt vmcnt(30)
  ds_read_b64_tr_b16 v[160:161], v18 offset:24576
  ds_read_b64_tr_b16 v[162:163], v18 offset:24704
  ds_read_b64_tr_b16 v[168:169], v18 offset:24584
  ds_read_b64_tr_b16 v[170:171], v18 offset:24712
  ds_read_b64_tr_b16 v[164:165], v18 offset:25088
  ds_read_b64_tr_b16 v[166:167], v18 offset:25216
  ds_read_b64_tr_b16 v[172:173], v18 offset:25096
  ds_read_b64_tr_b16 v[174:175], v18 offset:25224
  s_waitcnt lgkmcnt(0)
  s_mov_b32 s8, s26
  s_and_b32 s9, s27, 0xffff
  s_mov_b32 s10, 0x400000
  s_mov_b32 s11, 0x20000
  s_mov_b32 s92, 1024
  v_lshrrev_b32 v16, 2, v0
  v_mul_lo_u32 v16, v16, s92
  v_lshl_add_u32 v16, v23, 4, v16
  s_add_u32 m0, s48, 24576
  s_add_u32 s92, s53, 0x0
  buffer_load_dwordx4 v16, s[8:11], s92 offen offset:0 lds
  s_add_u32 s92, s53, 0x3c00
  buffer_load_dwordx4 v16, s[8:11], s92 offen offset:1024 lds
  s_add_u32 s92, s53, 0x7800
  buffer_load_dwordx4 v16, s[8:11], s92 offen offset:2048 lds
  s_add_u32 s92, s53, 0xb400
  buffer_load_dwordx4 v16, s[8:11], s92 offen offset:3072 lds
  s_waitcnt vmcnt(30)
  ds_read_b64_tr_b16 v[176:177], v18 offset:28672
  ds_read_b64_tr_b16 v[178:179], v18 offset:28800
  ds_read_b64_tr_b16 v[184:185], v18 offset:28680
  ds_read_b64_tr_b16 v[186:187], v18 offset:28808
  ds_read_b64_tr_b16 v[180:181], v18 offset:29184
  ds_read_b64_tr_b16 v[182:183], v18 offset:29312
  ds_read_b64_tr_b16 v[188:189], v18 offset:29192
  ds_read_b64_tr_b16 v[190:191], v18 offset:29320
  s_waitcnt lgkmcnt(0)
  s_add_u32 m0, s48, 28672
  s_add_u32 s92, s53, 0x10000
  buffer_load_dwordx4 v16, s[8:11], s92 offen offset:0 lds
  s_add_u32 s92, s53, 0x13c00
  buffer_load_dwordx4 v16, s[8:11], s92 offen offset:1024 lds
  s_add_u32 s92, s53, 0x17800
  buffer_load_dwordx4 v16, s[8:11], s92 offen offset:2048 lds
  s_add_u32 s92, s53, 0x1b400
  buffer_load_dwordx4 v16, s[8:11], s92 offen offset:3072 lds
  s_waitcnt vmcnt(30)
  ds_read_b64_tr_b16 v[24:25], v17 offset:0
  ds_read_b64_tr_b16 v[26:27], v17 offset:128
  ds_read_b64_tr_b16 v[32:33], v17 offset:32
  ds_read_b64_tr_b16 v[34:35], v17 offset:160
  ds_read_b64_tr_b16 v[28:29], v17 offset:2048
  ds_read_b64_tr_b16 v[30:31], v17 offset:2176
  ds_read_b64_tr_b16 v[36:37], v17 offset:2080
  ds_read_b64_tr_b16 v[38:39], v17 offset:2208
  s_waitcnt lgkmcnt(0)
  ds_write_b128 v21, v[24:27] offset:0
  ds_write_b128 v21, v[28:31] offset:1024
  ds_write_b128 v21, v[32:35] offset:2048
  ds_write_b128 v21, v[36:39] offset:3072
  s_waitcnt vmcnt(26)
  ds_read_b64_tr_b16 v[24:25], v17 offset:4096
  ds_read_b64_tr_b16 v[26:27], v17 offset:4224
  ds_read_b64_tr_b16 v[32:33], v17 offset:4128
  ds_read_b64_tr_b16 v[34:35], v17 offset:4256
  ds_read_b64_tr_b16 v[28:29], v17 offset:6144
  ds_read_b64_tr_b16 v[30:31], v17 offset:6272
  ds_read_b64_tr_b16 v[36:37], v17 offset:6176
  ds_read_b64_tr_b16 v[38:39], v17 offset:6304
  s_waitcnt lgkmcnt(0)
  ds_write_b128 v21, v[24:27] offset:4096
  ds_write_b128 v21, v[28:31] offset:5120
  ds_write_b128 v21, v[32:35] offset:6144
  ds_write_b128 v21, v[36:39] offset:7168
  s_waitcnt vmcnt(22)
  ds_read_b64_tr_b16 v[24:25], v17 offset:8192
  ds_read_b64_tr_b16 v[26:27], v17 offset:8320
  ds_read_b64_tr_b16 v[32:33], v17 offset:8224
  ds_read_b64_tr_b16 v[34:35], v17 offset:8352
  ds_read_b64_tr_b16 v[28:29], v17 offset:10240
  ds_read_b64_tr_b16 v[30:31], v17 offset:10368
  ds_read_b64_tr_b16 v[36:37], v17 offset:10272
  ds_read_b64_tr_b16 v[38:39], v17 offset:10400
  s_waitcnt lgkmcnt(0)
  ds_write_b128 v21, v[24:27] offset:8192
  ds_write_b128 v21, v[28:31] offset:9216
  ds_write_b128 v21, v[32:35] offset:10240
  ds_write_b128 v21, v[36:39] offset:11264
  s_waitcnt vmcnt(16)
  ds_read_b64_tr_b16 v[24:25], v17 offset:12288
  ds_read_b64_tr_b16 v[26:27], v17 offset:12416
  ds_read_b64_tr_b16 v[32:33], v17 offset:12320
  ds_read_b64_tr_b16 v[34:35], v17 offset:12448
  ds_read_b64_tr_b16 v[28:29], v17 offset:14336
  ds_read_b64_tr_b16 v[30:31], v17 offset:14464
  ds_read_b64_tr_b16 v[36:37], v17 offset:14368
  ds_read_b64_tr_b16 v[38:39], v17 offset:14496
  s_waitcnt lgkmcnt(0)
  ds_write_b128 v21, v[24:27] offset:12288
  ds_write_b128 v21, v[28:31] offset:13312
  ds_write_b128 v21, v[32:35] offset:14336
  ds_write_b128 v21, v[36:39] offset:15360
  s_waitcnt vmcnt(12)
  ds_read_b64_tr_b16 v[24:25], v17 offset:16384
  ds_read_b64_tr_b16 v[26:27], v17 offset:16512
  ds_read_b64_tr_b16 v[32:33], v17 offset:16416
  ds_read_b64_tr_b16 v[34:35], v17 offset:16544
  ds_read_b64_tr_b16 v[28:29], v17 offset:18432
  ds_read_b64_tr_b16 v[30:31], v17 offset:18560
  ds_read_b64_tr_b16 v[36:37], v17 offset:18464
  ds_read_b64_tr_b16 v[38:39], v17 offset:18592
  s_waitcnt lgkmcnt(0)
  ds_write_b128 v21, v[24:27] offset:16384
  ds_write_b128 v21, v[28:31] offset:17408
  ds_write_b128 v21, v[32:35] offset:18432
  ds_write_b128 v21, v[36:39] offset:19456
  s_waitcnt vmcnt(8)
  ds_read_b64_tr_b16 v[24:25], v17 offset:20480
  ds_read_b64_tr_b16 v[26:27], v17 offset:20608
  ds_read_b64_tr_b16 v[32:33], v17 offset:20512
  ds_read_b64_tr_b16 v[34:35], v17 offset:20640
  ds_read_b64_tr_b16 v[28:29], v17 offset:22528
  ds_read_b64_tr_b16 v[30:31], v17 offset:22656
  ds_read_b64_tr_b16 v[36:37], v17 offset:22560
  ds_read_b64_tr_b16 v[38:39], v17 offset:22688
  s_waitcnt lgkmcnt(0)
  ds_write_b128 v21, v[24:27] offset:20480
  ds_write_b128 v21, v[28:31] offset:21504
  ds_write_b128 v21, v[32:35] offset:22528
  ds_write_b128 v21, v[36:39] offset:23552
  s_waitcnt vmcnt(4)
  ds_read_b64_tr_b16 v[24:25], v18 offset:24576
  ds_read_b64_tr_b16 v[26:27], v18 offset:24704
  ds_read_b64_tr_b16 v[32:33], v18 offset:24584
  ds_read_b64_tr_b16 v[34:35], v18 offset:24712
  ds_read_b64_tr_b16 v[28:29], v18 offset:25088
  ds_read_b64_tr_b16 v[30:31], v18 offset:25216
  ds_read_b64_tr_b16 v[36:37], v18 offset:25096
  ds_read_b64_tr_b16 v[38:39], v18 offset:25224
  s_waitcnt lgkmcnt(0)
  ds_write_b128 v21, v[24:27] offset:24576
  ds_write_b128 v21, v[28:31] offset:25600
  ds_write_b128 v21, v[32:35] offset:26624
  ds_write_b128 v21, v[36:39] offset:27648
  s_waitcnt vmcnt(0)
  ds_read_b64_tr_b16 v[24:25], v18 offset:28672
  ds_read_b64_tr_b16 v[26:27], v18 offset:28800
  ds_read_b64_tr_b16 v[32:33], v18 offset:28680
  ds_read_b64_tr_b16 v[34:35], v18 offset:28808
  ds_read_b64_tr_b16 v[28:29], v18 offset:29184
  ds_read_b64_tr_b16 v[30:31], v18 offset:29312
  ds_read_b64_tr_b16 v[36:37], v18 offset:29192
  ds_read_b64_tr_b16 v[38:39], v18 offset:29320
  s_waitcnt lgkmcnt(0)
  ds_write_b128 v21, v[24:27] offset:28672
  ds_write_b128 v21, v[28:31] offset:29696
  ds_write_b128 v21, v[32:35] offset:30720
  ds_write_b128 v21, v[36:39] offset:31744
  s_waitcnt lgkmcnt(0)
cld_9:
  v_add_u32 v10, s72, v1
  v_add_u32 v13, s73, v1
  v_add_u32 v15, s74, v1
  v_cmp_eq_u32 vcc, 32, v42
  s_nop 0
  s_and_b32 s92, vcc_lo, 0xff
  s_lshl_b32 s93, s44, 2
  s_add_u32 s93, s93, 163360
  v_mov_b32 v2, s93
  v_mov_b32 v3, s92
  ds_write_b32 v2, v3
  v_mov_b32 v2, 163360
  s_waitcnt lgkmcnt(0)
  s_barrier
  ds_read_b128 v[4:7], v2
  s_waitcnt lgkmcnt(0)
  v_max3_u32 v4, v4, v5, v6
  v_max_u32 v4, v4, v7
  s_nop 0
  v_readfirstlane_b32 s92, v4
  s_nop 0
  s_cmp_eq_u32 s92, 0xff
  s_cbranch_scc1 cf_1550
  s_cmp_lg_u32 s46, 0
  s_cbranch_scc1 cen_1551
  v_mov_b32 v4, 163328
  s_cmp_lg_u32 s44, 0
  s_cbranch_scc1 cen_1552
  v_min_u32 v5, 9, v0
  v_lshlrev_b32 v5, 3, v5
  s_mov_b32 s92, 128
  v_writelane_b32 v5, s92, 0
cen_1553:
  buffer_load_dword v2, v5, s[12:15], 0 offen sc1
  s_mov_b32 s92, 0
  s_waitcnt vmcnt(0)
  v_readlane_b32 s93, v2, 0
  s_nop 0
  s_add_u32 s92, s92, s93
  v_readlane_b32 s93, v2, 1
  s_nop 0
  s_add_u32 s92, s92, s93
  v_readlane_b32 s93, v2, 2
  s_nop 0
  s_add_u32 s92, s92, s93
  v_readlane_b32 s93, v2, 3
  s_nop 0
  s_add_u32 s92, s92, s93
  v_readlane_b32 s93, v2, 4
  s_nop 0
  s_add_u32 s92, s92, s93
  v_readlane_b32 s93, v2, 5
  s_nop 0
  s_add_u32 s92, s92, s93
  v_readlane_b32 s93, v2, 6
  s_nop 0
  s_add_u32 s92, s92, s93
  v_readlane_b32 s93, v2, 7
  s_nop 0
  s_add_u32 s92, s92, s93
  v_readlane_b32 s93, v2, 8
  s_nop 0
  s_add_u32 s92, s92, s93
  s_cmp_eq_u32 s92, 256
  s_cbranch_scc1 cen_1554
  s_add_u32 s47, s47, 1
  s_mov_b32 s49, 1
  s_cmp_gt_u32 s47, 131072
  s_cbranch_scc1 TIMEOUT
  s_sleep 4
  s_branch cen_1553
cen_1554:
  v_cmp_ne_u32 vcc, 32, v2
  ds_read2_b32 v[6:7], v4 offset0:0 offset1:1
  s_and_b32 s94, vcc_lo, 0xff
  s_waitcnt lgkmcnt(0)
  v_readfirstlane_b32 s92, v6
  v_readfirstlane_b32 s95, v7
  v_readlane_b32 s93, v2, 0
  s_cmp_gt_u32 s95, 0
  s_cselect_b32 s93, s93, 0
  s_add_u32 s92, s92, s93
  v_readlane_b32 s93, v2, 1
  s_cmp_gt_u32 s95, 1
  s_cselect_b32 s93, s93, 0
  s_add_u32 s92, s92, s93
  v_readlane_b32 s93, v2, 2
  s_cmp_gt_u32 s95, 2
  s_cselect_b32 s93, s93, 0
  s_add_u32 s92, s92, s93
  v_readlane_b32 s93, v2, 3
  s_cmp_gt_u32 s95, 3
  s_cselect_b32 s93, s93, 0
  s_add_u32 s92, s92, s93
  v_readlane_b32 s93, v2, 4
  s_cmp_gt_u32 s95, 4
  s_cselect_b32 s93, s93, 0
  s_add_u32 s92, s92, s93
  v_readlane_b32 s93, v2, 5
  s_cmp_gt_u32 s95, 5
  s_cselect_b32 s93, s93, 0
  s_add_u32 s92, s92, s93
  v_readlane_b32 s93, v2, 6
  s_cmp_gt_u32 s95, 6
  s_cselect_b32 s93, s93, 0
  s_add_u32 s92, s92, s93
  v_readlane_b32 s93, v2, 7
  s_cmp_gt_u32 s95, 7
  s_cselect_b32 s93, s93, 0
  s_add_u32 s92, s92, s93
  v_mov_b32 v2, s92
  v_mov_b32 v3, s94
  ds_write2_b32 v4, v2, v3 offset0:2 offset1:3
cen_1552:
  s_waitcnt lgkmcnt(0)
  s_barrier
  ds_read2_b32 v[2:3], v4 offset0:2 offset1:3
  s_waitcnt lgkmcnt(0)
  v_readfirstlane_b32 s92, v2
  v_readfirstlane_b32 s93, v3
  s_nop 0
  s_cmp_eq_u32 s93, 0
  s_cbranch_scc1 cen_1551
  s_mov_b32 s46, 1
  s_mov_b32 s45, s92
  s_branch DISPATCH
cen_1551:
cf_1550:
  v_and_b32 v120, 15, v0
  v_lshrrev_b32 v121, 4, v0
  v_cmp_gt_u32 s[68:69], 8, v120
  s_mov_b32 s66, 0xcccccccc
  s_mov_b32 s67, 0xcccccccc
  v_mov_b32 v122, 0xeeee
  v_mov_b32 v123, 0x4444
  v_cndmask_b32 v2, v123, v122, s[66:67]
  v_add_u32 v3, s48, v1
  s_lshl_b32 s74, s44, 11
  s_lshl_b32 s75, s44, 10
  v_lshlrev_b32 v122, 5, v120
  v_lshl_add_u32 v122, v121, 3, v122
  s_add_u32 s92, s75, 155648
  v_add_u32 v4, s92, v122
  v_bfe_u32 v122, v0, 2, 2
  v_lshl_add_u32 v122, v121, 3, v122
  v_lshlrev_b32 v122, 5, v122
  v_and_b32 v123, 3, v0
  v_lshl_add_u32 v122, v123, 3, v122
  v_add_u32 v5, 155648, v122
  s_lshr_b32 s92, s44, 1
  s_lshl_b32 s92, s92, 10
  s_and_b32 s93, s44, 1
  s_lshl_b32 s82, s93, 12
  s_lshl_b32 s93, s93, 5
  s_add_u32 s92, s92, s93
  s_add_u32 s92, s92, 159712
  v_add_u32 v6, s92, v1
  v_bfe_u32 v122, v0, 2, 2
  v_lshlrev_b32 v7, 13, v122
  v_lshl_add_u32 v7, v121, 6, v7
  v_lshl_add_u32 v7, v123, 4, v7
  v_bfe_u32 v122, v0, 2, 1
  v_lshlrev_b32 v8, 9, v122
  v_lshl_add_u32 v8, v121, 6, v8
  v_and_b32 v122, 1, v0
  v_lshl_add_u32 v8, v122, 4, v8
  v_bfe_u32 v122, v0, 1, 1
  v_lshl_add_u32 v8, v122, 3, v8
  v_lshlrev_b32 v9, 2, v123
  s_mov_b32 s60, 0x3e0293ee
  s_mov_b32 s61, 0x3e0293ee
  s_mov_b32 s89, 0x34800000
  s_lshl_b32 s55, s50, 20
  s_add_u32 s55, s55, 0x200000
  s_lshl_b32 s56, s50, 15
  s_add_u32 s56, s56, 0x40000
  s_lshl_b32 s57, s50, 11
  s_add_u32 s57, s57, s51
  s_lshl_b32 s57, s57, 15
  s_add_u32 s57, s57, 0x4000000
  s_lshl_b32 s59, s50, 18
  s_lshl_b32 s92, s51, 7
  s_add_u32 s59, s59, s92
  s_add_u32 s58, s59, 0xc000000
  s_add_u32 s59, s59, 0xc080000
  s_lshl_b32 s92, s51, 8
  s_lshl_b32 s70, s44, 16
  s_add_u32 s70, s70, s92
  s_add_u32 s70, s70, s55
  s_lshr_b32 s76, s51, 2
  s_lshl_b32 s76, s76, 10
  s_bfe_u32 s92, s51, 0x10001
  s_lshl_b32 s92, s92, 8
  s_add_u32 s76, s76, s92
  s_and_b32 s92, s51, 1
  s_lshl_b32 s92, s92, 5
  s_add_u32 s76, s76, s92
  s_add_u32 s76, s76, s56
  s_lshl_b32 s77, s51, 13
  s_add_u32 s77, s77, s55
  s_add_u32 s78, s56, s74
  s_add_u32 s75, s75, 24576
  s_add_u32 s92, s74, 147456
  v_add_u32 v12, s92, v1
  v_and_b32 v121, 1, v0
  v_lshlrev_b32 v121, 4, v121
  v_mov_b32 v122, 0x3f80
  v_lshlrev_b32 v122, v121, v122
  v_lshrrev_b32 v120, 1, v120
  v_cmp_eq_u32 vcc, 0, v120
  s_nop 1
  v_cndmask_b32 v124, 0, v122, vcc
  v_cmp_eq_u32 vcc, 1, v120
  s_nop 1
  v_cndmask_b32 v125, 0, v122, vcc
  v_cmp_eq_u32 vcc, 2, v120
  s_nop 1
  v_cndmask_b32 v126, 0, v122, vcc
  v_cmp_eq_u32 vcc, 3, v120
  s_nop 1
  v_cndmask_b32 v127, 0, v122, vcc
  v_add_u32 v14, 131072, v1
  ds_write_b128 v14, v[124:127] offset:31232
  s_lshl_b32 s92, s44, 18
  s_add_u32 s92, s92, s77
  v_lshlrev_b32 v120, 7, v0
  buffer_load_dword v121, v120, s[4:7], s92 offen sc1
  s_lshl_b32 s92, s44, 13
  s_add_u32 s92, s92, s56
  buffer_load_dword v122, v120, s[4:7], s92 offen sc1
  s_cmp_lg_u32 s46, 0
  s_cbranch_scc1 CHAIN_SAFE
  s_cmp_lg_u32 s44, 0
  s_cbranch_scc1 cm_1555
  s_add_u32 s92, s76, 24576
  s_mov_b64 exec, s[68:69]
  buffer_store_dwordx2 v[44:45], v8, s[4:7], s92 offen sc0
  s_mov_b64 exec, -1
cm_1555:
  s_add_u32 s92, s58, 4096
  buffer_load_dword v11, v9, s[4:7], s92 offen sc1
  s_mov_b32 s101, 0
poll_1556:
  buffer_load_dword v123, v9, s[4:7], s58 offen sc1
  s_waitcnt vmcnt(0)
  v_cmp_eq_u32 vcc, 0, v123
  s_nop 0
  s_cbranch_vccz polld_1557
  s_add_u32 s47, s47, 1
  s_mov_b32 s49, 6
  s_cmp_gt_u32 s47, 131072
  s_cbranch_scc1 TIMEOUT
  s_sleep 3
  s_branch poll_1556
polld_1557:
  s_add_u32 s72, s57, s74
  s_add_u32 s72, s72, 8192
  s_add_u32 s73, s72, 8192
  s_add_u32 m0, s74, 131072
  s_nop 0
  buffer_load_dwordx4 v1, s[4:7], s72 offen offset:0 sc1 lds
  buffer_load_dwordx4 v1, s[4:7], s72 offen offset:1024 sc1 lds
  buffer_load_dwordx4 v[80:83], v1, s[4:7], s73 offen offset:0 sc1
  buffer_load_dwordx4 v[84:87], v1, s[4:7], s73 offen offset:1024 sc1
  s_mov_b32 s54, 0
  v_cmp_ne_u32 s[98:99], 0, v11
  s_lshl_b32 s80, s45, 7
  s_add_u32 s80, s80, 0x80000
  s_add_u32 s63, s78, 24576
  s_cmp_eq_u64 s[98:99], -1
  s_cselect_b32 s71, 0, 1
  s_cselect_b32 s92, 0x100000, 0
  s_cmp_ge_u32 s54, 62
  s_cselect_b32 s71, 0, s71
  s_cselect_b32 s92, 0xffe00000, s92
  s_add_u32 s92, s92, s57
  s_add_u32 s72, s92, s74
  s_add_u32 s72, s72, 8192
  s_add_u32 s73, s72, 8192
  s_add_u32 s92, s58, 4096
  s_cmp_lg_u32 s71, 0
  s_cselect_b32 s73, s92, s73
  s_add_u32 m0, s74, 139264
  s_add_u32 s79, s57, s75
  s_add_u32 s81, s58, 8192
  s_cmp_ge_u32 s54, 61
  s_cselect_b32 s81, s58, s81
  ds_read_b128 v[48:51], v3 offset:0
  ds_read_b128 v[52:55], v3 offset:1024
  ds_read_b128 v[56:59], v3 offset:2048
  ds_read_b128 v[60:63], v3 offset:3072
  ds_read_b128 v[64:67], v3 offset:4096
  ds_read_b128 v[68:71], v3 offset:5120
  ds_read_b128 v[72:75], v3 offset:6144
  ds_read_b128 v[76:79], v3 offset:7168
  v_mov_b64 v[112:113], 0
  v_mov_b64 v[114:115], 0
  v_mov_b64 v[116:117], 0
  v_mov_b64 v[118:119], 0
  v_mov_b64 v[96:97], 0
  v_mov_b64 v[98:99], 0
  v_mov_b64 v[100:101], 0
  v_mov_b64 v[102:103], 0
  v_mov_b64 v[104:105], 0
  v_mov_b64 v[106:107], 0
  v_mov_b64 v[108:109], 0
  v_mov_b64 v[110:111], 0
  buffer_load_dwordx4 v[40:43], v1, s[4:7], s63 offen offset:0 sc0 sc1
  buffer_load_dwordx4 v[44:47], v1, s[4:7], s63 offen offset:1024 sc0 sc1
h2_1558:
  buffer_load_dwordx4 v[88:91], v1, s[4:7], s63 offen offset:0 sc0 sc1
  buffer_load_dwordx4 v[92:95], v1, s[4:7], s63 offen offset:1024 sc0 sc1
  s_waitcnt vmcnt(3)
  v_mfma_f32_16x16x32_bf16 v[120:123], v[40:43], v[124:127], 0
  s_waitcnt vmcnt(2)
  ds_write_b128 v12, v[40:43] offset:0
  v_mfma_f32_16x16x32_bf16 v[120:123], v[44:47], v[124:127], v[120:123]
  ds_write_b128 v12, v[44:47] offset:1024
  s_nop 6
  v_cmp_u_f32 vcc, v120, v121
  v_cmp_u_f32 s[96:97], v122, v123
  s_nop 0
  s_or_b64 s[96:97], vcc, s[96:97]
  s_cbranch_scc0 h2a_1559
  buffer_load_dwordx4 v[40:43], v1, s[4:7], s63 offen offset:0 sc0 sc1
  buffer_load_dwordx4 v[44:47], v1, s[4:7], s63 offen offset:1024 sc0 sc1
  s_waitcnt vmcnt(3)
  v_mfma_f32_16x16x32_bf16 v[120:123], v[88:91], v[124:127], 0
  s_waitcnt vmcnt(2)
  ds_write_b128 v12, v[88:91] offset:0
  v_mfma_f32_16x16x32_bf16 v[120:123], v[92:95], v[124:127], v[120:123]
  ds_write_b128 v12, v[92:95] offset:1024
  s_nop 6
  v_cmp_u_f32 vcc, v120, v121
  v_cmp_u_f32 s[96:97], v122, v123
  s_nop 0
  s_or_b64 s[96:97], vcc, s[96:97]
  s_cbranch_scc0 h2b_1560
  s_add_u32 s47, s47, 1
  s_mov_b32 s49, 7
  s_cmp_gt_u32 s47, 131072
  s_cbranch_scc1 TIMEOUT
  s_branch h2_1558
h2b_1560:
  v_smfmac_f32_16x16x64_bf16 v[96:99], v[88:91], a[64:71], v2
  buffer_load_dwordx4 v1, s[4:7], s72 offen offset:0 sc1 lds
  v_smfmac_f32_16x16x64_bf16 v[100:103], v[88:91], a[72:79], v2
  buffer_load_dwordx4 v1, s[4:7], s72 offen offset:1024 sc1 lds
  v_smfmac_f32_16x16x64_bf16 v[96:99], v[92:95], a[80:87], v2
  s_waitcnt lgkmcnt(0)
  s_barrier
  ds_read_b128 v[16:19], v10 offset:0
  ds_read_b128 v[20:23], v10 offset:1024
  v_smfmac_f32_16x16x64_bf16 v[100:103], v[92:95], a[88:95], v2
  ds_read_b128 v[24:27], v13 offset:0
  v_smfmac_f32_16x16x64_bf16 v[104:107], v[88:91], a[160:167], v2
  ds_read_b128 v[28:31], v13 offset:1024
  v_smfmac_f32_16x16x64_bf16 v[108:111], v[88:91], a[168:175], v2
  ds_read_b128 v[32:35], v15 offset:0
  v_smfmac_f32_16x16x64_bf16 v[104:107], v[92:95], a[176:183], v2
  ds_read_b128 v[36:39], v15 offset:1024
  v_smfmac_f32_16x16x64_bf16 v[108:111], v[92:95], a[184:191], v2
  s_branch h2d_1561
h2a_1559:
  v_smfmac_f32_16x16x64_bf16 v[96:99], v[40:43], a[64:71], v2
  buffer_load_dwordx4 v1, s[4:7], s72 offen offset:0 sc1 lds
  v_smfmac_f32_16x16x64_bf16 v[100:103], v[40:43], a[72:79], v2
  buffer_load_dwordx4 v1, s[4:7], s72 offen offset:1024 sc1 lds
  v_smfmac_f32_16x16x64_bf16 v[96:99], v[44:47], a[80:87], v2
  s_waitcnt lgkmcnt(0)
  s_barrier
  ds_read_b128 v[16:19], v10 offset:0
  ds_read_b128 v[20:23], v10 offset:1024
  v_smfmac_f32_16x16x64_bf16 v[100:103], v[44:47], a[88:95], v2
  ds_read_b128 v[24:27], v13 offset:0
  v_smfmac_f32_16x16x64_bf16 v[104:107], v[40:43], a[160:167], v2
  ds_read_b128 v[28:31], v13 offset:1024
  v_smfmac_f32_16x16x64_bf16 v[108:111], v[40:43], a[168:175], v2
  ds_read_b128 v[32:35], v15 offset:0
  v_smfmac_f32_16x16x64_bf16 v[104:107], v[44:47], a[176:183], v2
  ds_read_b128 v[36:39], v15 offset:1024
  v_smfmac_f32_16x16x64_bf16 v[108:111], v[44:47], a[184:191], v2
h2d_1561:
CF_LOOP:
  s_waitcnt lgkmcnt(5)
  v_smfmac_f32_16x16x64_bf16 v[96:99], v[16:19], v[48:55], v2
  buffer_load_dwordx4 v[88:91], v1, s[4:7], s73 offen offset:0 sc1
  v_smfmac_f32_16x16x64_bf16 v[100:103], v[16:19], v[56:63], v2
  s_mov_b64 exec, 1
  buffer_store_dword v2, off, s[4:7], s80 sc1
  s_mov_b64 exec, -1
  s_waitcnt lgkmcnt(4)
  v_smfmac_f32_16x16x64_bf16 v[96:99], v[20:23], v[64:71], v2
  buffer_load_dwordx4 v[92:95], v1, s[4:7], s73 offen offset:1024 sc1
  v_smfmac_f32_16x16x64_bf16 v[100:103], v[20:23], v[72:79], v2
  s_and_b32 s87, s54, 3
  s_lshl_b32 s88, s87, 13
  ds_read_b128 v[48:51], v3 offset:8192
  s_waitcnt lgkmcnt(4)
  v_smfmac_f32_16x16x64_bf16 v[96:99], v[24:27], a[0:7], v2
  s_add_u32 s85, s76, s88
  s_add_u32 s63, s78, s88
  ds_read_b128 v[52:55], v3 offset:9216
  v_smfmac_f32_16x16x64_bf16 v[100:103], v[24:27], a[8:15], v2
  s_xor_b32 s88, s88, 16384
  s_add_u32 s65, s76, s88
  ds_read_b128 v[56:59], v3 offset:10240
  s_waitcnt lgkmcnt(5)
  v_smfmac_f32_16x16x64_bf16 v[96:99], v[28:31], a[16:23], v2
  s_lshl_b32 s88, s87, 18
  s_add_u32 s64, s70, s88
  ds_read_b128 v[60:63], v3 offset:11264
  v_smfmac_f32_16x16x64_bf16 v[100:103], v[28:31], a[24:31], v2
  s_add_u32 s86, s64, 32768
  s_add_u32 s83, s77, s88
  ds_read_b128 v[64:67], v3 offset:12288
  s_waitcnt lgkmcnt(6)
  v_smfmac_f32_16x16x64_bf16 v[96:99], v[32:35], a[32:39], v2
  s_add_u32 s84, s83, 4096
  s_add_u32 s87, s87, 3
  ds_read_b128 v[68:71], v3 offset:13312
  v_smfmac_f32_16x16x64_bf16 v[100:103], v[32:35], a[40:47], v2
  s_and_b32 s87, s87, 3
  s_lshl_b32 s87, s87, 18
  ds_read_b128 v[72:75], v3 offset:14336
  s_waitcnt lgkmcnt(7)
  v_smfmac_f32_16x16x64_bf16 v[96:99], v[36:39], a[48:55], v2
  s_add_u32 s62, s77, s87
  s_add_u32 s62, s62, s74
  ds_read_b128 v[76:79], v3 offset:15360
  v_smfmac_f32_16x16x64_bf16 v[100:103], v[36:39], a[56:63], v2
  v_mov_b64 v[120:121], -1
  v_smfmac_f32_16x16x64_bf16 v[104:107], v[24:27], a[96:103], v2
  v_mov_b64 v[122:123], -1
  v_smfmac_f32_16x16x64_bf16 v[108:111], v[24:27], a[104:111], v2
  buffer_store_dwordx4 v[120:123], v1, s[4:7], s62 offen offset:0 sc0
  v_smfmac_f32_16x16x64_bf16 v[104:107], v[28:31], a[112:119], v2
  v_add_f32 v96, v96, v98
  v_smfmac_f32_16x16x64_bf16 v[108:111], v[28:31], a[120:127], v2
  s_waitcnt lgkmcnt(6)
  v_add_f32 v97, v97, v99
  v_smfmac_f32_16x16x64_bf16 v[104:107], v[16:19], v[48:55], v2
  s_waitcnt lgkmcnt(4)
  v_cvt_pk_bf16_f32 v125, v96, v97
  v_smfmac_f32_16x16x64_bf16 v[108:111], v[16:19], v[56:63], v2
  s_waitcnt lgkmcnt(2)
  v_add_f32 v100, v100, v102
  v_smfmac_f32_16x16x64_bf16 v[104:107], v[20:23], v[64:71], v2
  s_waitcnt lgkmcnt(0)
  v_add_f32 v101, v101, v103
  v_smfmac_f32_16x16x64_bf16 v[108:111], v[20:23], v[72:79], v2
  ds_read_b128 v[48:51], v3 offset:16384
  v_smfmac_f32_16x16x64_bf16 v[104:107], v[32:35], a[128:135], v2
  ds_read_b128 v[52:55], v3 offset:17408
  v_smfmac_f32_16x16x64_bf16 v[108:111], v[32:35], a[136:143], v2
  ds_read_b128 v[56:59], v3 offset:18432
  v_smfmac_f32_16x16x64_bf16 v[104:107], v[36:39], a[144:151], v2
  ds_read_b128 v[60:63], v3 offset:19456
  v_smfmac_f32_16x16x64_bf16 v[108:111], v[36:39], a[152:159], v2
  s_waitcnt vmcnt(7)
  v_cvt_pk_bf16_f32 v127, v100, v101
  v_smfmac_f32_16x16x64_bf16 v[112:115], v[40:43], v[128:135], v2
  ds_write2_b32 v4, v125, v127 offset0:1 offset1:129
  v_smfmac_f32_16x16x64_bf16 v[116:119], v[40:43], v[136:143], v2
  s_waitcnt vmcnt(6)
  v_add_f32 v104, v104, v106
  v_add_f32 v105, v105, v107
  v_cvt_pk_bf16_f32 v124, v104, v105
  v_smfmac_f32_16x16x64_bf16 v[112:115], v[44:47], v[144:151], v2
  v_add_f32 v108, v108, v110
  v_add_f32 v109, v109, v111
  v_cvt_pk_bf16_f32 v126, v108, v109
  v_smfmac_f32_16x16x64_bf16 v[116:119], v[44:47], v[152:159], v2
  ds_write2_b32 v4, v124, v126 offset0:0 offset1:128
  v_smfmac_f32_16x16x64_bf16 v[112:115], v[24:27], a[192:199], v2
  ds_read_b128 v[64:67], v3 offset:20480
  v_smfmac_f32_16x16x64_bf16 v[116:119], v[24:27], a[200:207], v2
  ds_read_b128 v[68:71], v3 offset:21504
  v_smfmac_f32_16x16x64_bf16 v[112:115], v[28:31], a[208:215], v2
  ds_read_b128 v[72:75], v3 offset:22528
  ds_read_b128 v[76:79], v3 offset:23552
  v_smfmac_f32_16x16x64_bf16 v[116:119], v[28:31], a[216:223], v2
  s_waitcnt lgkmcnt(4)
  s_barrier
  ds_read_b64_tr_b16 v[96:97], v5 offset:0
  ds_read_b64_tr_b16 v[98:99], v5 offset:128
  v_smfmac_f32_16x16x64_bf16 v[112:115], v[16:19], v[48:55], v2
  ds_read_b64_tr_b16 v[100:101], v5 offset:1024
  ds_read_b64_tr_b16 v[102:103], v5 offset:1152
  v_smfmac_f32_16x16x64_bf16 v[116:119], v[16:19], v[56:63], v2
  s_waitcnt lgkmcnt(6)
  ds_read_b64_tr_b16 v[104:105], v5 offset:2048
  ds_read_b64_tr_b16 v[106:107], v5 offset:2176
  v_smfmac_f32_16x16x64_bf16 v[112:115], v[20:23], v[64:71], v2
  s_waitcnt lgkmcnt(6)
  ds_read_b64_tr_b16 v[108:109], v5 offset:3072
  ds_read_b64_tr_b16 v[110:111], v5 offset:3200
  v_smfmac_f32_16x16x64_bf16 v[116:119], v[20:23], v[72:79], v2
  ds_read_b128 v[40:43], v14 offset:0
  v_smfmac_f32_16x16x64_bf16 v[112:115], v[32:35], a[224:231], v2
  ds_read_b128 v[44:47], v14 offset:1024
  v_smfmac_f32_16x16x64_bf16 v[116:119], v[32:35], a[232:239], v2
  ds_read_b128 v[24:27], v14 offset:2048
  v_smfmac_f32_16x16x64_bf16 v[112:115], v[36:39], a[240:247], v2
  ds_read_b128 v[28:31], v14 offset:3072
  v_smfmac_f32_16x16x64_bf16 v[116:119], v[36:39], a[248:255], v2
  s_waitcnt lgkmcnt(10)
  buffer_store_dwordx4 v[120:123], v1, s[4:7], s62 offen offset:1024 sc0
  v_mfma_f32_16x16x32_bf16 v[56:59], v[96:99], v[96:99], 0
  s_waitcnt lgkmcnt(8)
  ds_read_b128 v[64:67], v14 offset:4096
  ds_read_b128 v[68:71], v14 offset:5120
  v_mfma_f32_16x16x32_bf16 v[56:59], v[100:103], v[100:103], v[56:59]
  s_waitcnt lgkmcnt(8)
  ds_read_b128 v[72:75], v14 offset:6144
  ds_read_b128 v[76:79], v14 offset:7168
  v_mfma_f32_16x16x32_bf16 v[56:59], v[104:107], v[104:107], v[56:59]
  s_waitcnt lgkmcnt(8)
  v_add_f32 v112, v112, v114
  v_add_f32 v113, v113, v115
  v_mfma_f32_16x16x32_bf16 v[56:59], v[108:111], v[108:111], v[56:59]
  s_waitcnt lgkmcnt(7)
  v_cvt_pk_bf16_f32 v125, v112, v113
  v_add_f32 v116, v116, v118
  v_mfma_f32_16x16x32_bf16 v[48:51], v[40:43], v[96:99], 0
  s_waitcnt lgkmcnt(6)
  v_add_f32 v117, v117, v119
  v_cvt_pk_bf16_f32 v127, v116, v117
  v_mfma_f32_16x16x32_bf16 v[48:51], v[44:47], v[100:103], v[48:51]
  s_waitcnt lgkmcnt(5)
  buffer_store_dwordx4 v[124:127], v1, s[4:7], s79 offen sc1
  v_mfma_f32_16x16x32_bf16 v[48:51], v[24:27], v[104:107], v[48:51]
  s_waitcnt lgkmcnt(4)
  buffer_load_dword v11, v9, s[4:7], s81 offen sc1
  v_mfma_f32_16x16x32_bf16 v[48:51], v[28:31], v[108:111], v[48:51]
  s_waitcnt lgkmcnt(3)
  v_mov_b32 v116, 0x3f803f80
  v_mov_b32 v117, 0x3f803f80
  v_mfma_f32_16x16x32_bf16 v[52:55], v[64:67], v[96:99], 0
  s_waitcnt lgkmcnt(2)
  v_mov_b64 v[118:119], v[116:117]
  v_mov_b64 v[16:17], 0
  v_mfma_f32_16x16x32_bf16 v[52:55], v[68:71], v[100:103], v[52:55]
  s_waitcnt lgkmcnt(1)
  v_mov_b64 v[18:19], 0
  v_mov_b64 v[20:21], 0
  v_mfma_f32_16x16x32_bf16 v[52:55], v[72:75], v[104:107], v[52:55]
  s_waitcnt lgkmcnt(0)
  v_mov_b64 v[22:23], 0
  v_mfma_f32_16x16x32_bf16 v[52:55], v[76:79], v[108:111], v[52:55]
  v_max3_f32 v120, v56, v57, v48
  v_max3_f32 v121, v49, v50, v51
  v_mov_b64 v[24:25], 0
  v_mov_b64 v[26:27], 0
  v_mov_b64 v[28:29], 0
  v_mov_b64 v[30:31], 0
  v_mov_b32 v64, 0
  s_cmp_eq_u32 s54, 63
  s_cbranch_scc1 CF_FINAL
  v_max3_f32 v120, v120, v121, v52
  v_max3_f32 v121, v53, v54, v55
  v_max_f32 v120, v120, v121
  v_mov_b32 v121, v120
  v_mov_b64 v[32:33], 0
  v_mov_b64 v[34:35], 0
  v_permlane16_swap_b32 v120, v121
  v_max_f32 v120, v120, v121
  v_mov_b32 v121, v120
  v_mov_b64 v[36:37], 0
  v_mov_b64 v[38:39], 0
  v_permlane32_swap_b32 v120, v121
  v_max_f32 v120, v120, v121
  v_mul_f32 v120, s60, v120
  v_fma_f32 v120, -abs(v120), s89, v120
  v_pk_fma_f32 v[56:57], v[56:57], s[60:61], v[120:121] op_sel_hi:[1,1,0] neg_lo:[0,0,1] neg_hi:[0,0,1]
  v_pk_fma_f32 v[48:49], v[48:49], s[60:61], v[120:121] op_sel_hi:[1,1,0] neg_lo:[0,0,1] neg_hi:[0,0,1]
  v_pk_fma_f32 v[50:51], v[50:51], s[60:61], v[120:121] op_sel_hi:[1,1,0] neg_lo:[0,0,1] neg_hi:[0,0,1]
  v_pk_fma_f32 v[52:53], v[52:53], s[60:61], v[120:121] op_sel_hi:[1,1,0] neg_lo:[0,0,1] neg_hi:[0,0,1]
  v_pk_fma_f32 v[54:55], v[54:55], s[60:61], v[120:121] op_sel_hi:[1,1,0] neg_lo:[0,0,1] neg_hi:[0,0,1]
  v_exp_f32_e64 v56, v56 clamp
  v_exp_f32_e64 v57, v57 clamp
  v_exp_f32_e64 v48, v48 clamp
  v_cvt_pk_bf16_f32 v65, v56, v57
  v_exp_f32_e64 v49, v49 clamp
  v_exp_f32_e64 v50, v50 clamp
  v_mfma_f32_16x16x16_bf16 v[76:79], v[116:117], v[64:65], 0
  v_exp_f32_e64 v51, v51 clamp
  v_mfma_f32_16x16x16_bf16 v[68:71], v[124:125], v[64:65], 0
  v_exp_f32_e64 v52, v52 clamp
  v_mfma_f32_16x16x16_bf16 v[72:75], v[126:127], v[64:65], 0
  v_exp_f32_e64 v53, v53 clamp
  v_exp_f32_e64 v54, v54 clamp
  v_exp_f32_e64 v55, v55 clamp
  v_cvt_pk_bf16_f32 v60, v48, v49
  v_cvt_pk_bf16_f32 v61, v50, v51
  v_cvt_pk_bf16_f32 v62, v52, v53
  v_cvt_pk_bf16_f32 v63, v54, v55
  v_mov_b64 v[96:97], 0
  v_mov_b64 v[98:99], 0
  v_mfma_f32_16x16x32_bf16 v[76:79], v[116:119], v[60:63], v[76:79]
  v_mfma_f32_16x16x32_bf16 v[68:71], v[80:83], v[60:63], v[68:71]
  v_mfma_f32_16x16x32_bf16 v[72:75], v[84:87], v[60:63], v[72:75]
  ds_read_b128 v[124:127], v14 offset:31232
  v_mov_b64 v[100:101], 0
  v_mov_b64 v[102:103], 0
  v_mov_b64 v[104:105], 0
  v_mov_b64 v[106:107], 0
  s_nop 0
  v_rcp_f32 v76, v76
  s_nop 0
  v_pk_mul_f32 v[68:69], v[68:69], v[76:77] op_sel_hi:[1,0]
  v_cvt_pk_bf16_f32 v112, v68, v69
  v_pk_mul_f32 v[70:71], v[70:71], v[76:77] op_sel_hi:[1,0]
  v_cvt_pk_bf16_f32 v113, v70, v71
  v_pk_mul_f32 v[72:73], v[72:73], v[76:77] op_sel_hi:[1,0]
  v_cvt_pk_bf16_f32 v114, v72, v73
  v_pk_mul_f32 v[74:75], v[74:75], v[76:77] op_sel_hi:[1,0]
  v_cvt_pk_bf16_f32 v115, v74, v75
  s_mov_b64 exec, s[66:67]
  ds_write_b128 v6, v[112:115]
  s_mov_b64 exec, -1
  v_mov_b64 v[108:109], 0
  v_mov_b64 v[110:111], 0
  v_mov_b64 v[40:41], 0
  v_mov_b64 v[42:43], 0
  v_mov_b64 v[44:45], 0
  v_mov_b64 v[46:47], 0
  s_cmp_eq_u32 s71, 0
  s_cbranch_scc1 k2_1562
  s_waitcnt vmcnt(6)
  v_min3_u32 v120, v88, v89, v90
  v_min_u32 v120, v120, v91
  s_nop 0
  v_readfirstlane_b32 s92, v120
  s_nop 0
  s_cmp_eq_u32 s92, 0
  s_cbranch_scc1 k2_1562
  s_add_u32 s92, s57, 0x100000
  s_add_u32 s72, s92, s74
  s_add_u32 s72, s72, 8192
  s_add_u32 s73, s72, 8192
  s_mov_b32 s71, 0
  buffer_load_dwordx4 v1, s[4:7], s72 offen offset:0 sc1 lds
  buffer_load_dwordx4 v1, s[4:7], s72 offen offset:1024 sc1 lds
  buffer_load_dwordx4 v[88:91], v1, s[4:7], s73 offen offset:0 sc1
  buffer_load_dwordx4 v[92:95], v1, s[4:7], s73 offen offset:1024 sc1
k2_1562:
  s_waitcnt lgkmcnt(0)
  s_barrier
  ds_read_b128 v[80:83], v14 offset:28672
  ds_read_b128 v[84:87], v14 offset:29696
  ds_read_b128 v[48:51], v3 offset:24576
  ds_read_b128 v[52:55], v3 offset:25600
  ds_read_b128 v[56:59], v3 offset:26624
  ds_read_b128 v[60:63], v3 offset:27648
  s_waitcnt lgkmcnt(5)
  v_smfmac_f32_16x16x64_bf16 v[32:35], v[80:83], v[192:199], v2
  ds_read_b128 v[64:67], v3 offset:28672
  v_smfmac_f32_16x16x64_bf16 v[36:39], v[80:83], v[200:207], v2
  s_waitcnt lgkmcnt(5)
  ds_read_b128 v[68:71], v3 offset:29696
  v_smfmac_f32_16x16x64_bf16 v[32:35], v[84:87], v[208:215], v2
  ds_read_b128 v[72:75], v3 offset:30720
  v_smfmac_f32_16x16x64_bf16 v[36:39], v[84:87], v[216:223], v2
  ds_read_b128 v[76:79], v3 offset:31744
  v_smfmac_f32_16x16x64_bf16 v[40:43], v[80:83], v[224:231], v2
  v_smfmac_f32_16x16x64_bf16 v[44:47], v[80:83], v[232:239], v2
  s_nop 2
  v_add_f32 v32, v32, v34
  v_add_f32 v33, v33, v35
  v_cvt_pk_bf16_f32 v116, v32, v33
  v_smfmac_f32_16x16x64_bf16 v[40:43], v[84:87], v[240:247], v2
  v_add_f32 v36, v36, v38
  v_add_f32 v37, v37, v39
  v_cvt_pk_bf16_f32 v117, v36, v37
  v_smfmac_f32_16x16x64_bf16 v[44:47], v[84:87], v[248:255], v2
  v_smfmac_f32_16x16x64_bf16 v[24:27], v[80:83], v[160:167], v2
  v_smfmac_f32_16x16x64_bf16 v[28:31], v[80:83], v[168:175], v2
  s_nop 1
  v_add_f32 v40, v40, v42
  v_add_f32 v41, v41, v43
  v_cvt_pk_bf16_f32 v118, v40, v41
  v_smfmac_f32_16x16x64_bf16 v[24:27], v[84:87], v[176:183], v2
  v_add_f32 v44, v44, v46
  v_add_f32 v45, v45, v47
  v_cvt_pk_bf16_f32 v119, v44, v45
  v_smfmac_f32_16x16x64_bf16 v[28:31], v[84:87], v[184:191], v2
  s_waitcnt lgkmcnt(6)
  buffer_store_dwordx4 v[116:119], v7, s[4:7], s86 offen sc0
  v_smfmac_f32_16x16x64_bf16 v[16:19], v[80:83], v[48:55], v2
  s_waitcnt lgkmcnt(4)
  v_smfmac_f32_16x16x64_bf16 v[20:23], v[80:83], v[56:63], v2
  s_waitcnt lgkmcnt(2)
  v_add_f32 v24, v24, v26
  v_smfmac_f32_16x16x64_bf16 v[16:19], v[84:87], v[64:71], v2
  s_waitcnt lgkmcnt(0)
  v_add_f32 v25, v25, v27
  v_smfmac_f32_16x16x64_bf16 v[20:23], v[84:87], v[72:79], v2
  v_cvt_pk_bf16_f32 v114, v24, v25
  s_cmp_lg_u32 s44, 0
  v_add_f32 v28, v28, v30
  v_add_f32 v29, v29, v31
  v_cvt_pk_bf16_f32 v115, v28, v29
  v_pk_add_f32 v[16:17], v[16:17], v[18:19]
  v_cvt_pk_bf16_f32 v112, v16, v17
  s_nop 0
  v_pk_add_f32 v[20:21], v[20:21], v[22:23]
  v_cvt_pk_bf16_f32 v113, v20, v21
  buffer_store_dwordx4 v[112:115], v7, s[4:7], s64 offen sc0
  ds_read_b128 v[48:51], v3 offset:0
  ds_read_b128 v[52:55], v3 offset:1024
  ds_read_b128 v[56:59], v3 offset:2048
  ds_read_b128 v[60:63], v3 offset:3072
  ds_read_b128 v[64:67], v3 offset:4096
  ds_read_b128 v[68:71], v3 offset:5120
  ds_read_b128 v[72:75], v3 offset:6144
  ds_read_b128 v[76:79], v3 offset:7168
  v_mov_b64 v[112:113], 0
  v_mov_b64 v[114:115], 0
  v_mov_b64 v[116:117], 0
  v_mov_b64 v[118:119], 0
  s_waitcnt vmcnt(2)
  v_cmp_ne_u32 vcc, 0, v11
  s_add_u32 s54, s54, 1
  s_add_u32 s57, s57, 0x100000
  s_add_u32 s58, s58, 4096
  s_mov_b32 s80, s59
  s_add_u32 s59, s59, 4096
  s_mov_b64 s[98:99], vcc
  s_cmp_lg_u32 s44, 0
  s_cbranch_scc1 hw1_1564
  s_sleep 5
h1_1566:
  buffer_load_dwordx4 v[16:19], v1, s[4:7], s83 offen offset:0 sc0 sc1
  buffer_load_dwordx4 v[20:23], v1, s[4:7], s83 offen offset:1024 sc0 sc1
  buffer_load_dwordx4 v[24:27], v1, s[4:7], s83 offen offset:2048 sc0 sc1
  buffer_load_dwordx4 v[28:31], v1, s[4:7], s83 offen offset:3072 sc0 sc1
  buffer_load_dwordx4 v[32:35], v1, s[4:7], s84 offen offset:0 sc0 sc1
  buffer_load_dwordx4 v[36:39], v1, s[4:7], s84 offen offset:1024 sc0 sc1
  buffer_load_dwordx4 v[40:43], v1, s[4:7], s84 offen offset:2048 sc0 sc1
  buffer_load_dwordx4 v[44:47], v1, s[4:7], s84 offen offset:3072 sc0 sc1
h1s_1567:
  s_waitcnt vmcnt(7)
  v_mfma_f32_16x16x32_bf16 v[120:123], v[16:19], v[124:127], 0
  s_waitcnt vmcnt(6)
  v_mfma_f32_16x16x32_bf16 v[120:123], v[20:23], v[124:127], v[120:123]
  s_waitcnt vmcnt(5)
  v_mfma_f32_16x16x32_bf16 v[120:123], v[24:27], v[124:127], v[120:123]
  s_waitcnt vmcnt(4)
  v_mfma_f32_16x16x32_bf16 v[120:123], v[28:31], v[124:127], v[120:123]
  s_waitcnt vmcnt(3)
  v_mfma_f32_16x16x32_bf16 v[120:123], v[32:35], v[124:127], v[120:123]
  s_waitcnt vmcnt(2)
  v_mfma_f32_16x16x32_bf16 v[120:123], v[36:39], v[124:127], v[120:123]
  s_waitcnt vmcnt(1)
  v_mfma_f32_16x16x32_bf16 v[120:123], v[40:43], v[124:127], v[120:123]
  s_waitcnt vmcnt(0)
  v_mfma_f32_16x16x32_bf16 v[120:123], v[44:47], v[124:127], v[120:123]
  s_mov_b64 exec, s[68:69]
  s_nop 6
  v_cvt_pk_bf16_f32 v16, v120, v121
  v_cvt_pk_bf16_f32 v17, v122, v123
  buffer_store_dwordx2 v[16:17], v8, s[4:7], s85 offen sc0
  v_cmp_u_f32 vcc, v120, v121
  v_cmp_u_f32 s[96:97], v122, v123
  s_mov_b64 exec, -1
  s_or_b64 s[96:97], vcc, s[96:97]
  s_cbranch_scc0 hd0_1565
  s_add_u32 s47, s47, 1
  s_mov_b32 s49, 8
  s_cmp_gt_u32 s47, 131072
  s_cbranch_scc1 TIMEOUT
  s_branch h1_1566
hw1_1564:
  s_mov_b32 s87, s71
  s_cmp_eq_u32 s71, 0
  s_cbranch_scc1 nk_1568
  s_mov_b32 s101, 0
poll_1569:
  buffer_load_dword v123, v9, s[4:7], s58 offen sc1
  s_waitcnt vmcnt(0)
  v_cmp_eq_u32 vcc, 0, v123
  s_nop 0
  s_cbranch_vccz polld_1570
  s_add_u32 s47, s47, 1
  s_mov_b32 s49, 6
  s_cmp_gt_u32 s47, 131072
  s_cbranch_scc1 TIMEOUT
  s_sleep 3
  s_branch poll_1569
polld_1570:
  s_add_u32 s72, s57, s74
  s_add_u32 s72, s72, 8192
  s_add_u32 s73, s72, 8192
  s_add_u32 m0, s74, 139264
  s_nop 0
  buffer_load_dwordx4 v1, s[4:7], s72 offen offset:0 sc1 lds
  buffer_load_dwordx4 v1, s[4:7], s72 offen offset:1024 sc1 lds
  buffer_load_dwordx4 v[88:91], v1, s[4:7], s73 offen offset:0 sc1
  buffer_load_dwordx4 v[92:95], v1, s[4:7], s73 offen offset:1024 sc1
  s_waitcnt vmcnt(0)
nk_1568:
  s_cmp_eq_u64 s[98:99], -1
  s_cselect_b32 s71, 0, 1
  s_cselect_b32 s92, 0x100000, 0
  s_cmp_ge_u32 s54, 62
  s_cselect_b32 s71, 0, s71
  s_cselect_b32 s92, 0xffe00000, s92
  s_add_u32 s92, s92, s57
  s_add_u32 s72, s92, s74
  s_add_u32 s72, s72, 8192
  s_add_u32 s73, s72, 8192
  s_add_u32 s92, s58, 4096
  s_cmp_lg_u32 s71, 0
  s_cselect_b32 s73, s92, s73
  s_add_u32 m0, s74, 131072
  s_add_u32 s79, s57, s75
  s_add_u32 s81, s58, 8192
  s_cmp_ge_u32 s54, 61
  s_cselect_b32 s81, s58, s81
  s_sleep 5
  s_cmp_lg_u32 s44, 1
  s_cbranch_scc1 nz_1571
  v_mov_b64 v[120:121], -1
  s_mov_b64 exec, s[68:69]
  buffer_store_dwordx2 v[120:121], v8, s[4:7], s65 offen sc0
  s_mov_b64 exec, -1
nz_1571:
  s_cmp_lg_u32 s87, 0
  s_cbranch_scc1 hdn_1563
  s_sleep 7
  s_branch hdn_1563
hd0_1565:
  s_cmp_eq_u32 s71, 0
  s_cbranch_scc1 nk_1572
  s_mov_b32 s101, 0
poll_1573:
  buffer_load_dword v123, v9, s[4:7], s58 offen sc1
  s_waitcnt vmcnt(0)
  v_cmp_eq_u32 vcc, 0, v123
  s_nop 0
  s_cbranch_vccz polld_1574
  s_add_u32 s47, s47, 1
  s_mov_b32 s49, 6
  s_cmp_gt_u32 s47, 131072
  s_cbranch_scc1 TIMEOUT
  s_sleep 3
  s_branch poll_1573
polld_1574:
  s_add_u32 s72, s57, s74
  s_add_u32 s72, s72, 8192
  s_add_u32 s73, s72, 8192
  s_add_u32 m0, s74, 139264
  s_nop 0
  buffer_load_dwordx4 v1, s[4:7], s72 offen offset:0 sc1 lds
  buffer_load_dwordx4 v1, s[4:7], s72 offen offset:1024 sc1 lds
  buffer_load_dwordx4 v[88:91], v1, s[4:7], s73 offen offset:0 sc1
  buffer_load_dwordx4 v[92:95], v1, s[4:7], s73 offen offset:1024 sc1
  s_waitcnt vmcnt(0)
nk_1572:
  s_cmp_eq_u64 s[98:99], -1
  s_cselect_b32 s71, 0, 1
  s_cselect_b32 s92, 0x100000, 0
  s_cmp_ge_u32 s54, 62
  s_cselect_b32 s71, 0, s71
  s_cselect_b32 s92, 0xffe00000, s92
  s_add_u32 s92, s92, s57
  s_add_u32 s72, s92, s74
  s_add_u32 s72, s72, 8192
  s_add_u32 s73, s72, 8192
  s_add_u32 s92, s58, 4096
  s_cmp_lg_u32 s71, 0
  s_cselect_b32 s73, s92, s73
  s_add_u32 m0, s74, 131072
  s_add_u32 s79, s57, s75
  s_add_u32 s81, s58, 8192
  s_cmp_ge_u32 s54, 61
  s_cselect_b32 s81, s58, s81
hdn_1563:
  buffer_load_dwordx4 v[40:43], v1, s[4:7], s63 offen offset:0 sc0 sc1
  buffer_load_dwordx4 v[44:47], v1, s[4:7], s63 offen offset:1024 sc0 sc1
  s_sleep 3
h2_1575:
  buffer_load_dwordx4 v[80:83], v1, s[4:7], s63 offen offset:0 sc0 sc1
  buffer_load_dwordx4 v[84:87], v1, s[4:7], s63 offen offset:1024 sc0 sc1
  s_waitcnt vmcnt(3)
  v_mfma_f32_16x16x32_bf16 v[120:123], v[40:43], v[124:127], 0
  s_waitcnt vmcnt(2)
  ds_write_b128 v12, v[40:43] offset:0
  v_mfma_f32_16x16x32_bf16 v[120:123], v[44:47], v[124:127], v[120:123]
  ds_write_b128 v12, v[44:47] offset:1024
  s_nop 6
  v_cmp_u_f32 vcc, v120, v121
  v_cmp_u_f32 s[96:97], v122, v123
  s_nop 0
  s_or_b64 s[96:97], vcc, s[96:97]
  s_cbranch_scc0 h2a_1576
  buffer_load_dwordx4 v[40:43], v1, s[4:7], s63 offen offset:0 sc0 sc1
  buffer_load_dwordx4 v[44:47], v1, s[4:7], s63 offen offset:1024 sc0 sc1
  s_waitcnt vmcnt(3)
  v_mfma_f32_16x16x32_bf16 v[120:123], v[80:83], v[124:127], 0
  s_waitcnt vmcnt(2)
  ds_write_b128 v12, v[80:83] offset:0
  v_mfma_f32_16x16x32_bf16 v[120:123], v[84:87], v[124:127], v[120:123]
  ds_write_b128 v12, v[84:87] offset:1024
  s_nop 6
  v_cmp_u_f32 vcc, v120, v121
  v_cmp_u_f32 s[96:97], v122, v123
  s_nop 0
  s_or_b64 s[96:97], vcc, s[96:97]
  s_cbranch_scc0 h2b_1577
  s_add_u32 s47, s47, 1
  s_mov_b32 s49, 7
  s_cmp_gt_u32 s47, 131072
  s_cbranch_scc1 TIMEOUT
  s_branch h2_1575
h2b_1577:
  v_smfmac_f32_16x16x64_bf16 v[96:99], v[80:83], a[64:71], v2
  buffer_load_dwordx4 v1, s[4:7], s72 offen offset:0 sc1 lds
  v_smfmac_f32_16x16x64_bf16 v[100:103], v[80:83], a[72:79], v2
  buffer_load_dwordx4 v1, s[4:7], s72 offen offset:1024 sc1 lds
  v_smfmac_f32_16x16x64_bf16 v[96:99], v[84:87], a[80:87], v2
  s_waitcnt lgkmcnt(0)
  s_barrier
  ds_read_b128 v[16:19], v10 offset:0
  ds_read_b128 v[20:23], v10 offset:1024
  v_smfmac_f32_16x16x64_bf16 v[100:103], v[84:87], a[88:95], v2
  ds_read_b128 v[24:27], v13 offset:0
  v_smfmac_f32_16x16x64_bf16 v[104:107], v[80:83], a[160:167], v2
  ds_read_b128 v[28:31], v13 offset:1024
  v_smfmac_f32_16x16x64_bf16 v[108:111], v[80:83], a[168:175], v2
  ds_read_b128 v[32:35], v15 offset:0
  v_smfmac_f32_16x16x64_bf16 v[104:107], v[84:87], a[176:183], v2
  ds_read_b128 v[36:39], v15 offset:1024
  v_smfmac_f32_16x16x64_bf16 v[108:111], v[84:87], a[184:191], v2
  s_branch h2d_1578
h2a_1576:
  v_smfmac_f32_16x16x64_bf16 v[96:99], v[40:43], a[64:71], v2
  buffer_load_dwordx4 v1, s[4:7], s72 offen offset:0 sc1 lds
  v_smfmac_f32_16x16x64_bf16 v[100:103], v[40:43], a[72:79], v2
  buffer_load_dwordx4 v1, s[4:7], s72 offen offset:1024 sc1 lds
  v_smfmac_f32_16x16x64_bf16 v[96:99], v[44:47], a[80:87], v2
  s_waitcnt lgkmcnt(0)
  s_barrier
  ds_read_b128 v[16:19], v10 offset:0
  ds_read_b128 v[20:23], v10 offset:1024
  v_smfmac_f32_16x16x64_bf16 v[100:103], v[44:47], a[88:95], v2
  ds_read_b128 v[24:27], v13 offset:0
  v_smfmac_f32_16x16x64_bf16 v[104:107], v[40:43], a[160:167], v2
  ds_read_b128 v[28:31], v13 offset:1024
  v_smfmac_f32_16x16x64_bf16 v[108:111], v[40:43], a[168:175], v2
  ds_read_b128 v[32:35], v15 offset:0
  v_smfmac_f32_16x16x64_bf16 v[104:107], v[44:47], a[176:183], v2
  ds_read_b128 v[36:39], v15 offset:1024
  v_smfmac_f32_16x16x64_bf16 v[108:111], v[44:47], a[184:191], v2
h2d_1578:
  s_waitcnt lgkmcnt(5)
  v_smfmac_f32_16x16x64_bf16 v[96:99], v[16:19], v[48:55], v2
  buffer_load_dwordx4 v[80:83], v1, s[4:7], s73 offen offset:0 sc1
  v_smfmac_f32_16x16x64_bf16 v[100:103], v[16:19], v[56:63], v2
  s_mov_b64 exec, 1
  buffer_store_dword v2, off, s[4:7], s80 sc1
  s_mov_b64 exec, -1
  s_waitcnt lgkmcnt(4)
  v_smfmac_f32_16x16x64_bf16 v[96:99], v[20:23], v[64:71], v2
  buffer_load_dwordx4 v[84:87], v1, s[4:7], s73 offen offset:1024 sc1
  v_smfmac_f32_16x16x64_bf16 v[100:103], v[20:23], v[72:79], v2
  s_and_b32 s87, s54, 3
  s_lshl_b32 s88, s87, 13
  ds_read_b128 v[48:51], v3 offset:8192
  s_waitcnt lgkmcnt(4)
  v_smfmac_f32_16x16x64_bf16 v[96:99], v[24:27], a[0:7], v2
  s_add_u32 s85, s76, s88
  s_add_u32 s63, s78, s88
  ds_read_b128 v[52:55], v3 offset:9216
  v_smfmac_f32_16x16x64_bf16 v[100:103], v[24:27], a[8:15], v2
  s_xor_b32 s88, s88, 16384
  s_add_u32 s65, s76, s88
  ds_read_b128 v[56:59], v3 offset:10240
  s_waitcnt lgkmcnt(5)
  v_smfmac_f32_16x16x64_bf16 v[96:99], v[28:31], a[16:23], v2
  s_lshl_b32 s88, s87, 18
  s_add_u32 s64, s70, s88
  ds_read_b128 v[60:63], v3 offset:11264
  v_smfmac_f32_16x16x64_bf16 v[100:103], v[28:31], a[24:31], v2
  s_add_u32 s86, s64, 32768
  s_add_u32 s83, s77, s88
  ds_read_b128 v[64:67], v3 offset:12288
  s_waitcnt lgkmcnt(6)
  v_smfmac_f32_16x16x64_bf16 v[96:99], v[32:35], a[32:39], v2
  s_add_u32 s84, s83, 4096
  s_add_u32 s87, s87, 3
  ds_read_b128 v[68:71], v3 offset:13312
  v_smfmac_f32_16x16x64_bf16 v[100:103], v[32:35], a[40:47], v2
  s_and_b32 s87, s87, 3
  s_lshl_b32 s87, s87, 18
  ds_read_b128 v[72:75], v3 offset:14336
  s_waitcnt lgkmcnt(7)
  v_smfmac_f32_16x16x64_bf16 v[96:99], v[36:39], a[48:55], v2
  s_add_u32 s62, s77, s87
  s_add_u32 s62, s62, s74
  ds_read_b128 v[76:79], v3 offset:15360
  v_smfmac_f32_16x16x64_bf16 v[100:103], v[36:39], a[56:63], v2
  v_mov_b64 v[120:121], -1
  v_smfmac_f32_16x16x64_bf16 v[104:107], v[24:27], a[96:103], v2
  v_mov_b64 v[122:123], -1
  v_smfmac_f32_16x16x64_bf16 v[108:111], v[24:27], a[104:111], v2
  buffer_store_dwordx4 v[120:123], v1, s[4:7], s62 offen offset:0 sc0
  v_smfmac_f32_16x16x64_bf16 v[104:107], v[28:31], a[112:119], v2
  v_add_f32 v96, v96, v98
  v_smfmac_f32_16x16x64_bf16 v[108:111], v[28:31], a[120:127], v2
  s_waitcnt lgkmcnt(6)
  v_add_f32 v97, v97, v99
  v_smfmac_f32_16x16x64_bf16 v[104:107], v[16:19], v[48:55], v2
  s_waitcnt lgkmcnt(4)
  v_cvt_pk_bf16_f32 v125, v96, v97
  v_smfmac_f32_16x16x64_bf16 v[108:111], v[16:19], v[56:63], v2
  s_waitcnt lgkmcnt(2)
  v_add_f32 v100, v100, v102
  v_smfmac_f32_16x16x64_bf16 v[104:107], v[20:23], v[64:71], v2
  s_waitcnt lgkmcnt(0)
  v_add_f32 v101, v101, v103
  v_smfmac_f32_16x16x64_bf16 v[108:111], v[20:23], v[72:79], v2
  ds_read_b128 v[48:51], v3 offset:16384
  v_smfmac_f32_16x16x64_bf16 v[104:107], v[32:35], a[128:135], v2
  ds_read_b128 v[52:55], v3 offset:17408
  v_smfmac_f32_16x16x64_bf16 v[108:111], v[32:35], a[136:143], v2
  ds_read_b128 v[56:59], v3 offset:18432
  v_smfmac_f32_16x16x64_bf16 v[104:107], v[36:39], a[144:151], v2
  ds_read_b128 v[60:63], v3 offset:19456
  v_smfmac_f32_16x16x64_bf16 v[108:111], v[36:39], a[152:159], v2
  s_waitcnt vmcnt(7)
  v_cvt_pk_bf16_f32 v127, v100, v101
  v_smfmac_f32_16x16x64_bf16 v[112:115], v[40:43], v[128:135], v2
  ds_write2_b32 v4, v125, v127 offset0:1 offset1:129
  v_smfmac_f32_16x16x64_bf16 v[116:119], v[40:43], v[136:143], v2
  s_waitcnt vmcnt(6)
  v_add_f32 v104, v104, v106
  v_add_f32 v105, v105, v107
  v_cvt_pk_bf16_f32 v124, v104, v105
  v_smfmac_f32_16x16x64_bf16 v[112:115], v[44:47], v[144:151], v2
  v_add_f32 v108, v108, v110
  v_add_f32 v109, v109, v111
  v_cvt_pk_bf16_f32 v126, v108, v109
  v_smfmac_f32_16x16x64_bf16 v[116:119], v[44:47], v[152:159], v2
  ds_write2_b32 v4, v124, v126 offset0:0 offset1:128
  v_smfmac_f32_16x16x64_bf16 v[112:115], v[24:27], a[192:199], v2
  ds_read_b128 v[64:67], v3 offset:20480
  v_smfmac_f32_16x16x64_bf16 v[116:119], v[24:27], a[200:207], v2
  ds_read_b128 v[68:71], v3 offset:21504
  v_smfmac_f32_16x16x64_bf16 v[112:115], v[28:31], a[208:215], v2
  ds_read_b128 v[72:75], v3 offset:22528
  ds_read_b128 v[76:79], v3 offset:23552
  v_smfmac_f32_16x16x64_bf16 v[116:119], v[28:31], a[216:223], v2
  s_waitcnt lgkmcnt(4)
  s_barrier
  ds_read_b64_tr_b16 v[96:97], v5 offset:0
  ds_read_b64_tr_b16 v[98:99], v5 offset:128
  v_smfmac_f32_16x16x64_bf16 v[112:115], v[16:19], v[48:55], v2
  ds_read_b64_tr_b16 v[100:101], v5 offset:1024
  ds_read_b64_tr_b16 v[102:103], v5 offset:1152
  v_smfmac_f32_16x16x64_bf16 v[116:119], v[16:19], v[56:63], v2
  s_waitcnt lgkmcnt(6)
  ds_read_b64_tr_b16 v[104:105], v5 offset:2048
  ds_read_b64_tr_b16 v[106:107], v5 offset:2176
  v_smfmac_f32_16x16x64_bf16 v[112:115], v[20:23], v[64:71], v2
  s_waitcnt lgkmcnt(6)
  ds_read_b64_tr_b16 v[108:109], v5 offset:3072
  ds_read_b64_tr_b16 v[110:111], v5 offset:3200
  v_smfmac_f32_16x16x64_bf16 v[116:119], v[20:23], v[72:79], v2
  ds_read_b128 v[40:43], v14 offset:8192
  v_smfmac_f32_16x16x64_bf16 v[112:115], v[32:35], a[224:231], v2
  ds_read_b128 v[44:47], v14 offset:9216
  v_smfmac_f32_16x16x64_bf16 v[116:119], v[32:35], a[232:239], v2
  ds_read_b128 v[24:27], v14 offset:10240
  v_smfmac_f32_16x16x64_bf16 v[112:115], v[36:39], a[240:247], v2
  ds_read_b128 v[28:31], v14 offset:11264
  v_smfmac_f32_16x16x64_bf16 v[116:119], v[36:39], a[248:255], v2
  s_waitcnt lgkmcnt(10)
  buffer_store_dwordx4 v[120:123], v1, s[4:7], s62 offen offset:1024 sc0
  v_mfma_f32_16x16x32_bf16 v[56:59], v[96:99], v[96:99], 0
  s_waitcnt lgkmcnt(8)
  ds_read_b128 v[64:67], v14 offset:12288
  ds_read_b128 v[68:71], v14 offset:13312
  v_mfma_f32_16x16x32_bf16 v[56:59], v[100:103], v[100:103], v[56:59]
  s_waitcnt lgkmcnt(8)
  ds_read_b128 v[72:75], v14 offset:14336
  ds_read_b128 v[76:79], v14 offset:15360
  v_mfma_f32_16x16x32_bf16 v[56:59], v[104:107], v[104:107], v[56:59]
  s_waitcnt lgkmcnt(8)
  v_add_f32 v112, v112, v114
  v_add_f32 v113, v113, v115
  v_mfma_f32_16x16x32_bf16 v[56:59], v[108:111], v[108:111], v[56:59]
  s_waitcnt lgkmcnt(7)
  v_cvt_pk_bf16_f32 v125, v112, v113
  v_add_f32 v116, v116, v118
  v_mfma_f32_16x16x32_bf16 v[48:51], v[40:43], v[96:99], 0
  s_waitcnt lgkmcnt(6)
  v_add_f32 v117, v117, v119
  v_cvt_pk_bf16_f32 v127, v116, v117
  v_mfma_f32_16x16x32_bf16 v[48:51], v[44:47], v[100:103], v[48:51]
  s_waitcnt lgkmcnt(5)
  buffer_store_dwordx4 v[124:127], v1, s[4:7], s79 offen sc1
  v_mfma_f32_16x16x32_bf16 v[48:51], v[24:27], v[104:107], v[48:51]
  s_waitcnt lgkmcnt(4)
  buffer_load_dword v11, v9, s[4:7], s81 offen sc1
  v_mfma_f32_16x16x32_bf16 v[48:51], v[28:31], v[108:111], v[48:51]
  s_waitcnt lgkmcnt(3)
  v_mov_b32 v116, 0x3f803f80
  v_mov_b32 v117, 0x3f803f80
  v_mfma_f32_16x16x32_bf16 v[52:55], v[64:67], v[96:99], 0
  s_waitcnt lgkmcnt(2)
  v_mov_b64 v[118:119], v[116:117]
  v_mov_b64 v[16:17], 0
  v_mfma_f32_16x16x32_bf16 v[52:55], v[68:71], v[100:103], v[52:55]
  s_waitcnt lgkmcnt(1)
  v_mov_b64 v[18:19], 0
  v_mov_b64 v[20:21], 0
  v_mfma_f32_16x16x32_bf16 v[52:55], v[72:75], v[104:107], v[52:55]
  s_waitcnt lgkmcnt(0)
  v_mov_b64 v[22:23], 0
  v_mfma_f32_16x16x32_bf16 v[52:55], v[76:79], v[108:111], v[52:55]
  v_max3_f32 v120, v56, v57, v48
  v_max3_f32 v121, v49, v50, v51
  v_mov_b64 v[24:25], 0
  v_mov_b64 v[26:27], 0
  v_mov_b64 v[28:29], 0
  v_mov_b64 v[30:31], 0
  v_mov_b32 v64, 0
  s_cmp_eq_u32 s54, 63
  s_cbranch_scc1 CF_FINAL
  v_max3_f32 v120, v120, v121, v52
  v_max3_f32 v121, v53, v54, v55
  v_max_f32 v120, v120, v121
  v_mov_b32 v121, v120
  v_mov_b64 v[32:33], 0
  v_mov_b64 v[34:35], 0
  v_permlane16_swap_b32 v120, v121
  v_max_f32 v120, v120, v121
  v_mov_b32 v121, v120
  v_mov_b64 v[36:37], 0
  v_mov_b64 v[38:39], 0
  v_permlane32_swap_b32 v120, v121
  v_max_f32 v120, v120, v121
  v_mul_f32 v120, s60, v120
  v_fma_f32 v120, -abs(v120), s89, v120
  v_pk_fma_f32 v[56:57], v[56:57], s[60:61], v[120:121] op_sel_hi:[1,1,0] neg_lo:[0,0,1] neg_hi:[0,0,1]
  v_pk_fma_f32 v[48:49], v[48:49], s[60:61], v[120:121] op_sel_hi:[1,1,0] neg_lo:[0,0,1] neg_hi:[0,0,1]
  v_pk_fma_f32 v[50:51], v[50:51], s[60:61], v[120:121] op_sel_hi:[1,1,0] neg_lo:[0,0,1] neg_hi:[0,0,1]
  v_pk_fma_f32 v[52:53], v[52:53], s[60:61], v[120:121] op_sel_hi:[1,1,0] neg_lo:[0,0,1] neg_hi:[0,0,1]
  v_pk_fma_f32 v[54:55], v[54:55], s[60:61], v[120:121] op_sel_hi:[1,1,0] neg_lo:[0,0,1] neg_hi:[0,0,1]
  v_exp_f32_e64 v56, v56 clamp
  v_exp_f32_e64 v57, v57 clamp
  v_exp_f32_e64 v48, v48 clamp
  v_cvt_pk_bf16_f32 v65, v56, v57
  v_exp_f32_e64 v49, v49 clamp
  v_exp_f32_e64 v50, v50 clamp
  v_mfma_f32_16x16x16_bf16 v[76:79], v[116:117], v[64:65], 0
  v_exp_f32_e64 v51, v51 clamp
  v_mfma_f32_16x16x16_bf16 v[68:71], v[124:125], v[64:65], 0
  v_exp_f32_e64 v52, v52 clamp
  v_mfma_f32_16x16x16_bf16 v[72:75], v[126:127], v[64:65], 0
  v_exp_f32_e64 v53, v53 clamp
  v_exp_f32_e64 v54, v54 clamp
  v_exp_f32_e64 v55, v55 clamp
  v_cvt_pk_bf16_f32 v60, v48, v49
  v_cvt_pk_bf16_f32 v61, v50, v51
  v_cvt_pk_bf16_f32 v62, v52, v53
  v_cvt_pk_bf16_f32 v63, v54, v55
  v_mov_b64 v[96:97], 0
  v_mov_b64 v[98:99], 0
  v_mfma_f32_16x16x32_bf16 v[76:79], v[116:119], v[60:63], v[76:79]
  v_mfma_f32_16x16x32_bf16 v[68:71], v[88:91], v[60:63], v[68:71]
  v_mfma_f32_16x16x32_bf16 v[72:75], v[92:95], v[60:63], v[72:75]
  ds_read_b128 v[124:127], v14 offset:31232
  v_mov_b64 v[100:101], 0
  v_mov_b64 v[102:103], 0
  v_mov_b64 v[104:105], 0
  v_mov_b64 v[106:107], 0
  s_nop 0
  v_rcp_f32 v76, v76
  s_nop 0
  v_pk_mul_f32 v[68:69], v[68:69], v[76:77] op_sel_hi:[1,0]
  v_cvt_pk_bf16_f32 v112, v68, v69
  v_pk_mul_f32 v[70:71], v[70:71], v[76:77] op_sel_hi:[1,0]
  v_cvt_pk_bf16_f32 v113, v70, v71
  v_pk_mul_f32 v[72:73], v[72:73], v[76:77] op_sel_hi:[1,0]
  v_cvt_pk_bf16_f32 v114, v72, v73
  v_pk_mul_f32 v[74:75], v[74:75], v[76:77] op_sel_hi:[1,0]
  v_cvt_pk_bf16_f32 v115, v74, v75
  s_mov_b64 exec, s[66:67]
  ds_write_b128 v6, v[112:115]
  s_mov_b64 exec, -1
  v_mov_b64 v[108:109], 0
  v_mov_b64 v[110:111], 0
  v_mov_b64 v[40:41], 0
  v_mov_b64 v[42:43], 0
  v_mov_b64 v[44:45], 0
  v_mov_b64 v[46:47], 0
  s_cmp_eq_u32 s71, 0
  s_cbranch_scc1 k2_1579
  s_waitcnt vmcnt(6)
  v_min3_u32 v120, v80, v81, v82
  v_min_u32 v120, v120, v83
  s_nop 0
  v_readfirstlane_b32 s92, v120
  s_nop 0
  s_cmp_eq_u32 s92, 0
  s_cbranch_scc1 k2_1579
  s_add_u32 s92, s57, 0x100000
  s_add_u32 s72, s92, s74
  s_add_u32 s72, s72, 8192
  s_add_u32 s73, s72, 8192
  s_mov_b32 s71, 0
  buffer_load_dwordx4 v1, s[4:7], s72 offen offset:0 sc1 lds
  buffer_load_dwordx4 v1, s[4:7], s72 offen offset:1024 sc1 lds
  buffer_load_dwordx4 v[80:83], v1, s[4:7], s73 offen offset:0 sc1
  buffer_load_dwordx4 v[84:87], v1, s[4:7], s73 offen offset:1024 sc1
k2_1579:
  s_waitcnt lgkmcnt(0)
  s_barrier
  ds_read_b128 v[88:91], v14 offset:28672
  ds_read_b128 v[92:95], v14 offset:29696
  ds_read_b128 v[48:51], v3 offset:24576
  ds_read_b128 v[52:55], v3 offset:25600
  ds_read_b128 v[56:59], v3 offset:26624
  ds_read_b128 v[60:63], v3 offset:27648
  s_waitcnt lgkmcnt(5)
  v_smfmac_f32_16x16x64_bf16 v[32:35], v[88:91], v[192:199], v2
  ds_read_b128 v[64:67], v3 offset:28672
  v_smfmac_f32_16x16x64_bf16 v[36:39], v[88:91], v[200:207], v2
  s_waitcnt lgkmcnt(5)
  ds_read_b128 v[68:71], v3 offset:29696
  v_smfmac_f32_16x16x64_bf16 v[32:35], v[92:95], v[208:215], v2
  ds_read_b128 v[72:75], v3 offset:30720
  v_smfmac_f32_16x16x64_bf16 v[36:39], v[92:95], v[216:223], v2
  ds_read_b128 v[76:79], v3 offset:31744
  v_smfmac_f32_16x16x64_bf16 v[40:43], v[88:91], v[224:231], v2
  v_smfmac_f32_16x16x64_bf16 v[44:47], v[88:91], v[232:239], v2
  s_nop 2
  v_add_f32 v32, v32, v34
  v_add_f32 v33, v33, v35
  v_cvt_pk_bf16_f32 v116, v32, v33
  v_smfmac_f32_16x16x64_bf16 v[40:43], v[92:95], v[240:247], v2
  v_add_f32 v36, v36, v38
  v_add_f32 v37, v37, v39
  v_cvt_pk_bf16_f32 v117, v36, v37
  v_smfmac_f32_16x16x64_bf16 v[44:47], v[92:95], v[248:255], v2
  v_smfmac_f32_16x16x64_bf16 v[24:27], v[88:91], v[160:167], v2
  v_smfmac_f32_16x16x64_bf16 v[28:31], v[88:91], v[168:175], v2
  s_nop 1
  v_add_f32 v40, v40, v42
  v_add_f32 v41, v41, v43
  v_cvt_pk_bf16_f32 v118, v40, v41
  v_smfmac_f32_16x16x64_bf16 v[24:27], v[92:95], v[176:183], v2
  v_add_f32 v44, v44, v46
  v_add_f32 v45, v45, v47
  v_cvt_pk_bf16_f32 v119, v44, v45
  v_smfmac_f32_16x16x64_bf16 v[28:31], v[92:95], v[184:191], v2
  s_waitcnt lgkmcnt(6)
  buffer_store_dwordx4 v[116:119], v7, s[4:7], s86 offen sc0
  v_smfmac_f32_16x16x64_bf16 v[16:19], v[88:91], v[48:55], v2
  s_waitcnt lgkmcnt(4)
  v_smfmac_f32_16x16x64_bf16 v[20:23], v[88:91], v[56:63], v2
  s_waitcnt lgkmcnt(2)
  v_add_f32 v24, v24, v26
  v_smfmac_f32_16x16x64_bf16 v[16:19], v[92:95], v[64:71], v2
  s_waitcnt lgkmcnt(0)
  v_add_f32 v25, v25, v27
  v_smfmac_f32_16x16x64_bf16 v[20:23], v[92:95], v[72:79], v2
  v_cvt_pk_bf16_f32 v114, v24, v25
  s_cmp_lg_u32 s44, 0
  v_add_f32 v28, v28, v30
  v_add_f32 v29, v29, v31
  v_cvt_pk_bf16_f32 v115, v28, v29
  v_pk_add_f32 v[16:17], v[16:17], v[18:19]
  v_cvt_pk_bf16_f32 v112, v16, v17
  s_nop 0
  v_pk_add_f32 v[20:21], v[20:21], v[22:23]
  v_cvt_pk_bf16_f32 v113, v20, v21
  buffer_store_dwordx4 v[112:115], v7, s[4:7], s64 offen sc0
  ds_read_b128 v[48:51], v3 offset:0
  ds_read_b128 v[52:55], v3 offset:1024
  ds_read_b128 v[56:59], v3 offset:2048
  ds_read_b128 v[60:63], v3 offset:3072
  ds_read_b128 v[64:67], v3 offset:4096
  ds_read_b128 v[68:71], v3 offset:5120
  ds_read_b128 v[72:75], v3 offset:6144
  ds_read_b128 v[76:79], v3 offset:7168
  v_mov_b64 v[112:113], 0
  v_mov_b64 v[114:115], 0
  v_mov_b64 v[116:117], 0
  v_mov_b64 v[118:119], 0
  s_waitcnt vmcnt(2)
  v_cmp_ne_u32 vcc, 0, v11
  s_add_u32 s54, s54, 1
  s_add_u32 s57, s57, 0x100000
  s_add_u32 s58, s58, 4096
  s_mov_b32 s80, s59
  s_add_u32 s59, s59, 4096
  s_mov_b64 s[98:99], vcc
  s_cmp_lg_u32 s44, 0
  s_cbranch_scc1 hw1_1581
  s_sleep 5
h1_1583:
  buffer_load_dwordx4 v[16:19], v1, s[4:7], s83 offen offset:0 sc0 sc1
  buffer_load_dwordx4 v[20:23], v1, s[4:7], s83 offen offset:1024 sc0 sc1
  buffer_load_dwordx4 v[24:27], v1, s[4:7], s83 offen offset:2048 sc0 sc1
  buffer_load_dwordx4 v[28:31], v1, s[4:7], s83 offen offset:3072 sc0 sc1
  buffer_load_dwordx4 v[32:35], v1, s[4:7], s84 offen offset:0 sc0 sc1
  buffer_load_dwordx4 v[36:39], v1, s[4:7], s84 offen offset:1024 sc0 sc1
  buffer_load_dwordx4 v[40:43], v1, s[4:7], s84 offen offset:2048 sc0 sc1
  buffer_load_dwordx4 v[44:47], v1, s[4:7], s84 offen offset:3072 sc0 sc1
h1s_1584:
  s_waitcnt vmcnt(7)
  v_mfma_f32_16x16x32_bf16 v[120:123], v[16:19], v[124:127], 0
  s_waitcnt vmcnt(6)
  v_mfma_f32_16x16x32_bf16 v[120:123], v[20:23], v[124:127], v[120:123]
  s_waitcnt vmcnt(5)
  v_mfma_f32_16x16x32_bf16 v[120:123], v[24:27], v[124:127], v[120:123]
  s_waitcnt vmcnt(4)
  v_mfma_f32_16x16x32_bf16 v[120:123], v[28:31], v[124:127], v[120:123]
  s_waitcnt vmcnt(3)
  v_mfma_f32_16x16x32_bf16 v[120:123], v[32:35], v[124:127], v[120:123]
  s_waitcnt vmcnt(2)
  v_mfma_f32_16x16x32_bf16 v[120:123], v[36:39], v[124:127], v[120:123]
  s_waitcnt vmcnt(1)
  v_mfma_f32_16x16x32_bf16 v[120:123], v[40:43], v[124:127], v[120:123]
  s_waitcnt vmcnt(0)
  v_mfma_f32_16x16x32_bf16 v[120:123], v[44:47], v[124:127], v[120:123]
  s_mov_b64 exec, s[68:69]
  s_nop 6
  v_cvt_pk_bf16_f32 v16, v120, v121
  v_cvt_pk_bf16_f32 v17, v122, v123
  buffer_store_dwordx2 v[16:17], v8, s[4:7], s85 offen sc0
  v_cmp_u_f32 vcc, v120, v121
  v_cmp_u_f32 s[96:97], v122, v123
  s_mov_b64 exec, -1
  s_or_b64 s[96:97], vcc, s[96:97]
  s_cbranch_scc0 hd0_1582
  s_add_u32 s47, s47, 1
  s_mov_b32 s49, 8
  s_cmp_gt_u32 s47, 131072
  s_cbranch_scc1 TIMEOUT
  s_branch h1_1583
hw1_1581:
  s_mov_b32 s87, s71
  s_cmp_eq_u32 s71, 0
  s_cbranch_scc1 nk_1585
  s_mov_b32 s101, 0
poll_1586:
  buffer_load_dword v123, v9, s[4:7], s58 offen sc1
  s_waitcnt vmcnt(0)
  v_cmp_eq_u32 vcc, 0, v123
  s_nop 0
  s_cbranch_vccz polld_1587
  s_add_u32 s47, s47, 1
  s_mov_b32 s49, 6
  s_cmp_gt_u32 s47, 131072
  s_cbranch_scc1 TIMEOUT
  s_sleep 3
  s_branch poll_1586
polld_1587:
  s_add_u32 s72, s57, s74
  s_add_u32 s72, s72, 8192
  s_add_u32 s73, s72, 8192
  s_add_u32 m0, s74, 131072
  s_nop 0
  buffer_load_dwordx4 v1, s[4:7], s72 offen offset:0 sc1 lds
  buffer_load_dwordx4 v1, s[4:7], s72 offen offset:1024 sc1 lds
  buffer_load_dwordx4 v[80:83], v1, s[4:7], s73 offen offset:0 sc1
  buffer_load_dwordx4 v[84:87], v1, s[4:7], s73 offen offset:1024 sc1
  s_waitcnt vmcnt(0)
nk_1585:
  s_cmp_eq_u64 s[98:99], -1
  s_cselect_b32 s71, 0, 1
  s_cselect_b32 s92, 0x100000, 0
  s_cmp_ge_u32 s54, 62
  s_cselect_b32 s71, 0, s71
  s_cselect_b32 s92, 0xffe00000, s92
  s_add_u32 s92, s92, s57
  s_add_u32 s72, s92, s74
  s_add_u32 s72, s72, 8192
  s_add_u32 s73, s72, 8192
  s_add_u32 s92, s58, 4096
  s_cmp_lg_u32 s71, 0
  s_cselect_b32 s73, s92, s73
  s_add_u32 m0, s74, 139264
  s_add_u32 s79, s57, s75
  s_add_u32 s81, s58, 8192
  s_cmp_ge_u32 s54, 61
  s_cselect_b32 s81, s58, s81
  s_sleep 5
  s_cmp_lg_u32 s44, 1
  s_cbranch_scc1 nz_1588
  v_mov_b64 v[120:121], -1
  s_mov_b64 exec, s[68:69]
  buffer_store_dwordx2 v[120:121], v8, s[4:7], s65 offen sc0
  s_mov_b64 exec, -1
nz_1588:
  s_cmp_lg_u32 s87, 0
  s_cbranch_scc1 hdn_1580
  s_sleep 7
  s_branch hdn_1580
hd0_1582:
  s_cmp_eq_u32 s71, 0
  s_cbranch_scc1 nk_1589
  s_mov_b32 s101, 0
poll_1590:
  buffer_load_dword v123, v9, s[4:7], s58 offen sc1
  s_waitcnt vmcnt(0)
  v_cmp_eq_u32 vcc, 0, v123
  s_nop 0
  s_cbranch_vccz polld_1591
  s_add_u32 s47, s47, 1
  s_mov_b32 s49, 6
  s_cmp_gt_u32 s47, 131072
  s_cbranch_scc1 TIMEOUT
  s_sleep 3
  s_branch poll_1590
polld_1591:
  s_add_u32 s72, s57, s74
  s_add_u32 s72, s72, 8192
  s_add_u32 s73, s72, 8192
  s_add_u32 m0, s74, 131072
  s_nop 0
  buffer_load_dwordx4 v1, s[4:7], s72 offen offset:0 sc1 lds
  buffer_load_dwordx4 v1, s[4:7], s72 offen offset:1024 sc1 lds
  buffer_load_dwordx4 v[80:83], v1, s[4:7], s73 offen offset:0 sc1
  buffer_load_dwordx4 v[84:87], v1, s[4:7], s73 offen offset:1024 sc1
  s_waitcnt vmcnt(0)
nk_1589:
  s_cmp_eq_u64 s[98:99], -1
  s_cselect_b32 s71, 0, 1
  s_cselect_b32 s92, 0x100000, 0
  s_cmp_ge_u32 s54, 62
  s_cselect_b32 s71, 0, s71
  s_cselect_b32 s92, 0xffe00000, s92
  s_add_u32 s92, s92, s57
  s_add_u32 s72, s92, s74
  s_add_u32 s72, s72, 8192
  s_add_u32 s73, s72, 8192
  s_add_u32 s92, s58, 4096
  s_cmp_lg_u32 s71, 0
  s_cselect_b32 s73, s92, s73
  s_add_u32 m0, s74, 139264
  s_add_u32 s79, s57, s75
  s_add_u32 s81, s58, 8192
  s_cmp_ge_u32 s54, 61
  s_cselect_b32 s81, s58, s81
hdn_1580:
  buffer_load_dwordx4 v[40:43], v1, s[4:7], s63 offen offset:0 sc0 sc1
  buffer_load_dwordx4 v[44:47], v1, s[4:7], s63 offen offset:1024 sc0 sc1
  s_sleep 3
h2_1592:
  buffer_load_dwordx4 v[88:91], v1, s[4:7], s63 offen offset:0 sc0 sc1
  buffer_load_dwordx4 v[92:95], v1, s[4:7], s63 offen offset:1024 sc0 sc1
  s_waitcnt vmcnt(3)
  v_mfma_f32_16x16x32_bf16 v[120:123], v[40:43], v[124:127], 0
  s_waitcnt vmcnt(2)
  ds_write_b128 v12, v[40:43] offset:0
  v_mfma_f32_16x16x32_bf16 v[120:123], v[44:47], v[124:127], v[120:123]
  ds_write_b128 v12, v[44:47] offset:1024
  s_nop 6
  v_cmp_u_f32 vcc, v120, v121
  v_cmp_u_f32 s[96:97], v122, v123
  s_nop 0
  s_or_b64 s[96:97], vcc, s[96:97]
  s_cbranch_scc0 h2a_1593
  buffer_load_dwordx4 v[40:43], v1, s[4:7], s63 offen offset:0 sc0 sc1
  buffer_load_dwordx4 v[44:47], v1, s[4:7], s63 offen offset:1024 sc0 sc1
  s_waitcnt vmcnt(3)
  v_mfma_f32_16x16x32_bf16 v[120:123], v[88:91], v[124:127], 0
  s_waitcnt vmcnt(2)
  ds_write_b128 v12, v[88:91] offset:0
  v_mfma_f32_16x16x32_bf16 v[120:123], v[92:95], v[124:127], v[120:123]
  ds_write_b128 v12, v[92:95] offset:1024
  s_nop 6
  v_cmp_u_f32 vcc, v120, v121
  v_cmp_u_f32 s[96:97], v122, v123
  s_nop 0
  s_or_b64 s[96:97], vcc, s[96:97]
  s_cbranch_scc0 h2b_1594
  s_add_u32 s47, s47, 1
  s_mov_b32 s49, 7
  s_cmp_gt_u32 s47, 131072
  s_cbranch_scc1 TIMEOUT
  s_branch h2_1592
h2b_1594:
  v_smfmac_f32_16x16x64_bf16 v[96:99], v[88:91], a[64:71], v2
  buffer_load_dwordx4 v1, s[4:7], s72 offen offset:0 sc1 lds
  v_smfmac_f32_16x16x64_bf16 v[100:103], v[88:91], a[72:79], v2
  buffer_load_dwordx4 v1, s[4:7], s72 offen offset:1024 sc1 lds
  v_smfmac_f32_16x16x64_bf16 v[96:99], v[92:95], a[80:87], v2
  s_waitcnt lgkmcnt(0)
  s_barrier
  ds_read_b128 v[16:19], v10 offset:0
  ds_read_b128 v[20:23], v10 offset:1024
  v_smfmac_f32_16x16x64_bf16 v[100:103], v[92:95], a[88:95], v2
  ds_read_b128 v[24:27], v13 offset:0
  v_smfmac_f32_16x16x64_bf16 v[104:107], v[88:91], a[160:167], v2
  ds_read_b128 v[28:31], v13 offset:1024
  v_smfmac_f32_16x16x64_bf16 v[108:111], v[88:91], a[168:175], v2
  ds_read_b128 v[32:35], v15 offset:0
  v_smfmac_f32_16x16x64_bf16 v[104:107], v[92:95], a[176:183], v2
  ds_read_b128 v[36:39], v15 offset:1024
  v_smfmac_f32_16x16x64_bf16 v[108:111], v[92:95], a[184:191], v2
  s_branch h2d_1595
h2a_1593:
  v_smfmac_f32_16x16x64_bf16 v[96:99], v[40:43], a[64:71], v2
  buffer_load_dwordx4 v1, s[4:7], s72 offen offset:0 sc1 lds
  v_smfmac_f32_16x16x64_bf16 v[100:103], v[40:43], a[72:79], v2
  buffer_load_dwordx4 v1, s[4:7], s72 offen offset:1024 sc1 lds
  v_smfmac_f32_16x16x64_bf16 v[96:99], v[44:47], a[80:87], v2
  s_waitcnt lgkmcnt(0)
  s_barrier
  ds_read_b128 v[16:19], v10 offset:0
  ds_read_b128 v[20:23], v10 offset:1024
  v_smfmac_f32_16x16x64_bf16 v[100:103], v[44:47], a[88:95], v2
  ds_read_b128 v[24:27], v13 offset:0
  v_smfmac_f32_16x16x64_bf16 v[104:107], v[40:43], a[160:167], v2
  ds_read_b128 v[28:31], v13 offset:1024
  v_smfmac_f32_16x16x64_bf16 v[108:111], v[40:43], a[168:175], v2
  ds_read_b128 v[32:35], v15 offset:0
  v_smfmac_f32_16x16x64_bf16 v[104:107], v[44:47], a[176:183], v2
  ds_read_b128 v[36:39], v15 offset:1024
  v_smfmac_f32_16x16x64_bf16 v[108:111], v[44:47], a[184:191], v2
h2d_1595:
  s_branch CF_LOOP
CF_FINAL:
  s_waitcnt vmcnt(0)
  s_barrier
  s_cmp_lg_u32 s44, 1
  s_cbranch_scc1 END
  s_mov_b64 exec, 1
  buffer_store_dword v2, off, s[4:7], s59 sc1
  s_mov_b64 exec, -1
  s_branch END
CHAIN_SAFE:
  s_cmp_lg_u32 s44, 0
  s_cbranch_scc1 cm_1596
  s_add_u32 s92, s76, 24576
  s_mov_b64 exec, s[68:69]
  buffer_store_dwordx2 v[44:45], v8, s[4:7], s92 offen sc1
  s_mov_b64 exec, -1
cm_1596:
  s_add_u32 s92, s58, 4096
  buffer_load_dword v11, v9, s[4:7], s92 offen sc1
  s_mov_b32 s101, 0
poll_1597:
  buffer_load_dword v123, v9, s[4:7], s58 offen sc1
  s_waitcnt vmcnt(0)
  v_cmp_eq_u32 vcc, 0, v123
  s_nop 0
  s_cbranch_vccz polld_1598
  s_add_u32 s47, s47, 1
  s_mov_b32 s49, 6
  s_cmp_gt_u32 s47, 131072
  s_cbranch_scc1 TIMEOUT
  s_sleep 3
  s_branch poll_1597
polld_1598:
  s_add_u32 s72, s57, s74
  s_add_u32 s72, s72, 8192
  s_add_u32 s73, s72, 8192
  s_add_u32 m0, s74, 131072
  s_nop 0
  buffer_load_dwordx4 v1, s[4:7], s72 offen offset:0 sc1 lds
  buffer_load_dwordx4 v1, s[4:7], s72 offen offset:1024 sc1 lds
  buffer_load_dwordx4 v[80:83], v1, s[4:7], s73 offen offset:0 sc1
  buffer_load_dwordx4 v[84:87], v1, s[4:7], s73 offen offset:1024 sc1
  s_mov_b32 s54, 0
  v_cmp_ne_u32 s[98:99], 0, v11
  s_lshl_b32 s80, s45, 7
  s_add_u32 s80, s80, 0x80000
  s_add_u32 s63, s78, 24576
  s_cmp_eq_u64 s[98:99], -1
  s_cselect_b32 s71, 0, 1
  s_cselect_b32 s92, 0x100000, 0
  s_cmp_ge_u32 s54, 62
  s_cselect_b32 s71, 0, s71
  s_cselect_b32 s92, 0xffe00000, s92
  s_add_u32 s92, s92, s57
  s_add_u32 s72, s92, s74
  s_add_u32 s72, s72, 8192
  s_add_u32 s73, s72, 8192
  s_add_u32 s92, s58, 4096
  s_cmp_lg_u32 s71, 0
  s_cselect_b32 s73, s92, s73
  s_add_u32 m0, s74, 139264
  s_add_u32 s79, s57, s75
  s_add_u32 s81, s58, 8192
  s_cmp_ge_u32 s54, 61
  s_cselect_b32 s81, s58, s81
  ds_read_b128 v[48:51], v3 offset:0
  ds_read_b128 v[52:55], v3 offset:1024
  ds_read_b128 v[56:59], v3 offset:2048
  ds_read_b128 v[60:63], v3 offset:3072
  ds_read_b128 v[64:67], v3 offset:4096
  ds_read_b128 v[68:71], v3 offset:5120
  ds_read_b128 v[72:75], v3 offset:6144
  ds_read_b128 v[76:79], v3 offset:7168
  v_mov_b64 v[112:113], 0
  v_mov_b64 v[114:115], 0
  v_mov_b64 v[116:117], 0
  v_mov_b64 v[118:119], 0
  v_mov_b64 v[96:97], 0
  v_mov_b64 v[98:99], 0
  v_mov_b64 v[100:101], 0
  v_mov_b64 v[102:103], 0
  v_mov_b64 v[104:105], 0
  v_mov_b64 v[106:107], 0
  v_mov_b64 v[108:109], 0
  v_mov_b64 v[110:111], 0
  buffer_load_dwordx4 v[40:43], v1, s[4:7], s63 offen offset:0 sc0 sc1
  buffer_load_dwordx4 v[44:47], v1, s[4:7], s63 offen offset:1024 sc0 sc1
h2_1599:
  buffer_load_dwordx4 v[88:91], v1, s[4:7], s63 offen offset:0 sc0 sc1
  buffer_load_dwordx4 v[92:95], v1, s[4:7], s63 offen offset:1024 sc0 sc1
  s_waitcnt vmcnt(3)
  v_mfma_f32_16x16x32_bf16 v[120:123], v[40:43], v[124:127], 0
  s_waitcnt vmcnt(2)
  ds_write_b128 v12, v[40:43] offset:0
  v_mfma_f32_16x16x32_bf16 v[120:123], v[44:47], v[124:127], v[120:123]
  ds_write_b128 v12, v[44:47] offset:1024
  s_nop 6
  v_cmp_u_f32 vcc, v120, v121
  v_cmp_u_f32 s[96:97], v122, v123
  s_nop 0
  s_or_b64 s[96:97], vcc, s[96:97]
  s_cbranch_scc0 h2a_1600
  buffer_load_dwordx4 v[40:43], v1, s[4:7], s63 offen offset:0 sc0 sc1
  buffer_load_dwordx4 v[44:47], v1, s[4:7], s63 offen offset:1024 sc0 sc1
  s_waitcnt vmcnt(3)
  v_mfma_f32_16x16x32_bf16 v[120:123], v[88:91], v[124:127], 0
  s_waitcnt vmcnt(2)
  ds_write_b128 v12, v[88:91] offset:0
  v_mfma_f32_16x16x32_bf16 v[120:123], v[92:95], v[124:127], v[120:123]
  ds_write_b128 v12, v[92:95] offset:1024
  s_nop 6
  v_cmp_u_f32 vcc, v120, v121
  v_cmp_u_f32 s[96:97], v122, v123
  s_nop 0
  s_or_b64 s[96:97], vcc, s[96:97]
  s_cbranch_scc0 h2b_1601
  s_add_u32 s47, s47, 1
  s_mov_b32 s49, 7
  s_cmp_gt_u32 s47, 131072
  s_cbranch_scc1 TIMEOUT
  s_branch h2_1599
h2b_1601:
  v_smfmac_f32_16x16x64_bf16 v[96:99], v[88:91], a[64:71], v2
  buffer_load_dwordx4 v1, s[4:7], s72 offen offset:0 sc1 lds
  v_smfmac_f32_16x16x64_bf16 v[100:103], v[88:91], a[72:79], v2
  buffer_load_dwordx4 v1, s[4:7], s72 offen offset:1024 sc1 lds
  v_smfmac_f32_16x16x64_bf16 v[96:99], v[92:95], a[80:87], v2
  s_waitcnt lgkmcnt(0)
  s_barrier
  ds_read_b128 v[16:19], v10 offset:0
  ds_read_b128 v[20:23], v10 offset:1024
  v_smfmac_f32_16x16x64_bf16 v[100:103], v[92:95], a[88:95], v2
  ds_read_b128 v[24:27], v13 offset:0
  v_smfmac_f32_16x16x64_bf16 v[104:107], v[88:91], a[160:167], v2
  ds_read_b128 v[28:31], v13 offset:1024
  v_smfmac_f32_16x16x64_bf16 v[108:111], v[88:91], a[168:175], v2
  ds_read_b128 v[32:35], v15 offset:0
  v_smfmac_f32_16x16x64_bf16 v[104:107], v[92:95], a[176:183], v2
  ds_read_b128 v[36:39], v15 offset:1024
  v_smfmac_f32_16x16x64_bf16 v[108:111], v[92:95], a[184:191], v2
  s_branch h2d_1602
h2a_1600:
  v_smfmac_f32_16x16x64_bf16 v[96:99], v[40:43], a[64:71], v2
  buffer_load_dwordx4 v1, s[4:7], s72 offen offset:0 sc1 lds
  v_smfmac_f32_16x16x64_bf16 v[100:103], v[40:43], a[72:79], v2
  buffer_load_dwordx4 v1, s[4:7], s72 offen offset:1024 sc1 lds
  v_smfmac_f32_16x16x64_bf16 v[96:99], v[44:47], a[80:87], v2
  s_waitcnt lgkmcnt(0)
  s_barrier
  ds_read_b128 v[16:19], v10 offset:0
  ds_read_b128 v[20:23], v10 offset:1024
  v_smfmac_f32_16x16x64_bf16 v[100:103], v[44:47], a[88:95], v2
  ds_read_b128 v[24:27], v13 offset:0
  v_smfmac_f32_16x16x64_bf16 v[104:107], v[40:43], a[160:167], v2
  ds_read_b128 v[28:31], v13 offset:1024
  v_smfmac_f32_16x16x64_bf16 v[108:111], v[40:43], a[168:175], v2
  ds_read_b128 v[32:35], v15 offset:0
  v_smfmac_f32_16x16x64_bf16 v[104:107], v[44:47], a[176:183], v2
  ds_read_b128 v[36:39], v15 offset:1024
  v_smfmac_f32_16x16x64_bf16 v[108:111], v[44:47], a[184:191], v2
h2d_1602:
CS_LOOP:
  s_waitcnt lgkmcnt(5)
  v_smfmac_f32_16x16x64_bf16 v[96:99], v[16:19], v[48:55], v2
  buffer_load_dwordx4 v[88:91], v1, s[4:7], s73 offen offset:0 sc1
  v_smfmac_f32_16x16x64_bf16 v[100:103], v[16:19], v[56:63], v2
  s_mov_b64 exec, 1
  buffer_store_dword v2, off, s[4:7], s80 sc1
  s_mov_b64 exec, -1
  s_waitcnt lgkmcnt(4)
  v_smfmac_f32_16x16x64_bf16 v[96:99], v[20:23], v[64:71], v2
  buffer_load_dwordx4 v[92:95], v1, s[4:7], s73 offen offset:1024 sc1
  v_smfmac_f32_16x16x64_bf16 v[100:103], v[20:23], v[72:79], v2
  s_and_b32 s87, s54, 3
  s_lshl_b32 s88, s87, 13
  ds_read_b128 v[48:51], v3 offset:8192
  s_waitcnt lgkmcnt(4)
  v_smfmac_f32_16x16x64_bf16 v[96:99], v[24:27], a[0:7], v2
  s_add_u32 s85, s76, s88
  s_add_u32 s63, s78, s88
  ds_read_b128 v[52:55], v3 offset:9216
  v_smfmac_f32_16x16x64_bf16 v[100:103], v[24:27], a[8:15], v2
  s_xor_b32 s88, s88, 16384
  s_add_u32 s65, s76, s88
  ds_read_b128 v[56:59], v3 offset:10240
  s_waitcnt lgkmcnt(5)
  v_smfmac_f32_16x16x64_bf16 v[96:99], v[28:31], a[16:23], v2
  s_lshl_b32 s88, s87, 18
  s_add_u32 s64, s70, s88
  ds_read_b128 v[60:63], v3 offset:11264
  v_smfmac_f32_16x16x64_bf16 v[100:103], v[28:31], a[24:31], v2
  s_add_u32 s86, s64, 32768
  s_add_u32 s83, s77, s88
  ds_read_b128 v[64:67], v3 offset:12288
  s_waitcnt lgkmcnt(6)
  v_smfmac_f32_16x16x64_bf16 v[96:99], v[32:35], a[32:39], v2
  s_add_u32 s84, s83, 4096
  s_add_u32 s87, s87, 3
  ds_read_b128 v[68:71], v3 offset:13312
  v_smfmac_f32_16x16x64_bf16 v[100:103], v[32:35], a[40:47], v2
  s_and_b32 s87, s87, 3
  s_lshl_b32 s87, s87, 18
  ds_read_b128 v[72:75], v3 offset:14336
  s_waitcnt lgkmcnt(7)
  v_smfmac_f32_16x16x64_bf16 v[96:99], v[36:39], a[48:55], v2
  s_add_u32 s62, s77, s87
  s_add_u32 s62, s62, s74
  ds_read_b128 v[76:79], v3 offset:15360
  v_smfmac_f32_16x16x64_bf16 v[100:103], v[36:39], a[56:63], v2
  v_mov_b64 v[120:121], -1
  v_smfmac_f32_16x16x64_bf16 v[104:107], v[24:27], a[96:103], v2
  v_mov_b64 v[122:123], -1
  v_smfmac_f32_16x16x64_bf16 v[108:111], v[24:27], a[104:111], v2
  buffer_store_dwordx4 v[120:123], v1, s[4:7], s62 offen offset:0 sc1
  v_smfmac_f32_16x16x64_bf16 v[104:107], v[28:31], a[112:119], v2
  v_add_f32 v96, v96, v98
  v_smfmac_f32_16x16x64_bf16 v[108:111], v[28:31], a[120:127], v2
  s_waitcnt lgkmcnt(6)
  v_add_f32 v97, v97, v99
  v_smfmac_f32_16x16x64_bf16 v[104:107], v[16:19], v[48:55], v2
  s_waitcnt lgkmcnt(4)
  v_cvt_pk_bf16_f32 v125, v96, v97
  v_smfmac_f32_16x16x64_bf16 v[108:111], v[16:19], v[56:63], v2
  s_waitcnt lgkmcnt(2)
  v_add_f32 v100, v100, v102
  v_smfmac_f32_16x16x64_bf16 v[104:107], v[20:23], v[64:71], v2
  s_waitcnt lgkmcnt(0)
  v_add_f32 v101, v101, v103
  v_smfmac_f32_16x16x64_bf16 v[108:111], v[20:23], v[72:79], v2
  ds_read_b128 v[48:51], v3 offset:16384
  v_smfmac_f32_16x16x64_bf16 v[104:107], v[32:35], a[128:135], v2
  ds_read_b128 v[52:55], v3 offset:17408
  v_smfmac_f32_16x16x64_bf16 v[108:111], v[32:35], a[136:143], v2
  ds_read_b128 v[56:59], v3 offset:18432
  v_smfmac_f32_16x16x64_bf16 v[104:107], v[36:39], a[144:151], v2
  ds_read_b128 v[60:63], v3 offset:19456
  v_smfmac_f32_16x16x64_bf16 v[108:111], v[36:39], a[152:159], v2
  s_waitcnt vmcnt(7)
  v_cvt_pk_bf16_f32 v127, v100, v101
  v_smfmac_f32_16x16x64_bf16 v[112:115], v[40:43], v[128:135], v2
  ds_write2_b32 v4, v125, v127 offset0:1 offset1:129
  v_smfmac_f32_16x16x64_bf16 v[116:119], v[40:43], v[136:143], v2
  s_waitcnt vmcnt(6)
  v_add_f32 v104, v104, v106
  v_add_f32 v105, v105, v107
  v_cvt_pk_bf16_f32 v124, v104, v105
  v_smfmac_f32_16x16x64_bf16 v[112:115], v[44:47], v[144:151], v2
  v_add_f32 v108, v108, v110
  v_add_f32 v109, v109, v111
  v_cvt_pk_bf16_f32 v126, v108, v109
  v_smfmac_f32_16x16x64_bf16 v[116:119], v[44:47], v[152:159], v2
  ds_write2_b32 v4, v124, v126 offset0:0 offset1:128
  v_smfmac_f32_16x16x64_bf16 v[112:115], v[24:27], a[192:199], v2
  ds_read_b128 v[64:67], v3 offset:20480
  v_smfmac_f32_16x16x64_bf16 v[116:119], v[24:27], a[200:207], v2
  ds_read_b128 v[68:71], v3 offset:21504
  v_smfmac_f32_16x16x64_bf16 v[112:115], v[28:31], a[208:215], v2
  ds_read_b128 v[72:75], v3 offset:22528
  ds_read_b128 v[76:79], v3 offset:23552
  v_smfmac_f32_16x16x64_bf16 v[116:119], v[28:31], a[216:223], v2
  s_waitcnt lgkmcnt(4)
  s_barrier
  ds_read_b64_tr_b16 v[96:97], v5 offset:0
  ds_read_b64_tr_b16 v[98:99], v5 offset:128
  v_smfmac_f32_16x16x64_bf16 v[112:115], v[16:19], v[48:55], v2
  ds_read_b64_tr_b16 v[100:101], v5 offset:1024
  ds_read_b64_tr_b16 v[102:103], v5 offset:1152
  v_smfmac_f32_16x16x64_bf16 v[116:119], v[16:19], v[56:63], v2
  s_waitcnt lgkmcnt(6)
  ds_read_b64_tr_b16 v[104:105], v5 offset:2048
  ds_read_b64_tr_b16 v[106:107], v5 offset:2176
  v_smfmac_f32_16x16x64_bf16 v[112:115], v[20:23], v[64:71], v2
  s_waitcnt lgkmcnt(6)
  ds_read_b64_tr_b16 v[108:109], v5 offset:3072
  ds_read_b64_tr_b16 v[110:111], v5 offset:3200
  v_smfmac_f32_16x16x64_bf16 v[116:119], v[20:23], v[72:79], v2
  ds_read_b128 v[40:43], v14 offset:0
  v_smfmac_f32_16x16x64_bf16 v[112:115], v[32:35], a[224:231], v2
  ds_read_b128 v[44:47], v14 offset:1024
  v_smfmac_f32_16x16x64_bf16 v[116:119], v[32:35], a[232:239], v2
  ds_read_b128 v[24:27], v14 offset:2048
  v_smfmac_f32_16x16x64_bf16 v[112:115], v[36:39], a[240:247], v2
  ds_read_b128 v[28:31], v14 offset:3072
  v_smfmac_f32_16x16x64_bf16 v[116:119], v[36:39], a[248:255], v2
  s_waitcnt lgkmcnt(10)
  buffer_store_dwordx4 v[120:123], v1, s[4:7], s62 offen offset:1024 sc1
  v_mfma_f32_16x16x32_bf16 v[56:59], v[96:99], v[96:99], 0
  s_waitcnt lgkmcnt(8)
  ds_read_b128 v[64:67], v14 offset:4096
  ds_read_b128 v[68:71], v14 offset:5120
  v_mfma_f32_16x16x32_bf16 v[56:59], v[100:103], v[100:103], v[56:59]
  s_waitcnt lgkmcnt(8)
  ds_read_b128 v[72:75], v14 offset:6144
  ds_read_b128 v[76:79], v14 offset:7168
  v_mfma_f32_16x16x32_bf16 v[56:59], v[104:107], v[104:107], v[56:59]
  s_waitcnt lgkmcnt(8)
  v_add_f32 v112, v112, v114
  v_add_f32 v113, v113, v115
  v_mfma_f32_16x16x32_bf16 v[56:59], v[108:111], v[108:111], v[56:59]
  s_waitcnt lgkmcnt(7)
  v_cvt_pk_bf16_f32 v125, v112, v113
  v_add_f32 v116, v116, v118
  v_mfma_f32_16x16x32_bf16 v[48:51], v[40:43], v[96:99], 0
  s_waitcnt lgkmcnt(6)
  v_add_f32 v117, v117, v119
  v_cvt_pk_bf16_f32 v127, v116, v117
  v_mfma_f32_16x16x32_bf16 v[48:51], v[44:47], v[100:103], v[48:51]
  s_waitcnt lgkmcnt(5)
  buffer_store_dwordx4 v[124:127], v1, s[4:7], s79 offen sc1
  v_mfma_f32_16x16x32_bf16 v[48:51], v[24:27], v[104:107], v[48:51]
  s_waitcnt lgkmcnt(4)
  buffer_load_dword v11, v9, s[4:7], s81 offen sc1
  v_mfma_f32_16x16x32_bf16 v[48:51], v[28:31], v[108:111], v[48:51]
  s_waitcnt lgkmcnt(3)
  v_mov_b32 v116, 0x3f803f80
  v_mov_b32 v117, 0x3f803f80
  v_mfma_f32_16x16x32_bf16 v[52:55], v[64:67], v[96:99], 0
  s_waitcnt lgkmcnt(2)
  v_mov_b64 v[118:119], v[116:117]
  v_mov_b64 v[16:17], 0
  v_mfma_f32_16x16x32_bf16 v[52:55], v[68:71], v[100:103], v[52:55]
  s_waitcnt lgkmcnt(1)
  v_mov_b64 v[18:19], 0
  v_mov_b64 v[20:21], 0
  v_mfma_f32_16x16x32_bf16 v[52:55], v[72:75], v[104:107], v[52:55]
  s_waitcnt lgkmcnt(0)
  v_mov_b64 v[22:23], 0
  v_mfma_f32_16x16x32_bf16 v[52:55], v[76:79], v[108:111], v[52:55]
  v_max3_f32 v120, v56, v57, v48
  v_max3_f32 v121, v49, v50, v51
  v_mov_b64 v[24:25], 0
  v_mov_b64 v[26:27], 0
  v_mov_b64 v[28:29], 0
  v_mov_b64 v[30:31], 0
  v_mov_b32 v64, 0
  s_cmp_eq_u32 s54, 63
  s_cbranch_scc1 CS_FINAL
  v_max3_f32 v120, v120, v121, v52
  v_max3_f32 v121, v53, v54, v55
  v_max_f32 v120, v120, v121
  v_mov_b32 v121, v120
  v_mov_b64 v[32:33], 0
  v_mov_b64 v[34:35], 0
  v_permlane16_swap_b32 v120, v121
  v_max_f32 v120, v120, v121
  v_mov_b32 v121, v120
  v_mov_b64 v[36:37], 0
  v_mov_b64 v[38:39], 0
  v_permlane32_swap_b32 v120, v121
  v_max_f32 v120, v120, v121
  v_mul_f32 v120, s60, v120
  v_fma_f32 v120, -abs(v120), s89, v120
  v_pk_fma_f32 v[56:57], v[56:57], s[60:61], v[120:121] op_sel_hi:[1,1,0] neg_lo:[0,0,1] neg_hi:[0,0,1]
  v_pk_fma_f32 v[48:49], v[48:49], s[60:61], v[120:121] op_sel_hi:[1,1,0] neg_lo:[0,0,1] neg_hi:[0,0,1]
  v_pk_fma_f32 v[50:51], v[50:51], s[60:61], v[120:121] op_sel_hi:[1,1,0] neg_lo:[0,0,1] neg_hi:[0,0,1]
  v_pk_fma_f32 v[52:53], v[52:53], s[60:61], v[120:121] op_sel_hi:[1,1,0] neg_lo:[0,0,1] neg_hi:[0,0,1]
  v_pk_fma_f32 v[54:55], v[54:55], s[60:61], v[120:121] op_sel_hi:[1,1,0] neg_lo:[0,0,1] neg_hi:[0,0,1]
  v_exp_f32_e64 v56, v56 clamp
  v_exp_f32_e64 v57, v57 clamp
  v_exp_f32_e64 v48, v48 clamp
  v_cvt_pk_bf16_f32 v65, v56, v57
  v_exp_f32_e64 v49, v49 clamp
  v_exp_f32_e64 v50, v50 clamp
  v_mfma_f32_16x16x16_bf16 v[76:79], v[116:117], v[64:65], 0
  v_exp_f32_e64 v51, v51 clamp
  v_mfma_f32_16x16x16_bf16 v[68:71], v[124:125], v[64:65], 0
  v_exp_f32_e64 v52, v52 clamp
  v_mfma_f32_16x16x16_bf16 v[72:75], v[126:127], v[64:65], 0
  v_exp_f32_e64 v53, v53 clamp
  v_exp_f32_e64 v54, v54 clamp
  v_exp_f32_e64 v55, v55 clamp
  v_cvt_pk_bf16_f32 v60, v48, v49
  v_cvt_pk_bf16_f32 v61, v50, v51
  v_cvt_pk_bf16_f32 v62, v52, v53
  v_cvt_pk_bf16_f32 v63, v54, v55
  v_mov_b64 v[96:97], 0
  v_mov_b64 v[98:99], 0
  v_mfma_f32_16x16x32_bf16 v[76:79], v[116:119], v[60:63], v[76:79]
  v_mfma_f32_16x16x32_bf16 v[68:71], v[80:83], v[60:63], v[68:71]
  v_mfma_f32_16x16x32_bf16 v[72:75], v[84:87], v[60:63], v[72:75]
  ds_read_b128 v[124:127], v14 offset:31232
  v_mov_b64 v[100:101], 0
  v_mov_b64 v[102:103], 0
  v_mov_b64 v[104:105], 0
  v_mov_b64 v[106:107], 0
  s_nop 0
  v_rcp_f32 v76, v76
  s_nop 0
  v_pk_mul_f32 v[68:69], v[68:69], v[76:77] op_sel_hi:[1,0]
  v_cvt_pk_bf16_f32 v112, v68, v69
  v_pk_mul_f32 v[70:71], v[70:71], v[76:77] op_sel_hi:[1,0]
  v_cvt_pk_bf16_f32 v113, v70, v71
  v_pk_mul_f32 v[72:73], v[72:73], v[76:77] op_sel_hi:[1,0]
  v_cvt_pk_bf16_f32 v114, v72, v73
  v_pk_mul_f32 v[74:75], v[74:75], v[76:77] op_sel_hi:[1,0]
  v_cvt_pk_bf16_f32 v115, v74, v75
  s_mov_b64 exec, s[66:67]
  ds_write_b128 v6, v[112:115]
  s_mov_b64 exec, -1
  v_mov_b64 v[108:109], 0
  v_mov_b64 v[110:111], 0
  v_mov_b64 v[40:41], 0
  v_mov_b64 v[42:43], 0
  v_mov_b64 v[44:45], 0
  v_mov_b64 v[46:47], 0
  s_cmp_eq_u32 s71, 0
  s_cbranch_scc1 k2_1603
  s_waitcnt vmcnt(6)
  v_min3_u32 v120, v88, v89, v90
  v_min_u32 v120, v120, v91
  s_nop 0
  v_readfirstlane_b32 s92, v120
  s_nop 0
  s_cmp_eq_u32 s92, 0
  s_cbranch_scc1 k2_1603
  s_add_u32 s92, s57, 0x100000
  s_add_u32 s72, s92, s74
  s_add_u32 s72, s72, 8192
  s_add_u32 s73, s72, 8192
  s_mov_b32 s71, 0
  buffer_load_dwordx4 v1, s[4:7], s72 offen offset:0 sc1 lds
  buffer_load_dwordx4 v1, s[4:7], s72 offen offset:1024 sc1 lds
  buffer_load_dwordx4 v[88:91], v1, s[4:7], s73 offen offset:0 sc1
  buffer_load_dwordx4 v[92:95], v1, s[4:7], s73 offen offset:1024 sc1
k2_1603:
  s_waitcnt lgkmcnt(0)
  s_barrier
  ds_read_b128 v[80:83], v14 offset:28672
  ds_read_b128 v[84:87], v14 offset:29696
  ds_read_b128 v[48:51], v3 offset:24576
  ds_read_b128 v[52:55], v3 offset:25600
  ds_read_b128 v[56:59], v3 offset:26624
  ds_read_b128 v[60:63], v3 offset:27648
  s_waitcnt lgkmcnt(5)
  v_smfmac_f32_16x16x64_bf16 v[32:35], v[80:83], v[192:199], v2
  ds_read_b128 v[64:67], v3 offset:28672
  v_smfmac_f32_16x16x64_bf16 v[36:39], v[80:83], v[200:207], v2
  s_waitcnt lgkmcnt(5)
  ds_read_b128 v[68:71], v3 offset:29696
  v_smfmac_f32_16x16x64_bf16 v[32:35], v[84:87], v[208:215], v2
  ds_read_b128 v[72:75], v3 offset:30720
  v_smfmac_f32_16x16x64_bf16 v[36:39], v[84:87], v[216:223], v2
  ds_read_b128 v[76:79], v3 offset:31744
  v_smfmac_f32_16x16x64_bf16 v[40:43], v[80:83], v[224:231], v2
  v_smfmac_f32_16x16x64_bf16 v[44:47], v[80:83], v[232:239], v2
  s_nop 2
  v_add_f32 v32, v32, v34
  v_add_f32 v33, v33, v35
  v_cvt_pk_bf16_f32 v116, v32, v33
  v_smfmac_f32_16x16x64_bf16 v[40:43], v[84:87], v[240:247], v2
  v_add_f32 v36, v36, v38
  v_add_f32 v37, v37, v39
  v_cvt_pk_bf16_f32 v117, v36, v37
  v_smfmac_f32_16x16x64_bf16 v[44:47], v[84:87], v[248:255], v2
  v_smfmac_f32_16x16x64_bf16 v[24:27], v[80:83], v[160:167], v2
  v_smfmac_f32_16x16x64_bf16 v[28:31], v[80:83], v[168:175], v2
  s_nop 1
  v_add_f32 v40, v40, v42
  v_add_f32 v41, v41, v43
  v_cvt_pk_bf16_f32 v118, v40, v41
  v_smfmac_f32_16x16x64_bf16 v[24:27], v[84:87], v[176:183], v2
  v_add_f32 v44, v44, v46
  v_add_f32 v45, v45, v47
  v_cvt_pk_bf16_f32 v119, v44, v45
  v_smfmac_f32_16x16x64_bf16 v[28:31], v[84:87], v[184:191], v2
  s_waitcnt lgkmcnt(6)
  buffer_store_dwordx4 v[116:119], v7, s[4:7], s86 offen sc1
  v_smfmac_f32_16x16x64_bf16 v[16:19], v[80:83], v[48:55], v2
  s_waitcnt lgkmcnt(4)
  v_smfmac_f32_16x16x64_bf16 v[20:23], v[80:83], v[56:63], v2
  s_waitcnt lgkmcnt(2)
  v_add_f32 v24, v24, v26
  v_smfmac_f32_16x16x64_bf16 v[16:19], v[84:87], v[64:71], v2
  s_waitcnt lgkmcnt(0)
  v_add_f32 v25, v25, v27
  v_smfmac_f32_16x16x64_bf16 v[20:23], v[84:87], v[72:79], v2
  v_cvt_pk_bf16_f32 v114, v24, v25
  s_cmp_lg_u32 s44, 0
  v_add_f32 v28, v28, v30
  v_add_f32 v29, v29, v31
  v_cvt_pk_bf16_f32 v115, v28, v29
  v_pk_add_f32 v[16:17], v[16:17], v[18:19]
  v_cvt_pk_bf16_f32 v112, v16, v17
  s_nop 0
  v_pk_add_f32 v[20:21], v[20:21], v[22:23]
  v_cvt_pk_bf16_f32 v113, v20, v21
  buffer_store_dwordx4 v[112:115], v7, s[4:7], s64 offen sc1
  ds_read_b128 v[48:51], v3 offset:0
  ds_read_b128 v[52:55], v3 offset:1024
  ds_read_b128 v[56:59], v3 offset:2048
  ds_read_b128 v[60:63], v3 offset:3072
  ds_read_b128 v[64:67], v3 offset:4096
  ds_read_b128 v[68:71], v3 offset:5120
  ds_read_b128 v[72:75], v3 offset:6144
  ds_read_b128 v[76:79], v3 offset:7168
  v_mov_b64 v[112:113], 0
  v_mov_b64 v[114:115], 0
  v_mov_b64 v[116:117], 0
  v_mov_b64 v[118:119], 0
  s_waitcnt vmcnt(2)
  v_cmp_ne_u32 vcc, 0, v11
  s_add_u32 s54, s54, 1
  s_add_u32 s57, s57, 0x100000
  s_add_u32 s58, s58, 4096
  s_mov_b32 s80, s59
  s_add_u32 s59, s59, 4096
  s_mov_b64 s[98:99], vcc
  s_cmp_lg_u32 s44, 0
  s_cbranch_scc1 hw1_1605
  s_sleep 5
h1_1607:
  buffer_load_dwordx4 v[16:19], v1, s[4:7], s83 offen offset:0 sc0 sc1
  buffer_load_dwordx4 v[20:23], v1, s[4:7], s83 offen offset:1024 sc0 sc1
  buffer_load_dwordx4 v[24:27], v1, s[4:7], s83 offen offset:2048 sc0 sc1
  buffer_load_dwordx4 v[28:31], v1, s[4:7], s83 offen offset:3072 sc0 sc1
  buffer_load_dwordx4 v[32:35], v1, s[4:7], s84 offen offset:0 sc0 sc1
  buffer_load_dwordx4 v[36:39], v1, s[4:7], s84 offen offset:1024 sc0 sc1
  buffer_load_dwordx4 v[40:43], v1, s[4:7], s84 offen offset:2048 sc0 sc1
  buffer_load_dwordx4 v[44:47], v1, s[4:7], s84 offen offset:3072 sc0 sc1
h1s_1608:
  s_waitcnt vmcnt(7)
  v_mfma_f32_16x16x32_bf16 v[120:123], v[16:19], v[124:127], 0
  s_waitcnt vmcnt(6)
  v_mfma_f32_16x16x32_bf16 v[120:123], v[20:23], v[124:127], v[120:123]
  s_waitcnt vmcnt(5)
  v_mfma_f32_16x16x32_bf16 v[120:123], v[24:27], v[124:127], v[120:123]
  s_waitcnt vmcnt(4)
  v_mfma_f32_16x16x32_bf16 v[120:123], v[28:31], v[124:127], v[120:123]
  s_waitcnt vmcnt(3)
  v_mfma_f32_16x16x32_bf16 v[120:123], v[32:35], v[124:127], v[120:123]
  s_waitcnt vmcnt(2)
  v_mfma_f32_16x16x32_bf16 v[120:123], v[36:39], v[124:127], v[120:123]
  s_waitcnt vmcnt(1)
  v_mfma_f32_16x16x32_bf16 v[120:123], v[40:43], v[124:127], v[120:123]
  s_waitcnt vmcnt(0)
  v_mfma_f32_16x16x32_bf16 v[120:123], v[44:47], v[124:127], v[120:123]
  s_mov_b64 exec, s[68:69]
  s_nop 6
  v_cvt_pk_bf16_f32 v16, v120, v121
  v_cvt_pk_bf16_f32 v17, v122, v123
  buffer_store_dwordx2 v[16:17], v8, s[4:7], s85 offen sc1
  v_cmp_u_f32 vcc, v120, v121
  v_cmp_u_f32 s[96:97], v122, v123
  s_mov_b64 exec, -1
  s_or_b64 s[96:97], vcc, s[96:97]
  s_cbranch_scc0 hd0_1606
  s_add_u32 s47, s47, 1
  s_mov_b32 s49, 8
  s_cmp_gt_u32 s47, 131072
  s_cbranch_scc1 TIMEOUT
  s_branch h1_1607
hw1_1605:
  s_mov_b32 s87, s71
  s_cmp_eq_u32 s71, 0
  s_cbranch_scc1 nk_1609
  s_mov_b32 s101, 0
poll_1610:
  buffer_load_dword v123, v9, s[4:7], s58 offen sc1
  s_waitcnt vmcnt(0)
  v_cmp_eq_u32 vcc, 0, v123
  s_nop 0
  s_cbranch_vccz polld_1611
  s_add_u32 s47, s47, 1
  s_mov_b32 s49, 6
  s_cmp_gt_u32 s47, 131072
  s_cbranch_scc1 TIMEOUT
  s_sleep 3
  s_branch poll_1610
polld_1611:
  s_add_u32 s72, s57, s74
  s_add_u32 s72, s72, 8192
  s_add_u32 s73, s72, 8192
  s_add_u32 m0, s74, 139264
  s_nop 0
  buffer_load_dwordx4 v1, s[4:7], s72 offen offset:0 sc1 lds
  buffer_load_dwordx4 v1, s[4:7], s72 offen offset:1024 sc1 lds
  buffer_load_dwordx4 v[88:91], v1, s[4:7], s73 offen offset:0 sc1
  buffer_load_dwordx4 v[92:95], v1, s[4:7], s73 offen offset:1024 sc1
  s_waitcnt vmcnt(0)
nk_1609:
  s_cmp_eq_u64 s[98:99], -1
  s_cselect_b32 s71, 0, 1
  s_cselect_b32 s92, 0x100000, 0
  s_cmp_ge_u32 s54, 62
  s_cselect_b32 s71, 0, s71
  s_cselect_b32 s92, 0xffe00000, s92
  s_add_u32 s92, s92, s57
  s_add_u32 s72, s92, s74
  s_add_u32 s72, s72, 8192
  s_add_u32 s73, s72, 8192
  s_add_u32 s92, s58, 4096
  s_cmp_lg_u32 s71, 0
  s_cselect_b32 s73, s92, s73
  s_add_u32 m0, s74, 131072
  s_add_u32 s79, s57, s75
  s_add_u32 s81, s58, 8192
  s_cmp_ge_u32 s54, 61
  s_cselect_b32 s81, s58, s81
  s_sleep 5
  s_cmp_lg_u32 s44, 1
  s_cbranch_scc1 nz_1612
  v_mov_b64 v[120:121], -1
  s_mov_b64 exec, s[68:69]
  buffer_store_dwordx2 v[120:121], v8, s[4:7], s65 offen sc1
  s_mov_b64 exec, -1
nz_1612:
  s_cmp_lg_u32 s87, 0
  s_cbranch_scc1 hdn_1604
  s_sleep 7
  s_branch hdn_1604
hd0_1606:
  s_cmp_eq_u32 s71, 0
  s_cbranch_scc1 nk_1613
  s_mov_b32 s101, 0
poll_1614:
  buffer_load_dword v123, v9, s[4:7], s58 offen sc1
  s_waitcnt vmcnt(0)
  v_cmp_eq_u32 vcc, 0, v123
  s_nop 0
  s_cbranch_vccz polld_1615
  s_add_u32 s47, s47, 1
  s_mov_b32 s49, 6
  s_cmp_gt_u32 s47, 131072
  s_cbranch_scc1 TIMEOUT
  s_sleep 3
  s_branch poll_1614
polld_1615:
  s_add_u32 s72, s57, s74
  s_add_u32 s72, s72, 8192
  s_add_u32 s73, s72, 8192
  s_add_u32 m0, s74, 139264
  s_nop 0
  buffer_load_dwordx4 v1, s[4:7], s72 offen offset:0 sc1 lds
  buffer_load_dwordx4 v1, s[4:7], s72 offen offset:1024 sc1 lds
  buffer_load_dwordx4 v[88:91], v1, s[4:7], s73 offen offset:0 sc1
  buffer_load_dwordx4 v[92:95], v1, s[4:7], s73 offen offset:1024 sc1
  s_waitcnt vmcnt(0)
nk_1613:
  s_cmp_eq_u64 s[98:99], -1
  s_cselect_b32 s71, 0, 1
  s_cselect_b32 s92, 0x100000, 0
  s_cmp_ge_u32 s54, 62
  s_cselect_b32 s71, 0, s71
  s_cselect_b32 s92, 0xffe00000, s92
  s_add_u32 s92, s92, s57
  s_add_u32 s72, s92, s74
  s_add_u32 s72, s72, 8192
  s_add_u32 s73, s72, 8192
  s_add_u32 s92, s58, 4096
  s_cmp_lg_u32 s71, 0
  s_cselect_b32 s73, s92, s73
  s_add_u32 m0, s74, 131072
  s_add_u32 s79, s57, s75
  s_add_u32 s81, s58, 8192
  s_cmp_ge_u32 s54, 61
  s_cselect_b32 s81, s58, s81
hdn_1604:
  buffer_load_dwordx4 v[40:43], v1, s[4:7], s63 offen offset:0 sc0 sc1
  buffer_load_dwordx4 v[44:47], v1, s[4:7], s63 offen offset:1024 sc0 sc1
  s_sleep 3
h2_1616:
  buffer_load_dwordx4 v[80:83], v1, s[4:7], s63 offen offset:0 sc0 sc1
  buffer_load_dwordx4 v[84:87], v1, s[4:7], s63 offen offset:1024 sc0 sc1
  s_waitcnt vmcnt(3)
  v_mfma_f32_16x16x32_bf16 v[120:123], v[40:43], v[124:127], 0
  s_waitcnt vmcnt(2)
  ds_write_b128 v12, v[40:43] offset:0
  v_mfma_f32_16x16x32_bf16 v[120:123], v[44:47], v[124:127], v[120:123]
  ds_write_b128 v12, v[44:47] offset:1024
  s_nop 6
  v_cmp_u_f32 vcc, v120, v121
  v_cmp_u_f32 s[96:97], v122, v123
  s_nop 0
  s_or_b64 s[96:97], vcc, s[96:97]
  s_cbranch_scc0 h2a_1617
  buffer_load_dwordx4 v[40:43], v1, s[4:7], s63 offen offset:0 sc0 sc1
  buffer_load_dwordx4 v[44:47], v1, s[4:7], s63 offen offset:1024 sc0 sc1
  s_waitcnt vmcnt(3)
  v_mfma_f32_16x16x32_bf16 v[120:123], v[80:83], v[124:127], 0
  s_waitcnt vmcnt(2)
  ds_write_b128 v12, v[80:83] offset:0
  v_mfma_f32_16x16x32_bf16 v[120:123], v[84:87], v[124:127], v[120:123]
  ds_write_b128 v12, v[84:87] offset:1024
  s_nop 6
  v_cmp_u_f32 vcc, v120, v121
  v_cmp_u_f32 s[96:97], v122, v123
  s_nop 0
  s_or_b64 s[96:97], vcc, s[96:97]
  s_cbranch_scc0 h2b_1618
  s_add_u32 s47, s47, 1
  s_mov_b32 s49, 7
  s_cmp_gt_u32 s47, 131072
  s_cbranch_scc1 TIMEOUT
  s_branch h2_1616
h2b_1618:
  v_smfmac_f32_16x16x64_bf16 v[96:99], v[80:83], a[64:71], v2
  buffer_load_dwordx4 v1, s[4:7], s72 offen offset:0 sc1 lds
  v_smfmac_f32_16x16x64_bf16 v[100:103], v[80:83], a[72:79], v2
  buffer_load_dwordx4 v1, s[4:7], s72 offen offset:1024 sc1 lds
  v_smfmac_f32_16x16x64_bf16 v[96:99], v[84:87], a[80:87], v2
  s_waitcnt lgkmcnt(0)
  s_barrier
  ds_read_b128 v[16:19], v10 offset:0
  ds_read_b128 v[20:23], v10 offset:1024
  v_smfmac_f32_16x16x64_bf16 v[100:103], v[84:87], a[88:95], v2
  ds_read_b128 v[24:27], v13 offset:0
  v_smfmac_f32_16x16x64_bf16 v[104:107], v[80:83], a[160:167], v2
  ds_read_b128 v[28:31], v13 offset:1024
  v_smfmac_f32_16x16x64_bf16 v[108:111], v[80:83], a[168:175], v2
  ds_read_b128 v[32:35], v15 offset:0
  v_smfmac_f32_16x16x64_bf16 v[104:107], v[84:87], a[176:183], v2
  ds_read_b128 v[36:39], v15 offset:1024
  v_smfmac_f32_16x16x64_bf16 v[108:111], v[84:87], a[184:191], v2
  s_branch h2d_1619
h2a_1617:
  v_smfmac_f32_16x16x64_bf16 v[96:99], v[40:43], a[64:71], v2
  buffer_load_dwordx4 v1, s[4:7], s72 offen offset:0 sc1 lds
  v_smfmac_f32_16x16x64_bf16 v[100:103], v[40:43], a[72:79], v2
  buffer_load_dwordx4 v1, s[4:7], s72 offen offset:1024 sc1 lds
  v_smfmac_f32_16x16x64_bf16 v[96:99], v[44:47], a[80:87], v2
  s_waitcnt lgkmcnt(0)
  s_barrier
  ds_read_b128 v[16:19], v10 offset:0
  ds_read_b128 v[20:23], v10 offset:1024
  v_smfmac_f32_16x16x64_bf16 v[100:103], v[44:47], a[88:95], v2
  ds_read_b128 v[24:27], v13 offset:0
  v_smfmac_f32_16x16x64_bf16 v[104:107], v[40:43], a[160:167], v2
  ds_read_b128 v[28:31], v13 offset:1024
  v_smfmac_f32_16x16x64_bf16 v[108:111], v[40:43], a[168:175], v2
  ds_read_b128 v[32:35], v15 offset:0
  v_smfmac_f32_16x16x64_bf16 v[104:107], v[44:47], a[176:183], v2
  ds_read_b128 v[36:39], v15 offset:1024
  v_smfmac_f32_16x16x64_bf16 v[108:111], v[44:47], a[184:191], v2
h2d_1619:
  s_waitcnt lgkmcnt(5)
  v_smfmac_f32_16x16x64_bf16 v[96:99], v[16:19], v[48:55], v2
  buffer_load_dwordx4 v[80:83], v1, s[4:7], s73 offen offset:0 sc1
  v_smfmac_f32_16x16x64_bf16 v[100:103], v[16:19], v[56:63], v2
  s_mov_b64 exec, 1
  buffer_store_dword v2, off, s[4:7], s80 sc1
  s_mov_b64 exec, -1
  s_waitcnt lgkmcnt(4)
  v_smfmac_f32_16x16x64_bf16 v[96:99], v[20:23], v[64:71], v2
  buffer_load_dwordx4 v[84:87], v1, s[4:7], s73 offen offset:1024 sc1
  v_smfmac_f32_16x16x64_bf16 v[100:103], v[20:23], v[72:79], v2
  s_and_b32 s87, s54, 3
  s_lshl_b32 s88, s87, 13
  ds_read_b128 v[48:51], v3 offset:8192
  s_waitcnt lgkmcnt(4)
  v_smfmac_f32_16x16x64_bf16 v[96:99], v[24:27], a[0:7], v2
  s_add_u32 s85, s76, s88
  s_add_u32 s63, s78, s88
  ds_read_b128 v[52:55], v3 offset:9216
  v_smfmac_f32_16x16x64_bf16 v[100:103], v[24:27], a[8:15], v2
  s_xor_b32 s88, s88, 16384
  s_add_u32 s65, s76, s88
  ds_read_b128 v[56:59], v3 offset:10240
  s_waitcnt lgkmcnt(5)
  v_smfmac_f32_16x16x64_bf16 v[96:99], v[28:31], a[16:23], v2
  s_lshl_b32 s88, s87, 18
  s_add_u32 s64, s70, s88
  ds_read_b128 v[60:63], v3 offset:11264
  v_smfmac_f32_16x16x64_bf16 v[100:103], v[28:31], a[24:31], v2
  s_add_u32 s86, s64, 32768
  s_add_u32 s83, s77, s88
  ds_read_b128 v[64:67], v3 offset:12288
  s_waitcnt lgkmcnt(6)
  v_smfmac_f32_16x16x64_bf16 v[96:99], v[32:35], a[32:39], v2
  s_add_u32 s84, s83, 4096
  s_add_u32 s87, s87, 3
  ds_read_b128 v[68:71], v3 offset:13312
  v_smfmac_f32_16x16x64_bf16 v[100:103], v[32:35], a[40:47], v2
  s_and_b32 s87, s87, 3
  s_lshl_b32 s87, s87, 18
  ds_read_b128 v[72:75], v3 offset:14336
  s_waitcnt lgkmcnt(7)
  v_smfmac_f32_16x16x64_bf16 v[96:99], v[36:39], a[48:55], v2
  s_add_u32 s62, s77, s87
  s_add_u32 s62, s62, s74
  ds_read_b128 v[76:79], v3 offset:15360
  v_smfmac_f32_16x16x64_bf16 v[100:103], v[36:39], a[56:63], v2
  v_mov_b64 v[120:121], -1
  v_smfmac_f32_16x16x64_bf16 v[104:107], v[24:27], a[96:103], v2
  v_mov_b64 v[122:123], -1
  v_smfmac_f32_16x16x64_bf16 v[108:111], v[24:27], a[104:111], v2
  buffer_store_dwordx4 v[120:123], v1, s[4:7], s62 offen offset:0 sc1
  v_smfmac_f32_16x16x64_bf16 v[104:107], v[28:31], a[112:119], v2
  v_add_f32 v96, v96, v98
  v_smfmac_f32_16x16x64_bf16 v[108:111], v[28:31], a[120:127], v2
  s_waitcnt lgkmcnt(6)
  v_add_f32 v97, v97, v99
  v_smfmac_f32_16x16x64_bf16 v[104:107], v[16:19], v[48:55], v2
  s_waitcnt lgkmcnt(4)
  v_cvt_pk_bf16_f32 v125, v96, v97
  v_smfmac_f32_16x16x64_bf16 v[108:111], v[16:19], v[56:63], v2
  s_waitcnt lgkmcnt(2)
  v_add_f32 v100, v100, v102
  v_smfmac_f32_16x16x64_bf16 v[104:107], v[20:23], v[64:71], v2
  s_waitcnt lgkmcnt(0)
  v_add_f32 v101, v101, v103
  v_smfmac_f32_16x16x64_bf16 v[108:111], v[20:23], v[72:79], v2
  ds_read_b128 v[48:51], v3 offset:16384
  v_smfmac_f32_16x16x64_bf16 v[104:107], v[32:35], a[128:135], v2
  ds_read_b128 v[52:55], v3 offset:17408
  v_smfmac_f32_16x16x64_bf16 v[108:111], v[32:35], a[136:143], v2
  ds_read_b128 v[56:59], v3 offset:18432
  v_smfmac_f32_16x16x64_bf16 v[104:107], v[36:39], a[144:151], v2
  ds_read_b128 v[60:63], v3 offset:19456
  v_smfmac_f32_16x16x64_bf16 v[108:111], v[36:39], a[152:159], v2
  s_waitcnt vmcnt(7)
  v_cvt_pk_bf16_f32 v127, v100, v101
  v_smfmac_f32_16x16x64_bf16 v[112:115], v[40:43], v[128:135], v2
  ds_write2_b32 v4, v125, v127 offset0:1 offset1:129
  v_smfmac_f32_16x16x64_bf16 v[116:119], v[40:43], v[136:143], v2
  s_waitcnt vmcnt(6)
  v_add_f32 v104, v104, v106
  v_add_f32 v105, v105, v107
  v_cvt_pk_bf16_f32 v124, v104, v105
  v_smfmac_f32_16x16x64_bf16 v[112:115], v[44:47], v[144:151], v2
  v_add_f32 v108, v108, v110
  v_add_f32 v109, v109, v111
  v_cvt_pk_bf16_f32 v126, v108, v109
  v_smfmac_f32_16x16x64_bf16 v[116:119], v[44:47], v[152:159], v2
  ds_write2_b32 v4, v124, v126 offset0:0 offset1:128
  v_smfmac_f32_16x16x64_bf16 v[112:115], v[24:27], a[192:199], v2
  ds_read_b128 v[64:67], v3 offset:20480
  v_smfmac_f32_16x16x64_bf16 v[116:119], v[24:27], a[200:207], v2
  ds_read_b128 v[68:71], v3 offset:21504
  v_smfmac_f32_16x16x64_bf16 v[112:115], v[28:31], a[208:215], v2
  ds_read_b128 v[72:75], v3 offset:22528
  ds_read_b128 v[76:79], v3 offset:23552
  v_smfmac_f32_16x16x64_bf16 v[116:119], v[28:31], a[216:223], v2
  s_waitcnt lgkmcnt(4)
  s_barrier
  ds_read_b64_tr_b16 v[96:97], v5 offset:0
  ds_read_b64_tr_b16 v[98:99], v5 offset:128
  v_smfmac_f32_16x16x64_bf16 v[112:115], v[16:19], v[48:55], v2
  ds_read_b64_tr_b16 v[100:101], v5 offset:1024
  ds_read_b64_tr_b16 v[102:103], v5 offset:1152
  v_smfmac_f32_16x16x64_bf16 v[116:119], v[16:19], v[56:63], v2
  s_waitcnt lgkmcnt(6)
  ds_read_b64_tr_b16 v[104:105], v5 offset:2048
  ds_read_b64_tr_b16 v[106:107], v5 offset:2176
  v_smfmac_f32_16x16x64_bf16 v[112:115], v[20:23], v[64:71], v2
  s_waitcnt lgkmcnt(6)
  ds_read_b64_tr_b16 v[108:109], v5 offset:3072
  ds_read_b64_tr_b16 v[110:111], v5 offset:3200
  v_smfmac_f32_16x16x64_bf16 v[116:119], v[20:23], v[72:79], v2
  ds_read_b128 v[40:43], v14 offset:8192
  v_smfmac_f32_16x16x64_bf16 v[112:115], v[32:35], a[224:231], v2
  ds_read_b128 v[44:47], v14 offset:9216
  v_smfmac_f32_16x16x64_bf16 v[116:119], v[32:35], a[232:239], v2
  ds_read_b128 v[24:27], v14 offset:10240
  v_smfmac_f32_16x16x64_bf16 v[112:115], v[36:39], a[240:247], v2
  ds_read_b128 v[28:31], v14 offset:11264
  v_smfmac_f32_16x16x64_bf16 v[116:119], v[36:39], a[248:255], v2
  s_waitcnt lgkmcnt(10)
  buffer_store_dwordx4 v[120:123], v1, s[4:7], s62 offen offset:1024 sc1
  v_mfma_f32_16x16x32_bf16 v[56:59], v[96:99], v[96:99], 0
  s_waitcnt lgkmcnt(8)
  ds_read_b128 v[64:67], v14 offset:12288
  ds_read_b128 v[68:71], v14 offset:13312
  v_mfma_f32_16x16x32_bf16 v[56:59], v[100:103], v[100:103], v[56:59]
  s_waitcnt lgkmcnt(8)
  ds_read_b128 v[72:75], v14 offset:14336
  ds_read_b128 v[76:79], v14 offset:15360
  v_mfma_f32_16x16x32_bf16 v[56:59], v[104:107], v[104:107], v[56:59]
  s_waitcnt lgkmcnt(8)
  v_add_f32 v112, v112, v114
  v_add_f32 v113, v113, v115
  v_mfma_f32_16x16x32_bf16 v[56:59], v[108:111], v[108:111], v[56:59]
  s_waitcnt lgkmcnt(7)
  v_cvt_pk_bf16_f32 v125, v112, v113
  v_add_f32 v116, v116, v118
  v_mfma_f32_16x16x32_bf16 v[48:51], v[40:43], v[96:99], 0
  s_waitcnt lgkmcnt(6)
  v_add_f32 v117, v117, v119
  v_cvt_pk_bf16_f32 v127, v116, v117
  v_mfma_f32_16x16x32_bf16 v[48:51], v[44:47], v[100:103], v[48:51]
  s_waitcnt lgkmcnt(5)
  buffer_store_dwordx4 v[124:127], v1, s[4:7], s79 offen sc1
  v_mfma_f32_16x16x32_bf16 v[48:51], v[24:27], v[104:107], v[48:51]
  s_waitcnt lgkmcnt(4)
  buffer_load_dword v11, v9, s[4:7], s81 offen sc1
  v_mfma_f32_16x16x32_bf16 v[48:51], v[28:31], v[108:111], v[48:51]
  s_waitcnt lgkmcnt(3)
  v_mov_b32 v116, 0x3f803f80
  v_mov_b32 v117, 0x3f803f80
  v_mfma_f32_16x16x32_bf16 v[52:55], v[64:67], v[96:99], 0
  s_waitcnt lgkmcnt(2)
  v_mov_b64 v[118:119], v[116:117]
  v_mov_b64 v[16:17], 0
  v_mfma_f32_16x16x32_bf16 v[52:55], v[68:71], v[100:103], v[52:55]
  s_waitcnt lgkmcnt(1)
  v_mov_b64 v[18:19], 0
  v_mov_b64 v[20:21], 0
  v_mfma_f32_16x16x32_bf16 v[52:55], v[72:75], v[104:107], v[52:55]
  s_waitcnt lgkmcnt(0)
  v_mov_b64 v[22:23], 0
  v_mfma_f32_16x16x32_bf16 v[52:55], v[76:79], v[108:111], v[52:55]
  v_max3_f32 v120, v56, v57, v48
  v_max3_f32 v121, v49, v50, v51
  v_mov_b64 v[24:25], 0
  v_mov_b64 v[26:27], 0
  v_mov_b64 v[28:29], 0
  v_mov_b64 v[30:31], 0
  v_mov_b32 v64, 0
  s_cmp_eq_u32 s54, 63
  s_cbranch_scc1 CS_FINAL
  v_max3_f32 v120, v120, v121, v52
  v_max3_f32 v121, v53, v54, v55
  v_max_f32 v120, v120, v121
  v_mov_b32 v121, v120
  v_mov_b64 v[32:33], 0
  v_mov_b64 v[34:35], 0
  v_permlane16_swap_b32 v120, v121
  v_max_f32 v120, v120, v121
  v_mov_b32 v121, v120
  v_mov_b64 v[36:37], 0
  v_mov_b64 v[38:39], 0
  v_permlane32_swap_b32 v120, v121
  v_max_f32 v120, v120, v121
  v_mul_f32 v120, s60, v120
  v_fma_f32 v120, -abs(v120), s89, v120
  v_pk_fma_f32 v[56:57], v[56:57], s[60:61], v[120:121] op_sel_hi:[1,1,0] neg_lo:[0,0,1] neg_hi:[0,0,1]
  v_pk_fma_f32 v[48:49], v[48:49], s[60:61], v[120:121] op_sel_hi:[1,1,0] neg_lo:[0,0,1] neg_hi:[0,0,1]
  v_pk_fma_f32 v[50:51], v[50:51], s[60:61], v[120:121] op_sel_hi:[1,1,0] neg_lo:[0,0,1] neg_hi:[0,0,1]
  v_pk_fma_f32 v[52:53], v[52:53], s[60:61], v[120:121] op_sel_hi:[1,1,0] neg_lo:[0,0,1] neg_hi:[0,0,1]
  v_pk_fma_f32 v[54:55], v[54:55], s[60:61], v[120:121] op_sel_hi:[1,1,0] neg_lo:[0,0,1] neg_hi:[0,0,1]
  v_exp_f32_e64 v56, v56 clamp
  v_exp_f32_e64 v57, v57 clamp
  v_exp_f32_e64 v48, v48 clamp
  v_cvt_pk_bf16_f32 v65, v56, v57
  v_exp_f32_e64 v49, v49 clamp
  v_exp_f32_e64 v50, v50 clamp
  v_mfma_f32_16x16x16_bf16 v[76:79], v[116:117], v[64:65], 0
  v_exp_f32_e64 v51, v51 clamp
  v_mfma_f32_16x16x16_bf16 v[68:71], v[124:125], v[64:65], 0
  v_exp_f32_e64 v52, v52 clamp
  v_mfma_f32_16x16x16_bf16 v[72:75], v[126:127], v[64:65], 0
  v_exp_f32_e64 v53, v53 clamp
  v_exp_f32_e64 v54, v54 clamp
  v_exp_f32_e64 v55, v55 clamp
  v_cvt_pk_bf16_f32 v60, v48, v49
  v_cvt_pk_bf16_f32 v61, v50, v51
  v_cvt_pk_bf16_f32 v62, v52, v53
  v_cvt_pk_bf16_f32 v63, v54, v55
  v_mov_b64 v[96:97], 0
  v_mov_b64 v[98:99], 0
  v_mfma_f32_16x16x32_bf16 v[76:79], v[116:119], v[60:63], v[76:79]
  v_mfma_f32_16x16x32_bf16 v[68:71], v[88:91], v[60:63], v[68:71]
  v_mfma_f32_16x16x32_bf16 v[72:75], v[92:95], v[60:63], v[72:75]
  ds_read_b128 v[124:127], v14 offset:31232
  v_mov_b64 v[100:101], 0
  v_mov_b64 v[102:103], 0
  v_mov_b64 v[104:105], 0
  v_mov_b64 v[106:107], 0
  s_nop 0
  v_rcp_f32 v76, v76
  s_nop 0
  v_pk_mul_f32 v[68:69], v[68:69], v[76:77] op_sel_hi:[1,0]
  v_cvt_pk_bf16_f32 v112, v68, v69
  v_pk_mul_f32 v[70:71], v[70:71], v[76:77] op_sel_hi:[1,0]
  v_cvt_pk_bf16_f32 v113, v70, v71
  v_pk_mul_f32 v[72:73], v[72:73], v[76:77] op_sel_hi:[1,0]
  v_cvt_pk_bf16_f32 v114, v72, v73
  v_pk_mul_f32 v[74:75], v[74:75], v[76:77] op_sel_hi:[1,0]
  v_cvt_pk_bf16_f32 v115, v74, v75
  s_mov_b64 exec, s[66:67]
  ds_write_b128 v6, v[112:115]
  s_mov_b64 exec, -1
  v_mov_b64 v[108:109], 0
  v_mov_b64 v[110:111], 0
  v_mov_b64 v[40:41], 0
  v_mov_b64 v[42:43], 0
  v_mov_b64 v[44:45], 0
  v_mov_b64 v[46:47], 0
  s_cmp_eq_u32 s71, 0
  s_cbranch_scc1 k2_1620
  s_waitcnt vmcnt(6)
  v_min3_u32 v120, v80, v81, v82
  v_min_u32 v120, v120, v83
  s_nop 0
  v_readfirstlane_b32 s92, v120
  s_nop 0
  s_cmp_eq_u32 s92, 0
  s_cbranch_scc1 k2_1620
  s_add_u32 s92, s57, 0x100000
  s_add_u32 s72, s92, s74
  s_add_u32 s72, s72, 8192
  s_add_u32 s73, s72, 8192
  s_mov_b32 s71, 0
  buffer_load_dwordx4 v1, s[4:7], s72 offen offset:0 sc1 lds
  buffer_load_dwordx4 v1, s[4:7], s72 offen offset:1024 sc1 lds
  buffer_load_dwordx4 v[80:83], v1, s[4:7], s73 offen offset:0 sc1
  buffer_load_dwordx4 v[84:87], v1, s[4:7], s73 offen offset:1024 sc1
k2_1620:
  s_waitcnt lgkmcnt(0)
  s_barrier
  ds_read_b128 v[88:91], v14 offset:28672
  ds_read_b128 v[92:95], v14 offset:29696
  ds_read_b128 v[48:51], v3 offset:24576
  ds_read_b128 v[52:55], v3 offset:25600
  ds_read_b128 v[56:59], v3 offset:26624
  ds_read_b128 v[60:63], v3 offset:27648
  s_waitcnt lgkmcnt(5)
  v_smfmac_f32_16x16x64_bf16 v[32:35], v[88:91], v[192:199], v2
  ds_read_b128 v[64:67], v3 offset:28672
  v_smfmac_f32_16x16x64_bf16 v[36:39], v[88:91], v[200:207], v2
  s_waitcnt lgkmcnt(5)
  ds_read_b128 v[68:71], v3 offset:29696
  v_smfmac_f32_16x16x64_bf16 v[32:35], v[92:95], v[208:215], v2
  ds_read_b128 v[72:75], v3 offset:30720
  v_smfmac_f32_16x16x64_bf16 v[36:39], v[92:95], v[216:223], v2
  ds_read_b128 v[76:79], v3 offset:31744
  v_smfmac_f32_16x16x64_bf16 v[40:43], v[88:91], v[224:231], v2
  v_smfmac_f32_16x16x64_bf16 v[44:47], v[88:91], v[232:239], v2
  s_nop 2
  v_add_f32 v32, v32, v34
  v_add_f32 v33, v33, v35
  v_cvt_pk_bf16_f32 v116, v32, v33
  v_smfmac_f32_16x16x64_bf16 v[40:43], v[92:95], v[240:247], v2
  v_add_f32 v36, v36, v38
  v_add_f32 v37, v37, v39
  v_cvt_pk_bf16_f32 v117, v36, v37
  v_smfmac_f32_16x16x64_bf16 v[44:47], v[92:95], v[248:255], v2
  v_smfmac_f32_16x16x64_bf16 v[24:27], v[88:91], v[160:167], v2
  v_smfmac_f32_16x16x64_bf16 v[28:31], v[88:91], v[168:175], v2
  s_nop 1
  v_add_f32 v40, v40, v42
  v_add_f32 v41, v41, v43
  v_cvt_pk_bf16_f32 v118, v40, v41
  v_smfmac_f32_16x16x64_bf16 v[24:27], v[92:95], v[176:183], v2
  v_add_f32 v44, v44, v46
  v_add_f32 v45, v45, v47
  v_cvt_pk_bf16_f32 v119, v44, v45
  v_smfmac_f32_16x16x64_bf16 v[28:31], v[92:95], v[184:191], v2
  s_waitcnt lgkmcnt(6)
  buffer_store_dwordx4 v[116:119], v7, s[4:7], s86 offen sc1
  v_smfmac_f32_16x16x64_bf16 v[16:19], v[88:91], v[48:55], v2
  s_waitcnt lgkmcnt(4)
  v_smfmac_f32_16x16x64_bf16 v[20:23], v[88:91], v[56:63], v2
  s_waitcnt lgkmcnt(2)
  v_add_f32 v24, v24, v26
  v_smfmac_f32_16x16x64_bf16 v[16:19], v[92:95], v[64:71], v2
  s_waitcnt lgkmcnt(0)
  v_add_f32 v25, v25, v27
  v_smfmac_f32_16x16x64_bf16 v[20:23], v[92:95], v[72:79], v2
  v_cvt_pk_bf16_f32 v114, v24, v25
  s_cmp_lg_u32 s44, 0
  v_add_f32 v28, v28, v30
  v_add_f32 v29, v29, v31
  v_cvt_pk_bf16_f32 v115, v28, v29
  v_pk_add_f32 v[16:17], v[16:17], v[18:19]
  v_cvt_pk_bf16_f32 v112, v16, v17
  s_nop 0
  v_pk_add_f32 v[20:21], v[20:21], v[22:23]
  v_cvt_pk_bf16_f32 v113, v20, v21
  buffer_store_dwordx4 v[112:115], v7, s[4:7], s64 offen sc1
  ds_read_b128 v[48:51], v3 offset:0
  ds_read_b128 v[52:55], v3 offset:1024
  ds_read_b128 v[56:59], v3 offset:2048
  ds_read_b128 v[60:63], v3 offset:3072
  ds_read_b128 v[64:67], v3 offset:4096
  ds_read_b128 v[68:71], v3 offset:5120
  ds_read_b128 v[72:75], v3 offset:6144
  ds_read_b128 v[76:79], v3 offset:7168
  v_mov_b64 v[112:113], 0
  v_mov_b64 v[114:115], 0
  v_mov_b64 v[116:117], 0
  v_mov_b64 v[118:119], 0
  s_waitcnt vmcnt(2)
  v_cmp_ne_u32 vcc, 0, v11
  s_add_u32 s54, s54, 1
  s_add_u32 s57, s57, 0x100000
  s_add_u32 s58, s58, 4096
  s_mov_b32 s80, s59
  s_add_u32 s59, s59, 4096
  s_mov_b64 s[98:99], vcc
  s_cmp_lg_u32 s44, 0
  s_cbranch_scc1 hw1_1622
  s_sleep 5
h1_1624:
  buffer_load_dwordx4 v[16:19], v1, s[4:7], s83 offen offset:0 sc0 sc1
  buffer_load_dwordx4 v[20:23], v1, s[4:7], s83 offen offset:1024 sc0 sc1
  buffer_load_dwordx4 v[24:27], v1, s[4:7], s83 offen offset:2048 sc0 sc1
  buffer_load_dwordx4 v[28:31], v1, s[4:7], s83 offen offset:3072 sc0 sc1
  buffer_load_dwordx4 v[32:35], v1, s[4:7], s84 offen offset:0 sc0 sc1
  buffer_load_dwordx4 v[36:39], v1, s[4:7], s84 offen offset:1024 sc0 sc1
  buffer_load_dwordx4 v[40:43], v1, s[4:7], s84 offen offset:2048 sc0 sc1
  buffer_load_dwordx4 v[44:47], v1, s[4:7], s84 offen offset:3072 sc0 sc1
h1s_1625:
  s_waitcnt vmcnt(7)
  v_mfma_f32_16x16x32_bf16 v[120:123], v[16:19], v[124:127], 0
  s_waitcnt vmcnt(6)
  v_mfma_f32_16x16x32_bf16 v[120:123], v[20:23], v[124:127], v[120:123]
  s_waitcnt vmcnt(5)
  v_mfma_f32_16x16x32_bf16 v[120:123], v[24:27], v[124:127], v[120:123]
  s_waitcnt vmcnt(4)
  v_mfma_f32_16x16x32_bf16 v[120:123], v[28:31], v[124:127], v[120:123]
  s_waitcnt vmcnt(3)
  v_mfma_f32_16x16x32_bf16 v[120:123], v[32:35], v[124:127], v[120:123]
  s_waitcnt vmcnt(2)
  v_mfma_f32_16x16x32_bf16 v[120:123], v[36:39], v[124:127], v[120:123]
  s_waitcnt vmcnt(1)
  v_mfma_f32_16x16x32_bf16 v[120:123], v[40:43], v[124:127], v[120:123]
  s_waitcnt vmcnt(0)
  v_mfma_f32_16x16x32_bf16 v[120:123], v[44:47], v[124:127], v[120:123]
  s_mov_b64 exec, s[68:69]
  s_nop 6
  v_cvt_pk_bf16_f32 v16, v120, v121
  v_cvt_pk_bf16_f32 v17, v122, v123
  buffer_store_dwordx2 v[16:17], v8, s[4:7], s85 offen sc1
  v_cmp_u_f32 vcc, v120, v121
  v_cmp_u_f32 s[96:97], v122, v123
  s_mov_b64 exec, -1
  s_or_b64 s[96:97], vcc, s[96:97]
  s_cbranch_scc0 hd0_1623
  s_add_u32 s47, s47, 1
  s_mov_b32 s49, 8
  s_cmp_gt_u32 s47, 131072
  s_cbranch_scc1 TIMEOUT
  s_branch h1_1624
hw1_1622:
  s_mov_b32 s87, s71
  s_cmp_eq_u32 s71, 0
  s_cbranch_scc1 nk_1626
  s_mov_b32 s101, 0
poll_1627:
  buffer_load_dword v123, v9, s[4:7], s58 offen sc1
  s_waitcnt vmcnt(0)
  v_cmp_eq_u32 vcc, 0, v123
  s_nop 0
  s_cbranch_vccz polld_1628
  s_add_u32 s47, s47, 1
  s_mov_b32 s49, 6
  s_cmp_gt_u32 s47, 131072
  s_cbranch_scc1 TIMEOUT
  s_sleep 3
  s_branch poll_1627
polld_1628:
  s_add_u32 s72, s57, s74
  s_add_u32 s72, s72, 8192
  s_add_u32 s73, s72, 8192
  s_add_u32 m0, s74, 131072
  s_nop 0
  buffer_load_dwordx4 v1, s[4:7], s72 offen offset:0 sc1 lds
  buffer_load_dwordx4 v1, s[4:7], s72 offen offset:1024 sc1 lds
  buffer_load_dwordx4 v[80:83], v1, s[4:7], s73 offen offset:0 sc1
  buffer_load_dwordx4 v[84:87], v1, s[4:7], s73 offen offset:1024 sc1
  s_waitcnt vmcnt(0)
nk_1626:
  s_cmp_eq_u64 s[98:99], -1
  s_cselect_b32 s71, 0, 1
  s_cselect_b32 s92, 0x100000, 0
  s_cmp_ge_u32 s54, 62
  s_cselect_b32 s71, 0, s71
  s_cselect_b32 s92, 0xffe00000, s92
  s_add_u32 s92, s92, s57
  s_add_u32 s72, s92, s74
  s_add_u32 s72, s72, 8192
  s_add_u32 s73, s72, 8192
  s_add_u32 s92, s58, 4096
  s_cmp_lg_u32 s71, 0
  s_cselect_b32 s73, s92, s73
  s_add_u32 m0, s74, 139264
  s_add_u32 s79, s57, s75
  s_add_u32 s81, s58, 8192
  s_cmp_ge_u32 s54, 61
  s_cselect_b32 s81, s58, s81
  s_sleep 5
  s_cmp_lg_u32 s44, 1
  s_cbranch_scc1 nz_1629
  v_mov_b64 v[120:121], -1
  s_mov_b64 exec, s[68:69]
  buffer_store_dwordx2 v[120:121], v8, s[4:7], s65 offen sc1
  s_mov_b64 exec, -1
nz_1629:
  s_cmp_lg_u32 s87, 0
  s_cbranch_scc1 hdn_1621
  s_sleep 7
  s_branch hdn_1621
hd0_1623:
  s_cmp_eq_u32 s71, 0
  s_cbranch_scc1 nk_1630
  s_mov_b32 s101, 0
poll_1631:
  buffer_load_dword v123, v9, s[4:7], s58 offen sc1
  s_waitcnt vmcnt(0)
  v_cmp_eq_u32 vcc, 0, v123
  s_nop 0
  s_cbranch_vccz polld_1632
  s_add_u32 s47, s47, 1
  s_mov_b32 s49, 6
  s_cmp_gt_u32 s47, 131072
  s_cbranch_scc1 TIMEOUT
  s_sleep 3
  s_branch poll_1631
polld_1632:
  s_add_u32 s72, s57, s74
  s_add_u32 s72, s72, 8192
  s_add_u32 s73, s72, 8192
  s_add_u32 m0, s74, 131072
  s_nop 0
  buffer_load_dwordx4 v1, s[4:7], s72 offen offset:0 sc1 lds
  buffer_load_dwordx4 v1, s[4:7], s72 offen offset:1024 sc1 lds
  buffer_load_dwordx4 v[80:83], v1, s[4:7], s73 offen offset:0 sc1
  buffer_load_dwordx4 v[84:87], v1, s[4:7], s73 offen offset:1024 sc1
  s_waitcnt vmcnt(0)
nk_1630:
  s_cmp_eq_u64 s[98:99], -1
  s_cselect_b32 s71, 0, 1
  s_cselect_b32 s92, 0x100000, 0
  s_cmp_ge_u32 s54, 62
  s_cselect_b32 s71, 0, s71
  s_cselect_b32 s92, 0xffe00000, s92
  s_add_u32 s92, s92, s57
  s_add_u32 s72, s92, s74
  s_add_u32 s72, s72, 8192
  s_add_u32 s73, s72, 8192
  s_add_u32 s92, s58, 4096
  s_cmp_lg_u32 s71, 0
  s_cselect_b32 s73, s92, s73
  s_add_u32 m0, s74, 139264
  s_add_u32 s79, s57, s75
  s_add_u32 s81, s58, 8192
  s_cmp_ge_u32 s54, 61
  s_cselect_b32 s81, s58, s81
hdn_1621:
  buffer_load_dwordx4 v[40:43], v1, s[4:7], s63 offen offset:0 sc0 sc1
  buffer_load_dwordx4 v[44:47], v1, s[4:7], s63 offen offset:1024 sc0 sc1
  s_sleep 3
h2_1633:
  buffer_load_dwordx4 v[88:91], v1, s[4:7], s63 offen offset:0 sc0 sc1
  buffer_load_dwordx4 v[92:95], v1, s[4:7], s63 offen offset:1024 sc0 sc1
  s_waitcnt vmcnt(3)
  v_mfma_f32_16x16x32_bf16 v[120:123], v[40:43], v[124:127], 0
  s_waitcnt vmcnt(2)
  ds_write_b128 v12, v[40:43] offset:0
  v_mfma_f32_16x16x32_bf16 v[120:123], v[44:47], v[124:127], v[120:123]
  ds_write_b128 v12, v[44:47] offset:1024
  s_nop 6
  v_cmp_u_f32 vcc, v120, v121
  v_cmp_u_f32 s[96:97], v122, v123
  s_nop 0
  s_or_b64 s[96:97], vcc, s[96:97]
  s_cbranch_scc0 h2a_1634
  buffer_load_dwordx4 v[40:43], v1, s[4:7], s63 offen offset:0 sc0 sc1
  buffer_load_dwordx4 v[44:47], v1, s[4:7], s63 offen offset:1024 sc0 sc1
  s_waitcnt vmcnt(3)
  v_mfma_f32_16x16x32_bf16 v[120:123], v[88:91], v[124:127], 0
  s_waitcnt vmcnt(2)
  ds_write_b128 v12, v[88:91] offset:0
  v_mfma_f32_16x16x32_bf16 v[120:123], v[92:95], v[124:127], v[120:123]
  ds_write_b128 v12, v[92:95] offset:1024
  s_nop 6
  v_cmp_u_f32 vcc, v120, v121
  v_cmp_u_f32 s[96:97], v122, v123
  s_nop 0
  s_or_b64 s[96:97], vcc, s[96:97]
  s_cbranch_scc0 h2b_1635
  s_add_u32 s47, s47, 1
  s_mov_b32 s49, 7
  s_cmp_gt_u32 s47, 131072
  s_cbranch_scc1 TIMEOUT
  s_branch h2_1633
h2b_1635:
  v_smfmac_f32_16x16x64_bf16 v[96:99], v[88:91], a[64:71], v2
  buffer_load_dwordx4 v1, s[4:7], s72 offen offset:0 sc1 lds
  v_smfmac_f32_16x16x64_bf16 v[100:103], v[88:91], a[72:79], v2
  buffer_load_dwordx4 v1, s[4:7], s72 offen offset:1024 sc1 lds
  v_smfmac_f32_16x16x64_bf16 v[96:99], v[92:95], a[80:87], v2
  s_waitcnt lgkmcnt(0)
  s_barrier
  ds_read_b128 v[16:19], v10 offset:0
  ds_read_b128 v[20:23], v10 offset:1024
  v_smfmac_f32_16x16x64_bf16 v[100:103], v[92:95], a[88:95], v2
  ds_read_b128 v[24:27], v13 offset:0
  v_smfmac_f32_16x16x64_bf16 v[104:107], v[88:91], a[160:167], v2
  ds_read_b128 v[28:31], v13 offset:1024
  v_smfmac_f32_16x16x64_bf16 v[108:111], v[88:91], a[168:175], v2
  ds_read_b128 v[32:35], v15 offset:0
  v_smfmac_f32_16x16x64_bf16 v[104:107], v[92:95], a[176:183], v2
  ds_read_b128 v[36:39], v15 offset:1024
  v_smfmac_f32_16x16x64_bf16 v[108:111], v[92:95], a[184:191], v2
  s_branch h2d_1636
h2a_1634:
  v_smfmac_f32_16x16x64_bf16 v[96:99], v[40:43], a[64:71], v2
  buffer_load_dwordx4 v1, s[4:7], s72 offen offset:0 sc1 lds
  v_smfmac_f32_16x16x64_bf16 v[100:103], v[40:43], a[72:79], v2
  buffer_load_dwordx4 v1, s[4:7], s72 offen offset:1024 sc1 lds
  v_smfmac_f32_16x16x64_bf16 v[96:99], v[44:47], a[80:87], v2
  s_waitcnt lgkmcnt(0)
  s_barrier
  ds_read_b128 v[16:19], v10 offset:0
  ds_read_b128 v[20:23], v10 offset:1024
  v_smfmac_f32_16x16x64_bf16 v[100:103], v[44:47], a[88:95], v2
  ds_read_b128 v[24:27], v13 offset:0
  v_smfmac_f32_16x16x64_bf16 v[104:107], v[40:43], a[160:167], v2
  ds_read_b128 v[28:31], v13 offset:1024
  v_smfmac_f32_16x16x64_bf16 v[108:111], v[40:43], a[168:175], v2
  ds_read_b128 v[32:35], v15 offset:0
  v_smfmac_f32_16x16x64_bf16 v[104:107], v[44:47], a[176:183], v2
  ds_read_b128 v[36:39], v15 offset:1024
  v_smfmac_f32_16x16x64_bf16 v[108:111], v[44:47], a[184:191], v2
h2d_1636:
  s_branch CS_LOOP
CS_FINAL:
  s_waitcnt vmcnt(0)
  s_barrier
  s_cmp_lg_u32 s44, 1
  s_cbranch_scc1 END
  s_mov_b64 exec, 1
  buffer_store_dword v2, off, s[4:7], s59 sc1
  s_mov_b64 exec, -1
  s_branch END
ROLE_H:
  s_sub_u32 s92, s45, 64
  s_mul_i32 s50, s92, 171
  s_lshr_b32 s50, s50, 9
  s_mul_i32 s93, s50, 3
  s_sub_u32 s51, s92, s93
  s_lshl_b32 s52, s50, 8
  s_lshl_b32 s92, s44, 6
  s_add_u32 s52, s52, s92
  s_mov_b32 s8, s22
  s_and_b32 s9, s23, 0xffff
  s_mov_b32 s10, 0x400000
  s_mov_b32 s11, 0x20000
  s_and_b32 s92, s25, 0xffff
  s_cmp_eq_u32 s51, 1
  s_cselect_b32 s8, s24, s8
  s_cselect_b32 s9, s92, s9
  s_and_b32 s92, s21, 0xffff
  s_cmp_eq_u32 s51, 2
  s_cselect_b32 s8, s20, s8
  s_cselect_b32 s9, s92, s9
  v_lshrrev_b32 v2, 1, v0
  v_lshlrev_b32 v2, 13, v2
  v_and_b32 v3, 1, v0
  v_lshl_add_u32 v2, v3, 7, v2
  s_lshl_b32 s92, s44, 20
  s_lshl_b32 s93, s50, 8
  s_add_u32 s92, s92, s93
  buffer_load_dword v4, v2, s[8:11], s92 offen
  s_add_u32 s92, s92, 262144
  buffer_load_dword v5, v2, s[8:11], s92 offen
  s_add_u32 s92, s92, 262144
  buffer_load_dword v6, v2, s[8:11], s92 offen
  s_add_u32 s92, s92, 262144
  buffer_load_dword v7, v2, s[8:11], s92 offen
  s_add_u32 s92, s92, 262144
  v_lshrrev_b32 v15, 4, v0
  v_bfe_u32 v16, v0, 2, 2
  v_and_b32 v17, 3, v0
  v_lshl_add_u32 v11, v15, 3, v16
  v_lshlrev_b32 v11, 6, v11
  v_lshl_add_u32 v11, v17, 4, v11
  v_add_u32 v11, s48, v11
  v_lshl_add_u32 v12, v15, 3, v16
  v_lshlrev_b32 v12, 6, v12
  v_lshl_add_u32 v12, v17, 3, v12
  v_add_u32 v12, s48, v12
  v_add_u32 v15, s48, v1
  s_mov_b32 s8, s22
  s_and_b32 s9, s23, 0xffff
  s_mov_b32 s10, 0x400000
  s_mov_b32 s11, 0x20000
  s_mov_b32 s92, 8192
  v_lshrrev_b32 v10, 2, v0
  v_mul_lo_u32 v10, v10, s92
  v_lshl_add_u32 v10, v17, 4, v10
  s_add_u32 m0, s48, 0
  s_add_u32 s92, s52, 0x0
  buffer_load_dwordx4 v10, s[8:11], s92 offen offset:0 lds
  s_add_u32 s92, s52, 0x1fc00
  buffer_load_dwordx4 v10, s[8:11], s92 offen offset:1024 lds
  s_add_u32 s92, s52, 0x3f800
  buffer_load_dwordx4 v10, s[8:11], s92 offen offset:2048 lds
  s_add_u32 s92, s52, 0x5f400
  buffer_load_dwordx4 v10, s[8:11], s92 offen offset:3072 lds
  s_add_u32 m0, s48, 4096
  s_add_u32 s92, s52, 0x80000
  buffer_load_dwordx4 v10, s[8:11], s92 offen offset:0 lds
  s_add_u32 s92, s52, 0x9fc00
  buffer_load_dwordx4 v10, s[8:11], s92 offen offset:1024 lds
  s_add_u32 s92, s52, 0xbf800
  buffer_load_dwordx4 v10, s[8:11], s92 offen offset:2048 lds
  s_add_u32 s92, s52, 0xdf400
  buffer_load_dwordx4 v10, s[8:11], s92 offen offset:3072 lds
  s_add_u32 m0, s48, 8192
  s_add_u32 s92, s52, 0x100000
  buffer_load_dwordx4 v10, s[8:11], s92 offen offset:0 lds
  s_add_u32 s92, s52, 0x11fc00
  buffer_load_dwordx4 v10, s[8:11], s92 offen offset:1024 lds
  s_add_u32 s92, s52, 0x13f800
  buffer_load_dwordx4 v10, s[8:11], s92 offen offset:2048 lds
  s_add_u32 s92, s52, 0x15f400
  buffer_load_dwordx4 v10, s[8:11], s92 offen offset:3072 lds
  s_add_u32 m0, s48, 12288
  s_add_u32 s92, s52, 0x180000
  buffer_load_dwordx4 v10, s[8:11], s92 offen offset:0 lds
  s_add_u32 s92, s52, 0x19fc00
  buffer_load_dwordx4 v10, s[8:11], s92 offen offset:1024 lds
  s_add_u32 s92, s52, 0x1bf800
  buffer_load_dwordx4 v10, s[8:11], s92 offen offset:2048 lds
  s_add_u32 s92, s52, 0x1df400
  buffer_load_dwordx4 v10, s[8:11], s92 offen offset:3072 lds
  s_add_u32 m0, s48, 16384
  s_add_u32 s92, s52, 0x200000
  buffer_load_dwordx4 v10, s[8:11], s92 offen offset:0 lds
  s_add_u32 s92, s52, 0x21fc00
  buffer_load_dwordx4 v10, s[8:11], s92 offen offset:1024 lds
  s_add_u32 s92, s52, 0x23f800
  buffer_load_dwordx4 v10, s[8:11], s92 offen offset:2048 lds
  s_add_u32 s92, s52, 0x25f400
  buffer_load_dwordx4 v10, s[8:11], s92 offen offset:3072 lds
  s_add_u32 m0, s48, 20480
  s_add_u32 s92, s52, 0x280000
  buffer_load_dwordx4 v10, s[8:11], s92 offen offset:0 lds
  s_add_u32 s92, s52, 0x29fc00
  buffer_load_dwordx4 v10, s[8:11], s92 offen offset:1024 lds
  s_add_u32 s92, s52, 0x2bf800
  buffer_load_dwordx4 v10, s[8:11], s92 offen offset:2048 lds
  s_add_u32 s92, s52, 0x2df400
  buffer_load_dwordx4 v10, s[8:11], s92 offen offset:3072 lds
  s_add_u32 m0, s48, 24576
  s_add_u32 s92, s52, 0x300000
  buffer_load_dwordx4 v10, s[8:11], s92 offen offset:0 lds
  s_add_u32 s92, s52, 0x31fc00
  buffer_load_dwordx4 v10, s[8:11], s92 offen offset:1024 lds
  s_add_u32 s92, s52, 0x33f800
  buffer_load_dwordx4 v10, s[8:11], s92 offen offset:2048 lds
  s_add_u32 s92, s52, 0x35f400
  buffer_load_dwordx4 v10, s[8:11], s92 offen offset:3072 lds
  s_add_u32 m0, s48, 28672
  s_add_u32 s92, s52, 0x380000
  buffer_load_dwordx4 v10, s[8:11], s92 offen offset:0 lds
  s_add_u32 s92, s52, 0x39fc00
  buffer_load_dwordx4 v10, s[8:11], s92 offen offset:1024 lds
  s_add_u32 s92, s52, 0x3bf800
  buffer_load_dwordx4 v10, s[8:11], s92 offen offset:2048 lds
  s_add_u32 s92, s52, 0x3df400
  buffer_load_dwordx4 v10, s[8:11], s92 offen offset:3072 lds
  s_waitcnt vmcnt(28)
  ds_read_b64_tr_b16 a[128:129], v11 offset:0
  ds_read_b64_tr_b16 a[130:131], v11 offset:256
  ds_read_b64_tr_b16 a[192:193], v11 offset:8
  ds_read_b64_tr_b16 a[194:195], v11 offset:264
  ds_read_b64_tr_b16 a[132:133], v11 offset:2048
  ds_read_b64_tr_b16 a[134:135], v11 offset:2304
  ds_read_b64_tr_b16 a[196:197], v11 offset:2056
  ds_read_b64_tr_b16 a[198:199], v11 offset:2312
  s_waitcnt lgkmcnt(0)
  s_mov_b32 s8, s24
  s_and_b32 s9, s25, 0xffff
  s_mov_b32 s10, 0x400000
  s_mov_b32 s11, 0x20000
  s_add_u32 m0, s48, 0
  s_add_u32 s92, s52, 0x0
  buffer_load_dwordx4 v10, s[8:11], s92 offen offset:0 lds
  s_add_u32 s92, s52, 0x1fc00
  buffer_load_dwordx4 v10, s[8:11], s92 offen offset:1024 lds
  s_add_u32 s92, s52, 0x3f800
  buffer_load_dwordx4 v10, s[8:11], s92 offen offset:2048 lds
  s_add_u32 s92, s52, 0x5f400
  buffer_load_dwordx4 v10, s[8:11], s92 offen offset:3072 lds
  s_waitcnt vmcnt(28)
  ds_read_b64_tr_b16 a[136:137], v11 offset:4096
  ds_read_b64_tr_b16 a[138:139], v11 offset:4352
  ds_read_b64_tr_b16 a[200:201], v11 offset:4104
  ds_read_b64_tr_b16 a[202:203], v11 offset:4360
  ds_read_b64_tr_b16 a[140:141], v11 offset:6144
  ds_read_b64_tr_b16 a[142:143], v11 offset:6400
  ds_read_b64_tr_b16 a[204:205], v11 offset:6152
  ds_read_b64_tr_b16 a[206:207], v11 offset:6408
  s_waitcnt lgkmcnt(0)
  s_add_u32 m0, s48, 4096
  s_add_u32 s92, s52, 0x80000
  buffer_load_dwordx4 v10, s[8:11], s92 offen offset:0 lds
  s_add_u32 s92, s52, 0x9fc00
  buffer_load_dwordx4 v10, s[8:11], s92 offen offset:1024 lds
  s_add_u32 s92, s52, 0xbf800
  buffer_load_dwordx4 v10, s[8:11], s92 offen offset:2048 lds
  s_add_u32 s92, s52, 0xdf400
  buffer_load_dwordx4 v10, s[8:11], s92 offen offset:3072 lds
  s_waitcnt vmcnt(28)
  ds_read_b64_tr_b16 a[144:145], v11 offset:8192
  ds_read_b64_tr_b16 a[146:147], v11 offset:8448
  ds_read_b64_tr_b16 a[208:209], v11 offset:8200
  ds_read_b64_tr_b16 a[210:211], v11 offset:8456
  ds_read_b64_tr_b16 a[148:149], v11 offset:10240
  ds_read_b64_tr_b16 a[150:151], v11 offset:10496
  ds_read_b64_tr_b16 a[212:213], v11 offset:10248
  ds_read_b64_tr_b16 a[214:215], v11 offset:10504
  s_waitcnt lgkmcnt(0)
  s_add_u32 m0, s48, 8192
  s_add_u32 s92, s52, 0x100000
  buffer_load_dwordx4 v10, s[8:11], s92 offen offset:0 lds
  s_add_u32 s92, s52, 0x11fc00
  buffer_load_dwordx4 v10, s[8:11], s92 offen offset:1024 lds
  s_add_u32 s92, s52, 0x13f800
  buffer_load_dwordx4 v10, s[8:11], s92 offen offset:2048 lds
  s_add_u32 s92, s52, 0x15f400
  buffer_load_dwordx4 v10, s[8:11], s92 offen offset:3072 lds
  s_waitcnt vmcnt(28)
  ds_read_b64_tr_b16 a[152:153], v11 offset:12288
  ds_read_b64_tr_b16 a[154:155], v11 offset:12544
  ds_read_b64_tr_b16 a[216:217], v11 offset:12296
  ds_read_b64_tr_b16 a[218:219], v11 offset:12552
  ds_read_b64_tr_b16 a[156:157], v11 offset:14336
  ds_read_b64_tr_b16 a[158:159], v11 offset:14592
  ds_read_b64_tr_b16 a[220:221], v11 offset:14344
  ds_read_b64_tr_b16 a[222:223], v11 offset:14600
  s_waitcnt lgkmcnt(0)
  s_add_u32 m0, s48, 12288
  s_add_u32 s92, s52, 0x180000
  buffer_load_dwordx4 v10, s[8:11], s92 offen offset:0 lds
  s_add_u32 s92, s52, 0x19fc00
  buffer_load_dwordx4 v10, s[8:11], s92 offen offset:1024 lds
  s_add_u32 s92, s52, 0x1bf800
  buffer_load_dwordx4 v10, s[8:11], s92 offen offset:2048 lds
  s_add_u32 s92, s52, 0x1df400
  buffer_load_dwordx4 v10, s[8:11], s92 offen offset:3072 lds
  s_waitcnt vmcnt(28)
  ds_read_b64_tr_b16 a[160:161], v11 offset:16384
  ds_read_b64_tr_b16 a[162:163], v11 offset:16640
  ds_read_b64_tr_b16 a[224:225], v11 offset:16392
  ds_read_b64_tr_b16 a[226:227], v11 offset:16648
  ds_read_b64_tr_b16 a[164:165], v11 offset:18432
  ds_read_b64_tr_b16 a[166:167], v11 offset:18688
  ds_read_b64_tr_b16 a[228:229], v11 offset:18440
  ds_read_b64_tr_b16 a[230:231], v11 offset:18696
  s_waitcnt lgkmcnt(0)
  s_add_u32 m0, s48, 16384
  s_add_u32 s92, s52, 0x200000
  buffer_load_dwordx4 v10, s[8:11], s92 offen offset:0 lds
  s_add_u32 s92, s52, 0x21fc00
  buffer_load_dwordx4 v10, s[8:11], s92 offen offset:1024 lds
  s_add_u32 s92, s52, 0x23f800
  buffer_load_dwordx4 v10, s[8:11], s92 offen offset:2048 lds
  s_add_u32 s92, s52, 0x25f400
  buffer_load_dwordx4 v10, s[8:11], s92 offen offset:3072 lds
  s_waitcnt vmcnt(28)
  ds_read_b64_tr_b16 a[168:169], v11 offset:20480
  ds_read_b64_tr_b16 a[170:171], v11 offset:20736
  ds_read_b64_tr_b16 a[232:233], v11 offset:20488
  ds_read_b64_tr_b16 a[234:235], v11 offset:20744
  ds_read_b64_tr_b16 a[172:173], v11 offset:22528
  ds_read_b64_tr_b16 a[174:175], v11 offset:22784
  ds_read_b64_tr_b16 a[236:237], v11 offset:22536
  ds_read_b64_tr_b16 a[238:239], v11 offset:22792
  s_waitcnt lgkmcnt(0)
  s_add_u32 m0, s48, 20480
  s_add_u32 s92, s52, 0x280000
  buffer_load_dwordx4 v10, s[8:11], s92 offen offset:0 lds
  s_add_u32 s92, s52, 0x29fc00
  buffer_load_dwordx4 v10, s[8:11], s92 offen offset:1024 lds
  s_add_u32 s92, s52, 0x2bf800
  buffer_load_dwordx4 v10, s[8:11], s92 offen offset:2048 lds
  s_add_u32 s92, s52, 0x2df400
  buffer_load_dwordx4 v10, s[8:11], s92 offen offset:3072 lds
  s_waitcnt vmcnt(28)
  ds_read_b64_tr_b16 a[176:177], v11 offset:24576
  ds_read_b64_tr_b16 a[178:179], v11 offset:24832
  ds_read_b64_tr_b16 a[240:241], v11 offset:24584
  ds_read_b64_tr_b16 a[242:243], v11 offset:24840
  ds_read_b64_tr_b16 a[180:181], v11 offset:26624
  ds_read_b64_tr_b16 a[182:183], v11 offset:26880
  ds_read_b64_tr_b16 a[244:245], v11 offset:26632
  ds_read_b64_tr_b16 a[246:247], v11 offset:26888
  s_waitcnt lgkmcnt(0)
  s_add_u32 m0, s48, 24576
  s_add_u32 s92, s52, 0x300000
  buffer_load_dwordx4 v10, s[8:11], s92 offen offset:0 lds
  s_add_u32 s92, s52, 0x31fc00
  buffer_load_dwordx4 v10, s[8:11], s92 offen offset:1024 lds
  s_add_u32 s92, s52, 0x33f800
  buffer_load_dwordx4 v10, s[8:11], s92 offen offset:2048 lds
  s_add_u32 s92, s52, 0x35f400
  buffer_load_dwordx4 v10, s[8:11], s92 offen offset:3072 lds
  s_waitcnt vmcnt(28)
  ds_read_b64_tr_b16 a[184:185], v11 offset:28672
  ds_read_b64_tr_b16 a[186:187], v11 offset:28928
  ds_read_b64_tr_b16 a[248:249], v11 offset:28680
  ds_read_b64_tr_b16 a[250:251], v11 offset:28936
  ds_read_b64_tr_b16 a[188:189], v11 offset:30720
  ds_read_b64_tr_b16 a[190:191], v11 offset:30976
  ds_read_b64_tr_b16 a[252:253], v11 offset:30728
  ds_read_b64_tr_b16 a[254:255], v11 offset:30984
  s_waitcnt lgkmcnt(0)
  s_add_u32 m0, s48, 28672
  s_add_u32 s92, s52, 0x380000
  buffer_load_dwordx4 v10, s[8:11], s92 offen offset:0 lds
  s_add_u32 s92, s52, 0x39fc00
  buffer_load_dwordx4 v10, s[8:11], s92 offen offset:1024 lds
  s_add_u32 s92, s52, 0x3bf800
  buffer_load_dwordx4 v10, s[8:11], s92 offen offset:2048 lds
  s_add_u32 s92, s52, 0x3df400
  buffer_load_dwordx4 v10, s[8:11], s92 offen offset:3072 lds
  s_waitcnt vmcnt(28)
  ds_read_b64_tr_b16 v[128:129], v12 offset:0
  ds_read_b64_tr_b16 v[130:131], v12 offset:256
  ds_read_b64_tr_b16 v[192:193], v12 offset:32
  ds_read_b64_tr_b16 v[194:195], v12 offset:288
  ds_read_b64_tr_b16 v[132:133], v12 offset:2048
  ds_read_b64_tr_b16 v[134:135], v12 offset:2304
  ds_read_b64_tr_b16 v[196:197], v12 offset:2080
  ds_read_b64_tr_b16 v[198:199], v12 offset:2336
  s_waitcnt lgkmcnt(0)
  s_mov_b32 s8, s20
  s_and_b32 s9, s21, 0xffff
  s_mov_b32 s10, 0x400000
  s_mov_b32 s11, 0x20000
  s_add_u32 m0, s48, 0
  s_add_u32 s92, s52, 0x0
  buffer_load_dwordx4 v10, s[8:11], s92 offen offset:0 lds
  s_add_u32 s92, s52, 0x1fc00
  buffer_load_dwordx4 v10, s[8:11], s92 offen offset:1024 lds
  s_add_u32 s92, s52, 0x3f800
  buffer_load_dwordx4 v10, s[8:11], s92 offen offset:2048 lds
  s_add_u32 s92, s52, 0x5f400
  buffer_load_dwordx4 v10, s[8:11], s92 offen offset:3072 lds
  s_waitcnt vmcnt(28)
  ds_read_b64_tr_b16 v[136:137], v12 offset:4096
  ds_read_b64_tr_b16 v[138:139], v12 offset:4352
  ds_read_b64_tr_b16 v[200:201], v12 offset:4128
  ds_read_b64_tr_b16 v[202:203], v12 offset:4384
  ds_read_b64_tr_b16 v[140:141], v12 offset:6144
  ds_read_b64_tr_b16 v[142:143], v12 offset:6400
  ds_read_b64_tr_b16 v[204:205], v12 offset:6176
  ds_read_b64_tr_b16 v[206:207], v12 offset:6432
  s_waitcnt lgkmcnt(0)
  s_add_u32 m0, s48, 4096
  s_add_u32 s92, s52, 0x80000
  buffer_load_dwordx4 v10, s[8:11], s92 offen offset:0 lds
  s_add_u32 s92, s52, 0x9fc00
  buffer_load_dwordx4 v10, s[8:11], s92 offen offset:1024 lds
  s_add_u32 s92, s52, 0xbf800
  buffer_load_dwordx4 v10, s[8:11], s92 offen offset:2048 lds
  s_add_u32 s92, s52, 0xdf400
  buffer_load_dwordx4 v10, s[8:11], s92 offen offset:3072 lds
  s_waitcnt vmcnt(28)
  ds_read_b64_tr_b16 v[144:145], v12 offset:8192
  ds_read_b64_tr_b16 v[146:147], v12 offset:8448
  ds_read_b64_tr_b16 v[208:209], v12 offset:8224
  ds_read_b64_tr_b16 v[210:211], v12 offset:8480
  ds_read_b64_tr_b16 v[148:149], v12 offset:10240
  ds_read_b64_tr_b16 v[150:151], v12 offset:10496
  ds_read_b64_tr_b16 v[212:213], v12 offset:10272
  ds_read_b64_tr_b16 v[214:215], v12 offset:10528
  s_waitcnt lgkmcnt(0)
  s_add_u32 m0, s48, 8192
  s_add_u32 s92, s52, 0x100000
  buffer_load_dwordx4 v10, s[8:11], s92 offen offset:0 lds
  s_add_u32 s92, s52, 0x11fc00
  buffer_load_dwordx4 v10, s[8:11], s92 offen offset:1024 lds
  s_add_u32 s92, s52, 0x13f800
  buffer_load_dwordx4 v10, s[8:11], s92 offen offset:2048 lds
  s_add_u32 s92, s52, 0x15f400
  buffer_load_dwordx4 v10, s[8:11], s92 offen offset:3072 lds
  s_waitcnt vmcnt(28)
  ds_read_b64_tr_b16 v[152:153], v12 offset:12288
  ds_read_b64_tr_b16 v[154:155], v12 offset:12544
  ds_read_b64_tr_b16 v[216:217], v12 offset:12320
  ds_read_b64_tr_b16 v[218:219], v12 offset:12576
  ds_read_b64_tr_b16 v[156:157], v12 offset:14336
  ds_read_b64_tr_b16 v[158:159], v12 offset:14592
  ds_read_b64_tr_b16 v[220:221], v12 offset:14368
  ds_read_b64_tr_b16 v[222:223], v12 offset:14624
  s_waitcnt lgkmcnt(0)
  s_add_u32 m0, s48, 12288
  s_add_u32 s92, s52, 0x180000
  buffer_load_dwordx4 v10, s[8:11], s92 offen offset:0 lds
  s_add_u32 s92, s52, 0x19fc00
  buffer_load_dwordx4 v10, s[8:11], s92 offen offset:1024 lds
  s_add_u32 s92, s52, 0x1bf800
  buffer_load_dwordx4 v10, s[8:11], s92 offen offset:2048 lds
  s_add_u32 s92, s52, 0x1df400
  buffer_load_dwordx4 v10, s[8:11], s92 offen offset:3072 lds
  s_waitcnt vmcnt(28)
  ds_read_b64_tr_b16 v[160:161], v12 offset:16384
  ds_read_b64_tr_b16 v[162:163], v12 offset:16640
  ds_read_b64_tr_b16 v[224:225], v12 offset:16416
  ds_read_b64_tr_b16 v[226:227], v12 offset:16672
  ds_read_b64_tr_b16 v[164:165], v12 offset:18432
  ds_read_b64_tr_b16 v[166:167], v12 offset:18688
  ds_read_b64_tr_b16 v[228:229], v12 offset:18464
  ds_read_b64_tr_b16 v[230:231], v12 offset:18720
  s_waitcnt lgkmcnt(0)
  s_add_u32 m0, s48, 16384
  s_add_u32 s92, s52, 0x200000
  buffer_load_dwordx4 v10, s[8:11], s92 offen offset:0 lds
  s_add_u32 s92, s52, 0x21fc00
  buffer_load_dwordx4 v10, s[8:11], s92 offen offset:1024 lds
  s_add_u32 s92, s52, 0x23f800
  buffer_load_dwordx4 v10, s[8:11], s92 offen offset:2048 lds
  s_add_u32 s92, s52, 0x25f400
  buffer_load_dwordx4 v10, s[8:11], s92 offen offset:3072 lds
  s_waitcnt vmcnt(28)
  ds_read_b64_tr_b16 v[168:169], v12 offset:20480
  ds_read_b64_tr_b16 v[170:171], v12 offset:20736
  ds_read_b64_tr_b16 v[232:233], v12 offset:20512
  ds_read_b64_tr_b16 v[234:235], v12 offset:20768
  ds_read_b64_tr_b16 v[172:173], v12 offset:22528
  ds_read_b64_tr_b16 v[174:175], v12 offset:22784
  ds_read_b64_tr_b16 v[236:237], v12 offset:22560
  ds_read_b64_tr_b16 v[238:239], v12 offset:22816
  s_waitcnt lgkmcnt(0)
  s_add_u32 m0, s48, 20480
  s_add_u32 s92, s52, 0x280000
  buffer_load_dwordx4 v10, s[8:11], s92 offen offset:0 lds
  s_add_u32 s92, s52, 0x29fc00
  buffer_load_dwordx4 v10, s[8:11], s92 offen offset:1024 lds
  s_add_u32 s92, s52, 0x2bf800
  buffer_load_dwordx4 v10, s[8:11], s92 offen offset:2048 lds
  s_add_u32 s92, s52, 0x2df400
  buffer_load_dwordx4 v10, s[8:11], s92 offen offset:3072 lds
  s_waitcnt vmcnt(28)
  ds_read_b64_tr_b16 v[176:177], v12 offset:24576
  ds_read_b64_tr_b16 v[178:179], v12 offset:24832
  ds_read_b64_tr_b16 v[240:241], v12 offset:24608
  ds_read_b64_tr_b16 v[242:243], v12 offset:24864
  ds_read_b64_tr_b16 v[180:181], v12 offset:26624
  ds_read_b64_tr_b16 v[182:183], v12 offset:26880
  ds_read_b64_tr_b16 v[244:245], v12 offset:26656
  ds_read_b64_tr_b16 v[246:247], v12 offset:26912
  s_waitcnt lgkmcnt(0)
  s_add_u32 m0, s48, 24576
  s_add_u32 s92, s52, 0x300000
  buffer_load_dwordx4 v10, s[8:11], s92 offen offset:0 lds
  s_add_u32 s92, s52, 0x31fc00
  buffer_load_dwordx4 v10, s[8:11], s92 offen offset:1024 lds
  s_add_u32 s92, s52, 0x33f800
  buffer_load_dwordx4 v10, s[8:11], s92 offen offset:2048 lds
  s_add_u32 s92, s52, 0x35f400
  buffer_load_dwordx4 v10, s[8:11], s92 offen offset:3072 lds
  s_waitcnt vmcnt(28)
  ds_read_b64_tr_b16 v[184:185], v12 offset:28672
  ds_read_b64_tr_b16 v[186:187], v12 offset:28928
  ds_read_b64_tr_b16 v[248:249], v12 offset:28704
  ds_read_b64_tr_b16 v[250:251], v12 offset:28960
  ds_read_b64_tr_b16 v[188:189], v12 offset:30720
  ds_read_b64_tr_b16 v[190:191], v12 offset:30976
  ds_read_b64_tr_b16 v[252:253], v12 offset:30752
  ds_read_b64_tr_b16 v[254:255], v12 offset:31008
  s_waitcnt lgkmcnt(0)
  s_add_u32 m0, s48, 28672
  s_add_u32 s92, s52, 0x380000
  buffer_load_dwordx4 v10, s[8:11], s92 offen offset:0 lds
  s_add_u32 s92, s52, 0x39fc00
  buffer_load_dwordx4 v10, s[8:11], s92 offen offset:1024 lds
  s_add_u32 s92, s52, 0x3bf800
  buffer_load_dwordx4 v10, s[8:11], s92 offen offset:2048 lds
  s_add_u32 s92, s52, 0x3df400
  buffer_load_dwordx4 v10, s[8:11], s92 offen offset:3072 lds
  s_waitcnt vmcnt(28)
  ds_read_b64_tr_b16 a[0:1], v11 offset:0
  ds_read_b64_tr_b16 a[2:3], v11 offset:256
  ds_read_b64_tr_b16 a[64:65], v11 offset:8
  ds_read_b64_tr_b16 a[66:67], v11 offset:264
  ds_read_b64_tr_b16 a[4:5], v11 offset:2048
  ds_read_b64_tr_b16 a[6:7], v11 offset:2304
  ds_read_b64_tr_b16 a[68:69], v11 offset:2056
  ds_read_b64_tr_b16 a[70:71], v11 offset:2312
  s_waitcnt lgkmcnt(0)
  s_waitcnt vmcnt(24)
  ds_read_b64_tr_b16 a[8:9], v11 offset:4096
  ds_read_b64_tr_b16 a[10:11], v11 offset:4352
  ds_read_b64_tr_b16 a[72:73], v11 offset:4104
  ds_read_b64_tr_b16 a[74:75], v11 offset:4360
  ds_read_b64_tr_b16 a[12:13], v11 offset:6144
  ds_read_b64_tr_b16 a[14:15], v11 offset:6400
  ds_read_b64_tr_b16 a[76:77], v11 offset:6152
  ds_read_b64_tr_b16 a[78:79], v11 offset:6408
  s_waitcnt lgkmcnt(0)
  s_waitcnt vmcnt(20)
  ds_read_b64_tr_b16 a[16:17], v11 offset:8192
  ds_read_b64_tr_b16 a[18:19], v11 offset:8448
  ds_read_b64_tr_b16 a[80:81], v11 offset:8200
  ds_read_b64_tr_b16 a[82:83], v11 offset:8456
  ds_read_b64_tr_b16 a[20:21], v11 offset:10240
  ds_read_b64_tr_b16 a[22:23], v11 offset:10496
  ds_read_b64_tr_b16 a[84:85], v11 offset:10248
  ds_read_b64_tr_b16 a[86:87], v11 offset:10504
  s_waitcnt lgkmcnt(0)
  s_waitcnt vmcnt(16)
  ds_read_b64_tr_b16 a[24:25], v11 offset:12288
  ds_read_b64_tr_b16 a[26:27], v11 offset:12544
  ds_read_b64_tr_b16 a[88:89], v11 offset:12296
  ds_read_b64_tr_b16 a[90:91], v11 offset:12552
  ds_read_b64_tr_b16 a[28:29], v11 offset:14336
  ds_read_b64_tr_b16 a[30:31], v11 offset:14592
  ds_read_b64_tr_b16 a[92:93], v11 offset:14344
  ds_read_b64_tr_b16 a[94:95], v11 offset:14600
  s_waitcnt lgkmcnt(0)
  s_waitcnt vmcnt(12)
  ds_read_b64_tr_b16 a[32:33], v11 offset:16384
  ds_read_b64_tr_b16 a[34:35], v11 offset:16640
  ds_read_b64_tr_b16 a[96:97], v11 offset:16392
  ds_read_b64_tr_b16 a[98:99], v11 offset:16648
  ds_read_b64_tr_b16 a[36:37], v11 offset:18432
  ds_read_b64_tr_b16 a[38:39], v11 offset:18688
  ds_read_b64_tr_b16 a[100:101], v11 offset:18440
  ds_read_b64_tr_b16 a[102:103], v11 offset:18696
  s_waitcnt lgkmcnt(0)
  s_waitcnt vmcnt(8)
  ds_read_b64_tr_b16 a[40:41], v11 offset:20480
  ds_read_b64_tr_b16 a[42:43], v11 offset:20736
  ds_read_b64_tr_b16 a[104:105], v11 offset:20488
  ds_read_b64_tr_b16 a[106:107], v11 offset:20744
  ds_read_b64_tr_b16 a[44:45], v11 offset:22528
  ds_read_b64_tr_b16 a[46:47], v11 offset:22784
  ds_read_b64_tr_b16 a[108:109], v11 offset:22536
  ds_read_b64_tr_b16 a[110:111], v11 offset:22792
  s_waitcnt lgkmcnt(0)
  s_waitcnt vmcnt(4)
  ds_read_b64_tr_b16 a[48:49], v11 offset:24576
  ds_read_b64_tr_b16 a[50:51], v11 offset:24832
  ds_read_b64_tr_b16 a[112:113], v11 offset:24584
  ds_read_b64_tr_b16 a[114:115], v11 offset:24840
  ds_read_b64_tr_b16 a[52:53], v11 offset:26624
  ds_read_b64_tr_b16 a[54:55], v11 offset:26880
  ds_read_b64_tr_b16 a[116:117], v11 offset:26632
  ds_read_b64_tr_b16 a[118:119], v11 offset:26888
  s_waitcnt lgkmcnt(0)
  s_waitcnt vmcnt(0)
  ds_read_b64_tr_b16 a[56:57], v11 offset:28672
  ds_read_b64_tr_b16 a[58:59], v11 offset:28928
  ds_read_b64_tr_b16 a[120:121], v11 offset:28680
  ds_read_b64_tr_b16 a[122:123], v11 offset:28936
  ds_read_b64_tr_b16 a[60:61], v11 offset:30720
  ds_read_b64_tr_b16 a[62:63], v11 offset:30976
  ds_read_b64_tr_b16 a[124:125], v11 offset:30728
  ds_read_b64_tr_b16 a[126:127], v11 offset:30984
  s_waitcnt lgkmcnt(0)
  s_waitcnt lgkmcnt(0)
  v_mov_b32 v64, 0x3f803f80
  v_mov_b32 v65, 0x3f803f80
  v_mov_b32 v66, 0x3f803f80
  v_mov_b32 v67, 0x3f803f80
  s_nop 1
  v_mfma_f32_16x16x32_bf16 v[16:19], a[0:3], v[64:67], 0
  v_mfma_f32_16x16x32_bf16 v[16:19], a[4:7], v[64:67], v[16:19]
  v_mfma_f32_16x16x32_bf16 v[16:19], a[8:11], v[64:67], v[16:19]
  v_mfma_f32_16x16x32_bf16 v[16:19], a[12:15], v[64:67], v[16:19]
  v_mfma_f32_16x16x32_bf16 v[16:19], a[16:19], v[64:67], v[16:19]
  v_mfma_f32_16x16x32_bf16 v[16:19], a[20:23], v[64:67], v[16:19]
  v_mfma_f32_16x16x32_bf16 v[16:19], a[24:27], v[64:67], v[16:19]
  v_mfma_f32_16x16x32_bf16 v[16:19], a[28:31], v[64:67], v[16:19]
  v_mfma_f32_16x16x32_bf16 v[16:19], a[32:35], v[64:67], v[16:19]
  v_mfma_f32_16x16x32_bf16 v[16:19], a[36:39], v[64:67], v[16:19]
  v_mfma_f32_16x16x32_bf16 v[16:19], a[40:43], v[64:67], v[16:19]
  v_mfma_f32_16x16x32_bf16 v[16:19], a[44:47], v[64:67], v[16:19]
  v_mfma_f32_16x16x32_bf16 v[16:19], a[48:51], v[64:67], v[16:19]
  v_mfma_f32_16x16x32_bf16 v[16:19], a[52:55], v[64:67], v[16:19]
  v_mfma_f32_16x16x32_bf16 v[16:19], a[56:59], v[64:67], v[16:19]
  v_mfma_f32_16x16x32_bf16 v[16:19], a[60:63], v[64:67], v[16:19]
  v_mfma_f32_16x16x32_bf16 v[20:23], a[64:67], v[64:67], 0
  v_mfma_f32_16x16x32_bf16 v[20:23], a[68:71], v[64:67], v[20:23]
  v_mfma_f32_16x16x32_bf16 v[20:23], a[72:75], v[64:67], v[20:23]
  v_mfma_f32_16x16x32_bf16 v[20:23], a[76:79], v[64:67], v[20:23]
  v_mfma_f32_16x16x32_bf16 v[20:23], a[80:83], v[64:67], v[20:23]
  v_mfma_f32_16x16x32_bf16 v[20:23], a[84:87], v[64:67], v[20:23]
  v_mfma_f32_16x16x32_bf16 v[20:23], a[88:91], v[64:67], v[20:23]
  v_mfma_f32_16x16x32_bf16 v[20:23], a[92:95], v[64:67], v[20:23]
  v_mfma_f32_16x16x32_bf16 v[20:23], a[96:99], v[64:67], v[20:23]
  v_mfma_f32_16x16x32_bf16 v[20:23], a[100:103], v[64:67], v[20:23]
  v_mfma_f32_16x16x32_bf16 v[20:23], a[104:107], v[64:67], v[20:23]
  v_mfma_f32_16x16x32_bf16 v[20:23], a[108:111], v[64:67], v[20:23]
  v_mfma_f32_16x16x32_bf16 v[20:23], a[112:115], v[64:67], v[20:23]
  v_mfma_f32_16x16x32_bf16 v[20:23], a[116:119], v[64:67], v[20:23]
  v_mfma_f32_16x16x32_bf16 v[20:23], a[120:123], v[64:67], v[20:23]
  v_mfma_f32_16x16x32_bf16 v[20:23], a[124:127], v[64:67], v[20:23]
  v_mfma_f32_16x16x32_bf16 v[24:27], a[128:131], v[64:67], 0
  v_mfma_f32_16x16x32_bf16 v[24:27], a[132:135], v[64:67], v[24:27]
  v_mfma_f32_16x16x32_bf16 v[24:27], a[136:139], v[64:67], v[24:27]
  v_mfma_f32_16x16x32_bf16 v[24:27], a[140:143], v[64:67], v[24:27]
  v_mfma_f32_16x16x32_bf16 v[24:27], a[144:147], v[64:67], v[24:27]
  v_mfma_f32_16x16x32_bf16 v[24:27], a[148:151], v[64:67], v[24:27]
  v_mfma_f32_16x16x32_bf16 v[24:27], a[152:155], v[64:67], v[24:27]
  v_mfma_f32_16x16x32_bf16 v[24:27], a[156:159], v[64:67], v[24:27]
  v_mfma_f32_16x16x32_bf16 v[24:27], a[160:163], v[64:67], v[24:27]
  v_mfma_f32_16x16x32_bf16 v[24:27], a[164:167], v[64:67], v[24:27]
  v_mfma_f32_16x16x32_bf16 v[24:27], a[168:171], v[64:67], v[24:27]
  v_mfma_f32_16x16x32_bf16 v[24:27], a[172:175], v[64:67], v[24:27]
  v_mfma_f32_16x16x32_bf16 v[24:27], a[176:179], v[64:67], v[24:27]
  v_mfma_f32_16x16x32_bf16 v[24:27], a[180:183], v[64:67], v[24:27]
  v_mfma_f32_16x16x32_bf16 v[24:27], a[184:187], v[64:67], v[24:27]
  v_mfma_f32_16x16x32_bf16 v[24:27], a[188:191], v[64:67], v[24:27]
  v_mfma_f32_16x16x32_bf16 v[28:31], a[192:195], v[64:67], 0
  v_mfma_f32_16x16x32_bf16 v[28:31], a[196:199], v[64:67], v[28:31]
  v_mfma_f32_16x16x32_bf16 v[28:31], a[200:203], v[64:67], v[28:31]
  v_mfma_f32_16x16x32_bf16 v[28:31], a[204:207], v[64:67], v[28:31]
  v_mfma_f32_16x16x32_bf16 v[28:31], a[208:211], v[64:67], v[28:31]
  v_mfma_f32_16x16x32_bf16 v[28:31], a[212:215], v[64:67], v[28:31]
  v_mfma_f32_16x16x32_bf16 v[28:31], a[216:219], v[64:67], v[28:31]
  v_mfma_f32_16x16x32_bf16 v[28:31], a[220:223], v[64:67], v[28:31]
  v_mfma_f32_16x16x32_bf16 v[28:31], a[224:227], v[64:67], v[28:31]
  v_mfma_f32_16x16x32_bf16 v[28:31], a[228:231], v[64:67], v[28:31]
  v_mfma_f32_16x16x32_bf16 v[28:31], a[232:235], v[64:67], v[28:31]
  v_mfma_f32_16x16x32_bf16 v[28:31], a[236:239], v[64:67], v[28:31]
  v_mfma_f32_16x16x32_bf16 v[28:31], a[240:243], v[64:67], v[28:31]
  v_mfma_f32_16x16x32_bf16 v[28:31], a[244:247], v[64:67], v[28:31]
  v_mfma_f32_16x16x32_bf16 v[28:31], a[248:251], v[64:67], v[28:31]
  v_mfma_f32_16x16x32_bf16 v[28:31], a[252:255], v[64:67], v[28:31]
  v_mfma_f32_16x16x32_bf16 v[32:35], v[64:67], v[128:131], 0
  v_mfma_f32_16x16x32_bf16 v[32:35], v[64:67], v[132:135], v[32:35]
  v_mfma_f32_16x16x32_bf16 v[32:35], v[64:67], v[136:139], v[32:35]
  v_mfma_f32_16x16x32_bf16 v[32:35], v[64:67], v[140:143], v[32:35]
  v_mfma_f32_16x16x32_bf16 v[32:35], v[64:67], v[144:147], v[32:35]
  v_mfma_f32_16x16x32_bf16 v[32:35], v[64:67], v[148:151], v[32:35]
  v_mfma_f32_16x16x32_bf16 v[32:35], v[64:67], v[152:155], v[32:35]
  v_mfma_f32_16x16x32_bf16 v[32:35], v[64:67], v[156:159], v[32:35]
  v_mfma_f32_16x16x32_bf16 v[32:35], v[64:67], v[160:163], v[32:35]
  v_mfma_f32_16x16x32_bf16 v[32:35], v[64:67], v[164:167], v[32:35]
  v_mfma_f32_16x16x32_bf16 v[32:35], v[64:67], v[168:171], v[32:35]
  v_mfma_f32_16x16x32_bf16 v[32:35], v[64:67], v[172:175], v[32:35]
  v_mfma_f32_16x16x32_bf16 v[32:35], v[64:67], v[176:179], v[32:35]
  v_mfma_f32_16x16x32_bf16 v[32:35], v[64:67], v[180:183], v[32:35]
  v_mfma_f32_16x16x32_bf16 v[32:35], v[64:67], v[184:187], v[32:35]
  v_mfma_f32_16x16x32_bf16 v[32:35], v[64:67], v[188:191], v[32:35]
  v_mfma_f32_16x16x32_bf16 v[36:39], v[64:67], v[192:195], 0
  v_mfma_f32_16x16x32_bf16 v[36:39], v[64:67], v[196:199], v[36:39]
  v_mfma_f32_16x16x32_bf16 v[36:39], v[64:67], v[200:203], v[36:39]
  v_mfma_f32_16x16x32_bf16 v[36:39], v[64:67], v[204:207], v[36:39]
  v_mfma_f32_16x16x32_bf16 v[36:39], v[64:67], v[208:211], v[36:39]
  v_mfma_f32_16x16x32_bf16 v[36:39], v[64:67], v[212:215], v[36:39]
  v_mfma_f32_16x16x32_bf16 v[36:39], v[64:67], v[216:219], v[36:39]
  v_mfma_f32_16x16x32_bf16 v[36:39], v[64:67], v[220:223], v[36:39]
  v_mfma_f32_16x16x32_bf16 v[36:39], v[64:67], v[224:227], v[36:39]
  v_mfma_f32_16x16x32_bf16 v[36:39], v[64:67], v[228:231], v[36:39]
  v_mfma_f32_16x16x32_bf16 v[36:39], v[64:67], v[232:235], v[36:39]
  v_mfma_f32_16x16x32_bf16 v[36:39], v[64:67], v[236:239], v[36:39]
  v_mfma_f32_16x16x32_bf16 v[36:39], v[64:67], v[240:243], v[36:39]
  v_mfma_f32_16x16x32_bf16 v[36:39], v[64:67], v[244:247], v[36:39]
  v_mfma_f32_16x16x32_bf16 v[36:39], v[64:67], v[248:251], v[36:39]
  v_mfma_f32_16x16x32_bf16 v[36:39], v[64:67], v[252:255], v[36:39]
  v_mov_b32 v110, v16
  v_mov_b32 v111, v17
  v_mov_b32 v112, v18
  v_mov_b32 v113, v19
  v_mov_b32 v114, v20
  v_mov_b32 v115, v21
  v_mov_b32 v116, v22
  v_mov_b32 v117, v23
  v_mov_b32 v118, v24
  v_mov_b32 v119, v25
  v_mov_b32 v120, v26
  v_mov_b32 v121, v27
  v_mov_b32 v122, v28
  v_mov_b32 v123, v29
  v_mov_b32 v124, v30
  v_mov_b32 v125, v31
  v_mov_b32 v126, v32
  v_mov_b32 v127, v36
  s_cmp_lg_u32 s46, 0
  s_cbranch_scc1 cen_1925
  v_mov_b32 v4, 163328
  s_cmp_lg_u32 s44, 0
  s_cbranch_scc1 cen_1926
  v_min_u32 v5, 9, v0
  v_lshlrev_b32 v5, 3, v5
  s_mov_b32 s92, 128
  v_writelane_b32 v5, s92, 0
cen_1927:
  buffer_load_dword v2, v5, s[12:15], 0 offen sc1
  s_mov_b32 s92, 0
  s_waitcnt vmcnt(0)
  v_readlane_b32 s93, v2, 0
  s_nop 0
  s_add_u32 s92, s92, s93
  v_readlane_b32 s93, v2, 1
  s_nop 0
  s_add_u32 s92, s92, s93
  v_readlane_b32 s93, v2, 2
  s_nop 0
  s_add_u32 s92, s92, s93
  v_readlane_b32 s93, v2, 3
  s_nop 0
  s_add_u32 s92, s92, s93
  v_readlane_b32 s93, v2, 4
  s_nop 0
  s_add_u32 s92, s92, s93
  v_readlane_b32 s93, v2, 5
  s_nop 0
  s_add_u32 s92, s92, s93
  v_readlane_b32 s93, v2, 6
  s_nop 0
  s_add_u32 s92, s92, s93
  v_readlane_b32 s93, v2, 7
  s_nop 0
  s_add_u32 s92, s92, s93
  v_readlane_b32 s93, v2, 8
  s_nop 0
  s_add_u32 s92, s92, s93
  s_cmp_eq_u32 s92, 256
  s_cbranch_scc1 cen_1928
  s_add_u32 s47, s47, 1
  s_mov_b32 s49, 1
  s_cmp_gt_u32 s47, 131072
  s_cbranch_scc1 TIMEOUT
  s_sleep 4
  s_branch cen_1927
cen_1928:
  v_cmp_ne_u32 vcc, 32, v2
  ds_read2_b32 v[6:7], v4 offset0:0 offset1:1
  s_and_b32 s94, vcc_lo, 0xff
  s_waitcnt lgkmcnt(0)
  v_readfirstlane_b32 s92, v6
  v_readfirstlane_b32 s95, v7
  v_readlane_b32 s93, v2, 0
  s_cmp_gt_u32 s95, 0
  s_cselect_b32 s93, s93, 0
  s_add_u32 s92, s92, s93
  v_readlane_b32 s93, v2, 1
  s_cmp_gt_u32 s95, 1
  s_cselect_b32 s93, s93, 0
  s_add_u32 s92, s92, s93
  v_readlane_b32 s93, v2, 2
  s_cmp_gt_u32 s95, 2
  s_cselect_b32 s93, s93, 0
  s_add_u32 s92, s92, s93
  v_readlane_b32 s93, v2, 3
  s_cmp_gt_u32 s95, 3
  s_cselect_b32 s93, s93, 0
  s_add_u32 s92, s92, s93
  v_readlane_b32 s93, v2, 4
  s_cmp_gt_u32 s95, 4
  s_cselect_b32 s93, s93, 0
  s_add_u32 s92, s92, s93
  v_readlane_b32 s93, v2, 5
  s_cmp_gt_u32 s95, 5
  s_cselect_b32 s93, s93, 0
  s_add_u32 s92, s92, s93
  v_readlane_b32 s93, v2, 6
  s_cmp_gt_u32 s95, 6
  s_cselect_b32 s93, s93, 0
  s_add_u32 s92, s92, s93
  v_readlane_b32 s93, v2, 7
  s_cmp_gt_u32 s95, 7
  s_cselect_b32 s93, s93, 0
  s_add_u32 s92, s92, s93
  v_mov_b32 v2, s92
  v_mov_b32 v3, s94
  ds_write2_b32 v4, v2, v3 offset0:2 offset1:3
cen_1926:
  s_waitcnt lgkmcnt(0)
  s_barrier
  ds_read2_b32 v[2:3], v4 offset0:2 offset1:3
  s_waitcnt lgkmcnt(0)
  v_readfirstlane_b32 s92, v2
  v_readfirstlane_b32 s93, v3
  s_nop 0
  s_cmp_eq_u32 s93, 0
  s_cbranch_scc1 cen_1925
  s_mov_b32 s46, 1
  s_mov_b32 s45, s92
  s_branch DISPATCH
cen_1925:
  s_barrier
  v_and_b32 v3, 31, v0
  v_lshlrev_b32 v108, 7, v3
  v_lshrrev_b32 v64, 5, v0
  v_lshlrev_b32 v2, 3, v3
  v_lshl_add_u32 v2, v64, 11, v2
  s_lshl_b32 s92, s44, 8
  s_add_u32 s92, s92, 81920
  v_lshl_add_u32 v3, v3, 2, s92
  v_and_b32 v64, 15, v0
  v_lshl_add_u32 v4, v64, 2, s92
  v_lshrrev_b32 v65, 4, v0
  v_lshl_add_u32 v5, v65, 4, s92
  v_mov_b32 v106, 1
  s_mul_i32 s66, s44, 9216
  s_lshl_b32 s65, s45, 7
  s_add_u32 s65, s65, 0x80000
  s_mov_b32 s64, s65
  s_mov_b32 s63, 36864
  s_lshl_b32 s69, s50, 7
  s_lshl_b32 s92, s44, 2
  s_add_u32 s69, s69, s92
  s_add_u32 s69, s69, 0xc000000
  s_lshl_b32 s70, s50, 15
  s_lshl_b32 s92, s44, 10
  s_add_u32 s70, s70, s92
  s_add_u32 s70, s70, 0x4000000
  s_sub_u32 s71, s51, 1
  s_mov_b32 s53, s51
  s_cmp_eq_u32 s51, 0
  s_cselect_b32 s68, 64, s71
  s_mov_b32 s72, 163344
  s_max_i32 s75, s71, 0
  s_lshl_b32 s75, s75, 13
  s_add_u32 s75, s75, 0xc300000
  v_lshlrev_b32 v64, 2, v0
  s_lshl_b32 s95, s44, 11
  s_add_u32 s95, s95, 0x0
hx_1929:
  buffer_load_dwordx4 v[64:67], v1, s[4:7], s95 offen offset:0 sc1
  buffer_load_dwordx4 v[68:71], v1, s[4:7], s95 offen offset:1024 sc1
  s_waitcnt vmcnt(1)
  v_min3_u32 v109, v64, v65, v66
  s_waitcnt vmcnt(0)
  v_min3_u32 v109, v109, v67, v68
  v_min3_u32 v109, v109, v69, v70
  v_min_u32 v109, v109, v71
  v_cmp_eq_u32 vcc, 0, v109
  s_nop 0
  s_cbranch_vccz hxd_1930
  s_add_u32 s47, s47, 1
  s_mov_b32 s49, 2
  s_cmp_gt_u32 s47, 131072
  s_cbranch_scc1 TIMEOUT
  s_sleep 2
  s_branch hx_1929
hxd_1930:
  s_barrier
  s_mov_b32 s54, 0
  s_mov_b32 s94, 0
  s_cmp_lt_u32 s68, 64
  s_cselect_b32 s94, s94, 0
  s_cmp_lt_u32 s53, 64
  s_cselect_b32 s73, 1, 0
  s_and_b32 s74, s54, 66
  s_cmp_eq_u32 s74, 64
  s_cselect_b32 s74, 1, 0
  s_sub_u32 s93, s68, 2
  s_cmp_ge_u32 s93, 62
  s_cselect_b32 s93, 1, 0
  s_cmp_eq_u32 s94, 2
  s_cselect_b32 s93, 0, s93
  s_or_b32 s74, s74, s93
  s_and_b32 s94, s94, 1
  s_sub_u32 s93, s53, s68
  s_cmp_lt_i32 s93, 20
  s_cselect_b32 s74, 1, s74
  s_and_b32 s73, s73, s74
  s_cmp_lg_u32 s94, 0
  s_cselect_b32 s60, 1, s73
  s_cselect_b32 s73, 0, s73
  s_add_u32 s55, s68, 64
  s_cmp_lg_u32 s73, 0
  s_cselect_b32 s55, s53, s55
  s_cselect_b32 s74, 0, 2
  s_add_u32 s68, s68, s74
  s_add_u32 s74, s53, 3
  s_cmp_lt_u32 s74, 48
  s_cselect_b32 s93, 3, 2
  s_cmp_eq_u32 s74, 48
  s_cselect_b32 s93, 64, s93
  s_mul_i32 s93, s93, s73
  s_add_u32 s53, s53, s93
  s_min_u32 s73, s55, 127
  s_and_b32 s74, s73, 64
  s_add_u32 s74, s74, s73
  s_mul_i32 s67, s74, 36864
  s_add_u32 s67, s67, 0x400000
  s_add_u32 s67, s67, s66
  s_mov_b32 s61, s67
  s_xor_b32 s62, s63, 36864
  s_add_u32 s62, s62, s66
  s_branch H_GO
H_WAIT:
  buffer_load_dword v109, v108, s[4:7], s56 offen sc1
  s_waitcnt vmcnt(0)
  v_cmp_eq_u32 vcc, 0, v109
  s_mov_b64 exec, 1
  buffer_store_dword v106, off, s[4:7], s64 sc1
  s_mov_b64 exec, -1
  s_cbranch_vccz polld_1932
  s_mov_b32 s101, 0
poll_1931:
  s_add_u32 s47, s47, 1
  s_mov_b32 s49, 2
  s_cmp_gt_u32 s47, 131072
  s_cbranch_scc1 TIMEOUT
  s_sleep 3
  buffer_load_dword v109, v108, s[4:7], s56 offen sc1
  s_waitcnt vmcnt(0)
  v_cmp_eq_u32 vcc, 0, v109
  s_nop 0
  s_cbranch_vccnz poll_1931
polld_1932:
H_GO:
  s_mov_b32 s61, s67
  s_add_u32 m0, s62, 0
  s_nop 0
  buffer_load_dwordx4 v1, s[4:7], s61 offen offset:0 sc1 lds
  buffer_load_dwordx4 v1, s[4:7], s61 offen offset:1024 sc1 lds
  buffer_load_dwordx4 v1, s[4:7], s61 offen offset:2048 sc1 lds
  buffer_load_dwordx4 v1, s[4:7], s61 offen offset:3072 sc1 lds
  s_add_u32 m0, s62, 4096
  s_add_u32 s61, s61, 4096
  buffer_load_dwordx4 v1, s[4:7], s61 offen offset:0 sc1 lds
  buffer_load_dwordx4 v1, s[4:7], s61 offen offset:1024 sc1 lds
  buffer_load_dwordx4 v1, s[4:7], s61 offen offset:2048 sc1 lds
  buffer_load_dwordx4 v1, s[4:7], s61 offen offset:3072 sc1 lds
  s_add_u32 m0, s62, 8192
  s_add_u32 s61, s61, 4096
  buffer_load_dwordx4 v1, s[4:7], s61 offen offset:0 sc1 lds
  s_waitcnt vmcnt(0)
H_LOOP:
  s_mov_b32 s54, s55
  s_xor_b32 s63, s63, 36864
  v_add_u32 v6, s63, v1
  v_add_u32 v7, s63, v2
  s_barrier
  ds_read_b128 v[64:67], v6 offset:0
  ds_read_b128 v[68:71], v6 offset:1024
  ds_read_b128 v[72:75], v6 offset:2048
  ds_read_b128 v[76:79], v6 offset:3072
  s_waitcnt lgkmcnt(3)
  v_mfma_f32_16x16x32_bf16 v[16:19], a[0:3], v[64:67], 0
  ds_read_b64 v[40:41], v7 offset:32768
  ds_read_b64 v[42:43], v7 offset:33024
  v_mfma_f32_16x16x32_bf16 v[20:23], a[64:67], v[64:67], 0
  ds_read_b64 v[44:45], v7 offset:33280
  ds_read_b64 v[46:47], v7 offset:33536
  v_mfma_f32_16x16x32_bf16 v[24:27], a[128:131], v[64:67], 0
  ds_read_b64 v[48:49], v7 offset:33792
  ds_read_b64 v[50:51], v7 offset:34048
  v_mfma_f32_16x16x32_bf16 v[28:31], a[192:195], v[64:67], 0
  ds_read_b64 v[52:53], v7 offset:34304
  ds_read_b64 v[54:55], v7 offset:34560
  v_mfma_f32_16x16x32_bf16 v[32:35], v[64:67], v[128:131], 0
  s_min_u32 s73, s68, 63
  s_lshl_b32 s56, s73, 12
  s_add_u32 s56, s56, 0xc180000
  v_mfma_f32_16x16x32_bf16 v[36:39], v[64:67], v[192:195], 0
  s_waitcnt lgkmcnt(10)
  ds_read_b128 v[64:67], v6 offset:4096
  v_mfma_f32_16x16x32_bf16 v[16:19], a[4:7], v[68:71], v[16:19]
  buffer_load_dword v109, v108, s[4:7], s56 offen sc1
  v_mfma_f32_16x16x32_bf16 v[20:23], a[68:71], v[68:71], v[20:23]
  buffer_load_dword v102, off, s[4:7], s75 sc1
  v_mfma_f32_16x16x32_bf16 v[24:27], a[132:135], v[68:71], v[24:27]
  v_mfma_f32_16x16x32_bf16 v[28:31], a[196:199], v[68:71], v[28:31]
  v_mfma_f32_16x16x32_bf16 v[32:35], v[68:71], v[132:135], v[32:35]
  v_mfma_f32_16x16x32_bf16 v[36:39], v[68:71], v[196:199], v[36:39]
  s_waitcnt lgkmcnt(7)
  v_add_f32 v56, v40, v42
  ds_read_b128 v[68:71], v6 offset:5120
  v_mfma_f32_16x16x32_bf16 v[16:19], a[8:11], v[72:75], v[16:19]
  s_waitcnt lgkmcnt(7)
  v_add_f32 v56, v56, v44
  s_waitcnt lgkmcnt(6)
  v_add_f32 v56, v56, v46
  v_mfma_f32_16x16x32_bf16 v[20:23], a[72:75], v[72:75], v[20:23]
  s_waitcnt lgkmcnt(5)
  v_add_f32 v56, v56, v48
  s_waitcnt lgkmcnt(4)
  v_add_f32 v56, v56, v50
  v_mfma_f32_16x16x32_bf16 v[24:27], a[136:139], v[72:75], v[24:27]
  s_waitcnt lgkmcnt(3)
  v_add_f32 v56, v56, v52
  s_waitcnt lgkmcnt(2)
  v_add_f32 v56, v56, v54
  v_mfma_f32_16x16x32_bf16 v[28:31], a[200:203], v[72:75], v[28:31]
  v_mov_b32 v58, v56
  v_mfma_f32_16x16x32_bf16 v[32:35], v[72:75], v[136:139], v[32:35]
  s_nop 0
  v_permlane32_swap_b32 v56, v58
  v_mfma_f32_16x16x32_bf16 v[36:39], v[72:75], v[200:203], v[36:39]
  v_add_f32 v56, v56, v58
  ds_read_b128 v[72:75], v6 offset:6144
  v_mfma_f32_16x16x32_bf16 v[16:19], a[12:15], v[76:79], v[16:19]
  v_mul_f32 v56, 0x3d800000, v56
  v_add_f32 v57, v41, v43
  v_mfma_f32_16x16x32_bf16 v[20:23], a[76:79], v[76:79], v[20:23]
  v_add_f32 v57, v57, v45
  v_add_f32 v57, v57, v47
  v_mfma_f32_16x16x32_bf16 v[24:27], a[140:143], v[76:79], v[24:27]
  v_add_f32 v57, v57, v49
  v_add_f32 v57, v57, v51
  v_mfma_f32_16x16x32_bf16 v[28:31], a[204:207], v[76:79], v[28:31]
  v_add_f32 v57, v57, v53
  v_add_f32 v57, v57, v55
  v_mfma_f32_16x16x32_bf16 v[32:35], v[76:79], v[140:143], v[32:35]
  v_sub_f32 v40, v40, v56
  v_sub_f32 v42, v42, v56
  v_mfma_f32_16x16x32_bf16 v[36:39], v[76:79], v[204:207], v[36:39]
  s_waitcnt lgkmcnt(2)
  v_sub_f32 v44, v44, v56
  ds_read_b128 v[76:79], v6 offset:7168
  v_mfma_f32_16x16x32_bf16 v[16:19], a[16:19], v[64:67], v[16:19]
  v_sub_f32 v46, v46, v56
  v_sub_f32 v48, v48, v56
  v_mfma_f32_16x16x32_bf16 v[20:23], a[80:83], v[64:67], v[20:23]
  v_sub_f32 v50, v50, v56
  v_sub_f32 v52, v52, v56
  v_mfma_f32_16x16x32_bf16 v[24:27], a[144:147], v[64:67], v[24:27]
  v_sub_f32 v54, v54, v56
  v_mul_f32 v58, v40, v40
  v_mfma_f32_16x16x32_bf16 v[28:31], a[208:211], v[64:67], v[28:31]
  v_fmac_f32 v58, v42, v42
  v_fmac_f32 v58, v44, v44
  v_mfma_f32_16x16x32_bf16 v[32:35], v[64:67], v[144:147], v[32:35]
  v_fmac_f32 v58, v46, v46
  v_fmac_f32 v58, v48, v48
  v_mfma_f32_16x16x32_bf16 v[36:39], v[64:67], v[208:211], v[36:39]
  s_waitcnt lgkmcnt(2)
  v_fmac_f32 v58, v50, v50
  ds_read_b128 v[64:67], v6 offset:8192
  v_mfma_f32_16x16x32_bf16 v[16:19], a[20:23], v[68:71], v[16:19]
  v_fmac_f32 v58, v52, v52
  v_fmac_f32 v58, v54, v54
  v_mfma_f32_16x16x32_bf16 v[20:23], a[84:87], v[68:71], v[20:23]
  v_fmac_f32 v57, 0x42000000, v58
  v_mov_b32 v58, v57
  v_mfma_f32_16x16x32_bf16 v[24:27], a[148:151], v[68:71], v[24:27]
  s_nop 0
  v_permlane32_swap_b32 v57, v58
  v_mfma_f32_16x16x32_bf16 v[28:31], a[212:215], v[68:71], v[28:31]
  v_add_f32 v57, v57, v58
  v_mul_f32 v57, 0x3b000000, v57
  v_mfma_f32_16x16x32_bf16 v[32:35], v[68:71], v[148:151], v[32:35]
  v_cvt_pk_bf16_f32 v56, v56, v56
  v_lshlrev_b32 v56, 16, v56
  v_mfma_f32_16x16x32_bf16 v[36:39], v[68:71], v[212:215], v[36:39]
  s_waitcnt lgkmcnt(2)
  v_cvt_pk_bf16_f32 v57, v57, v57
  ds_read_b128 v[68:71], v6 offset:9216
  v_mfma_f32_16x16x32_bf16 v[16:19], a[24:27], v[72:75], v[16:19]
  v_lshlrev_b32 v57, 16, v57
  v_add_f32 v57, 0x3727c5ac, v57
  v_mfma_f32_16x16x32_bf16 v[20:23], a[88:91], v[72:75], v[20:23]
  v_cvt_pk_bf16_f32 v57, v57, v57
  v_lshlrev_b32 v57, 16, v57
  v_mfma_f32_16x16x32_bf16 v[24:27], a[152:155], v[72:75], v[24:27]
  v_sqrt_f32 v57, v57
  v_mfma_f32_16x16x32_bf16 v[28:31], a[216:219], v[72:75], v[28:31]
  v_cvt_pk_bf16_f32 v57, v57, v57
  v_lshlrev_b32 v57, 16, v57
  v_mfma_f32_16x16x32_bf16 v[32:35], v[72:75], v[152:155], v[32:35]
  v_rcp_f32 v57, v57
  v_mfma_f32_16x16x32_bf16 v[36:39], v[72:75], v[216:219], v[36:39]
  s_waitcnt lgkmcnt(2)
  v_sub_f32 v56, 0, v56
  ds_read_b128 v[72:75], v6 offset:10240
  v_mfma_f32_16x16x32_bf16 v[16:19], a[28:31], v[76:79], v[16:19]
  ds_write_b32 v3, v57
  ds_write_b32 v3, v56 offset:128
  v_mfma_f32_16x16x32_bf16 v[20:23], a[92:95], v[76:79], v[20:23]
  ds_read_b32 v80, v4 offset:0
  ds_read_b32 v81, v4 offset:128
  v_mfma_f32_16x16x32_bf16 v[24:27], a[156:159], v[76:79], v[24:27]
  ds_read_b128 v[84:87], v5 offset:0
  ds_read_b128 v[88:91], v5 offset:128
  v_mfma_f32_16x16x32_bf16 v[28:31], a[220:223], v[76:79], v[28:31]
  ds_read_b32 v82, v4 offset:64
  ds_read_b32 v83, v4 offset:192
  v_mfma_f32_16x16x32_bf16 v[32:35], v[76:79], v[156:159], v[32:35]
  ds_read_b128 v[92:95], v5 offset:64
  ds_read_b128 v[96:99], v5 offset:192
  v_mfma_f32_16x16x32_bf16 v[36:39], v[76:79], v[220:223], v[36:39]
  s_lshl_b32 s59, s54, 12
  s_add_u32 s59, s59, s69
  ds_read_b128 v[76:79], v6 offset:11264
  s_waitcnt lgkmcnt(13)
  v_mfma_f32_16x16x32_bf16 v[16:19], a[32:35], v[64:67], v[16:19]
  s_lshl_b32 s57, s54, 20
  s_add_u32 s57, s57, s70
  s_lshl_b32 s92, s44, 10
  v_mfma_f32_16x16x32_bf16 v[20:23], a[96:99], v[64:67], v[20:23]
  s_add_u32 s58, s57, s92
  s_add_u32 s58, s58, 16384
  v_mfma_f32_16x16x32_bf16 v[24:27], a[160:163], v[64:67], v[24:27]
  v_mfma_f32_16x16x32_bf16 v[28:31], a[224:227], v[64:67], v[28:31]
  v_mfma_f32_16x16x32_bf16 v[32:35], v[64:67], v[160:163], v[32:35]
  v_mfma_f32_16x16x32_bf16 v[36:39], v[64:67], v[224:227], v[36:39]
  s_waitcnt vmcnt(2)
  s_mov_b64 exec, 1
  buffer_store_dword v106, off, s[4:7], s64 sc1
  s_mov_b64 exec, -1
  ds_read_b128 v[64:67], v6 offset:12288
  s_waitcnt lgkmcnt(13)
  v_mfma_f32_16x16x32_bf16 v[16:19], a[36:39], v[68:71], v[16:19]
  s_waitcnt vmcnt(2)
  v_cmp_ne_u32 vcc, 0, v109
  s_waitcnt vmcnt(1)
  v_readfirstlane_b32 s94, v102
  v_mfma_f32_16x16x32_bf16 v[20:23], a[100:103], v[68:71], v[20:23]
  s_lshl_b32 s93, s44, 4
  s_add_u32 s93, s93, s72
  s_cmp_lg_u32 s94, 0
  v_mfma_f32_16x16x32_bf16 v[24:27], a[164:167], v[68:71], v[24:27]
  s_cselect_b32 s94, 2, 0
  s_cmp_eq_u64 vcc, -1
  s_cselect_b32 s94, 1, s94
  v_mfma_f32_16x16x32_bf16 v[28:31], a[228:231], v[68:71], v[28:31]
  v_mov_b32 v100, s93
  v_mov_b32 v101, s94
  v_mfma_f32_16x16x32_bf16 v[32:35], v[68:71], v[164:167], v[32:35]
  ds_write_b32 v100, v101
  v_mov_b32 v100, s72
  v_mfma_f32_16x16x32_bf16 v[36:39], v[68:71], v[228:231], v[36:39]
  s_waitcnt lgkmcnt(13)
  ds_read_b128 v[68:71], v6 offset:13312
  v_mfma_f32_16x16x32_bf16 v[16:19], a[40:43], v[72:75], v[16:19]
  v_mfma_f32_16x16x32_bf16 v[20:23], a[104:107], v[72:75], v[20:23]
  v_mfma_f32_16x16x32_bf16 v[24:27], a[168:171], v[72:75], v[24:27]
  v_mfma_f32_16x16x32_bf16 v[28:31], a[232:235], v[72:75], v[28:31]
  s_waitcnt lgkmcnt(1)
  s_barrier
  ds_read_b32 v101, v100
  s_xor_b32 s72, s72, 4
  v_mfma_f32_16x16x32_bf16 v[32:35], v[72:75], v[168:171], v[32:35]
  v_mfma_f32_16x16x32_bf16 v[36:39], v[72:75], v[232:235], v[36:39]
  ds_read_b128 v[72:75], v6 offset:14336
  v_mfma_f32_16x16x32_bf16 v[16:19], a[44:47], v[76:79], v[16:19]
  v_mfma_f32_16x16x32_bf16 v[20:23], a[108:111], v[76:79], v[20:23]
  v_mfma_f32_16x16x32_bf16 v[24:27], a[172:175], v[76:79], v[24:27]
  v_mfma_f32_16x16x32_bf16 v[28:31], a[236:239], v[76:79], v[28:31]
  s_waitcnt lgkmcnt(1)
  v_readfirstlane_b32 s94, v101
  s_cmp_lt_u32 s68, 64
  v_mfma_f32_16x16x32_bf16 v[32:35], v[76:79], v[172:175], v[32:35]
  s_cselect_b32 s94, s94, 0
  s_cmp_lt_u32 s53, 64
  s_cselect_b32 s73, 1, 0
  v_mfma_f32_16x16x32_bf16 v[36:39], v[76:79], v[236:239], v[36:39]
  s_and_b32 s74, s54, 66
  s_cmp_eq_u32 s74, 64
  ds_read_b128 v[76:79], v6 offset:15360
  v_mfma_f32_16x16x32_bf16 v[16:19], a[48:51], v[64:67], v[16:19]
  s_cselect_b32 s74, 1, 0
  s_sub_u32 s93, s68, 2
  s_cmp_ge_u32 s93, 62
  v_mfma_f32_16x16x32_bf16 v[20:23], a[112:115], v[64:67], v[20:23]
  s_cselect_b32 s93, 1, 0
  s_cmp_eq_u32 s94, 2
  s_cselect_b32 s93, 0, s93
  v_mfma_f32_16x16x32_bf16 v[24:27], a[176:179], v[64:67], v[24:27]
  s_or_b32 s74, s74, s93
  s_and_b32 s94, s94, 1
  s_sub_u32 s93, s53, s68
  v_mfma_f32_16x16x32_bf16 v[28:31], a[240:243], v[64:67], v[28:31]
  s_cmp_lt_i32 s93, 20
  s_cselect_b32 s74, 1, s74
  s_and_b32 s73, s73, s74
  v_mfma_f32_16x16x32_bf16 v[32:35], v[64:67], v[176:179], v[32:35]
  s_cmp_lg_u32 s94, 0
  s_cselect_b32 s60, 1, s73
  s_cselect_b32 s73, 0, s73
  v_mfma_f32_16x16x32_bf16 v[36:39], v[64:67], v[240:243], v[36:39]
  s_add_u32 s55, s68, 64
  s_cmp_lg_u32 s73, 0
  ds_read_b128 v[64:67], v6 offset:16384
  v_mfma_f32_16x16x32_bf16 v[16:19], a[52:55], v[68:71], v[16:19]
  s_cselect_b32 s55, s53, s55
  s_cselect_b32 s74, 0, 2
  s_add_u32 s68, s68, s74
  v_mfma_f32_16x16x32_bf16 v[20:23], a[116:119], v[68:71], v[20:23]
  s_add_u32 s74, s53, 3
  s_cmp_lt_u32 s74, 48
  s_cselect_b32 s93, 3, 2
  v_mfma_f32_16x16x32_bf16 v[24:27], a[180:183], v[68:71], v[24:27]
  s_cmp_eq_u32 s74, 48
  s_cselect_b32 s93, 64, s93
  s_mul_i32 s93, s93, s73
  v_mfma_f32_16x16x32_bf16 v[28:31], a[244:247], v[68:71], v[28:31]
  s_add_u32 s53, s53, s93
  s_min_u32 s73, s55, 127
  s_and_b32 s74, s73, 64
  v_mfma_f32_16x16x32_bf16 v[32:35], v[68:71], v[180:183], v[32:35]
  s_add_u32 s74, s74, s73
  s_mul_i32 s67, s74, 36864
  s_add_u32 s67, s67, 0x400000
  v_mfma_f32_16x16x32_bf16 v[36:39], v[68:71], v[244:247], v[36:39]
  s_add_u32 s67, s67, s66
  s_mov_b32 s61, s67
  ds_read_b128 v[68:71], v6 offset:17408
  s_waitcnt lgkmcnt(3)
  v_mfma_f32_16x16x32_bf16 v[16:19], a[56:59], v[72:75], v[16:19]
  s_xor_b32 s62, s63, 36864
  s_add_u32 s62, s62, s66
  v_mfma_f32_16x16x32_bf16 v[20:23], a[120:123], v[72:75], v[20:23]
  v_mfma_f32_16x16x32_bf16 v[24:27], a[184:187], v[72:75], v[24:27]
  s_cmp_eq_u32 s60, 0
  s_cbranch_scc1 hpl_1933
  v_mfma_f32_16x16x32_bf16 v[28:31], a[248:251], v[72:75], v[28:31]
  s_add_u32 m0, s62, 0
  s_nop 0
  v_mfma_f32_16x16x32_bf16 v[32:35], v[72:75], v[184:187], v[32:35]
  buffer_load_dwordx4 v1, s[4:7], s61 offen offset:0 sc1 lds
  v_mfma_f32_16x16x32_bf16 v[36:39], v[72:75], v[248:251], v[36:39]
  s_waitcnt lgkmcnt(2)
  ds_read_b128 v[72:75], v6 offset:18432
  v_mfma_f32_16x16x32_bf16 v[16:19], a[60:63], v[76:79], v[16:19]
  v_mfma_f32_16x16x32_bf16 v[20:23], a[124:127], v[76:79], v[20:23]
  buffer_load_dwordx4 v1, s[4:7], s61 offen offset:1024 sc1 lds
  v_mfma_f32_16x16x32_bf16 v[24:27], a[188:191], v[76:79], v[24:27]
  v_mfma_f32_16x16x32_bf16 v[28:31], a[252:255], v[76:79], v[28:31]
  v_mfma_f32_16x16x32_bf16 v[32:35], v[76:79], v[188:191], v[32:35]
  v_mfma_f32_16x16x32_bf16 v[36:39], v[76:79], v[252:255], v[36:39]
  s_waitcnt lgkmcnt(2)
  ds_read_b128 v[76:79], v6 offset:19456
  v_mfma_f32_16x16x32_bf16 v[40:43], a[0:3], v[64:67], 0
  buffer_load_dwordx4 v1, s[4:7], s61 offen offset:2048 sc1 lds
  v_mfma_f32_16x16x32_bf16 v[44:47], a[64:67], v[64:67], 0
  v_mfma_f32_16x16x32_bf16 v[48:51], a[128:131], v[64:67], 0
  v_fmac_f32 v16, v81, v110
  v_fmac_f32 v17, v81, v111
  v_mfma_f32_16x16x32_bf16 v[52:55], a[192:195], v[64:67], 0
  v_mul_f32 v16, v80, v16
  v_mul_f32 v17, v80, v17
  v_mfma_f32_16x16x32_bf16 v[56:59], v[64:67], v[128:131], 0
  v_fmac_f32 v18, v81, v112
  v_fmac_f32 v19, v81, v113
  v_mfma_f32_16x16x32_bf16 v[60:63], v[64:67], v[192:195], 0
  s_waitcnt lgkmcnt(2)
  v_mul_f32 v18, v80, v18
  ds_read_b128 v[64:67], v6 offset:20480
  v_mfma_f32_16x16x32_bf16 v[40:43], a[4:7], v[68:71], v[40:43]
  v_mul_f32 v19, v80, v19
  v_mfma_f32_16x16x32_bf16 v[44:47], a[68:71], v[68:71], v[44:47]
  buffer_load_dwordx4 v1, s[4:7], s61 offen offset:3072 sc1 lds
  v_mfma_f32_16x16x32_bf16 v[48:51], a[132:135], v[68:71], v[48:51]
  v_fmac_f32 v20, v81, v114
  v_fmac_f32 v21, v81, v115
  v_mfma_f32_16x16x32_bf16 v[52:55], a[196:199], v[68:71], v[52:55]
  v_mul_f32 v20, v80, v20
  v_mul_f32 v21, v80, v21
  v_mfma_f32_16x16x32_bf16 v[56:59], v[68:71], v[132:135], v[56:59]
  v_fmac_f32 v22, v81, v116
  v_fmac_f32 v23, v81, v117
  v_mfma_f32_16x16x32_bf16 v[60:63], v[68:71], v[196:199], v[60:63]
  s_waitcnt lgkmcnt(2)
  v_mul_f32 v22, v80, v22
  ds_read_b128 v[68:71], v6 offset:21504
  v_mfma_f32_16x16x32_bf16 v[40:43], a[8:11], v[72:75], v[40:43]
  v_mul_f32 v23, v80, v23
  s_add_u32 m0, s62, 4096
  v_mfma_f32_16x16x32_bf16 v[44:47], a[72:75], v[72:75], v[44:47]
  s_add_u32 s61, s61, 4096
  buffer_load_dwordx4 v1, s[4:7], s61 offen offset:0 sc1 lds
  v_mfma_f32_16x16x32_bf16 v[48:51], a[136:139], v[72:75], v[48:51]
  v_cvt_pk_bf16_f32 v16, v16, v17
  v_cvt_pk_bf16_f32 v17, v18, v19
  v_mfma_f32_16x16x32_bf16 v[52:55], a[200:203], v[72:75], v[52:55]
  v_cvt_pk_bf16_f32 v18, v20, v21
  v_cvt_pk_bf16_f32 v19, v22, v23
  v_mfma_f32_16x16x32_bf16 v[56:59], v[72:75], v[136:139], v[56:59]
  s_add_u32 s3, s57, 0
  buffer_store_dwordx4 v[16:19], v1, s[4:7], s3 offen sc1
  v_mfma_f32_16x16x32_bf16 v[60:63], v[72:75], v[200:203], v[60:63]
  s_waitcnt lgkmcnt(2)
  v_fmac_f32 v24, v81, v118
  ds_read_b128 v[72:75], v6 offset:22528
  v_mfma_f32_16x16x32_bf16 v[40:43], a[12:15], v[76:79], v[40:43]
  v_fmac_f32 v25, v81, v119
  v_mfma_f32_16x16x32_bf16 v[44:47], a[76:79], v[76:79], v[44:47]
  buffer_load_dwordx4 v1, s[4:7], s61 offen offset:1024 sc1 lds
  v_mfma_f32_16x16x32_bf16 v[48:51], a[140:143], v[76:79], v[48:51]
  v_mul_f32 v24, v80, v24
  v_mul_f32 v25, v80, v25
  v_mfma_f32_16x16x32_bf16 v[52:55], a[204:207], v[76:79], v[52:55]
  v_fmac_f32 v26, v81, v120
  v_fmac_f32 v27, v81, v121
  v_mfma_f32_16x16x32_bf16 v[56:59], v[76:79], v[140:143], v[56:59]
  v_mul_f32 v26, v80, v26
  v_mul_f32 v27, v80, v27
  v_mfma_f32_16x16x32_bf16 v[60:63], v[76:79], v[204:207], v[60:63]
  s_waitcnt lgkmcnt(2)
  v_fmac_f32 v28, v81, v122
  ds_read_b128 v[76:79], v6 offset:23552
  v_mfma_f32_16x16x32_bf16 v[40:43], a[16:19], v[64:67], v[40:43]
  v_fmac_f32 v29, v81, v123
  v_mfma_f32_16x16x32_bf16 v[44:47], a[80:83], v[64:67], v[44:47]
  buffer_load_dwordx4 v1, s[4:7], s61 offen offset:2048 sc1 lds
  v_mfma_f32_16x16x32_bf16 v[48:51], a[144:147], v[64:67], v[48:51]
  v_mul_f32 v28, v80, v28
  v_mul_f32 v29, v80, v29
  v_mfma_f32_16x16x32_bf16 v[52:55], a[208:211], v[64:67], v[52:55]
  v_fmac_f32 v30, v81, v124
  v_fmac_f32 v31, v81, v125
  v_mfma_f32_16x16x32_bf16 v[56:59], v[64:67], v[144:147], v[56:59]
  v_mul_f32 v30, v80, v30
  v_mul_f32 v31, v80, v31
  v_mfma_f32_16x16x32_bf16 v[60:63], v[64:67], v[208:211], v[60:63]
  s_waitcnt lgkmcnt(2)
  v_cvt_pk_bf16_f32 v24, v24, v25
  ds_read_b128 v[64:67], v6 offset:24576
  v_mfma_f32_16x16x32_bf16 v[40:43], a[20:23], v[68:71], v[40:43]
  v_cvt_pk_bf16_f32 v25, v26, v27
  v_mfma_f32_16x16x32_bf16 v[44:47], a[84:87], v[68:71], v[44:47]
  buffer_load_dwordx4 v1, s[4:7], s61 offen offset:3072 sc1 lds
  v_mfma_f32_16x16x32_bf16 v[48:51], a[148:151], v[68:71], v[48:51]
  v_cvt_pk_bf16_f32 v26, v28, v29
  v_cvt_pk_bf16_f32 v27, v30, v31
  v_mfma_f32_16x16x32_bf16 v[52:55], a[212:215], v[68:71], v[52:55]
  s_add_u32 s3, s57, 8192
  buffer_store_dwordx4 v[24:27], v1, s[4:7], s3 offen sc1
  v_mfma_f32_16x16x32_bf16 v[56:59], v[68:71], v[148:151], v[56:59]
  v_fmac_f32 v32, v88, v126
  v_fmac_f32 v33, v89, v126
  v_mfma_f32_16x16x32_bf16 v[60:63], v[68:71], v[212:215], v[60:63]
  s_waitcnt lgkmcnt(2)
  v_mul_f32 v32, v84, v32
  ds_read_b128 v[68:71], v6 offset:25600
  v_mfma_f32_16x16x32_bf16 v[40:43], a[24:27], v[72:75], v[40:43]
  v_mul_f32 v33, v85, v33
  s_add_u32 m0, s62, 8192
  v_mfma_f32_16x16x32_bf16 v[44:47], a[88:91], v[72:75], v[44:47]
  s_add_u32 s61, s61, 4096
  buffer_load_dwordx4 v1, s[4:7], s61 offen offset:0 sc1 lds
  v_mfma_f32_16x16x32_bf16 v[48:51], a[152:155], v[72:75], v[48:51]
  v_fmac_f32 v34, v90, v126
  v_fmac_f32 v35, v91, v126
  v_mfma_f32_16x16x32_bf16 v[52:55], a[216:219], v[72:75], v[52:55]
  v_mul_f32 v34, v86, v34
  v_mul_f32 v35, v87, v35
  v_mfma_f32_16x16x32_bf16 v[56:59], v[72:75], v[152:155], v[56:59]
  v_cvt_pk_bf16_f32 v8, v32, v33
  v_cvt_pk_bf16_f32 v9, v34, v35
  v_mfma_f32_16x16x32_bf16 v[60:63], v[72:75], v[216:219], v[60:63]
  s_waitcnt lgkmcnt(2)
  v_fmac_f32 v36, v88, v127
  ds_read_b128 v[72:75], v6 offset:26624
  v_mfma_f32_16x16x32_bf16 v[40:43], a[28:31], v[76:79], v[40:43]
  v_fmac_f32 v37, v89, v127
  v_mul_f32 v36, v84, v36
  v_mfma_f32_16x16x32_bf16 v[44:47], a[92:95], v[76:79], v[44:47]
  v_mul_f32 v37, v85, v37
  v_fmac_f32 v38, v90, v127
  v_mfma_f32_16x16x32_bf16 v[48:51], a[156:159], v[76:79], v[48:51]
  v_fmac_f32 v39, v91, v127
  v_mul_f32 v38, v86, v38
  v_mfma_f32_16x16x32_bf16 v[52:55], a[220:223], v[76:79], v[52:55]
  v_mul_f32 v39, v87, v39
  v_cvt_pk_bf16_f32 v12, v36, v37
  v_mfma_f32_16x16x32_bf16 v[56:59], v[76:79], v[156:159], v[56:59]
  v_cvt_pk_bf16_f32 v13, v38, v39
  v_mfma_f32_16x16x32_bf16 v[60:63], v[76:79], v[220:223], v[60:63]
  s_waitcnt lgkmcnt(2)
  ds_read_b128 v[76:79], v6 offset:27648
  v_mfma_f32_16x16x32_bf16 v[40:43], a[32:35], v[64:67], v[40:43]
  v_mfma_f32_16x16x32_bf16 v[44:47], a[96:99], v[64:67], v[44:47]
  v_mfma_f32_16x16x32_bf16 v[48:51], a[160:163], v[64:67], v[48:51]
  v_mfma_f32_16x16x32_bf16 v[52:55], a[224:227], v[64:67], v[52:55]
  v_mfma_f32_16x16x32_bf16 v[56:59], v[64:67], v[160:163], v[56:59]
  v_mfma_f32_16x16x32_bf16 v[60:63], v[64:67], v[224:227], v[60:63]
  s_waitcnt lgkmcnt(2)
  ds_read_b128 v[64:67], v6 offset:28672
  v_mfma_f32_16x16x32_bf16 v[40:43], a[36:39], v[68:71], v[40:43]
  v_mfma_f32_16x16x32_bf16 v[44:47], a[100:103], v[68:71], v[44:47]
  v_mfma_f32_16x16x32_bf16 v[48:51], a[164:167], v[68:71], v[48:51]
  v_mfma_f32_16x16x32_bf16 v[52:55], a[228:231], v[68:71], v[52:55]
  v_mfma_f32_16x16x32_bf16 v[56:59], v[68:71], v[164:167], v[56:59]
  v_mfma_f32_16x16x32_bf16 v[60:63], v[68:71], v[228:231], v[60:63]
  s_waitcnt lgkmcnt(2)
  ds_read_b128 v[68:71], v6 offset:29696
  v_mfma_f32_16x16x32_bf16 v[40:43], a[40:43], v[72:75], v[40:43]
  v_mfma_f32_16x16x32_bf16 v[44:47], a[104:107], v[72:75], v[44:47]
  v_mfma_f32_16x16x32_bf16 v[48:51], a[168:171], v[72:75], v[48:51]
  v_mfma_f32_16x16x32_bf16 v[52:55], a[232:235], v[72:75], v[52:55]
  v_mfma_f32_16x16x32_bf16 v[56:59], v[72:75], v[168:171], v[56:59]
  v_mfma_f32_16x16x32_bf16 v[60:63], v[72:75], v[232:235], v[60:63]
  s_waitcnt lgkmcnt(2)
  ds_read_b128 v[72:75], v6 offset:30720
  v_mfma_f32_16x16x32_bf16 v[40:43], a[44:47], v[76:79], v[40:43]
  v_mfma_f32_16x16x32_bf16 v[44:47], a[108:111], v[76:79], v[44:47]
  v_mfma_f32_16x16x32_bf16 v[48:51], a[172:175], v[76:79], v[48:51]
  v_mfma_f32_16x16x32_bf16 v[52:55], a[236:239], v[76:79], v[52:55]
  v_mfma_f32_16x16x32_bf16 v[56:59], v[76:79], v[172:175], v[56:59]
  v_mfma_f32_16x16x32_bf16 v[60:63], v[76:79], v[236:239], v[60:63]
  s_waitcnt lgkmcnt(2)
  ds_read_b128 v[76:79], v6 offset:31744
  v_mfma_f32_16x16x32_bf16 v[40:43], a[48:51], v[64:67], v[40:43]
  v_mfma_f32_16x16x32_bf16 v[44:47], a[112:115], v[64:67], v[44:47]
  v_mfma_f32_16x16x32_bf16 v[48:51], a[176:179], v[64:67], v[48:51]
  v_mfma_f32_16x16x32_bf16 v[52:55], a[240:243], v[64:67], v[52:55]
  v_mfma_f32_16x16x32_bf16 v[56:59], v[64:67], v[176:179], v[56:59]
  v_mfma_f32_16x16x32_bf16 v[60:63], v[64:67], v[240:243], v[60:63]
  s_waitcnt lgkmcnt(2)
  v_mfma_f32_16x16x32_bf16 v[40:43], a[52:55], v[68:71], v[40:43]
  v_mfma_f32_16x16x32_bf16 v[44:47], a[116:119], v[68:71], v[44:47]
  v_mfma_f32_16x16x32_bf16 v[48:51], a[180:183], v[68:71], v[48:51]
  v_mfma_f32_16x16x32_bf16 v[52:55], a[244:247], v[68:71], v[52:55]
  v_mfma_f32_16x16x32_bf16 v[56:59], v[68:71], v[180:183], v[56:59]
  v_mfma_f32_16x16x32_bf16 v[60:63], v[68:71], v[244:247], v[60:63]
  s_waitcnt lgkmcnt(1)
  v_mfma_f32_16x16x32_bf16 v[40:43], a[56:59], v[72:75], v[40:43]
  v_mfma_f32_16x16x32_bf16 v[44:47], a[120:123], v[72:75], v[44:47]
  v_mfma_f32_16x16x32_bf16 v[48:51], a[184:187], v[72:75], v[48:51]
  v_mfma_f32_16x16x32_bf16 v[52:55], a[248:251], v[72:75], v[52:55]
  v_mfma_f32_16x16x32_bf16 v[56:59], v[72:75], v[184:187], v[56:59]
  v_mfma_f32_16x16x32_bf16 v[60:63], v[72:75], v[248:251], v[60:63]
  s_waitcnt lgkmcnt(0)
  v_mfma_f32_16x16x32_bf16 v[40:43], a[60:63], v[76:79], v[40:43]
  v_mfma_f32_16x16x32_bf16 v[44:47], a[124:127], v[76:79], v[44:47]
  v_mfma_f32_16x16x32_bf16 v[48:51], a[188:191], v[76:79], v[48:51]
  v_mfma_f32_16x16x32_bf16 v[52:55], a[252:255], v[76:79], v[52:55]
  v_mfma_f32_16x16x32_bf16 v[56:59], v[76:79], v[188:191], v[56:59]
  v_mfma_f32_16x16x32_bf16 v[60:63], v[76:79], v[252:255], v[60:63]
  s_branch hsc_1934
hpl_1933:
  v_mfma_f32_16x16x32_bf16 v[28:31], a[248:251], v[72:75], v[28:31]
  v_mfma_f32_16x16x32_bf16 v[32:35], v[72:75], v[184:187], v[32:35]
  v_mfma_f32_16x16x32_bf16 v[36:39], v[72:75], v[248:251], v[36:39]
  s_waitcnt lgkmcnt(2)
  ds_read_b128 v[72:75], v6 offset:18432
  v_mfma_f32_16x16x32_bf16 v[16:19], a[60:63], v[76:79], v[16:19]
  v_mfma_f32_16x16x32_bf16 v[20:23], a[124:127], v[76:79], v[20:23]
  v_mfma_f32_16x16x32_bf16 v[24:27], a[188:191], v[76:79], v[24:27]
  v_mfma_f32_16x16x32_bf16 v[28:31], a[252:255], v[76:79], v[28:31]
  v_mfma_f32_16x16x32_bf16 v[32:35], v[76:79], v[188:191], v[32:35]
  v_mfma_f32_16x16x32_bf16 v[36:39], v[76:79], v[252:255], v[36:39]
  s_waitcnt lgkmcnt(2)
  ds_read_b128 v[76:79], v6 offset:19456
  v_mfma_f32_16x16x32_bf16 v[40:43], a[0:3], v[64:67], 0
  v_mfma_f32_16x16x32_bf16 v[44:47], a[64:67], v[64:67], 0
  v_mfma_f32_16x16x32_bf16 v[48:51], a[128:131], v[64:67], 0
  v_fmac_f32 v16, v81, v110
  v_fmac_f32 v17, v81, v111
  v_mfma_f32_16x16x32_bf16 v[52:55], a[192:195], v[64:67], 0
  v_mul_f32 v16, v80, v16
  v_mul_f32 v17, v80, v17
  v_mfma_f32_16x16x32_bf16 v[56:59], v[64:67], v[128:131], 0
  v_fmac_f32 v18, v81, v112
  v_fmac_f32 v19, v81, v113
  v_mfma_f32_16x16x32_bf16 v[60:63], v[64:67], v[192:195], 0
  s_waitcnt lgkmcnt(2)
  v_mul_f32 v18, v80, v18
  ds_read_b128 v[64:67], v6 offset:20480
  v_mfma_f32_16x16x32_bf16 v[40:43], a[4:7], v[68:71], v[40:43]
  v_mul_f32 v19, v80, v19
  v_fmac_f32 v20, v81, v114
  v_mfma_f32_16x16x32_bf16 v[44:47], a[68:71], v[68:71], v[44:47]
  v_fmac_f32 v21, v81, v115
  v_mul_f32 v20, v80, v20
  v_mfma_f32_16x16x32_bf16 v[48:51], a[132:135], v[68:71], v[48:51]
  v_mul_f32 v21, v80, v21
  v_fmac_f32 v22, v81, v116
  v_mfma_f32_16x16x32_bf16 v[52:55], a[196:199], v[68:71], v[52:55]
  v_fmac_f32 v23, v81, v117
  v_mul_f32 v22, v80, v22
  v_mfma_f32_16x16x32_bf16 v[56:59], v[68:71], v[132:135], v[56:59]
  v_mul_f32 v23, v80, v23
  v_cvt_pk_bf16_f32 v16, v16, v17
  v_mfma_f32_16x16x32_bf16 v[60:63], v[68:71], v[196:199], v[60:63]
  s_waitcnt lgkmcnt(2)
  v_cvt_pk_bf16_f32 v17, v18, v19
  ds_read_b128 v[68:71], v6 offset:21504
  v_mfma_f32_16x16x32_bf16 v[40:43], a[8:11], v[72:75], v[40:43]
  v_cvt_pk_bf16_f32 v18, v20, v21
  v_cvt_pk_bf16_f32 v19, v22, v23
  v_mfma_f32_16x16x32_bf16 v[44:47], a[72:75], v[72:75], v[44:47]
  s_add_u32 s3, s57, 0
  buffer_store_dwordx4 v[16:19], v1, s[4:7], s3 offen sc1
  v_mfma_f32_16x16x32_bf16 v[48:51], a[136:139], v[72:75], v[48:51]
  v_fmac_f32 v24, v81, v118
  v_fmac_f32 v25, v81, v119
  v_mfma_f32_16x16x32_bf16 v[52:55], a[200:203], v[72:75], v[52:55]
  v_mul_f32 v24, v80, v24
  v_mul_f32 v25, v80, v25
  v_mfma_f32_16x16x32_bf16 v[56:59], v[72:75], v[136:139], v[56:59]
  v_fmac_f32 v26, v81, v120
  v_fmac_f32 v27, v81, v121
  v_mfma_f32_16x16x32_bf16 v[60:63], v[72:75], v[200:203], v[60:63]
  s_waitcnt lgkmcnt(2)
  v_mul_f32 v26, v80, v26
  ds_read_b128 v[72:75], v6 offset:22528
  v_mfma_f32_16x16x32_bf16 v[40:43], a[12:15], v[76:79], v[40:43]
  v_mul_f32 v27, v80, v27
  v_fmac_f32 v28, v81, v122
  v_mfma_f32_16x16x32_bf16 v[44:47], a[76:79], v[76:79], v[44:47]
  v_fmac_f32 v29, v81, v123
  v_mul_f32 v28, v80, v28
  v_mfma_f32_16x16x32_bf16 v[48:51], a[140:143], v[76:79], v[48:51]
  v_mul_f32 v29, v80, v29
  v_fmac_f32 v30, v81, v124
  v_mfma_f32_16x16x32_bf16 v[52:55], a[204:207], v[76:79], v[52:55]
  v_fmac_f32 v31, v81, v125
  v_mul_f32 v30, v80, v30
  v_mfma_f32_16x16x32_bf16 v[56:59], v[76:79], v[140:143], v[56:59]
  v_mul_f32 v31, v80, v31
  v_cvt_pk_bf16_f32 v24, v24, v25
  v_mfma_f32_16x16x32_bf16 v[60:63], v[76:79], v[204:207], v[60:63]
  s_waitcnt lgkmcnt(2)
  v_cvt_pk_bf16_f32 v25, v26, v27
  ds_read_b128 v[76:79], v6 offset:23552
  v_mfma_f32_16x16x32_bf16 v[40:43], a[16:19], v[64:67], v[40:43]
  v_cvt_pk_bf16_f32 v26, v28, v29
  v_cvt_pk_bf16_f32 v27, v30, v31
  v_mfma_f32_16x16x32_bf16 v[44:47], a[80:83], v[64:67], v[44:47]
  s_add_u32 s3, s57, 8192
  buffer_store_dwordx4 v[24:27], v1, s[4:7], s3 offen sc1
  v_mfma_f32_16x16x32_bf16 v[48:51], a[144:147], v[64:67], v[48:51]
  v_fmac_f32 v32, v88, v126
  v_fmac_f32 v33, v89, v126
  v_mfma_f32_16x16x32_bf16 v[52:55], a[208:211], v[64:67], v[52:55]
  v_mul_f32 v32, v84, v32
  v_mul_f32 v33, v85, v33
  v_mfma_f32_16x16x32_bf16 v[56:59], v[64:67], v[144:147], v[56:59]
  v_fmac_f32 v34, v90, v126
  v_fmac_f32 v35, v91, v126
  v_mfma_f32_16x16x32_bf16 v[60:63], v[64:67], v[208:211], v[60:63]
  s_waitcnt lgkmcnt(2)
  v_mul_f32 v34, v86, v34
  ds_read_b128 v[64:67], v6 offset:24576
  v_mfma_f32_16x16x32_bf16 v[40:43], a[20:23], v[68:71], v[40:43]
  v_mul_f32 v35, v87, v35
  v_cvt_pk_bf16_f32 v8, v32, v33
  v_mfma_f32_16x16x32_bf16 v[44:47], a[84:87], v[68:71], v[44:47]
  v_cvt_pk_bf16_f32 v9, v34, v35
  v_fmac_f32 v36, v88, v127
  v_mfma_f32_16x16x32_bf16 v[48:51], a[148:151], v[68:71], v[48:51]
  v_fmac_f32 v37, v89, v127
  v_mul_f32 v36, v84, v36
  v_mfma_f32_16x16x32_bf16 v[52:55], a[212:215], v[68:71], v[52:55]
  v_mul_f32 v37, v85, v37
  v_fmac_f32 v38, v90, v127
  v_mfma_f32_16x16x32_bf16 v[56:59], v[68:71], v[148:151], v[56:59]
  v_fmac_f32 v39, v91, v127
  v_mul_f32 v38, v86, v38
  v_mfma_f32_16x16x32_bf16 v[60:63], v[68:71], v[212:215], v[60:63]
  s_waitcnt lgkmcnt(2)
  v_mul_f32 v39, v87, v39
  ds_read_b128 v[68:71], v6 offset:25600
  v_mfma_f32_16x16x32_bf16 v[40:43], a[24:27], v[72:75], v[40:43]
  v_cvt_pk_bf16_f32 v12, v36, v37
  v_cvt_pk_bf16_f32 v13, v38, v39
  v_mfma_f32_16x16x32_bf16 v[44:47], a[88:91], v[72:75], v[44:47]
  v_mfma_f32_16x16x32_bf16 v[48:51], a[152:155], v[72:75], v[48:51]
  v_mfma_f32_16x16x32_bf16 v[52:55], a[216:219], v[72:75], v[52:55]
  v_mfma_f32_16x16x32_bf16 v[56:59], v[72:75], v[152:155], v[56:59]
  v_mfma_f32_16x16x32_bf16 v[60:63], v[72:75], v[216:219], v[60:63]
  s_waitcnt lgkmcnt(2)
  ds_read_b128 v[72:75], v6 offset:26624
  v_mfma_f32_16x16x32_bf16 v[40:43], a[28:31], v[76:79], v[40:43]
  v_mfma_f32_16x16x32_bf16 v[44:47], a[92:95], v[76:79], v[44:47]
  buffer_load_dword v109, v108, s[4:7], s56 offen sc1
  v_mfma_f32_16x16x32_bf16 v[48:51], a[156:159], v[76:79], v[48:51]
  v_mfma_f32_16x16x32_bf16 v[52:55], a[220:223], v[76:79], v[52:55]
  v_mfma_f32_16x16x32_bf16 v[56:59], v[76:79], v[156:159], v[56:59]
  v_mfma_f32_16x16x32_bf16 v[60:63], v[76:79], v[220:223], v[60:63]
  s_waitcnt lgkmcnt(2)
  ds_read_b128 v[76:79], v6 offset:27648
  v_mfma_f32_16x16x32_bf16 v[40:43], a[32:35], v[64:67], v[40:43]
  v_mfma_f32_16x16x32_bf16 v[44:47], a[96:99], v[64:67], v[44:47]
  v_mfma_f32_16x16x32_bf16 v[48:51], a[160:163], v[64:67], v[48:51]
  v_mfma_f32_16x16x32_bf16 v[52:55], a[224:227], v[64:67], v[52:55]
  v_mfma_f32_16x16x32_bf16 v[56:59], v[64:67], v[160:163], v[56:59]
  v_mfma_f32_16x16x32_bf16 v[60:63], v[64:67], v[224:227], v[60:63]
  s_waitcnt lgkmcnt(2)
  ds_read_b128 v[64:67], v6 offset:28672
  v_mfma_f32_16x16x32_bf16 v[40:43], a[36:39], v[68:71], v[40:43]
  v_mfma_f32_16x16x32_bf16 v[44:47], a[100:103], v[68:71], v[44:47]
  v_mfma_f32_16x16x32_bf16 v[48:51], a[164:167], v[68:71], v[48:51]
  v_mfma_f32_16x16x32_bf16 v[52:55], a[228:231], v[68:71], v[52:55]
  v_mfma_f32_16x16x32_bf16 v[56:59], v[68:71], v[164:167], v[56:59]
  v_mfma_f32_16x16x32_bf16 v[60:63], v[68:71], v[228:231], v[60:63]
  s_waitcnt lgkmcnt(2)
  ds_read_b128 v[68:71], v6 offset:29696
  v_mfma_f32_16x16x32_bf16 v[40:43], a[40:43], v[72:75], v[40:43]
  v_mfma_f32_16x16x32_bf16 v[44:47], a[104:107], v[72:75], v[44:47]
  v_mfma_f32_16x16x32_bf16 v[48:51], a[168:171], v[72:75], v[48:51]
  v_mfma_f32_16x16x32_bf16 v[52:55], a[232:235], v[72:75], v[52:55]
  v_mfma_f32_16x16x32_bf16 v[56:59], v[72:75], v[168:171], v[56:59]
  v_mfma_f32_16x16x32_bf16 v[60:63], v[72:75], v[232:235], v[60:63]
  s_waitcnt lgkmcnt(2)
  ds_read_b128 v[72:75], v6 offset:30720
  v_mfma_f32_16x16x32_bf16 v[40:43], a[44:47], v[76:79], v[40:43]
  v_mfma_f32_16x16x32_bf16 v[44:47], a[108:111], v[76:79], v[44:47]
  v_mfma_f32_16x16x32_bf16 v[48:51], a[172:175], v[76:79], v[48:51]
  v_mfma_f32_16x16x32_bf16 v[52:55], a[236:239], v[76:79], v[52:55]
  v_mfma_f32_16x16x32_bf16 v[56:59], v[76:79], v[172:175], v[56:59]
  v_mfma_f32_16x16x32_bf16 v[60:63], v[76:79], v[236:239], v[60:63]
  s_waitcnt lgkmcnt(2)
  ds_read_b128 v[76:79], v6 offset:31744
  v_mfma_f32_16x16x32_bf16 v[40:43], a[48:51], v[64:67], v[40:43]
  v_mfma_f32_16x16x32_bf16 v[44:47], a[112:115], v[64:67], v[44:47]
  v_mfma_f32_16x16x32_bf16 v[48:51], a[176:179], v[64:67], v[48:51]
  v_mfma_f32_16x16x32_bf16 v[52:55], a[240:243], v[64:67], v[52:55]
  v_mfma_f32_16x16x32_bf16 v[56:59], v[64:67], v[176:179], v[56:59]
  v_mfma_f32_16x16x32_bf16 v[60:63], v[64:67], v[240:243], v[60:63]
  s_waitcnt lgkmcnt(2)
  v_mfma_f32_16x16x32_bf16 v[40:43], a[52:55], v[68:71], v[40:43]
  v_mfma_f32_16x16x32_bf16 v[44:47], a[116:119], v[68:71], v[44:47]
  v_mfma_f32_16x16x32_bf16 v[48:51], a[180:183], v[68:71], v[48:51]
  v_mfma_f32_16x16x32_bf16 v[52:55], a[244:247], v[68:71], v[52:55]
  v_mfma_f32_16x16x32_bf16 v[56:59], v[68:71], v[180:183], v[56:59]
  v_mfma_f32_16x16x32_bf16 v[60:63], v[68:71], v[244:247], v[60:63]
  s_waitcnt lgkmcnt(1)
  v_mfma_f32_16x16x32_bf16 v[40:43], a[56:59], v[72:75], v[40:43]
  v_mfma_f32_16x16x32_bf16 v[44:47], a[120:123], v[72:75], v[44:47]
  v_mfma_f32_16x16x32_bf16 v[48:51], a[184:187], v[72:75], v[48:51]
  v_mfma_f32_16x16x32_bf16 v[52:55], a[248:251], v[72:75], v[52:55]
  v_mfma_f32_16x16x32_bf16 v[56:59], v[72:75], v[184:187], v[56:59]
  v_mfma_f32_16x16x32_bf16 v[60:63], v[72:75], v[248:251], v[60:63]
  s_waitcnt lgkmcnt(0)
  v_mfma_f32_16x16x32_bf16 v[40:43], a[60:63], v[76:79], v[40:43]
  v_mfma_f32_16x16x32_bf16 v[44:47], a[124:127], v[76:79], v[44:47]
  v_mfma_f32_16x16x32_bf16 v[48:51], a[188:191], v[76:79], v[48:51]
  v_mfma_f32_16x16x32_bf16 v[52:55], a[252:255], v[76:79], v[52:55]
  v_mfma_f32_16x16x32_bf16 v[56:59], v[76:79], v[188:191], v[56:59]
  v_mfma_f32_16x16x32_bf16 v[60:63], v[76:79], v[252:255], v[60:63]
  s_waitcnt vmcnt(0)
  v_cmp_ne_u32 vcc, 0, v109
  s_nop 0
  s_cmp_eq_u64 vcc, -1
  s_cselect_b32 s60, 1, 0
  s_cmp_lt_u32 s55, 128
  s_cselect_b32 s60, s60, 0
  s_mov_b32 s61, s67
  s_cmp_eq_u32 s60, 0
  s_cbranch_scc1 hsc_1934
  s_add_u32 m0, s62, 0
  s_nop 0
  buffer_load_dwordx4 v1, s[4:7], s61 offen offset:0 sc1 lds
  buffer_load_dwordx4 v1, s[4:7], s61 offen offset:1024 sc1 lds
  buffer_load_dwordx4 v1, s[4:7], s61 offen offset:2048 sc1 lds
  buffer_load_dwordx4 v1, s[4:7], s61 offen offset:3072 sc1 lds
  s_add_u32 m0, s62, 4096
  s_add_u32 s61, s61, 4096
  buffer_load_dwordx4 v1, s[4:7], s61 offen offset:0 sc1 lds
  buffer_load_dwordx4 v1, s[4:7], s61 offen offset:1024 sc1 lds
  buffer_load_dwordx4 v1, s[4:7], s61 offen offset:2048 sc1 lds
  buffer_load_dwordx4 v1, s[4:7], s61 offen offset:3072 sc1 lds
  s_add_u32 m0, s62, 8192
  s_add_u32 s61, s61, 4096
  buffer_load_dwordx4 v1, s[4:7], s61 offen offset:0 sc1 lds
hsc_1934:
  s_nop 1
  v_pk_fma_f32 v[40:41], v[82:83], v[110:111], v[40:41] op_sel:[1,0,0] op_sel_hi:[1,1,1]
  v_pk_mul_f32 v[40:41], v[82:83], v[40:41] op_sel_hi:[0,1]
  v_pk_fma_f32 v[42:43], v[82:83], v[112:113], v[42:43] op_sel:[1,0,0] op_sel_hi:[1,1,1]
  v_pk_mul_f32 v[42:43], v[82:83], v[42:43] op_sel_hi:[0,1]
  v_pk_fma_f32 v[44:45], v[82:83], v[114:115], v[44:45] op_sel:[1,0,0] op_sel_hi:[1,1,1]
  v_pk_mul_f32 v[44:45], v[82:83], v[44:45] op_sel_hi:[0,1]
  v_pk_fma_f32 v[46:47], v[82:83], v[116:117], v[46:47] op_sel:[1,0,0] op_sel_hi:[1,1,1]
  v_pk_mul_f32 v[46:47], v[82:83], v[46:47] op_sel_hi:[0,1]
  v_cvt_pk_bf16_f32 v40, v40, v41
  v_cvt_pk_bf16_f32 v41, v42, v43
  v_cvt_pk_bf16_f32 v42, v44, v45
  v_cvt_pk_bf16_f32 v43, v46, v47
  s_add_u32 s3, s57, 4096
  buffer_store_dwordx4 v[40:43], v1, s[4:7], s3 offen sc1
  v_pk_fma_f32 v[48:49], v[82:83], v[118:119], v[48:49] op_sel:[1,0,0] op_sel_hi:[1,1,1]
  v_pk_mul_f32 v[48:49], v[82:83], v[48:49] op_sel_hi:[0,1]
  v_pk_fma_f32 v[50:51], v[82:83], v[120:121], v[50:51] op_sel:[1,0,0] op_sel_hi:[1,1,1]
  v_pk_mul_f32 v[50:51], v[82:83], v[50:51] op_sel_hi:[0,1]
  v_pk_fma_f32 v[52:53], v[82:83], v[122:123], v[52:53] op_sel:[1,0,0] op_sel_hi:[1,1,1]
  v_pk_mul_f32 v[52:53], v[82:83], v[52:53] op_sel_hi:[0,1]
  v_pk_fma_f32 v[54:55], v[82:83], v[124:125], v[54:55] op_sel:[1,0,0] op_sel_hi:[1,1,1]
  v_pk_mul_f32 v[54:55], v[82:83], v[54:55] op_sel_hi:[0,1]
  v_cvt_pk_bf16_f32 v48, v48, v49
  v_cvt_pk_bf16_f32 v49, v50, v51
  v_cvt_pk_bf16_f32 v50, v52, v53
  v_cvt_pk_bf16_f32 v51, v54, v55
  s_add_u32 s3, s57, 12288
  buffer_store_dwordx4 v[48:51], v1, s[4:7], s3 offen sc1
  v_pk_fma_f32 v[56:57], v[96:97], v[126:127], v[56:57] op_sel:[0,0,0] op_sel_hi:[1,0,1]
  v_pk_mul_f32 v[56:57], v[92:93], v[56:57]
  v_pk_fma_f32 v[58:59], v[98:99], v[126:127], v[58:59] op_sel:[0,0,0] op_sel_hi:[1,0,1]
  v_pk_mul_f32 v[58:59], v[94:95], v[58:59]
  v_cvt_pk_bf16_f32 v10, v56, v57
  v_cvt_pk_bf16_f32 v11, v58, v59
  buffer_store_dwordx4 v[8:11], v1, s[4:7], s58 offen offset:0 sc1
  v_pk_fma_f32 v[60:61], v[96:97], v[126:127], v[60:61] op_sel:[0,1,0] op_sel_hi:[1,1,1]
  v_pk_mul_f32 v[60:61], v[92:93], v[60:61]
  v_pk_fma_f32 v[62:63], v[98:99], v[126:127], v[62:63] op_sel:[0,1,0] op_sel_hi:[1,1,1]
  v_pk_mul_f32 v[62:63], v[94:95], v[62:63]
  v_cvt_pk_bf16_f32 v14, v60, v61
  v_cvt_pk_bf16_f32 v15, v62, v63
  buffer_store_dwordx4 v[12:15], v1, s[4:7], s58 offen offset:1024 sc1
  s_waitcnt vmcnt(4)
  s_mov_b32 s64, s59
  s_cmp_lg_u32 s60, 0
  s_cbranch_scc1 H_LOOP
  s_cmp_lt_u32 s55, 128
  s_cbranch_scc1 H_WAIT
  s_waitcnt vmcnt(0)
  s_mov_b64 exec, 1
  buffer_store_dword v106, off, s[4:7], s64 sc1
  s_mov_b64 exec, -1
  s_cmp_lg_u32 s51, 0
  s_cbranch_scc1 END
  s_add_u32 s72, s50, 32
  s_mov_b32 s55, s44
  s_mov_b32 s74, 4
  s_branch ATT_ENTRY
ROLE_ATT:
  s_cmp_lg_u32 s46, 0
  s_cbranch_scc1 cen_1935
  v_mov_b32 v4, 163328
  s_cmp_lg_u32 s44, 0
  s_cbranch_scc1 cen_1936
  v_min_u32 v5, 9, v0
  v_lshlrev_b32 v5, 3, v5
  s_mov_b32 s92, 128
  v_writelane_b32 v5, s92, 0
cen_1937:
  buffer_load_dword v2, v5, s[12:15], 0 offen sc1
  s_mov_b32 s92, 0
  s_waitcnt vmcnt(0)
  v_readlane_b32 s93, v2, 0
  s_nop 0
  s_add_u32 s92, s92, s93
  v_readlane_b32 s93, v2, 1
  s_nop 0
  s_add_u32 s92, s92, s93
  v_readlane_b32 s93, v2, 2
  s_nop 0
  s_add_u32 s92, s92, s93
  v_readlane_b32 s93, v2, 3
  s_nop 0
  s_add_u32 s92, s92, s93
  v_readlane_b32 s93, v2, 4
  s_nop 0
  s_add_u32 s92, s92, s93
  v_readlane_b32 s93, v2, 5
  s_nop 0
  s_add_u32 s92, s92, s93
  v_readlane_b32 s93, v2, 6
  s_nop 0
  s_add_u32 s92, s92, s93
  v_readlane_b32 s93, v2, 7
  s_nop 0
  s_add_u32 s92, s92, s93
  v_readlane_b32 s93, v2, 8
  s_nop 0
  s_add_u32 s92, s92, s93
  s_cmp_eq_u32 s92, 256
  s_cbranch_scc1 cen_1938
  s_add_u32 s47, s47, 1
  s_mov_b32 s49, 1
  s_cmp_gt_u32 s47, 131072
  s_cbranch_scc1 TIMEOUT
  s_sleep 4
  s_branch cen_1937
cen_1938:
  v_cmp_ne_u32 vcc, 32, v2
  ds_read2_b32 v[6:7], v4 offset0:0 offset1:1
  s_and_b32 s94, vcc_lo, 0xff
  s_waitcnt lgkmcnt(0)
  v_readfirstlane_b32 s92, v6
  v_readfirstlane_b32 s95, v7
  v_readlane_b32 s93, v2, 0
  s_cmp_gt_u32 s95, 0
  s_cselect_b32 s93, s93, 0
  s_add_u32 s92, s92, s93
  v_readlane_b32 s93, v2, 1
  s_cmp_gt_u32 s95, 1
  s_cselect_b32 s93, s93, 0
  s_add_u32 s92, s92, s93
  v_readlane_b32 s93, v2, 2
  s_cmp_gt_u32 s95, 2
  s_cselect_b32 s93, s93, 0
  s_add_u32 s92, s92, s93
  v_readlane_b32 s93, v2, 3
  s_cmp_gt_u32 s95, 3
  s_cselect_b32 s93, s93, 0
  s_add_u32 s92, s92, s93
  v_readlane_b32 s93, v2, 4
  s_cmp_gt_u32 s95, 4
  s_cselect_b32 s93, s93, 0
  s_add_u32 s92, s92, s93
  v_readlane_b32 s93, v2, 5
  s_cmp_gt_u32 s95, 5
  s_cselect_b32 s93, s93, 0
  s_add_u32 s92, s92, s93
  v_readlane_b32 s93, v2, 6
  s_cmp_gt_u32 s95, 6
  s_cselect_b32 s93, s93, 0
  s_add_u32 s92, s92, s93
  v_readlane_b32 s93, v2, 7
  s_cmp_gt_u32 s95, 7
  s_cselect_b32 s93, s93, 0
  s_add_u32 s92, s92, s93
  v_mov_b32 v2, s92
  v_mov_b32 v3, s94
  ds_write2_b32 v4, v2, v3 offset0:2 offset1:3
cen_1936:
  s_waitcnt lgkmcnt(0)
  s_barrier
  ds_read2_b32 v[2:3], v4 offset0:2 offset1:3
  s_waitcnt lgkmcnt(0)
  v_readfirstlane_b32 s92, v2
  v_readfirstlane_b32 s93, v3
  s_nop 0
  s_cmp_eq_u32 s93, 0
  s_cbranch_scc1 cen_1935
  s_mov_b32 s46, 1
  s_mov_b32 s45, s92
  s_branch DISPATCH
cen_1935:
  s_sub_u32 s50, s45, 160
  s_mov_b32 s8, s16
  s_and_b32 s9, s17, 0xffff
  s_mov_b32 s10, 0x200000
  s_mov_b32 s11, 0x20000
  v_and_b32 v2, 15, v0
  v_lshlrev_b32 v3, 10, v2
  v_lshrrev_b32 v4, 4, v0
  v_lshl_add_u32 v3, v4, 4, v3
  v_lshlrev_b32 v5, 3, v2
  s_lshl_b32 s92, s50, 15
  s_lshr_b32 s93, s44, 1
  s_lshl_b32 s94, s93, 14
  s_add_u32 s92, s92, s94
  s_and_b32 s95, s44, 1
  s_lshl_b32 s94, s95, 9
  s_add_u32 s92, s92, s94
  buffer_load_dwordx4 v[16:19], v3, s[8:11], s92 offen offset:0
  buffer_load_dwordx4 v[20:23], v3, s[8:11], s92 offen offset:64
  buffer_load_dwordx4 v[24:27], v3, s[8:11], s92 offen offset:128
  buffer_load_dwordx4 v[28:31], v3, s[8:11], s92 offen offset:192
  buffer_load_dwordx4 v[32:35], v3, s[8:11], s92 offen offset:256
  buffer_load_dwordx4 v[36:39], v3, s[8:11], s92 offen offset:320
  buffer_load_dwordx4 v[40:43], v3, s[8:11], s92 offen offset:384
  buffer_load_dwordx4 v[44:47], v3, s[8:11], s92 offen offset:448
  s_mul_i32 s52, s50, 36864
  s_add_u32 s52, s52, 0x400000
  s_lshl_b32 s94, s44, 13
  s_add_u32 s53, s52, s94
  s_add_u32 s54, s53, 4096
  s_lshl_b32 s94, s95, 11
  s_add_u32 s52, s52, s94
  s_lshl_b32 s94, s93, 7
  s_add_u32 s52, s52, s94
  s_add_u32 s52, s52, 32768
  s_waitcnt vmcnt(7)
  buffer_store_dwordx4 v[16:19], v1, s[4:7], s53 offen offset:0 sc1
  v_lshlrev_b32 v48, 16, v16
  v_and_b32 v49, 0xffff0000, v16
  v_lshlrev_b32 v50, 16, v17
  v_and_b32 v51, 0xffff0000, v17
  v_lshlrev_b32 v52, 16, v18
  v_and_b32 v53, 0xffff0000, v18
  v_lshlrev_b32 v54, 16, v19
  v_and_b32 v55, 0xffff0000, v19
  v_pk_add_f32 v[56:57], v[48:49], v[50:51]
  v_pk_add_f32 v[58:59], v[52:53], v[54:55]
  v_pk_add_f32 v[56:57], v[56:57], v[58:59]
  v_add_f32 v56, v56, v57
  v_mov_b32 v58, v56
  s_nop 1
  v_permlane16_swap_b32 v56, v58
  v_add_f32 v56, v56, v58
  v_mov_b32 v58, v56
  s_nop 1
  v_permlane32_swap_b32 v56, v58
  v_add_f32 v56, v56, v58
  v_mul_f32 v56, 0x3d000000, v56
  v_pk_add_f32 v[48:49], v[48:49], v[56:57] op_sel_hi:[1,0] neg_lo:[0,1] neg_hi:[0,1]
  v_pk_add_f32 v[50:51], v[50:51], v[56:57] op_sel_hi:[1,0] neg_lo:[0,1] neg_hi:[0,1]
  v_pk_add_f32 v[52:53], v[52:53], v[56:57] op_sel_hi:[1,0] neg_lo:[0,1] neg_hi:[0,1]
  v_pk_add_f32 v[54:55], v[54:55], v[56:57] op_sel_hi:[1,0] neg_lo:[0,1] neg_hi:[0,1]
  v_pk_mul_f32 v[58:59], v[48:49], v[48:49]
  v_pk_fma_f32 v[58:59], v[50:51], v[50:51], v[58:59]
  v_pk_fma_f32 v[58:59], v[52:53], v[52:53], v[58:59]
  v_pk_fma_f32 v[58:59], v[54:55], v[54:55], v[58:59]
  v_add_f32 v57, v58, v59
  v_mov_b32 v58, v57
  s_nop 1
  v_permlane16_swap_b32 v57, v58
  v_add_f32 v57, v57, v58
  v_mov_b32 v58, v57
  s_nop 1
  v_permlane32_swap_b32 v57, v58
  v_add_f32 v57, v57, v58
  s_mov_b64 exec, 0xffff
  buffer_store_dwordx2 v[56:57], v5, s[4:7], s52 offen offset:0 sc1
  s_mov_b64 exec, -1
  s_waitcnt vmcnt(8)
  buffer_store_dwordx4 v[20:23], v1, s[4:7], s53 offen offset:1024 sc1
  v_lshlrev_b32 v48, 16, v20
  v_and_b32 v49, 0xffff0000, v20
  v_lshlrev_b32 v50, 16, v21
  v_and_b32 v51, 0xffff0000, v21
  v_lshlrev_b32 v52, 16, v22
  v_and_b32 v53, 0xffff0000, v22
  v_lshlrev_b32 v54, 16, v23
  v_and_b32 v55, 0xffff0000, v23
  v_pk_add_f32 v[56:57], v[48:49], v[50:51]
  v_pk_add_f32 v[58:59], v[52:53], v[54:55]
  v_pk_add_f32 v[56:57], v[56:57], v[58:59]
  v_add_f32 v56, v56, v57
  v_mov_b32 v58, v56
  s_nop 1
  v_permlane16_swap_b32 v56, v58
  v_add_f32 v56, v56, v58
  v_mov_b32 v58, v56
  s_nop 1
  v_permlane32_swap_b32 v56, v58
  v_add_f32 v56, v56, v58
  v_mul_f32 v56, 0x3d000000, v56
  v_pk_add_f32 v[48:49], v[48:49], v[56:57] op_sel_hi:[1,0] neg_lo:[0,1] neg_hi:[0,1]
  v_pk_add_f32 v[50:51], v[50:51], v[56:57] op_sel_hi:[1,0] neg_lo:[0,1] neg_hi:[0,1]
  v_pk_add_f32 v[52:53], v[52:53], v[56:57] op_sel_hi:[1,0] neg_lo:[0,1] neg_hi:[0,1]
  v_pk_add_f32 v[54:55], v[54:55], v[56:57] op_sel_hi:[1,0] neg_lo:[0,1] neg_hi:[0,1]
  v_pk_mul_f32 v[58:59], v[48:49], v[48:49]
  v_pk_fma_f32 v[58:59], v[50:51], v[50:51], v[58:59]
  v_pk_fma_f32 v[58:59], v[52:53], v[52:53], v[58:59]
  v_pk_fma_f32 v[58:59], v[54:55], v[54:55], v[58:59]
  v_add_f32 v57, v58, v59
  v_mov_b32 v58, v57
  s_nop 1
  v_permlane16_swap_b32 v57, v58
  v_add_f32 v57, v57, v58
  v_mov_b32 v58, v57
  s_nop 1
  v_permlane32_swap_b32 v57, v58
  v_add_f32 v57, v57, v58
  s_mov_b64 exec, 0xffff
  buffer_store_dwordx2 v[56:57], v5, s[4:7], s52 offen offset:256 sc1
  s_mov_b64 exec, -1
  s_waitcnt vmcnt(9)
  buffer_store_dwordx4 v[24:27], v1, s[4:7], s53 offen offset:2048 sc1
  v_lshlrev_b32 v48, 16, v24
  v_and_b32 v49, 0xffff0000, v24
  v_lshlrev_b32 v50, 16, v25
  v_and_b32 v51, 0xffff0000, v25
  v_lshlrev_b32 v52, 16, v26
  v_and_b32 v53, 0xffff0000, v26
  v_lshlrev_b32 v54, 16, v27
  v_and_b32 v55, 0xffff0000, v27
  v_pk_add_f32 v[56:57], v[48:49], v[50:51]
  v_pk_add_f32 v[58:59], v[52:53], v[54:55]
  v_pk_add_f32 v[56:57], v[56:57], v[58:59]
  v_add_f32 v56, v56, v57
  v_mov_b32 v58, v56
  s_nop 1
  v_permlane16_swap_b32 v56, v58
  v_add_f32 v56, v56, v58
  v_mov_b32 v58, v56
  s_nop 1
  v_permlane32_swap_b32 v56, v58
  v_add_f32 v56, v56, v58
  v_mul_f32 v56, 0x3d000000, v56
  v_pk_add_f32 v[48:49], v[48:49], v[56:57] op_sel_hi:[1,0] neg_lo:[0,1] neg_hi:[0,1]
  v_pk_add_f32 v[50:51], v[50:51], v[56:57] op_sel_hi:[1,0] neg_lo:[0,1] neg_hi:[0,1]
  v_pk_add_f32 v[52:53], v[52:53], v[56:57] op_sel_hi:[1,0] neg_lo:[0,1] neg_hi:[0,1]
  v_pk_add_f32 v[54:55], v[54:55], v[56:57] op_sel_hi:[1,0] neg_lo:[0,1] neg_hi:[0,1]
  v_pk_mul_f32 v[58:59], v[48:49], v[48:49]
  v_pk_fma_f32 v[58:59], v[50:51], v[50:51], v[58:59]
  v_pk_fma_f32 v[58:59], v[52:53], v[52:53], v[58:59]
  v_pk_fma_f32 v[58:59], v[54:55], v[54:55], v[58:59]
  v_add_f32 v57, v58, v59
  v_mov_b32 v58, v57
  s_nop 1
  v_permlane16_swap_b32 v57, v58
  v_add_f32 v57, v57, v58
  v_mov_b32 v58, v57
  s_nop 1
  v_permlane32_swap_b32 v57, v58
  v_add_f32 v57, v57, v58
  s_mov_b64 exec, 0xffff
  buffer_store_dwordx2 v[56:57], v5, s[4:7], s52 offen offset:512 sc1
  s_mov_b64 exec, -1
  s_waitcnt vmcnt(10)
  buffer_store_dwordx4 v[28:31], v1, s[4:7], s53 offen offset:3072 sc1
  v_lshlrev_b32 v48, 16, v28
  v_and_b32 v49, 0xffff0000, v28
  v_lshlrev_b32 v50, 16, v29
  v_and_b32 v51, 0xffff0000, v29
  v_lshlrev_b32 v52, 16, v30
  v_and_b32 v53, 0xffff0000, v30
  v_lshlrev_b32 v54, 16, v31
  v_and_b32 v55, 0xffff0000, v31
  v_pk_add_f32 v[56:57], v[48:49], v[50:51]
  v_pk_add_f32 v[58:59], v[52:53], v[54:55]
  v_pk_add_f32 v[56:57], v[56:57], v[58:59]
  v_add_f32 v56, v56, v57
  v_mov_b32 v58, v56
  s_nop 1
  v_permlane16_swap_b32 v56, v58
  v_add_f32 v56, v56, v58
  v_mov_b32 v58, v56
  s_nop 1
  v_permlane32_swap_b32 v56, v58
  v_add_f32 v56, v56, v58
  v_mul_f32 v56, 0x3d000000, v56
  v_pk_add_f32 v[48:49], v[48:49], v[56:57] op_sel_hi:[1,0] neg_lo:[0,1] neg_hi:[0,1]
  v_pk_add_f32 v[50:51], v[50:51], v[56:57] op_sel_hi:[1,0] neg_lo:[0,1] neg_hi:[0,1]
  v_pk_add_f32 v[52:53], v[52:53], v[56:57] op_sel_hi:[1,0] neg_lo:[0,1] neg_hi:[0,1]
  v_pk_add_f32 v[54:55], v[54:55], v[56:57] op_sel_hi:[1,0] neg_lo:[0,1] neg_hi:[0,1]
  v_pk_mul_f32 v[58:59], v[48:49], v[48:49]
  v_pk_fma_f32 v[58:59], v[50:51], v[50:51], v[58:59]
  v_pk_fma_f32 v[58:59], v[52:53], v[52:53], v[58:59]
  v_pk_fma_f32 v[58:59], v[54:55], v[54:55], v[58:59]
  v_add_f32 v57, v58, v59
  v_mov_b32 v58, v57
  s_nop 1
  v_permlane16_swap_b32 v57, v58
  v_add_f32 v57, v57, v58
  v_mov_b32 v58, v57
  s_nop 1
  v_permlane32_swap_b32 v57, v58
  v_add_f32 v57, v57, v58
  s_mov_b64 exec, 0xffff
  buffer_store_dwordx2 v[56:57], v5, s[4:7], s52 offen offset:768 sc1
  s_mov_b64 exec, -1
  s_waitcnt vmcnt(11)
  buffer_store_dwordx4 v[32:35], v1, s[4:7], s54 offen offset:0 sc1
  v_lshlrev_b32 v48, 16, v32
  v_and_b32 v49, 0xffff0000, v32
  v_lshlrev_b32 v50, 16, v33
  v_and_b32 v51, 0xffff0000, v33
  v_lshlrev_b32 v52, 16, v34
  v_and_b32 v53, 0xffff0000, v34
  v_lshlrev_b32 v54, 16, v35
  v_and_b32 v55, 0xffff0000, v35
  v_pk_add_f32 v[56:57], v[48:49], v[50:51]
  v_pk_add_f32 v[58:59], v[52:53], v[54:55]
  v_pk_add_f32 v[56:57], v[56:57], v[58:59]
  v_add_f32 v56, v56, v57
  v_mov_b32 v58, v56
  s_nop 1
  v_permlane16_swap_b32 v56, v58
  v_add_f32 v56, v56, v58
  v_mov_b32 v58, v56
  s_nop 1
  v_permlane32_swap_b32 v56, v58
  v_add_f32 v56, v56, v58
  v_mul_f32 v56, 0x3d000000, v56
  v_pk_add_f32 v[48:49], v[48:49], v[56:57] op_sel_hi:[1,0] neg_lo:[0,1] neg_hi:[0,1]
  v_pk_add_f32 v[50:51], v[50:51], v[56:57] op_sel_hi:[1,0] neg_lo:[0,1] neg_hi:[0,1]
  v_pk_add_f32 v[52:53], v[52:53], v[56:57] op_sel_hi:[1,0] neg_lo:[0,1] neg_hi:[0,1]
  v_pk_add_f32 v[54:55], v[54:55], v[56:57] op_sel_hi:[1,0] neg_lo:[0,1] neg_hi:[0,1]
  v_pk_mul_f32 v[58:59], v[48:49], v[48:49]
  v_pk_fma_f32 v[58:59], v[50:51], v[50:51], v[58:59]
  v_pk_fma_f32 v[58:59], v[52:53], v[52:53], v[58:59]
  v_pk_fma_f32 v[58:59], v[54:55], v[54:55], v[58:59]
  v_add_f32 v57, v58, v59
  v_mov_b32 v58, v57
  s_nop 1
  v_permlane16_swap_b32 v57, v58
  v_add_f32 v57, v57, v58
  v_mov_b32 v58, v57
  s_nop 1
  v_permlane32_swap_b32 v57, v58
  v_add_f32 v57, v57, v58
  s_mov_b64 exec, 0xffff
  buffer_store_dwordx2 v[56:57], v5, s[4:7], s52 offen offset:1024 sc1
  s_mov_b64 exec, -1
  s_waitcnt vmcnt(12)
  buffer_store_dwordx4 v[36:39], v1, s[4:7], s54 offen offset:1024 sc1
  v_lshlrev_b32 v48, 16, v36
  v_and_b32 v49, 0xffff0000, v36
  v_lshlrev_b32 v50, 16, v37
  v_and_b32 v51, 0xffff0000, v37
  v_lshlrev_b32 v52, 16, v38
  v_and_b32 v53, 0xffff0000, v38
  v_lshlrev_b32 v54, 16, v39
  v_and_b32 v55, 0xffff0000, v39
  v_pk_add_f32 v[56:57], v[48:49], v[50:51]
  v_pk_add_f32 v[58:59], v[52:53], v[54:55]
  v_pk_add_f32 v[56:57], v[56:57], v[58:59]
  v_add_f32 v56, v56, v57
  v_mov_b32 v58, v56
  s_nop 1
  v_permlane16_swap_b32 v56, v58
  v_add_f32 v56, v56, v58
  v_mov_b32 v58, v56
  s_nop 1
  v_permlane32_swap_b32 v56, v58
  v_add_f32 v56, v56, v58
  v_mul_f32 v56, 0x3d000000, v56
  v_pk_add_f32 v[48:49], v[48:49], v[56:57] op_sel_hi:[1,0] neg_lo:[0,1] neg_hi:[0,1]
  v_pk_add_f32 v[50:51], v[50:51], v[56:57] op_sel_hi:[1,0] neg_lo:[0,1] neg_hi:[0,1]
  v_pk_add_f32 v[52:53], v[52:53], v[56:57] op_sel_hi:[1,0] neg_lo:[0,1] neg_hi:[0,1]
  v_pk_add_f32 v[54:55], v[54:55], v[56:57] op_sel_hi:[1,0] neg_lo:[0,1] neg_hi:[0,1]
  v_pk_mul_f32 v[58:59], v[48:49], v[48:49]
  v_pk_fma_f32 v[58:59], v[50:51], v[50:51], v[58:59]
  v_pk_fma_f32 v[58:59], v[52:53], v[52:53], v[58:59]
  v_pk_fma_f32 v[58:59], v[54:55], v[54:55], v[58:59]
  v_add_f32 v57, v58, v59
  v_mov_b32 v58, v57
  s_nop 1
  v_permlane16_swap_b32 v57, v58
  v_add_f32 v57, v57, v58
  v_mov_b32 v58, v57
  s_nop 1
  v_permlane32_swap_b32 v57, v58
  v_add_f32 v57, v57, v58
  s_mov_b64 exec, 0xffff
  buffer_store_dwordx2 v[56:57], v5, s[4:7], s52 offen offset:1280 sc1
  s_mov_b64 exec, -1
  s_waitcnt vmcnt(13)
  buffer_store_dwordx4 v[40:43], v1, s[4:7], s54 offen offset:2048 sc1
  v_lshlrev_b32 v48, 16, v40
  v_and_b32 v49, 0xffff0000, v40
  v_lshlrev_b32 v50, 16, v41
  v_and_b32 v51, 0xffff0000, v41
  v_lshlrev_b32 v52, 16, v42
  v_and_b32 v53, 0xffff0000, v42
  v_lshlrev_b32 v54, 16, v43
  v_and_b32 v55, 0xffff0000, v43
  v_pk_add_f32 v[56:57], v[48:49], v[50:51]
  v_pk_add_f32 v[58:59], v[52:53], v[54:55]
  v_pk_add_f32 v[56:57], v[56:57], v[58:59]
  v_add_f32 v56, v56, v57
  v_mov_b32 v58, v56
  s_nop 1
  v_permlane16_swap_b32 v56, v58
  v_add_f32 v56, v56, v58
  v_mov_b32 v58, v56
  s_nop 1
  v_permlane32_swap_b32 v56, v58
  v_add_f32 v56, v56, v58
  v_mul_f32 v56, 0x3d000000, v56
  v_pk_add_f32 v[48:49], v[48:49], v[56:57] op_sel_hi:[1,0] neg_lo:[0,1] neg_hi:[0,1]
  v_pk_add_f32 v[50:51], v[50:51], v[56:57] op_sel_hi:[1,0] neg_lo:[0,1] neg_hi:[0,1]
  v_pk_add_f32 v[52:53], v[52:53], v[56:57] op_sel_hi:[1,0] neg_lo:[0,1] neg_hi:[0,1]
  v_pk_add_f32 v[54:55], v[54:55], v[56:57] op_sel_hi:[1,0] neg_lo:[0,1] neg_hi:[0,1]
  v_pk_mul_f32 v[58:59], v[48:49], v[48:49]
  v_pk_fma_f32 v[58:59], v[50:51], v[50:51], v[58:59]
  v_pk_fma_f32 v[58:59], v[52:53], v[52:53], v[58:59]
  v_pk_fma_f32 v[58:59], v[54:55], v[54:55], v[58:59]
  v_add_f32 v57, v58, v59
  v_mov_b32 v58, v57
  s_nop 1
  v_permlane16_swap_b32 v57, v58
  v_add_f32 v57, v57, v58
  v_mov_b32 v58, v57
  s_nop 1
  v_permlane32_swap_b32 v57, v58
  v_add_f32 v57, v57, v58
  s_mov_b64 exec, 0xffff
  buffer_store_dwordx2 v[56:57], v5, s[4:7], s52 offen offset:1536 sc1
  s_mov_b64 exec, -1
  s_waitcnt vmcnt(14)
  buffer_store_dwordx4 v[44:47], v1, s[4:7], s54 offen offset:3072 sc1
  v_lshlrev_b32 v48, 16, v44
  v_and_b32 v49, 0xffff0000, v44
  v_lshlrev_b32 v50, 16, v45
  v_and_b32 v51, 0xffff0000, v45
  v_lshlrev_b32 v52, 16, v46
  v_and_b32 v53, 0xffff0000, v46
  v_lshlrev_b32 v54, 16, v47
  v_and_b32 v55, 0xffff0000, v47
  v_pk_add_f32 v[56:57], v[48:49], v[50:51]
  v_pk_add_f32 v[58:59], v[52:53], v[54:55]
  v_pk_add_f32 v[56:57], v[56:57], v[58:59]
  v_add_f32 v56, v56, v57
  v_mov_b32 v58, v56
  s_nop 1
  v_permlane16_swap_b32 v56, v58
  v_add_f32 v56, v56, v58
  v_mov_b32 v58, v56
  s_nop 1
  v_permlane32_swap_b32 v56, v58
  v_add_f32 v56, v56, v58
  v_mul_f32 v56, 0x3d000000, v56
  v_pk_add_f32 v[48:49], v[48:49], v[56:57] op_sel_hi:[1,0] neg_lo:[0,1] neg_hi:[0,1]
  v_pk_add_f32 v[50:51], v[50:51], v[56:57] op_sel_hi:[1,0] neg_lo:[0,1] neg_hi:[0,1]
  v_pk_add_f32 v[52:53], v[52:53], v[56:57] op_sel_hi:[1,0] neg_lo:[0,1] neg_hi:[0,1]
  v_pk_add_f32 v[54:55], v[54:55], v[56:57] op_sel_hi:[1,0] neg_lo:[0,1] neg_hi:[0,1]
  v_pk_mul_f32 v[58:59], v[48:49], v[48:49]
  v_pk_fma_f32 v[58:59], v[50:51], v[50:51], v[58:59]
  v_pk_fma_f32 v[58:59], v[52:53], v[52:53], v[58:59]
  v_pk_fma_f32 v[58:59], v[54:55], v[54:55], v[58:59]
  v_add_f32 v57, v58, v59
  v_mov_b32 v58, v57
  s_nop 1
  v_permlane16_swap_b32 v57, v58
  v_add_f32 v57, v57, v58
  v_mov_b32 v58, v57
  s_nop 1
  v_permlane32_swap_b32 v57, v58
  v_add_f32 v57, v57, v58
  s_mov_b64 exec, 0xffff
  buffer_store_dwordx2 v[56:57], v5, s[4:7], s52 offen offset:1792 sc1
  s_mov_b64 exec, -1
  s_lshl_b32 s52, s50, 2
  s_lshl_b32 s94, s95, 12
  s_add_u32 s52, s52, s94
  s_lshl_b32 s94, s93, 8
  s_add_u32 s52, s52, s94
  s_add_u32 s52, s52, 0x0
  v_lshlrev_b32 v6, 9, v0
  v_mov_b32 v7, 1
  s_waitcnt vmcnt(0)
  s_mov_b64 exec, 0xff
  buffer_store_dword v7, v6, s[4:7], s52 offen sc1
  s_mov_b64 exec, -1
  s_sub_u32 s92, s45, 192
  s_lshl_b32 s72, s92, 1
  s_lshr_b32 s92, s44, 1
  s_add_u32 s72, s72, s92
  s_and_b32 s55, s44, 1
  s_mov_b32 s74, 2
ATT_ENTRY:
  s_lshr_b32 s93, s72, 5
  s_and_b32 s94, s72, 31
  s_lshl_b32 s95, s93, 6
  s_add_u32 s95, s95, s55
  s_lshl_b32 s56, s95, 5
  s_add_u32 s56, s56, s94
  s_lshl_b32 s56, s56, 15
  s_add_u32 s56, s56, 0x4000000
  s_lshl_b32 s58, s95, 5
  s_add_u32 s58, s58, s94
  s_lshl_b32 s58, s58, 7
  s_add_u32 s57, s58, 0xc000000
  s_add_u32 s60, s58, 0xc100000
  s_add_u32 s58, s58, 0xc080000
  s_lshl_b32 s59, s95, 18
  s_lshl_b32 s94, s94, 12
  s_add_u32 s59, s59, s94
  s_add_u32 s59, s59, 0x2000000
  s_mov_b32 s61, 0x3e0293ee
  s_mov_b32 s75, 0x34800000
  s_lshl_b32 s73, s45, 7
  s_add_u32 s73, s73, 0x80000
  v_and_b32 v2, 3, v0
  v_lshlrev_b32 v4, 8, v2
  v_bfe_u32 v7, v0, 4, 1
  v_lshl_add_u32 v4, v7, 7, v4
  v_bfe_u32 v7, v0, 2, 2
  v_lshl_add_u32 v4, v7, 4, v4
  v_lshrrev_b32 v7, 5, v0
  v_lshl_add_u32 v4, v7, 3, v4
  s_lshl_b32 s92, s44, 12
  s_add_u32 s92, s92, 98304
  v_add_u32 v4, s92, v4
  v_add_u32 v5, s92, v1
  v_lshlrev_b32 v2, 2, v2
  v_mov_b32 v3, 1
  v_mov_b32 v6, 0xff800000
  v_mov_b32 v192, 0x3f803f80
  v_mov_b32 v193, 0x3f803f80
  v_mov_b32 v194, 0x3f803f80
  v_mov_b32 v195, 0x3f803f80
  v_mov_b32 v176, 0
  v_mov_b32 v178, 0
  v_mov_b64 v[170:171], 0
  v_and_b32 v7, 15, v0
  v_lshrrev_b32 v180, 4, v0
  v_lshlrev_b32 v180, 2, v180
  v_sub_u32 v7, v7, v180
  v_cmp_le_i32 s[64:65], 0, v7
  v_cmp_le_i32 s[66:67], 1, v7
  v_cmp_le_i32 s[68:69], 2, v7
  v_cmp_le_i32 s[70:71], 3, v7
ATT_LOOPR:
  buffer_load_dword v7, v2, s[4:7], s57 offen sc1
  s_waitcnt vmcnt(0)
  v_cmp_eq_u32 vcc, 0, v7
  s_mov_b64 exec, 1
  buffer_store_dword v3, off, s[4:7], s73 sc1
  s_mov_b64 exec, -1
  s_cbranch_vccz polld_1940
  s_mov_b32 s101, 0
poll_1939:
  s_add_u32 s47, s47, 1
  s_mov_b32 s49, 9
  s_cmp_gt_u32 s47, 131072
  s_cbranch_scc1 TIMEOUT
  s_sleep 3
  buffer_load_dword v7, v2, s[4:7], s57 offen sc1
  s_waitcnt vmcnt(0)
  v_cmp_eq_u32 vcc, 0, v7
  s_nop 0
  s_cbranch_vccnz poll_1939
polld_1940:
  s_add_u32 s62, s56, 0
  buffer_load_dwordx4 v[16:19], v1, s[4:7], s62 offen offset:0 sc1
  buffer_load_dwordx4 v[20:23], v1, s[4:7], s62 offen offset:1024 sc1
  buffer_load_dwordx4 v[24:27], v1, s[4:7], s62 offen offset:2048 sc1
  buffer_load_dwordx4 v[28:31], v1, s[4:7], s62 offen offset:3072 sc1
  s_add_u32 s62, s56, 4096
  buffer_load_dwordx4 v[32:35], v1, s[4:7], s62 offen offset:0 sc1
  buffer_load_dwordx4 v[36:39], v1, s[4:7], s62 offen offset:1024 sc1
  buffer_load_dwordx4 v[40:43], v1, s[4:7], s62 offen offset:2048 sc1
  buffer_load_dwordx4 v[44:47], v1, s[4:7], s62 offen offset:3072 sc1
  s_add_u32 s62, s56, 8192
  buffer_load_dwordx4 v[48:51], v1, s[4:7], s62 offen offset:0 sc1
  buffer_load_dwordx4 v[52:55], v1, s[4:7], s62 offen offset:1024 sc1
  buffer_load_dwordx4 v[56:59], v1, s[4:7], s62 offen offset:2048 sc1
  buffer_load_dwordx4 v[60:63], v1, s[4:7], s62 offen offset:3072 sc1
  s_add_u32 s62, s56, 12288
  buffer_load_dwordx4 v[64:67], v1, s[4:7], s62 offen offset:0 sc1
  buffer_load_dwordx4 v[68:71], v1, s[4:7], s62 offen offset:1024 sc1
  buffer_load_dwordx4 v[72:75], v1, s[4:7], s62 offen offset:2048 sc1
  buffer_load_dwordx4 v[76:79], v1, s[4:7], s62 offen offset:3072 sc1
  s_add_u32 s62, s56, 16384
  buffer_load_dwordx4 v[80:83], v1, s[4:7], s62 offen offset:0 sc1
  buffer_load_dwordx4 v[84:87], v1, s[4:7], s62 offen offset:1024 sc1
  buffer_load_dwordx4 v[88:91], v1, s[4:7], s62 offen offset:2048 sc1
  buffer_load_dwordx4 v[92:95], v1, s[4:7], s62 offen offset:3072 sc1
  s_add_u32 s62, s56, 20480
  buffer_load_dwordx4 v[96:99], v1, s[4:7], s62 offen offset:0 sc1
  buffer_load_dwordx4 v[100:103], v1, s[4:7], s62 offen offset:1024 sc1
  buffer_load_dwordx4 v[104:107], v1, s[4:7], s62 offen offset:2048 sc1
  buffer_load_dwordx4 v[108:111], v1, s[4:7], s62 offen offset:3072 sc1
  s_waitcnt vmcnt(15)
  v_mfma_f32_16x16x32_bf16 v[144:147], v[48:51], v[16:19], 0
  s_waitcnt vmcnt(14)
  v_mfma_f32_16x16x32_bf16 v[144:147], v[52:55], v[20:23], v[144:147]
  s_waitcnt vmcnt(13)
  v_mfma_f32_16x16x32_bf16 v[144:147], v[56:59], v[24:27], v[144:147]
  s_waitcnt vmcnt(12)
  v_mfma_f32_16x16x32_bf16 v[144:147], v[60:63], v[28:31], v[144:147]
  v_mfma_f32_16x16x32_bf16 v[156:159], v[48:51], v[32:35], 0
  v_mfma_f32_16x16x32_bf16 v[156:159], v[52:55], v[36:39], v[156:159]
  v_mfma_f32_16x16x32_bf16 v[156:159], v[56:59], v[40:43], v[156:159]
  v_mfma_f32_16x16x32_bf16 v[156:159], v[60:63], v[44:47], v[156:159]
  s_waitcnt vmcnt(11)
  v_mfma_f32_16x16x32_bf16 v[160:163], v[64:67], v[32:35], 0
  s_waitcnt vmcnt(10)
  v_mfma_f32_16x16x32_bf16 v[160:163], v[68:71], v[36:39], v[160:163]
  s_waitcnt vmcnt(9)
  v_mfma_f32_16x16x32_bf16 v[160:163], v[72:75], v[40:43], v[160:163]
  s_waitcnt vmcnt(8)
  v_mfma_f32_16x16x32_bf16 v[160:163], v[76:79], v[44:47], v[160:163]
  v_cndmask_b32 v144, v6, v144, s[64:65]
  v_cndmask_b32 v145, v6, v145, s[66:67]
  v_cndmask_b32 v146, v6, v146, s[68:69]
  v_cndmask_b32 v147, v6, v147, s[70:71]
  s_nop 3
  v_cndmask_b32 v160, v6, v160, s[64:65]
  v_cndmask_b32 v161, v6, v161, s[66:67]
  v_cndmask_b32 v162, v6, v162, s[68:69]
  v_cndmask_b32 v163, v6, v163, s[70:71]
  v_max3_f32 v180, v144, v145, v146
  v_max_f32 v180, v180, v147
  v_max3_f32 v181, v156, v157, v158
  v_max3_f32 v181, v181, v159, v160
  v_max3_f32 v181, v181, v161, v162
  v_max_f32 v181, v181, v163
  s_add_u32 s62, s56, 24576
ap_1941:
  buffer_load_dword v7, off, s[4:7], s58 sc1
  s_waitcnt vmcnt(0)
  v_cmp_ne_u32 vcc, 0, v7
  s_nop 0
  s_cbranch_vccnz apo_1942
  s_add_u32 s47, s47, 1
  s_mov_b32 s49, 10
  s_cmp_gt_u32 s47, 131072
  s_cbranch_scc1 TIMEOUT
  s_sleep 3
  s_branch ap_1941
apo_1942:
  buffer_load_dwordx4 v[112:115], v1, s[4:7], s62 offen offset:0 sc1
  buffer_load_dwordx4 v[116:119], v1, s[4:7], s62 offen offset:1024 sc1
  buffer_load_dwordx4 v[120:123], v1, s[4:7], s62 offen offset:2048 sc1
  buffer_load_dwordx4 v[124:127], v1, s[4:7], s62 offen offset:3072 sc1
  s_waitcnt vmcnt(3)
  ds_write_b128 v5, v[112:115] offset:0
  ds_read_b64_tr_b16 v[128:129], v4 offset:0
  ds_read_b64_tr_b16 v[130:131], v4 offset:64
  s_waitcnt vmcnt(2)
  ds_write_b128 v5, v[116:119] offset:1024
  ds_read_b64_tr_b16 v[132:133], v4 offset:1024
  ds_read_b64_tr_b16 v[134:135], v4 offset:1088
  s_waitcnt vmcnt(1)
  ds_write_b128 v5, v[120:123] offset:2048
  ds_read_b64_tr_b16 v[136:137], v4 offset:2048
  ds_read_b64_tr_b16 v[138:139], v4 offset:2112
  s_waitcnt vmcnt(0)
  ds_write_b128 v5, v[124:127] offset:3072
  ds_read_b64_tr_b16 v[140:141], v4 offset:3072
  ds_read_b64_tr_b16 v[142:143], v4 offset:3136
  s_waitcnt lgkmcnt(9)
  v_mfma_f32_16x16x32_bf16 v[152:155], v[128:131], v[16:19], 0
  v_mfma_f32_16x16x32_bf16 v[164:167], v[128:131], v[32:35], 0
  s_waitcnt lgkmcnt(6)
  v_mfma_f32_16x16x32_bf16 v[152:155], v[132:135], v[20:23], v[152:155]
  v_mfma_f32_16x16x32_bf16 v[164:167], v[132:135], v[36:39], v[164:167]
  s_waitcnt lgkmcnt(3)
  v_mfma_f32_16x16x32_bf16 v[152:155], v[136:139], v[24:27], v[152:155]
  v_mfma_f32_16x16x32_bf16 v[164:167], v[136:139], v[40:43], v[164:167]
  s_waitcnt lgkmcnt(0)
  v_mfma_f32_16x16x32_bf16 v[152:155], v[140:143], v[28:31], v[152:155]
  v_mfma_f32_16x16x32_bf16 v[164:167], v[140:143], v[44:47], v[164:167]
  s_nop 6
  v_max3_f32 v180, v180, v152, v153
  v_max3_f32 v181, v181, v164, v165
  v_mov_b32 v182, v180
  v_mov_b32 v183, v181
  s_nop 0
  v_permlane16_swap_b32 v180, v182
  v_permlane16_swap_b32 v181, v183
  v_max_f32 v180, v180, v182
  v_max_f32 v181, v181, v183
  v_mov_b32 v182, v180
  v_mov_b32 v183, v181
  s_nop 0
  v_permlane32_swap_b32 v180, v182
  v_permlane32_swap_b32 v181, v183
  v_max_f32 v180, v180, v182
  v_max_f32 v181, v181, v183
  v_mul_f32 v180, s61, v180
  v_mul_f32 v181, s61, v181
  v_fma_f32 v180, -abs(v180), s75, v180
  v_fma_f32 v181, -abs(v181), s75, v181
  v_fma_f32 v144, v144, s61, -v180
  v_fma_f32 v145, v145, s61, -v180
  v_fma_f32 v146, v146, s61, -v180
  v_fma_f32 v147, v147, s61, -v180
  v_fma_f32 v152, v152, s61, -v180
  v_fma_f32 v153, v153, s61, -v180
  v_exp_f32_e64 v144, v144 clamp
  v_exp_f32_e64 v145, v145 clamp
  v_exp_f32_e64 v146, v146 clamp
  v_exp_f32_e64 v147, v147 clamp
  v_exp_f32_e64 v152, v152 clamp
  v_exp_f32_e64 v153, v153 clamp
  v_cvt_pk_bf16_f32 v168, v144, v145
  v_cvt_pk_bf16_f32 v169, v146, v147
  v_cvt_pk_bf16_f32 v177, v152, v153
  s_nop 0
  v_mfma_f32_16x16x32_bf16 v[184:187], v[192:195], v[168:171], 0
  v_fma_f32 v156, v156, s61, -v181
  v_fma_f32 v157, v157, s61, -v181
  v_mfma_f32_16x16x32_bf16 v[200:203], v[80:83], v[168:171], 0
  v_fma_f32 v158, v158, s61, -v181
  v_fma_f32 v159, v159, s61, -v181
  v_mfma_f32_16x16x32_bf16 v[204:207], v[84:87], v[168:171], 0
  v_fma_f32 v160, v160, s61, -v181
  v_fma_f32 v161, v161, s61, -v181
  v_mfma_f32_16x16x32_bf16 v[208:211], v[88:91], v[168:171], 0
  v_fma_f32 v162, v162, s61, -v181
  v_fma_f32 v163, v163, s61, -v181
  v_mfma_f32_16x16x32_bf16 v[212:215], v[92:95], v[168:171], 0
  v_fma_f32 v164, v164, s61, -v181
  v_fma_f32 v165, v165, s61, -v181
  v_mfma_f32_16x16x32_bf16 v[216:219], v[96:99], v[168:171], 0
  v_exp_f32_e64 v156, v156 clamp
  v_mfma_f32_16x16x32_bf16 v[220:223], v[100:103], v[168:171], 0
  v_exp_f32_e64 v157, v157 clamp
  v_mfma_f32_16x16x32_bf16 v[224:227], v[104:107], v[168:171], 0
  v_exp_f32_e64 v158, v158 clamp
  v_mfma_f32_16x16x32_bf16 v[228:231], v[108:111], v[168:171], 0
  v_exp_f32_e64 v159, v159 clamp
  v_mfma_f32_16x16x16_bf16 v[184:187], v[192:193], v[176:177], v[184:187]
  v_exp_f32_e64 v160, v160 clamp
  v_mfma_f32_16x16x16_bf16 v[200:203], v[112:113], v[176:177], v[200:203]
  v_exp_f32_e64 v161, v161 clamp
  v_mfma_f32_16x16x16_bf16 v[204:207], v[114:115], v[176:177], v[204:207]
  v_exp_f32_e64 v162, v162 clamp
  v_mfma_f32_16x16x16_bf16 v[208:211], v[116:117], v[176:177], v[208:211]
  v_exp_f32_e64 v163, v163 clamp
  v_mfma_f32_16x16x16_bf16 v[212:215], v[118:119], v[176:177], v[212:215]
  v_exp_f32_e64 v164, v164 clamp
  v_mfma_f32_16x16x16_bf16 v[216:219], v[120:121], v[176:177], v[216:219]
  v_exp_f32_e64 v165, v165 clamp
  v_mfma_f32_16x16x16_bf16 v[220:223], v[122:123], v[176:177], v[220:223]
  v_cvt_pk_bf16_f32 v172, v156, v157
  v_cvt_pk_bf16_f32 v173, v158, v159
  v_mfma_f32_16x16x16_bf16 v[224:227], v[124:125], v[176:177], v[224:227]
  v_cvt_pk_bf16_f32 v174, v160, v161
  v_cvt_pk_bf16_f32 v175, v162, v163
  v_mfma_f32_16x16x16_bf16 v[228:231], v[126:127], v[176:177], v[228:231]
  v_cvt_pk_bf16_f32 v179, v164, v165
  v_mfma_f32_16x16x32_bf16 v[188:191], v[192:195], v[172:175], 0
  v_mfma_f32_16x16x32_bf16 v[48:51], v[80:83], v[172:175], 0
  v_mfma_f32_16x16x32_bf16 v[52:55], v[84:87], v[172:175], 0
  v_rcp_f32 v184, v184
  v_mfma_f32_16x16x32_bf16 v[56:59], v[88:91], v[172:175], 0
  s_add_u32 s63, s59, 0
  v_mul_f32 v200, v184, v200
  v_mul_f32 v201, v184, v201
  v_mfma_f32_16x16x32_bf16 v[60:63], v[92:95], v[172:175], 0
  v_mul_f32 v202, v184, v202
  v_mul_f32 v203, v184, v203
  v_mfma_f32_16x16x32_bf16 v[64:67], v[96:99], v[172:175], 0
  v_mul_f32 v204, v184, v204
  v_mul_f32 v205, v184, v205
  v_mfma_f32_16x16x32_bf16 v[68:71], v[100:103], v[172:175], 0
  v_mul_f32 v206, v184, v206
  v_mul_f32 v207, v184, v207
  v_mfma_f32_16x16x32_bf16 v[72:75], v[104:107], v[172:175], 0
  v_cvt_pk_bf16_f32 v200, v200, v201
  v_cvt_pk_bf16_f32 v201, v202, v203
  v_mfma_f32_16x16x32_bf16 v[76:79], v[108:111], v[172:175], 0
  v_cvt_pk_bf16_f32 v202, v204, v205
  v_cvt_pk_bf16_f32 v203, v206, v207
  v_mfma_f32_16x16x16_bf16 v[188:191], v[192:193], v[178:179], v[188:191]
  buffer_store_dwordx4 v[200:203], v1, s[4:7], s63 offen offset:0 sc1
  v_mfma_f32_16x16x16_bf16 v[48:51], v[112:113], v[178:179], v[48:51]
  v_mul_f32 v208, v184, v208
  v_mul_f32 v209, v184, v209
  v_mfma_f32_16x16x16_bf16 v[52:55], v[114:115], v[178:179], v[52:55]
  v_mul_f32 v210, v184, v210
  v_mul_f32 v211, v184, v211
  v_mfma_f32_16x16x16_bf16 v[56:59], v[116:117], v[178:179], v[56:59]
  v_mul_f32 v212, v184, v212
  v_mul_f32 v213, v184, v213
  v_mfma_f32_16x16x16_bf16 v[60:63], v[118:119], v[178:179], v[60:63]
  v_mul_f32 v214, v184, v214
  v_mul_f32 v215, v184, v215
  v_mfma_f32_16x16x16_bf16 v[64:67], v[120:121], v[178:179], v[64:67]
  v_cvt_pk_bf16_f32 v208, v208, v209
  v_cvt_pk_bf16_f32 v209, v210, v211
  v_mfma_f32_16x16x16_bf16 v[68:71], v[122:123], v[178:179], v[68:71]
  v_cvt_pk_bf16_f32 v210, v212, v213
  v_cvt_pk_bf16_f32 v211, v214, v215
  v_mfma_f32_16x16x16_bf16 v[72:75], v[124:125], v[178:179], v[72:75]
  buffer_store_dwordx4 v[208:211], v1, s[4:7], s63 offen offset:1024 sc1
  v_mfma_f32_16x16x16_bf16 v[76:79], v[126:127], v[178:179], v[76:79]
  v_mul_f32 v216, v184, v216
  v_mul_f32 v217, v184, v217
  v_mul_f32 v218, v184, v218
  v_mul_f32 v219, v184, v219
  v_mul_f32 v220, v184, v220
  v_mul_f32 v221, v184, v221
  v_mul_f32 v222, v184, v222
  v_mul_f32 v223, v184, v223
  v_cvt_pk_bf16_f32 v216, v216, v217
  v_cvt_pk_bf16_f32 v217, v218, v219
  v_cvt_pk_bf16_f32 v218, v220, v221
  v_cvt_pk_bf16_f32 v219, v222, v223
  buffer_store_dwordx4 v[216:219], v1, s[4:7], s63 offen offset:2048 sc1
  v_mul_f32 v224, v184, v224
  v_mul_f32 v225, v184, v225
  v_mul_f32 v226, v184, v226
  v_mul_f32 v227, v184, v227
  v_mul_f32 v228, v184, v228
  v_mul_f32 v229, v184, v229
  v_mul_f32 v230, v184, v230
  v_mul_f32 v231, v184, v231
  v_cvt_pk_bf16_f32 v224, v224, v225
  v_cvt_pk_bf16_f32 v225, v226, v227
  v_cvt_pk_bf16_f32 v226, v228, v229
  v_cvt_pk_bf16_f32 v227, v230, v231
  buffer_store_dwordx4 v[224:227], v1, s[4:7], s63 offen offset:3072 sc1
  v_rcp_f32 v188, v188
  s_add_u32 s63, s59, 131072
  v_pk_mul_f32 v[48:49], v[48:49], v[188:189] op_sel_hi:[1,0]
  v_pk_mul_f32 v[50:51], v[50:51], v[188:189] op_sel_hi:[1,0]
  v_pk_mul_f32 v[52:53], v[52:53], v[188:189] op_sel_hi:[1,0]
  v_pk_mul_f32 v[54:55], v[54:55], v[188:189] op_sel_hi:[1,0]
  v_cvt_pk_bf16_f32 v48, v48, v49
  v_cvt_pk_bf16_f32 v49, v50, v51
  v_cvt_pk_bf16_f32 v50, v52, v53
  v_cvt_pk_bf16_f32 v51, v54, v55
  buffer_store_dwordx4 v[48:51], v1, s[4:7], s63 offen offset:0 sc1
  v_pk_mul_f32 v[56:57], v[56:57], v[188:189] op_sel_hi:[1,0]
  v_pk_mul_f32 v[58:59], v[58:59], v[188:189] op_sel_hi:[1,0]
  v_pk_mul_f32 v[60:61], v[60:61], v[188:189] op_sel_hi:[1,0]
  v_pk_mul_f32 v[62:63], v[62:63], v[188:189] op_sel_hi:[1,0]
  v_cvt_pk_bf16_f32 v56, v56, v57
  v_cvt_pk_bf16_f32 v57, v58, v59
  v_cvt_pk_bf16_f32 v58, v60, v61
  v_cvt_pk_bf16_f32 v59, v62, v63
  buffer_store_dwordx4 v[56:59], v1, s[4:7], s63 offen offset:1024 sc1
  v_pk_mul_f32 v[64:65], v[64:65], v[188:189] op_sel_hi:[1,0]
  v_pk_mul_f32 v[66:67], v[66:67], v[188:189] op_sel_hi:[1,0]
  v_pk_mul_f32 v[68:69], v[68:69], v[188:189] op_sel_hi:[1,0]
  v_pk_mul_f32 v[70:71], v[70:71], v[188:189] op_sel_hi:[1,0]
  v_cvt_pk_bf16_f32 v64, v64, v65
  v_cvt_pk_bf16_f32 v65, v66, v67
  v_cvt_pk_bf16_f32 v66, v68, v69
  v_cvt_pk_bf16_f32 v67, v70, v71
  buffer_store_dwordx4 v[64:67], v1, s[4:7], s63 offen offset:2048 sc1
  v_pk_mul_f32 v[72:73], v[72:73], v[188:189] op_sel_hi:[1,0]
  v_pk_mul_f32 v[74:75], v[74:75], v[188:189] op_sel_hi:[1,0]
  v_pk_mul_f32 v[76:77], v[76:77], v[188:189] op_sel_hi:[1,0]
  v_pk_mul_f32 v[78:79], v[78:79], v[188:189] op_sel_hi:[1,0]
  v_cvt_pk_bf16_f32 v72, v72, v73
  v_cvt_pk_bf16_f32 v73, v74, v75
  v_cvt_pk_bf16_f32 v74, v76, v77
  v_cvt_pk_bf16_f32 v75, v78, v79
  buffer_store_dwordx4 v[72:75], v1, s[4:7], s63 offen offset:3072 sc1
  s_add_u32 s55, s55, s74
  s_lshl_b32 s92, s74, 20
  s_add_u32 s56, s56, s92
  s_lshl_b32 s92, s74, 12
  s_add_u32 s57, s57, s92
  s_lshl_b32 s92, s74, 18
  s_add_u32 s59, s59, s92
  s_mov_b32 s73, s60
  s_lshl_b32 s92, s74, 12
  s_add_u32 s58, s58, s92
  s_add_u32 s60, s60, s92
  s_cmp_lt_u32 s55, 64
  s_cbranch_scc1 ATT_LOOPR
  s_waitcnt vmcnt(0)
  s_mov_b64 exec, 1
  buffer_store_dword v3, off, s[4:7], s73 sc1
  s_mov_b64 exec, -1
  s_branch END
ROLE_W:
  s_cmp_lg_u32 s46, 0
  s_cbranch_scc1 cen_1943
  v_mov_b32 v4, 163328
  s_cmp_lg_u32 s44, 0
  s_cbranch_scc1 cen_1944
  v_min_u32 v5, 9, v0
  v_lshlrev_b32 v5, 3, v5
  s_mov_b32 s92, 128
  v_writelane_b32 v5, s92, 0
cen_1945:
  buffer_load_dword v2, v5, s[12:15], 0 offen sc1
  s_mov_b32 s92, 0
  s_waitcnt vmcnt(0)
  v_readlane_b32 s93, v2, 0
  s_nop 0
  s_add_u32 s92, s92, s93
  v_readlane_b32 s93, v2, 1
  s_nop 0
  s_add_u32 s92, s92, s93
  v_readlane_b32 s93, v2, 2
  s_nop 0
  s_add_u32 s92, s92, s93
  v_readlane_b32 s93, v2, 3
  s_nop 0
  s_add_u32 s92, s92, s93
  v_readlane_b32 s93, v2, 4
  s_nop 0
  s_add_u32 s92, s92, s93
  v_readlane_b32 s93, v2, 5
  s_nop 0
  s_add_u32 s92, s92, s93
  v_readlane_b32 s93, v2, 6
  s_nop 0
  s_add_u32 s92, s92, s93
  v_readlane_b32 s93, v2, 7
  s_nop 0
  s_add_u32 s92, s92, s93
  v_readlane_b32 s93, v2, 8
  s_nop 0
  s_add_u32 s92, s92, s93
  s_cmp_eq_u32 s92, 256
  s_cbranch_scc1 cen_1946
  s_add_u32 s47, s47, 1
  s_mov_b32 s49, 1
  s_cmp_gt_u32 s47, 131072
  s_cbranch_scc1 TIMEOUT
  s_sleep 4
  s_branch cen_1945
cen_1946:
  v_cmp_ne_u32 vcc, 32, v2
  ds_read2_b32 v[6:7], v4 offset0:0 offset1:1
  s_and_b32 s94, vcc_lo, 0xff
  s_waitcnt lgkmcnt(0)
  v_readfirstlane_b32 s92, v6
  v_readfirstlane_b32 s95, v7
  v_readlane_b32 s93, v2, 0
  s_cmp_gt_u32 s95, 0
  s_cselect_b32 s93, s93, 0
  s_add_u32 s92, s92, s93
  v_readlane_b32 s93, v2, 1
  s_cmp_gt_u32 s95, 1
  s_cselect_b32 s93, s93, 0
  s_add_u32 s92, s92, s93
  v_readlane_b32 s93, v2, 2
  s_cmp_gt_u32 s95, 2
  s_cselect_b32 s93, s93, 0
  s_add_u32 s92, s92, s93
  v_readlane_b32 s93, v2, 3
  s_cmp_gt_u32 s95, 3
  s_cselect_b32 s93, s93, 0
  s_add_u32 s92, s92, s93
  v_readlane_b32 s93, v2, 4
  s_cmp_gt_u32 s95, 4
  s_cselect_b32 s93, s93, 0
  s_add_u32 s92, s92, s93
  v_readlane_b32 s93, v2, 5
  s_cmp_gt_u32 s95, 5
  s_cselect_b32 s93, s93, 0
  s_add_u32 s92, s92, s93
  v_readlane_b32 s93, v2, 6
  s_cmp_gt_u32 s95, 6
  s_cselect_b32 s93, s93, 0
  s_add_u32 s92, s92, s93
  v_readlane_b32 s93, v2, 7
  s_cmp_gt_u32 s95, 7
  s_cselect_b32 s93, s93, 0
  s_add_u32 s92, s92, s93
  v_mov_b32 v2, s92
  v_mov_b32 v3, s94
  ds_write2_b32 v4, v2, v3 offset0:2 offset1:3
cen_1944:
  s_waitcnt lgkmcnt(0)
  s_barrier
  ds_read2_b32 v[2:3], v4 offset0:2 offset1:3
  s_waitcnt lgkmcnt(0)
  v_readfirstlane_b32 s92, v2
  v_readfirstlane_b32 s93, v3
  s_nop 0
  s_cmp_eq_u32 s93, 0
  s_cbranch_scc1 cen_1943
  s_mov_b32 s46, 1
  s_mov_b32 s45, s92
  s_branch DISPATCH
cen_1943:
  s_sub_u32 s50, s45, 160
  s_mov_b32 s8, s16
  s_and_b32 s9, s17, 0xffff
  s_mov_b32 s10, 0x200000
  s_mov_b32 s11, 0x20000
  v_and_b32 v2, 15, v0
  v_lshlrev_b32 v3, 10, v2
  v_lshrrev_b32 v4, 4, v0
  v_lshl_add_u32 v3, v4, 4, v3
  v_lshlrev_b32 v5, 3, v2
  s_lshl_b32 s92, s50, 15
  s_lshr_b32 s93, s44, 1
  s_lshl_b32 s94, s93, 14
  s_add_u32 s92, s92, s94
  s_and_b32 s95, s44, 1
  s_lshl_b32 s94, s95, 9
  s_add_u32 s92, s92, s94
  buffer_load_dwordx4 v[16:19], v3, s[8:11], s92 offen offset:0
  buffer_load_dwordx4 v[20:23], v3, s[8:11], s92 offen offset:64
  buffer_load_dwordx4 v[24:27], v3, s[8:11], s92 offen offset:128
  buffer_load_dwordx4 v[28:31], v3, s[8:11], s92 offen offset:192
  buffer_load_dwordx4 v[32:35], v3, s[8:11], s92 offen offset:256
  buffer_load_dwordx4 v[36:39], v3, s[8:11], s92 offen offset:320
  buffer_load_dwordx4 v[40:43], v3, s[8:11], s92 offen offset:384
  buffer_load_dwordx4 v[44:47], v3, s[8:11], s92 offen offset:448
  s_mul_i32 s52, s50, 36864
  s_add_u32 s52, s52, 0x400000
  s_lshl_b32 s94, s44, 13
  s_add_u32 s53, s52, s94
  s_add_u32 s54, s53, 4096
  s_lshl_b32 s94, s95, 11
  s_add_u32 s52, s52, s94
  s_lshl_b32 s94, s93, 7
  s_add_u32 s52, s52, s94
  s_add_u32 s52, s52, 32768
  s_waitcnt vmcnt(7)
  buffer_store_dwordx4 v[16:19], v1, s[4:7], s53 offen offset:0 sc1
  v_lshlrev_b32 v48, 16, v16
  v_and_b32 v49, 0xffff0000, v16
  v_lshlrev_b32 v50, 16, v17
  v_and_b32 v51, 0xffff0000, v17
  v_lshlrev_b32 v52, 16, v18
  v_and_b32 v53, 0xffff0000, v18
  v_lshlrev_b32 v54, 16, v19
  v_and_b32 v55, 0xffff0000, v19
  v_pk_add_f32 v[56:57], v[48:49], v[50:51]
  v_pk_add_f32 v[58:59], v[52:53], v[54:55]
  v_pk_add_f32 v[56:57], v[56:57], v[58:59]
  v_add_f32 v56, v56, v57
  v_mov_b32 v58, v56
  s_nop 1
  v_permlane16_swap_b32 v56, v58
  v_add_f32 v56, v56, v58
  v_mov_b32 v58, v56
  s_nop 1
  v_permlane32_swap_b32 v56, v58
  v_add_f32 v56, v56, v58
  v_mul_f32 v56, 0x3d000000, v56
  v_pk_add_f32 v[48:49], v[48:49], v[56:57] op_sel_hi:[1,0] neg_lo:[0,1] neg_hi:[0,1]
  v_pk_add_f32 v[50:51], v[50:51], v[56:57] op_sel_hi:[1,0] neg_lo:[0,1] neg_hi:[0,1]
  v_pk_add_f32 v[52:53], v[52:53], v[56:57] op_sel_hi:[1,0] neg_lo:[0,1] neg_hi:[0,1]
  v_pk_add_f32 v[54:55], v[54:55], v[56:57] op_sel_hi:[1,0] neg_lo:[0,1] neg_hi:[0,1]
  v_pk_mul_f32 v[58:59], v[48:49], v[48:49]
  v_pk_fma_f32 v[58:59], v[50:51], v[50:51], v[58:59]
  v_pk_fma_f32 v[58:59], v[52:53], v[52:53], v[58:59]
  v_pk_fma_f32 v[58:59], v[54:55], v[54:55], v[58:59]
  v_add_f32 v57, v58, v59
  v_mov_b32 v58, v57
  s_nop 1
  v_permlane16_swap_b32 v57, v58
  v_add_f32 v57, v57, v58
  v_mov_b32 v58, v57
  s_nop 1
  v_permlane32_swap_b32 v57, v58
  v_add_f32 v57, v57, v58
  s_mov_b64 exec, 0xffff
  buffer_store_dwordx2 v[56:57], v5, s[4:7], s52 offen offset:0 sc1
  s_mov_b64 exec, -1
  s_waitcnt vmcnt(8)
  buffer_store_dwordx4 v[20:23], v1, s[4:7], s53 offen offset:1024 sc1
  v_lshlrev_b32 v48, 16, v20
  v_and_b32 v49, 0xffff0000, v20
  v_lshlrev_b32 v50, 16, v21
  v_and_b32 v51, 0xffff0000, v21
  v_lshlrev_b32 v52, 16, v22
  v_and_b32 v53, 0xffff0000, v22
  v_lshlrev_b32 v54, 16, v23
  v_and_b32 v55, 0xffff0000, v23
  v_pk_add_f32 v[56:57], v[48:49], v[50:51]
  v_pk_add_f32 v[58:59], v[52:53], v[54:55]
  v_pk_add_f32 v[56:57], v[56:57], v[58:59]
  v_add_f32 v56, v56, v57
  v_mov_b32 v58, v56
  s_nop 1
  v_permlane16_swap_b32 v56, v58
  v_add_f32 v56, v56, v58
  v_mov_b32 v58, v56
  s_nop 1
  v_permlane32_swap_b32 v56, v58
  v_add_f32 v56, v56, v58
  v_mul_f32 v56, 0x3d000000, v56
  v_pk_add_f32 v[48:49], v[48:49], v[56:57] op_sel_hi:[1,0] neg_lo:[0,1] neg_hi:[0,1]
  v_pk_add_f32 v[50:51], v[50:51], v[56:57] op_sel_hi:[1,0] neg_lo:[0,1] neg_hi:[0,1]
  v_pk_add_f32 v[52:53], v[52:53], v[56:57] op_sel_hi:[1,0] neg_lo:[0,1] neg_hi:[0,1]
  v_pk_add_f32 v[54:55], v[54:55], v[56:57] op_sel_hi:[1,0] neg_lo:[0,1] neg_hi:[0,1]
  v_pk_mul_f32 v[58:59], v[48:49], v[48:49]
  v_pk_fma_f32 v[58:59], v[50:51], v[50:51], v[58:59]
  v_pk_fma_f32 v[58:59], v[52:53], v[52:53], v[58:59]
  v_pk_fma_f32 v[58:59], v[54:55], v[54:55], v[58:59]
  v_add_f32 v57, v58, v59
  v_mov_b32 v58, v57
  s_nop 1
  v_permlane16_swap_b32 v57, v58
  v_add_f32 v57, v57, v58
  v_mov_b32 v58, v57
  s_nop 1
  v_permlane32_swap_b32 v57, v58
  v_add_f32 v57, v57, v58
  s_mov_b64 exec, 0xffff
  buffer_store_dwordx2 v[56:57], v5, s[4:7], s52 offen offset:256 sc1
  s_mov_b64 exec, -1
  s_waitcnt vmcnt(9)
  buffer_store_dwordx4 v[24:27], v1, s[4:7], s53 offen offset:2048 sc1
  v_lshlrev_b32 v48, 16, v24
  v_and_b32 v49, 0xffff0000, v24
  v_lshlrev_b32 v50, 16, v25
  v_and_b32 v51, 0xffff0000, v25
  v_lshlrev_b32 v52, 16, v26
  v_and_b32 v53, 0xffff0000, v26
  v_lshlrev_b32 v54, 16, v27
  v_and_b32 v55, 0xffff0000, v27
  v_pk_add_f32 v[56:57], v[48:49], v[50:51]
  v_pk_add_f32 v[58:59], v[52:53], v[54:55]
  v_pk_add_f32 v[56:57], v[56:57], v[58:59]
  v_add_f32 v56, v56, v57
  v_mov_b32 v58, v56
  s_nop 1
  v_permlane16_swap_b32 v56, v58
  v_add_f32 v56, v56, v58
  v_mov_b32 v58, v56
  s_nop 1
  v_permlane32_swap_b32 v56, v58
  v_add_f32 v56, v56, v58
  v_mul_f32 v56, 0x3d000000, v56
  v_pk_add_f32 v[48:49], v[48:49], v[56:57] op_sel_hi:[1,0] neg_lo:[0,1] neg_hi:[0,1]
  v_pk_add_f32 v[50:51], v[50:51], v[56:57] op_sel_hi:[1,0] neg_lo:[0,1] neg_hi:[0,1]
  v_pk_add_f32 v[52:53], v[52:53], v[56:57] op_sel_hi:[1,0] neg_lo:[0,1] neg_hi:[0,1]
  v_pk_add_f32 v[54:55], v[54:55], v[56:57] op_sel_hi:[1,0] neg_lo:[0,1] neg_hi:[0,1]
  v_pk_mul_f32 v[58:59], v[48:49], v[48:49]
  v_pk_fma_f32 v[58:59], v[50:51], v[50:51], v[58:59]
  v_pk_fma_f32 v[58:59], v[52:53], v[52:53], v[58:59]
  v_pk_fma_f32 v[58:59], v[54:55], v[54:55], v[58:59]
  v_add_f32 v57, v58, v59
  v_mov_b32 v58, v57
  s_nop 1
  v_permlane16_swap_b32 v57, v58
  v_add_f32 v57, v57, v58
  v_mov_b32 v58, v57
  s_nop 1
  v_permlane32_swap_b32 v57, v58
  v_add_f32 v57, v57, v58
  s_mov_b64 exec, 0xffff
  buffer_store_dwordx2 v[56:57], v5, s[4:7], s52 offen offset:512 sc1
  s_mov_b64 exec, -1
  s_waitcnt vmcnt(10)
  buffer_store_dwordx4 v[28:31], v1, s[4:7], s53 offen offset:3072 sc1
  v_lshlrev_b32 v48, 16, v28
  v_and_b32 v49, 0xffff0000, v28
  v_lshlrev_b32 v50, 16, v29
  v_and_b32 v51, 0xffff0000, v29
  v_lshlrev_b32 v52, 16, v30
  v_and_b32 v53, 0xffff0000, v30
  v_lshlrev_b32 v54, 16, v31
  v_and_b32 v55, 0xffff0000, v31
  v_pk_add_f32 v[56:57], v[48:49], v[50:51]
  v_pk_add_f32 v[58:59], v[52:53], v[54:55]
  v_pk_add_f32 v[56:57], v[56:57], v[58:59]
  v_add_f32 v56, v56, v57
  v_mov_b32 v58, v56
  s_nop 1
  v_permlane16_swap_b32 v56, v58
  v_add_f32 v56, v56, v58
  v_mov_b32 v58, v56
  s_nop 1
  v_permlane32_swap_b32 v56, v58
  v_add_f32 v56, v56, v58
  v_mul_f32 v56, 0x3d000000, v56
  v_pk_add_f32 v[48:49], v[48:49], v[56:57] op_sel_hi:[1,0] neg_lo:[0,1] neg_hi:[0,1]
  v_pk_add_f32 v[50:51], v[50:51], v[56:57] op_sel_hi:[1,0] neg_lo:[0,1] neg_hi:[0,1]
  v_pk_add_f32 v[52:53], v[52:53], v[56:57] op_sel_hi:[1,0] neg_lo:[0,1] neg_hi:[0,1]
  v_pk_add_f32 v[54:55], v[54:55], v[56:57] op_sel_hi:[1,0] neg_lo:[0,1] neg_hi:[0,1]
  v_pk_mul_f32 v[58:59], v[48:49], v[48:49]
  v_pk_fma_f32 v[58:59], v[50:51], v[50:51], v[58:59]
  v_pk_fma_f32 v[58:59], v[52:53], v[52:53], v[58:59]
  v_pk_fma_f32 v[58:59], v[54:55], v[54:55], v[58:59]
  v_add_f32 v57, v58, v59
  v_mov_b32 v58, v57
  s_nop 1
  v_permlane16_swap_b32 v57, v58
  v_add_f32 v57, v57, v58
  v_mov_b32 v58, v57
  s_nop 1
  v_permlane32_swap_b32 v57, v58
  v_add_f32 v57, v57, v58
  s_mov_b64 exec, 0xffff
  buffer_store_dwordx2 v[56:57], v5, s[4:7], s52 offen offset:768 sc1
  s_mov_b64 exec, -1
  s_waitcnt vmcnt(11)
  buffer_store_dwordx4 v[32:35], v1, s[4:7], s54 offen offset:0 sc1
  v_lshlrev_b32 v48, 16, v32
  v_and_b32 v49, 0xffff0000, v32
  v_lshlrev_b32 v50, 16, v33
  v_and_b32 v51, 0xffff0000, v33
  v_lshlrev_b32 v52, 16, v34
  v_and_b32 v53, 0xffff0000, v34
  v_lshlrev_b32 v54, 16, v35
  v_and_b32 v55, 0xffff0000, v35
  v_pk_add_f32 v[56:57], v[48:49], v[50:51]
  v_pk_add_f32 v[58:59], v[52:53], v[54:55]
  v_pk_add_f32 v[56:57], v[56:57], v[58:59]
  v_add_f32 v56, v56, v57
  v_mov_b32 v58, v56
  s_nop 1
  v_permlane16_swap_b32 v56, v58
  v_add_f32 v56, v56, v58
  v_mov_b32 v58, v56
  s_nop 1
  v_permlane32_swap_b32 v56, v58
  v_add_f32 v56, v56, v58
  v_mul_f32 v56, 0x3d000000, v56
  v_pk_add_f32 v[48:49], v[48:49], v[56:57] op_sel_hi:[1,0] neg_lo:[0,1] neg_hi:[0,1]
  v_pk_add_f32 v[50:51], v[50:51], v[56:57] op_sel_hi:[1,0] neg_lo:[0,1] neg_hi:[0,1]
  v_pk_add_f32 v[52:53], v[52:53], v[56:57] op_sel_hi:[1,0] neg_lo:[0,1] neg_hi:[0,1]
  v_pk_add_f32 v[54:55], v[54:55], v[56:57] op_sel_hi:[1,0] neg_lo:[0,1] neg_hi:[0,1]
  v_pk_mul_f32 v[58:59], v[48:49], v[48:49]
  v_pk_fma_f32 v[58:59], v[50:51], v[50:51], v[58:59]
  v_pk_fma_f32 v[58:59], v[52:53], v[52:53], v[58:59]
  v_pk_fma_f32 v[58:59], v[54:55], v[54:55], v[58:59]
  v_add_f32 v57, v58, v59
  v_mov_b32 v58, v57
  s_nop 1
  v_permlane16_swap_b32 v57, v58
  v_add_f32 v57, v57, v58
  v_mov_b32 v58, v57
  s_nop 1
  v_permlane32_swap_b32 v57, v58
  v_add_f32 v57, v57, v58
  s_mov_b64 exec, 0xffff
  buffer_store_dwordx2 v[56:57], v5, s[4:7], s52 offen offset:1024 sc1
  s_mov_b64 exec, -1
  s_waitcnt vmcnt(12)
  buffer_store_dwordx4 v[36:39], v1, s[4:7], s54 offen offset:1024 sc1
  v_lshlrev_b32 v48, 16, v36
  v_and_b32 v49, 0xffff0000, v36
  v_lshlrev_b32 v50, 16, v37
  v_and_b32 v51, 0xffff0000, v37
  v_lshlrev_b32 v52, 16, v38
  v_and_b32 v53, 0xffff0000, v38
  v_lshlrev_b32 v54, 16, v39
  v_and_b32 v55, 0xffff0000, v39
  v_pk_add_f32 v[56:57], v[48:49], v[50:51]
  v_pk_add_f32 v[58:59], v[52:53], v[54:55]
  v_pk_add_f32 v[56:57], v[56:57], v[58:59]
  v_add_f32 v56, v56, v57
  v_mov_b32 v58, v56
  s_nop 1
  v_permlane16_swap_b32 v56, v58
  v_add_f32 v56, v56, v58
  v_mov_b32 v58, v56
  s_nop 1
  v_permlane32_swap_b32 v56, v58
  v_add_f32 v56, v56, v58
  v_mul_f32 v56, 0x3d000000, v56
  v_pk_add_f32 v[48:49], v[48:49], v[56:57] op_sel_hi:[1,0] neg_lo:[0,1] neg_hi:[0,1]
  v_pk_add_f32 v[50:51], v[50:51], v[56:57] op_sel_hi:[1,0] neg_lo:[0,1] neg_hi:[0,1]
  v_pk_add_f32 v[52:53], v[52:53], v[56:57] op_sel_hi:[1,0] neg_lo:[0,1] neg_hi:[0,1]
  v_pk_add_f32 v[54:55], v[54:55], v[56:57] op_sel_hi:[1,0] neg_lo:[0,1] neg_hi:[0,1]
  v_pk_mul_f32 v[58:59], v[48:49], v[48:49]
  v_pk_fma_f32 v[58:59], v[50:51], v[50:51], v[58:59]
  v_pk_fma_f32 v[58:59], v[52:53], v[52:53], v[58:59]
  v_pk_fma_f32 v[58:59], v[54:55], v[54:55], v[58:59]
  v_add_f32 v57, v58, v59
  v_mov_b32 v58, v57
  s_nop 1
  v_permlane16_swap_b32 v57, v58
  v_add_f32 v57, v57, v58
  v_mov_b32 v58, v57
  s_nop 1
  v_permlane32_swap_b32 v57, v58
  v_add_f32 v57, v57, v58
  s_mov_b64 exec, 0xffff
  buffer_store_dwordx2 v[56:57], v5, s[4:7], s52 offen offset:1280 sc1
  s_mov_b64 exec, -1
  s_waitcnt vmcnt(13)
  buffer_store_dwordx4 v[40:43], v1, s[4:7], s54 offen offset:2048 sc1
  v_lshlrev_b32 v48, 16, v40
  v_and_b32 v49, 0xffff0000, v40
  v_lshlrev_b32 v50, 16, v41
  v_and_b32 v51, 0xffff0000, v41
  v_lshlrev_b32 v52, 16, v42
  v_and_b32 v53, 0xffff0000, v42
  v_lshlrev_b32 v54, 16, v43
  v_and_b32 v55, 0xffff0000, v43
  v_pk_add_f32 v[56:57], v[48:49], v[50:51]
  v_pk_add_f32 v[58:59], v[52:53], v[54:55]
  v_pk_add_f32 v[56:57], v[56:57], v[58:59]
  v_add_f32 v56, v56, v57
  v_mov_b32 v58, v56
  s_nop 1
  v_permlane16_swap_b32 v56, v58
  v_add_f32 v56, v56, v58
  v_mov_b32 v58, v56
  s_nop 1
  v_permlane32_swap_b32 v56, v58
  v_add_f32 v56, v56, v58
  v_mul_f32 v56, 0x3d000000, v56
  v_pk_add_f32 v[48:49], v[48:49], v[56:57] op_sel_hi:[1,0] neg_lo:[0,1] neg_hi:[0,1]
  v_pk_add_f32 v[50:51], v[50:51], v[56:57] op_sel_hi:[1,0] neg_lo:[0,1] neg_hi:[0,1]
  v_pk_add_f32 v[52:53], v[52:53], v[56:57] op_sel_hi:[1,0] neg_lo:[0,1] neg_hi:[0,1]
  v_pk_add_f32 v[54:55], v[54:55], v[56:57] op_sel_hi:[1,0] neg_lo:[0,1] neg_hi:[0,1]
  v_pk_mul_f32 v[58:59], v[48:49], v[48:49]
  v_pk_fma_f32 v[58:59], v[50:51], v[50:51], v[58:59]
  v_pk_fma_f32 v[58:59], v[52:53], v[52:53], v[58:59]
  v_pk_fma_f32 v[58:59], v[54:55], v[54:55], v[58:59]
  v_add_f32 v57, v58, v59
  v_mov_b32 v58, v57
  s_nop 1
  v_permlane16_swap_b32 v57, v58
  v_add_f32 v57, v57, v58
  v_mov_b32 v58, v57
  s_nop 1
  v_permlane32_swap_b32 v57, v58
  v_add_f32 v57, v57, v58
  s_mov_b64 exec, 0xffff
  buffer_store_dwordx2 v[56:57], v5, s[4:7], s52 offen offset:1536 sc1
  s_mov_b64 exec, -1
  s_waitcnt vmcnt(14)
  buffer_store_dwordx4 v[44:47], v1, s[4:7], s54 offen offset:3072 sc1
  v_lshlrev_b32 v48, 16, v44
  v_and_b32 v49, 0xffff0000, v44
  v_lshlrev_b32 v50, 16, v45
  v_and_b32 v51, 0xffff0000, v45
  v_lshlrev_b32 v52, 16, v46
  v_and_b32 v53, 0xffff0000, v46
  v_lshlrev_b32 v54, 16, v47
  v_and_b32 v55, 0xffff0000, v47
  v_pk_add_f32 v[56:57], v[48:49], v[50:51]
  v_pk_add_f32 v[58:59], v[52:53], v[54:55]
  v_pk_add_f32 v[56:57], v[56:57], v[58:59]
  v_add_f32 v56, v56, v57
  v_mov_b32 v58, v56
  s_nop 1
  v_permlane16_swap_b32 v56, v58
  v_add_f32 v56, v56, v58
  v_mov_b32 v58, v56
  s_nop 1
  v_permlane32_swap_b32 v56, v58
  v_add_f32 v56, v56, v58
  v_mul_f32 v56, 0x3d000000, v56
  v_pk_add_f32 v[48:49], v[48:49], v[56:57] op_sel_hi:[1,0] neg_lo:[0,1] neg_hi:[0,1]
  v_pk_add_f32 v[50:51], v[50:51], v[56:57] op_sel_hi:[1,0] neg_lo:[0,1] neg_hi:[0,1]
  v_pk_add_f32 v[52:53], v[52:53], v[56:57] op_sel_hi:[1,0] neg_lo:[0,1] neg_hi:[0,1]
  v_pk_add_f32 v[54:55], v[54:55], v[56:57] op_sel_hi:[1,0] neg_lo:[0,1] neg_hi:[0,1]
  v_pk_mul_f32 v[58:59], v[48:49], v[48:49]
  v_pk_fma_f32 v[58:59], v[50:51], v[50:51], v[58:59]
  v_pk_fma_f32 v[58:59], v[52:53], v[52:53], v[58:59]
  v_pk_fma_f32 v[58:59], v[54:55], v[54:55], v[58:59]
  v_add_f32 v57, v58, v59
  v_mov_b32 v58, v57
  s_nop 1
  v_permlane16_swap_b32 v57, v58
  v_add_f32 v57, v57, v58
  v_mov_b32 v58, v57
  s_nop 1
  v_permlane32_swap_b32 v57, v58
  v_add_f32 v57, v57, v58
  s_mov_b64 exec, 0xffff
  buffer_store_dwordx2 v[56:57], v5, s[4:7], s52 offen offset:1792 sc1
  s_mov_b64 exec, -1
  s_lshl_b32 s52, s50, 2
  s_lshl_b32 s94, s95, 12
  s_add_u32 s52, s52, s94
  s_lshl_b32 s94, s93, 8
  s_add_u32 s52, s52, s94
  s_add_u32 s52, s52, 0x0
  v_lshlrev_b32 v6, 9, v0
  v_mov_b32 v7, 1
  s_waitcnt vmcnt(0)
  s_mov_b64 exec, 0xff
  buffer_store_dword v7, v6, s[4:7], s52 offen sc1
  s_mov_b64 exec, -1
  s_sub_u32 s92, s45, 160
  s_lshr_b32 s55, s92, 4
  s_and_b32 s56, s92, 7
  s_bfe_u32 s60, s92, 0x10003
  s_mul_i32 s57, s44, 1048576
  s_lshl_b32 s92, s56, 7
  s_add_u32 s57, s57, s92
  s_add_u32 s92, s56, 0
  s_sub_u32 s93, s92, 8
  s_cmp_ge_u32 s92, 8
  s_cselect_b32 s92, s93, s92
  s_mul_i32 s72, s92, 4096
  s_mul_i32 s92, s92, 131072
  s_add_u32 s80, s57, s92
  s_add_u32 s92, s56, 1
  s_sub_u32 s93, s92, 8
  s_cmp_ge_u32 s92, 8
  s_cselect_b32 s92, s93, s92
  s_mul_i32 s73, s92, 4096
  s_mul_i32 s92, s92, 131072
  s_add_u32 s81, s57, s92
  s_add_u32 s92, s56, 2
  s_sub_u32 s93, s92, 8
  s_cmp_ge_u32 s92, 8
  s_cselect_b32 s92, s93, s92
  s_mul_i32 s74, s92, 4096
  s_mul_i32 s92, s92, 131072
  s_add_u32 s82, s57, s92
  s_add_u32 s92, s56, 3
  s_sub_u32 s93, s92, 8
  s_cmp_ge_u32 s92, 8
  s_cselect_b32 s92, s93, s92
  s_mul_i32 s75, s92, 4096
  s_mul_i32 s92, s92, 131072
  s_add_u32 s83, s57, s92
  s_add_u32 s92, s56, 4
  s_sub_u32 s93, s92, 8
  s_cmp_ge_u32 s92, 8
  s_cselect_b32 s92, s93, s92
  s_mul_i32 s76, s92, 4096
  s_mul_i32 s92, s92, 131072
  s_add_u32 s84, s57, s92
  s_add_u32 s92, s56, 5
  s_sub_u32 s93, s92, 8
  s_cmp_ge_u32 s92, 8
  s_cselect_b32 s92, s93, s92
  s_mul_i32 s77, s92, 4096
  s_mul_i32 s92, s92, 131072
  s_add_u32 s85, s57, s92
  s_add_u32 s92, s56, 6
  s_sub_u32 s93, s92, 8
  s_cmp_ge_u32 s92, 8
  s_cselect_b32 s92, s93, s92
  s_mul_i32 s78, s92, 4096
  s_mul_i32 s92, s92, 131072
  s_add_u32 s86, s57, s92
  s_add_u32 s92, s56, 7
  s_sub_u32 s93, s92, 8
  s_cmp_ge_u32 s92, 8
  s_cselect_b32 s92, s93, s92
  s_mul_i32 s79, s92, 4096
  s_mul_i32 s92, s92, 131072
  s_add_u32 s87, s57, s92
  v_lshrrev_b32 v21, 4, v0
  v_bfe_u32 v22, v0, 2, 2
  v_and_b32 v23, 3, v0
  v_lshl_add_u32 v17, v21, 2, v22
  v_lshlrev_b32 v17, 6, v17
  v_lshl_add_u32 v17, v23, 4, v17
  v_add_u32 v17, s48, v17
  v_add_u32 v21, s48, v1
  s_mov_b32 s8, s26
  s_and_b32 s9, s27, 0xffff
  s_mov_b32 s10, 0x400000
  s_mov_b32 s11, 0x20000
  s_mov_b32 s92, 1024
  v_lshrrev_b32 v16, 2, v0
  v_mul_lo_u32 v16, v16, s92
  v_lshl_add_u32 v16, v23, 4, v16
  s_add_u32 m0, s48, 0
  s_add_u32 s92, s80, 0x0
  buffer_load_dwordx4 v16, s[8:11], s92 offen offset:0 lds
  s_add_u32 s92, s80, 0x3c00
  buffer_load_dwordx4 v16, s[8:11], s92 offen offset:1024 lds
  s_add_u32 s92, s80, 0x7800
  buffer_load_dwordx4 v16, s[8:11], s92 offen offset:2048 lds
  s_add_u32 s92, s80, 0xb400
  buffer_load_dwordx4 v16, s[8:11], s92 offen offset:3072 lds
  s_add_u32 m0, s48, 4096
  s_add_u32 s92, s80, 0x40
  buffer_load_dwordx4 v16, s[8:11], s92 offen offset:0 lds
  s_add_u32 s92, s80, 0x3c40
  buffer_load_dwordx4 v16, s[8:11], s92 offen offset:1024 lds
  s_add_u32 s92, s80, 0x7840
  buffer_load_dwordx4 v16, s[8:11], s92 offen offset:2048 lds
  s_add_u32 s92, s80, 0xb440
  buffer_load_dwordx4 v16, s[8:11], s92 offen offset:3072 lds
  s_add_u32 m0, s48, 8192
  s_add_u32 s92, s80, 0x10000
  buffer_load_dwordx4 v16, s[8:11], s92 offen offset:0 lds
  s_add_u32 s92, s80, 0x13c00
  buffer_load_dwordx4 v16, s[8:11], s92 offen offset:1024 lds
  s_add_u32 s92, s80, 0x17800
  buffer_load_dwordx4 v16, s[8:11], s92 offen offset:2048 lds
  s_add_u32 s92, s80, 0x1b400
  buffer_load_dwordx4 v16, s[8:11], s92 offen offset:3072 lds
  s_add_u32 m0, s48, 12288
  s_add_u32 s92, s81, 0x0
  buffer_load_dwordx4 v16, s[8:11], s92 offen offset:0 lds
  s_add_u32 s92, s81, 0x3c00
  buffer_load_dwordx4 v16, s[8:11], s92 offen offset:1024 lds
  s_add_u32 s92, s81, 0x7800
  buffer_load_dwordx4 v16, s[8:11], s92 offen offset:2048 lds
  s_add_u32 s92, s81, 0xb400
  buffer_load_dwordx4 v16, s[8:11], s92 offen offset:3072 lds
  s_add_u32 m0, s48, 16384
  s_add_u32 s92, s81, 0x40
  buffer_load_dwordx4 v16, s[8:11], s92 offen offset:0 lds
  s_add_u32 s92, s81, 0x3c40
  buffer_load_dwordx4 v16, s[8:11], s92 offen offset:1024 lds
  s_add_u32 s92, s81, 0x7840
  buffer_load_dwordx4 v16, s[8:11], s92 offen offset:2048 lds
  s_add_u32 s92, s81, 0xb440
  buffer_load_dwordx4 v16, s[8:11], s92 offen offset:3072 lds
  s_add_u32 m0, s48, 20480
  s_add_u32 s92, s81, 0x10000
  buffer_load_dwordx4 v16, s[8:11], s92 offen offset:0 lds
  s_add_u32 s92, s81, 0x13c00
  buffer_load_dwordx4 v16, s[8:11], s92 offen offset:1024 lds
  s_add_u32 s92, s81, 0x17800
  buffer_load_dwordx4 v16, s[8:11], s92 offen offset:2048 lds
  s_add_u32 s92, s81, 0x1b400
  buffer_load_dwordx4 v16, s[8:11], s92 offen offset:3072 lds
  s_add_u32 m0, s48, 24576
  s_add_u32 s92, s82, 0x0
  buffer_load_dwordx4 v16, s[8:11], s92 offen offset:0 lds
  s_add_u32 s92, s82, 0x3c00
  buffer_load_dwordx4 v16, s[8:11], s92 offen offset:1024 lds
  s_add_u32 s92, s82, 0x7800
  buffer_load_dwordx4 v16, s[8:11], s92 offen offset:2048 lds
  s_add_u32 s92, s82, 0xb400
  buffer_load_dwordx4 v16, s[8:11], s92 offen offset:3072 lds
  s_add_u32 m0, s48, 28672
  s_add_u32 s92, s82, 0x40
  buffer_load_dwordx4 v16, s[8:11], s92 offen offset:0 lds
  s_add_u32 s92, s82, 0x3c40
  buffer_load_dwordx4 v16, s[8:11], s92 offen offset:1024 lds
  s_add_u32 s92, s82, 0x7840
  buffer_load_dwordx4 v16, s[8:11], s92 offen offset:2048 lds
  s_add_u32 s92, s82, 0xb440
  buffer_load_dwordx4 v16, s[8:11], s92 offen offset:3072 lds
  s_waitcnt vmcnt(28)
  ds_read_b64_tr_b16 a[0:1], v17 offset:0
  ds_read_b64_tr_b16 a[2:3], v17 offset:1024
  ds_read_b64_tr_b16 a[8:9], v17 offset:8
  ds_read_b64_tr_b16 a[10:11], v17 offset:1032
  ds_read_b64_tr_b16 a[4:5], v17 offset:2048
  ds_read_b64_tr_b16 a[6:7], v17 offset:3072
  ds_read_b64_tr_b16 a[12:13], v17 offset:2056
  ds_read_b64_tr_b16 a[14:15], v17 offset:3080
  s_waitcnt lgkmcnt(0)
  s_add_u32 m0, s48, 0
  s_add_u32 s92, s82, 0x10000
  buffer_load_dwordx4 v16, s[8:11], s92 offen offset:0 lds
  s_add_u32 s92, s82, 0x13c00
  buffer_load_dwordx4 v16, s[8:11], s92 offen offset:1024 lds
  s_add_u32 s92, s82, 0x17800
  buffer_load_dwordx4 v16, s[8:11], s92 offen offset:2048 lds
  s_add_u32 s92, s82, 0x1b400
  buffer_load_dwordx4 v16, s[8:11], s92 offen offset:3072 lds
  s_waitcnt vmcnt(28)
  ds_read_b64_tr_b16 a[16:17], v17 offset:4096
  ds_read_b64_tr_b16 a[18:19], v17 offset:5120
  ds_read_b64_tr_b16 a[24:25], v17 offset:4104
  ds_read_b64_tr_b16 a[26:27], v17 offset:5128
  ds_read_b64_tr_b16 a[20:21], v17 offset:6144
  ds_read_b64_tr_b16 a[22:23], v17 offset:7168
  ds_read_b64_tr_b16 a[28:29], v17 offset:6152
  ds_read_b64_tr_b16 a[30:31], v17 offset:7176
  s_waitcnt lgkmcnt(0)
  s_add_u32 m0, s48, 4096
  s_add_u32 s92, s83, 0x0
  buffer_load_dwordx4 v16, s[8:11], s92 offen offset:0 lds
  s_add_u32 s92, s83, 0x3c00
  buffer_load_dwordx4 v16, s[8:11], s92 offen offset:1024 lds
  s_add_u32 s92, s83, 0x7800
  buffer_load_dwordx4 v16, s[8:11], s92 offen offset:2048 lds
  s_add_u32 s92, s83, 0xb400
  buffer_load_dwordx4 v16, s[8:11], s92 offen offset:3072 lds
  s_waitcnt vmcnt(28)
  ds_read_b64_tr_b16 a[32:33], v17 offset:8192
  ds_read_b64_tr_b16 a[34:35], v17 offset:9216
  ds_read_b64_tr_b16 a[40:41], v17 offset:8200
  ds_read_b64_tr_b16 a[42:43], v17 offset:9224
  ds_read_b64_tr_b16 a[36:37], v17 offset:10240
  ds_read_b64_tr_b16 a[38:39], v17 offset:11264
  ds_read_b64_tr_b16 a[44:45], v17 offset:10248
  ds_read_b64_tr_b16 a[46:47], v17 offset:11272
  s_waitcnt lgkmcnt(0)
  s_add_u32 m0, s48, 8192
  s_add_u32 s92, s83, 0x40
  buffer_load_dwordx4 v16, s[8:11], s92 offen offset:0 lds
  s_add_u32 s92, s83, 0x3c40
  buffer_load_dwordx4 v16, s[8:11], s92 offen offset:1024 lds
  s_add_u32 s92, s83, 0x7840
  buffer_load_dwordx4 v16, s[8:11], s92 offen offset:2048 lds
  s_add_u32 s92, s83, 0xb440
  buffer_load_dwordx4 v16, s[8:11], s92 offen offset:3072 lds
  s_waitcnt vmcnt(28)
  ds_read_b64_tr_b16 a[48:49], v17 offset:12288
  ds_read_b64_tr_b16 a[50:51], v17 offset:13312
  ds_read_b64_tr_b16 a[56:57], v17 offset:12296
  ds_read_b64_tr_b16 a[58:59], v17 offset:13320
  ds_read_b64_tr_b16 a[52:53], v17 offset:14336
  ds_read_b64_tr_b16 a[54:55], v17 offset:15360
  ds_read_b64_tr_b16 a[60:61], v17 offset:14344
  ds_read_b64_tr_b16 a[62:63], v17 offset:15368
  s_waitcnt lgkmcnt(0)
  s_add_u32 m0, s48, 12288
  s_add_u32 s92, s83, 0x10000
  buffer_load_dwordx4 v16, s[8:11], s92 offen offset:0 lds
  s_add_u32 s92, s83, 0x13c00
  buffer_load_dwordx4 v16, s[8:11], s92 offen offset:1024 lds
  s_add_u32 s92, s83, 0x17800
  buffer_load_dwordx4 v16, s[8:11], s92 offen offset:2048 lds
  s_add_u32 s92, s83, 0x1b400
  buffer_load_dwordx4 v16, s[8:11], s92 offen offset:3072 lds
  s_waitcnt vmcnt(28)
  ds_read_b64_tr_b16 a[64:65], v17 offset:16384
  ds_read_b64_tr_b16 a[66:67], v17 offset:17408
  ds_read_b64_tr_b16 a[72:73], v17 offset:16392
  ds_read_b64_tr_b16 a[74:75], v17 offset:17416
  ds_read_b64_tr_b16 a[68:69], v17 offset:18432
  ds_read_b64_tr_b16 a[70:71], v17 offset:19456
  ds_read_b64_tr_b16 a[76:77], v17 offset:18440
  ds_read_b64_tr_b16 a[78:79], v17 offset:19464
  s_waitcnt lgkmcnt(0)
  s_add_u32 m0, s48, 16384
  s_add_u32 s92, s84, 0x0
  buffer_load_dwordx4 v16, s[8:11], s92 offen offset:0 lds
  s_add_u32 s92, s84, 0x3c00
  buffer_load_dwordx4 v16, s[8:11], s92 offen offset:1024 lds
  s_add_u32 s92, s84, 0x7800
  buffer_load_dwordx4 v16, s[8:11], s92 offen offset:2048 lds
  s_add_u32 s92, s84, 0xb400
  buffer_load_dwordx4 v16, s[8:11], s92 offen offset:3072 lds
  s_waitcnt vmcnt(28)
  ds_read_b64_tr_b16 a[80:81], v17 offset:20480
  ds_read_b64_tr_b16 a[82:83], v17 offset:21504
  ds_read_b64_tr_b16 a[88:89], v17 offset:20488
  ds_read_b64_tr_b16 a[90:91], v17 offset:21512
  ds_read_b64_tr_b16 a[84:85], v17 offset:22528
  ds_read_b64_tr_b16 a[86:87], v17 offset:23552
  ds_read_b64_tr_b16 a[92:93], v17 offset:22536
  ds_read_b64_tr_b16 a[94:95], v17 offset:23560
  s_waitcnt lgkmcnt(0)
  s_add_u32 m0, s48, 20480
  s_add_u32 s92, s84, 0x40
  buffer_load_dwordx4 v16, s[8:11], s92 offen offset:0 lds
  s_add_u32 s92, s84, 0x3c40
  buffer_load_dwordx4 v16, s[8:11], s92 offen offset:1024 lds
  s_add_u32 s92, s84, 0x7840
  buffer_load_dwordx4 v16, s[8:11], s92 offen offset:2048 lds
  s_add_u32 s92, s84, 0xb440
  buffer_load_dwordx4 v16, s[8:11], s92 offen offset:3072 lds
  s_waitcnt vmcnt(28)
  ds_read_b64_tr_b16 a[96:97], v17 offset:24576
  ds_read_b64_tr_b16 a[98:99], v17 offset:25600
  ds_read_b64_tr_b16 a[104:105], v17 offset:24584
  ds_read_b64_tr_b16 a[106:107], v17 offset:25608
  ds_read_b64_tr_b16 a[100:101], v17 offset:26624
  ds_read_b64_tr_b16 a[102:103], v17 offset:27648
  ds_read_b64_tr_b16 a[108:109], v17 offset:26632
  ds_read_b64_tr_b16 a[110:111], v17 offset:27656
  s_waitcnt lgkmcnt(0)
  s_add_u32 m0, s48, 24576
  s_add_u32 s92, s84, 0x10000
  buffer_load_dwordx4 v16, s[8:11], s92 offen offset:0 lds
  s_add_u32 s92, s84, 0x13c00
  buffer_load_dwordx4 v16, s[8:11], s92 offen offset:1024 lds
  s_add_u32 s92, s84, 0x17800
  buffer_load_dwordx4 v16, s[8:11], s92 offen offset:2048 lds
  s_add_u32 s92, s84, 0x1b400
  buffer_load_dwordx4 v16, s[8:11], s92 offen offset:3072 lds
  s_waitcnt vmcnt(28)
  ds_read_b64_tr_b16 a[112:113], v17 offset:28672
  ds_read_b64_tr_b16 a[114:115], v17 offset:29696
  ds_read_b64_tr_b16 a[120:121], v17 offset:28680
  ds_read_b64_tr_b16 a[122:123], v17 offset:29704
  ds_read_b64_tr_b16 a[116:117], v17 offset:30720
  ds_read_b64_tr_b16 a[118:119], v17 offset:31744
  ds_read_b64_tr_b16 a[124:125], v17 offset:30728
  ds_read_b64_tr_b16 a[126:127], v17 offset:31752
  s_waitcnt lgkmcnt(0)
  s_add_u32 m0, s48, 28672
  s_add_u32 s92, s85, 0x0
  buffer_load_dwordx4 v16, s[8:11], s92 offen offset:0 lds
  s_add_u32 s92, s85, 0x3c00
  buffer_load_dwordx4 v16, s[8:11], s92 offen offset:1024 lds
  s_add_u32 s92, s85, 0x7800
  buffer_load_dwordx4 v16, s[8:11], s92 offen offset:2048 lds
  s_add_u32 s92, s85, 0xb400
  buffer_load_dwordx4 v16, s[8:11], s92 offen offset:3072 lds
  s_waitcnt vmcnt(28)
  ds_read_b64_tr_b16 a[128:129], v17 offset:0
  ds_read_b64_tr_b16 a[130:131], v17 offset:1024
  ds_read_b64_tr_b16 a[136:137], v17 offset:8
  ds_read_b64_tr_b16 a[138:139], v17 offset:1032
  ds_read_b64_tr_b16 a[132:133], v17 offset:2048
  ds_read_b64_tr_b16 a[134:135], v17 offset:3072
  ds_read_b64_tr_b16 a[140:141], v17 offset:2056
  ds_read_b64_tr_b16 a[142:143], v17 offset:3080
  s_waitcnt lgkmcnt(0)
  s_add_u32 m0, s48, 0
  s_add_u32 s92, s85, 0x40
  buffer_load_dwordx4 v16, s[8:11], s92 offen offset:0 lds
  s_add_u32 s92, s85, 0x3c40
  buffer_load_dwordx4 v16, s[8:11], s92 offen offset:1024 lds
  s_add_u32 s92, s85, 0x7840
  buffer_load_dwordx4 v16, s[8:11], s92 offen offset:2048 lds
  s_add_u32 s92, s85, 0xb440
  buffer_load_dwordx4 v16, s[8:11], s92 offen offset:3072 lds
  s_waitcnt vmcnt(28)
  ds_read_b64_tr_b16 a[144:145], v17 offset:4096
  ds_read_b64_tr_b16 a[146:147], v17 offset:5120
  ds_read_b64_tr_b16 a[152:153], v17 offset:4104
  ds_read_b64_tr_b16 a[154:155], v17 offset:5128
  ds_read_b64_tr_b16 a[148:149], v17 offset:6144
  ds_read_b64_tr_b16 a[150:151], v17 offset:7168
  ds_read_b64_tr_b16 a[156:157], v17 offset:6152
  ds_read_b64_tr_b16 a[158:159], v17 offset:7176
  s_waitcnt lgkmcnt(0)
  s_add_u32 m0, s48, 4096
  s_add_u32 s92, s85, 0x10000
  buffer_load_dwordx4 v16, s[8:11], s92 offen offset:0 lds
  s_add_u32 s92, s85, 0x13c00
  buffer_load_dwordx4 v16, s[8:11], s92 offen offset:1024 lds
  s_add_u32 s92, s85, 0x17800
  buffer_load_dwordx4 v16, s[8:11], s92 offen offset:2048 lds
  s_add_u32 s92, s85, 0x1b400
  buffer_load_dwordx4 v16, s[8:11], s92 offen offset:3072 lds
  s_waitcnt vmcnt(28)
  ds_read_b64_tr_b16 a[160:161], v17 offset:8192
  ds_read_b64_tr_b16 a[162:163], v17 offset:9216
  ds_read_b64_tr_b16 a[168:169], v17 offset:8200
  ds_read_b64_tr_b16 a[170:171], v17 offset:9224
  ds_read_b64_tr_b16 a[164:165], v17 offset:10240
  ds_read_b64_tr_b16 a[166:167], v17 offset:11264
  ds_read_b64_tr_b16 a[172:173], v17 offset:10248
  ds_read_b64_tr_b16 a[174:175], v17 offset:11272
  s_waitcnt lgkmcnt(0)
  s_add_u32 m0, s48, 8192
  s_add_u32 s92, s86, 0x0
  buffer_load_dwordx4 v16, s[8:11], s92 offen offset:0 lds
  s_add_u32 s92, s86, 0x3c00
  buffer_load_dwordx4 v16, s[8:11], s92 offen offset:1024 lds
  s_add_u32 s92, s86, 0x7800
  buffer_load_dwordx4 v16, s[8:11], s92 offen offset:2048 lds
  s_add_u32 s92, s86, 0xb400
  buffer_load_dwordx4 v16, s[8:11], s92 offen offset:3072 lds
  s_waitcnt vmcnt(28)
  ds_read_b64_tr_b16 a[176:177], v17 offset:12288
  ds_read_b64_tr_b16 a[178:179], v17 offset:13312
  ds_read_b64_tr_b16 a[184:185], v17 offset:12296
  ds_read_b64_tr_b16 a[186:187], v17 offset:13320
  ds_read_b64_tr_b16 a[180:181], v17 offset:14336
  ds_read_b64_tr_b16 a[182:183], v17 offset:15360
  ds_read_b64_tr_b16 a[188:189], v17 offset:14344
  ds_read_b64_tr_b16 a[190:191], v17 offset:15368
  s_waitcnt lgkmcnt(0)
  s_add_u32 m0, s48, 12288
  s_add_u32 s92, s86, 0x40
  buffer_load_dwordx4 v16, s[8:11], s92 offen offset:0 lds
  s_add_u32 s92, s86, 0x3c40
  buffer_load_dwordx4 v16, s[8:11], s92 offen offset:1024 lds
  s_add_u32 s92, s86, 0x7840
  buffer_load_dwordx4 v16, s[8:11], s92 offen offset:2048 lds
  s_add_u32 s92, s86, 0xb440
  buffer_load_dwordx4 v16, s[8:11], s92 offen offset:3072 lds
  s_waitcnt vmcnt(28)
  ds_read_b64_tr_b16 a[192:193], v17 offset:16384
  ds_read_b64_tr_b16 a[194:195], v17 offset:17408
  ds_read_b64_tr_b16 a[200:201], v17 offset:16392
  ds_read_b64_tr_b16 a[202:203], v17 offset:17416
  ds_read_b64_tr_b16 a[196:197], v17 offset:18432
  ds_read_b64_tr_b16 a[198:199], v17 offset:19456
  ds_read_b64_tr_b16 a[204:205], v17 offset:18440
  ds_read_b64_tr_b16 a[206:207], v17 offset:19464
  s_waitcnt lgkmcnt(0)
  s_add_u32 m0, s48, 16384
  s_add_u32 s92, s86, 0x10000
  buffer_load_dwordx4 v16, s[8:11], s92 offen offset:0 lds
  s_add_u32 s92, s86, 0x13c00
  buffer_load_dwordx4 v16, s[8:11], s92 offen offset:1024 lds
  s_add_u32 s92, s86, 0x17800
  buffer_load_dwordx4 v16, s[8:11], s92 offen offset:2048 lds
  s_add_u32 s92, s86, 0x1b400
  buffer_load_dwordx4 v16, s[8:11], s92 offen offset:3072 lds
  s_waitcnt vmcnt(28)
  ds_read_b64_tr_b16 a[208:209], v17 offset:20480
  ds_read_b64_tr_b16 a[210:211], v17 offset:21504
  ds_read_b64_tr_b16 a[216:217], v17 offset:20488
  ds_read_b64_tr_b16 a[218:219], v17 offset:21512
  ds_read_b64_tr_b16 a[212:213], v17 offset:22528
  ds_read_b64_tr_b16 a[214:215], v17 offset:23552
  ds_read_b64_tr_b16 a[220:221], v17 offset:22536
  ds_read_b64_tr_b16 a[222:223], v17 offset:23560
  s_waitcnt lgkmcnt(0)
  s_add_u32 m0, s48, 20480
  s_add_u32 s92, s87, 0x0
  buffer_load_dwordx4 v16, s[8:11], s92 offen offset:0 lds
  s_add_u32 s92, s87, 0x3c00
  buffer_load_dwordx4 v16, s[8:11], s92 offen offset:1024 lds
  s_add_u32 s92, s87, 0x7800
  buffer_load_dwordx4 v16, s[8:11], s92 offen offset:2048 lds
  s_add_u32 s92, s87, 0xb400
  buffer_load_dwordx4 v16, s[8:11], s92 offen offset:3072 lds
  s_waitcnt vmcnt(28)
  ds_read_b64_tr_b16 a[224:225], v17 offset:24576
  ds_read_b64_tr_b16 a[226:227], v17 offset:25600
  ds_read_b64_tr_b16 a[232:233], v17 offset:24584
  ds_read_b64_tr_b16 a[234:235], v17 offset:25608
  ds_read_b64_tr_b16 a[228:229], v17 offset:26624
  ds_read_b64_tr_b16 a[230:231], v17 offset:27648
  ds_read_b64_tr_b16 a[236:237], v17 offset:26632
  ds_read_b64_tr_b16 a[238:239], v17 offset:27656
  s_waitcnt lgkmcnt(0)
  s_add_u32 m0, s48, 24576
  s_add_u32 s92, s87, 0x40
  buffer_load_dwordx4 v16, s[8:11], s92 offen offset:0 lds
  s_add_u32 s92, s87, 0x3c40
  buffer_load_dwordx4 v16, s[8:11], s92 offen offset:1024 lds
  s_add_u32 s92, s87, 0x7840
  buffer_load_dwordx4 v16, s[8:11], s92 offen offset:2048 lds
  s_add_u32 s92, s87, 0xb440
  buffer_load_dwordx4 v16, s[8:11], s92 offen offset:3072 lds
  s_waitcnt vmcnt(28)
  ds_read_b64_tr_b16 a[240:241], v17 offset:28672
  ds_read_b64_tr_b16 a[242:243], v17 offset:29696
  ds_read_b64_tr_b16 a[248:249], v17 offset:28680
  ds_read_b64_tr_b16 a[250:251], v17 offset:29704
  ds_read_b64_tr_b16 a[244:245], v17 offset:30720
  ds_read_b64_tr_b16 a[246:247], v17 offset:31744
  ds_read_b64_tr_b16 a[252:253], v17 offset:30728
  ds_read_b64_tr_b16 a[254:255], v17 offset:31752
  s_waitcnt lgkmcnt(0)
  s_add_u32 m0, s48, 28672
  s_add_u32 s92, s87, 0x10000
  buffer_load_dwordx4 v16, s[8:11], s92 offen offset:0 lds
  s_add_u32 s92, s87, 0x13c00
  buffer_load_dwordx4 v16, s[8:11], s92 offen offset:1024 lds
  s_add_u32 s92, s87, 0x17800
  buffer_load_dwordx4 v16, s[8:11], s92 offen offset:2048 lds
  s_add_u32 s92, s87, 0x1b400
  buffer_load_dwordx4 v16, s[8:11], s92 offen offset:3072 lds
  s_waitcnt vmcnt(28)
  ds_read_b64_tr_b16 v[128:129], v17 offset:0
  ds_read_b64_tr_b16 v[130:131], v17 offset:1024
  ds_read_b64_tr_b16 v[136:137], v17 offset:8
  ds_read_b64_tr_b16 v[138:139], v17 offset:1032
  ds_read_b64_tr_b16 v[132:133], v17 offset:2048
  ds_read_b64_tr_b16 v[134:135], v17 offset:3072
  ds_read_b64_tr_b16 v[140:141], v17 offset:2056
  ds_read_b64_tr_b16 v[142:143], v17 offset:3080
  s_waitcnt lgkmcnt(0)
  s_add_u32 m0, s48, 0
  s_add_u32 s92, s80, 0x10040
  buffer_load_dwordx4 v16, s[8:11], s92 offen offset:0 lds
  s_add_u32 s92, s80, 0x13c40
  buffer_load_dwordx4 v16, s[8:11], s92 offen offset:1024 lds
  s_add_u32 s92, s80, 0x17840
  buffer_load_dwordx4 v16, s[8:11], s92 offen offset:2048 lds
  s_add_u32 s92, s80, 0x1b440
  buffer_load_dwordx4 v16, s[8:11], s92 offen offset:3072 lds
  s_waitcnt vmcnt(28)
  ds_read_b64_tr_b16 v[144:145], v17 offset:4096
  ds_read_b64_tr_b16 v[146:147], v17 offset:5120
  ds_read_b64_tr_b16 v[152:153], v17 offset:4104
  ds_read_b64_tr_b16 v[154:155], v17 offset:5128
  ds_read_b64_tr_b16 v[148:149], v17 offset:6144
  ds_read_b64_tr_b16 v[150:151], v17 offset:7168
  ds_read_b64_tr_b16 v[156:157], v17 offset:6152
  ds_read_b64_tr_b16 v[158:159], v17 offset:7176
  s_waitcnt lgkmcnt(0)
  s_add_u32 m0, s48, 4096
  s_add_u32 s92, s81, 0x10040
  buffer_load_dwordx4 v16, s[8:11], s92 offen offset:0 lds
  s_add_u32 s92, s81, 0x13c40
  buffer_load_dwordx4 v16, s[8:11], s92 offen offset:1024 lds
  s_add_u32 s92, s81, 0x17840
  buffer_load_dwordx4 v16, s[8:11], s92 offen offset:2048 lds
  s_add_u32 s92, s81, 0x1b440
  buffer_load_dwordx4 v16, s[8:11], s92 offen offset:3072 lds
  s_waitcnt vmcnt(28)
  ds_read_b64_tr_b16 v[160:161], v17 offset:8192
  ds_read_b64_tr_b16 v[162:163], v17 offset:9216
  ds_read_b64_tr_b16 v[168:169], v17 offset:8200
  ds_read_b64_tr_b16 v[170:171], v17 offset:9224
  ds_read_b64_tr_b16 v[164:165], v17 offset:10240
  ds_read_b64_tr_b16 v[166:167], v17 offset:11264
  ds_read_b64_tr_b16 v[172:173], v17 offset:10248
  ds_read_b64_tr_b16 v[174:175], v17 offset:11272
  s_waitcnt lgkmcnt(0)
  s_add_u32 m0, s48, 8192
  s_add_u32 s92, s82, 0x10040
  buffer_load_dwordx4 v16, s[8:11], s92 offen offset:0 lds
  s_add_u32 s92, s82, 0x13c40
  buffer_load_dwordx4 v16, s[8:11], s92 offen offset:1024 lds
  s_add_u32 s92, s82, 0x17840
  buffer_load_dwordx4 v16, s[8:11], s92 offen offset:2048 lds
  s_add_u32 s92, s82, 0x1b440
  buffer_load_dwordx4 v16, s[8:11], s92 offen offset:3072 lds
  s_waitcnt vmcnt(28)
  ds_read_b64_tr_b16 v[176:177], v17 offset:12288
  ds_read_b64_tr_b16 v[178:179], v17 offset:13312
  ds_read_b64_tr_b16 v[184:185], v17 offset:12296
  ds_read_b64_tr_b16 v[186:187], v17 offset:13320
  ds_read_b64_tr_b16 v[180:181], v17 offset:14336
  ds_read_b64_tr_b16 v[182:183], v17 offset:15360
  ds_read_b64_tr_b16 v[188:189], v17 offset:14344
  ds_read_b64_tr_b16 v[190:191], v17 offset:15368
  s_waitcnt lgkmcnt(0)
  s_add_u32 m0, s48, 12288
  s_add_u32 s92, s83, 0x10040
  buffer_load_dwordx4 v16, s[8:11], s92 offen offset:0 lds
  s_add_u32 s92, s83, 0x13c40
  buffer_load_dwordx4 v16, s[8:11], s92 offen offset:1024 lds
  s_add_u32 s92, s83, 0x17840
  buffer_load_dwordx4 v16, s[8:11], s92 offen offset:2048 lds
  s_add_u32 s92, s83, 0x1b440
  buffer_load_dwordx4 v16, s[8:11], s92 offen offset:3072 lds
  s_waitcnt vmcnt(28)
  ds_read_b64_tr_b16 v[192:193], v17 offset:16384
  ds_read_b64_tr_b16 v[194:195], v17 offset:17408
  ds_read_b64_tr_b16 v[200:201], v17 offset:16392
  ds_read_b64_tr_b16 v[202:203], v17 offset:17416
  ds_read_b64_tr_b16 v[196:197], v17 offset:18432
  ds_read_b64_tr_b16 v[198:199], v17 offset:19456
  ds_read_b64_tr_b16 v[204:205], v17 offset:18440
  ds_read_b64_tr_b16 v[206:207], v17 offset:19464
  s_waitcnt lgkmcnt(0)
  s_add_u32 m0, s48, 16384
  s_add_u32 s92, s84, 0x10040
  buffer_load_dwordx4 v16, s[8:11], s92 offen offset:0 lds
  s_add_u32 s92, s84, 0x13c40
  buffer_load_dwordx4 v16, s[8:11], s92 offen offset:1024 lds
  s_add_u32 s92, s84, 0x17840
  buffer_load_dwordx4 v16, s[8:11], s92 offen offset:2048 lds
  s_add_u32 s92, s84, 0x1b440
  buffer_load_dwordx4 v16, s[8:11], s92 offen offset:3072 lds
  s_waitcnt vmcnt(28)
  ds_read_b64_tr_b16 v[208:209], v17 offset:20480
  ds_read_b64_tr_b16 v[210:211], v17 offset:21504
  ds_read_b64_tr_b16 v[216:217], v17 offset:20488
  ds_read_b64_tr_b16 v[218:219], v17 offset:21512
  ds_read_b64_tr_b16 v[212:213], v17 offset:22528
  ds_read_b64_tr_b16 v[214:215], v17 offset:23552
  ds_read_b64_tr_b16 v[220:221], v17 offset:22536
  ds_read_b64_tr_b16 v[222:223], v17 offset:23560
  s_waitcnt lgkmcnt(0)
  s_add_u32 m0, s48, 20480
  s_add_u32 s92, s85, 0x10040
  buffer_load_dwordx4 v16, s[8:11], s92 offen offset:0 lds
  s_add_u32 s92, s85, 0x13c40
  buffer_load_dwordx4 v16, s[8:11], s92 offen offset:1024 lds
  s_add_u32 s92, s85, 0x17840
  buffer_load_dwordx4 v16, s[8:11], s92 offen offset:2048 lds
  s_add_u32 s92, s85, 0x1b440
  buffer_load_dwordx4 v16, s[8:11], s92 offen offset:3072 lds
  s_waitcnt vmcnt(28)
  ds_read_b64_tr_b16 v[224:225], v17 offset:24576
  ds_read_b64_tr_b16 v[226:227], v17 offset:25600
  ds_read_b64_tr_b16 v[232:233], v17 offset:24584
  ds_read_b64_tr_b16 v[234:235], v17 offset:25608
  ds_read_b64_tr_b16 v[228:229], v17 offset:26624
  ds_read_b64_tr_b16 v[230:231], v17 offset:27648
  ds_read_b64_tr_b16 v[236:237], v17 offset:26632
  ds_read_b64_tr_b16 v[238:239], v17 offset:27656
  s_waitcnt lgkmcnt(0)
  s_add_u32 m0, s48, 24576
  s_add_u32 s92, s86, 0x10040
  buffer_load_dwordx4 v16, s[8:11], s92 offen offset:0 lds
  s_add_u32 s92, s86, 0x13c40
  buffer_load_dwordx4 v16, s[8:11], s92 offen offset:1024 lds
  s_add_u32 s92, s86, 0x17840
  buffer_load_dwordx4 v16, s[8:11], s92 offen offset:2048 lds
  s_add_u32 s92, s86, 0x1b440
  buffer_load_dwordx4 v16, s[8:11], s92 offen offset:3072 lds
  s_waitcnt vmcnt(28)
  ds_read_b64_tr_b16 v[240:241], v17 offset:28672
  ds_read_b64_tr_b16 v[242:243], v17 offset:29696
  ds_read_b64_tr_b16 v[248:249], v17 offset:28680
  ds_read_b64_tr_b16 v[250:251], v17 offset:29704
  ds_read_b64_tr_b16 v[244:245], v17 offset:30720
  ds_read_b64_tr_b16 v[246:247], v17 offset:31744
  ds_read_b64_tr_b16 v[252:253], v17 offset:30728
  ds_read_b64_tr_b16 v[254:255], v17 offset:31752
  s_waitcnt lgkmcnt(0)
  s_add_u32 m0, s48, 28672
  s_add_u32 s92, s87, 0x10040
  buffer_load_dwordx4 v16, s[8:11], s92 offen offset:0 lds
  s_add_u32 s92, s87, 0x13c40
  buffer_load_dwordx4 v16, s[8:11], s92 offen offset:1024 lds
  s_add_u32 s92, s87, 0x17840
  buffer_load_dwordx4 v16, s[8:11], s92 offen offset:2048 lds
  s_add_u32 s92, s87, 0x1b440
  buffer_load_dwordx4 v16, s[8:11], s92 offen offset:3072 lds
  s_waitcnt vmcnt(28)
  ds_read_b64_tr_b16 v[24:25], v17 offset:0
  ds_read_b64_tr_b16 v[26:27], v17 offset:1024
  ds_read_b64_tr_b16 v[32:33], v17 offset:8
  ds_read_b64_tr_b16 v[34:35], v17 offset:1032
  ds_read_b64_tr_b16 v[28:29], v17 offset:2048
  ds_read_b64_tr_b16 v[30:31], v17 offset:3072
  ds_read_b64_tr_b16 v[36:37], v17 offset:2056
  ds_read_b64_tr_b16 v[38:39], v17 offset:3080
  s_waitcnt lgkmcnt(0)
  ds_write_b128 v21, v[24:27] offset:0
  ds_write_b128 v21, v[28:31] offset:1024
  ds_write_b128 v21, v[32:35] offset:2048
  ds_write_b128 v21, v[36:39] offset:3072
  s_waitcnt vmcnt(24)
  ds_read_b64_tr_b16 v[24:25], v17 offset:4096
  ds_read_b64_tr_b16 v[26:27], v17 offset:5120
  ds_read_b64_tr_b16 v[32:33], v17 offset:4104
  ds_read_b64_tr_b16 v[34:35], v17 offset:5128
  ds_read_b64_tr_b16 v[28:29], v17 offset:6144
  ds_read_b64_tr_b16 v[30:31], v17 offset:7168
  ds_read_b64_tr_b16 v[36:37], v17 offset:6152
  ds_read_b64_tr_b16 v[38:39], v17 offset:7176
  s_waitcnt lgkmcnt(0)
  ds_write_b128 v21, v[24:27] offset:4096
  ds_write_b128 v21, v[28:31] offset:5120
  ds_write_b128 v21, v[32:35] offset:6144
  ds_write_b128 v21, v[36:39] offset:7168
  s_waitcnt vmcnt(20)
  ds_read_b64_tr_b16 v[24:25], v17 offset:8192
  ds_read_b64_tr_b16 v[26:27], v17 offset:9216
  ds_read_b64_tr_b16 v[32:33], v17 offset:8200
  ds_read_b64_tr_b16 v[34:35], v17 offset:9224
  ds_read_b64_tr_b16 v[28:29], v17 offset:10240
  ds_read_b64_tr_b16 v[30:31], v17 offset:11264
  ds_read_b64_tr_b16 v[36:37], v17 offset:10248
  ds_read_b64_tr_b16 v[38:39], v17 offset:11272
  s_waitcnt lgkmcnt(0)
  ds_write_b128 v21, v[24:27] offset:8192
  ds_write_b128 v21, v[28:31] offset:9216
  ds_write_b128 v21, v[32:35] offset:10240
  ds_write_b128 v21, v[36:39] offset:11264
  s_waitcnt vmcnt(16)
  ds_read_b64_tr_b16 v[24:25], v17 offset:12288
  ds_read_b64_tr_b16 v[26:27], v17 offset:13312
  ds_read_b64_tr_b16 v[32:33], v17 offset:12296
  ds_read_b64_tr_b16 v[34:35], v17 offset:13320
  ds_read_b64_tr_b16 v[28:29], v17 offset:14336
  ds_read_b64_tr_b16 v[30:31], v17 offset:15360
  ds_read_b64_tr_b16 v[36:37], v17 offset:14344
  ds_read_b64_tr_b16 v[38:39], v17 offset:15368
  s_waitcnt lgkmcnt(0)
  ds_write_b128 v21, v[24:27] offset:12288
  ds_write_b128 v21, v[28:31] offset:13312
  ds_write_b128 v21, v[32:35] offset:14336
  ds_write_b128 v21, v[36:39] offset:15360
  s_waitcnt vmcnt(12)
  ds_read_b64_tr_b16 v[24:25], v17 offset:16384
  ds_read_b64_tr_b16 v[26:27], v17 offset:17408
  ds_read_b64_tr_b16 v[32:33], v17 offset:16392
  ds_read_b64_tr_b16 v[34:35], v17 offset:17416
  ds_read_b64_tr_b16 v[28:29], v17 offset:18432
  ds_read_b64_tr_b16 v[30:31], v17 offset:19456
  ds_read_b64_tr_b16 v[36:37], v17 offset:18440
  ds_read_b64_tr_b16 v[38:39], v17 offset:19464
  s_waitcnt lgkmcnt(0)
  ds_write_b128 v21, v[24:27] offset:16384
  ds_write_b128 v21, v[28:31] offset:17408
  ds_write_b128 v21, v[32:35] offset:18432
  ds_write_b128 v21, v[36:39] offset:19456
  s_waitcnt vmcnt(8)
  ds_read_b64_tr_b16 v[24:25], v17 offset:20480
  ds_read_b64_tr_b16 v[26:27], v17 offset:21504
  ds_read_b64_tr_b16 v[32:33], v17 offset:20488
  ds_read_b64_tr_b16 v[34:35], v17 offset:21512
  ds_read_b64_tr_b16 v[28:29], v17 offset:22528
  ds_read_b64_tr_b16 v[30:31], v17 offset:23552
  ds_read_b64_tr_b16 v[36:37], v17 offset:22536
  ds_read_b64_tr_b16 v[38:39], v17 offset:23560
  s_waitcnt lgkmcnt(0)
  ds_write_b128 v21, v[24:27] offset:20480
  ds_write_b128 v21, v[28:31] offset:21504
  ds_write_b128 v21, v[32:35] offset:22528
  ds_write_b128 v21, v[36:39] offset:23552
  s_waitcnt vmcnt(4)
  ds_read_b64_tr_b16 v[24:25], v17 offset:24576
  ds_read_b64_tr_b16 v[26:27], v17 offset:25600
  ds_read_b64_tr_b16 v[32:33], v17 offset:24584
  ds_read_b64_tr_b16 v[34:35], v17 offset:25608
  ds_read_b64_tr_b16 v[28:29], v17 offset:26624
  ds_read_b64_tr_b16 v[30:31], v17 offset:27648
  ds_read_b64_tr_b16 v[36:37], v17 offset:26632
  ds_read_b64_tr_b16 v[38:39], v17 offset:27656
  s_waitcnt lgkmcnt(0)
  ds_write_b128 v21, v[24:27] offset:24576
  ds_write_b128 v21, v[28:31] offset:25600
  ds_write_b128 v21, v[32:35] offset:26624
  ds_write_b128 v21, v[36:39] offset:27648
  s_waitcnt vmcnt(0)
  ds_read_b64_tr_b16 v[24:25], v17 offset:28672
  ds_read_b64_tr_b16 v[26:27], v17 offset:29696
  ds_read_b64_tr_b16 v[32:33], v17 offset:28680
  ds_read_b64_tr_b16 v[34:35], v17 offset:29704
  ds_read_b64_tr_b16 v[28:29], v17 offset:30720
  ds_read_b64_tr_b16 v[30:31], v17 offset:31744
  ds_read_b64_tr_b16 v[36:37], v17 offset:30728
  ds_read_b64_tr_b16 v[38:39], v17 offset:31752
  s_waitcnt lgkmcnt(0)
  ds_write_b128 v21, v[24:27] offset:28672
  ds_write_b128 v21, v[28:31] offset:29696
  ds_write_b128 v21, v[32:35] offset:30720
  ds_write_b128 v21, v[36:39] offset:31744
  s_waitcnt lgkmcnt(0)
  s_barrier
  v_and_b32 v2, 7, v0
  v_lshlrev_b32 v2, 7, v2
  s_lshl_b32 s92, s44, 10
  v_add_u32 v2, s92, v2
  v_mov_b32 v3, 1
  v_add_u32 v11, s48, v1
  v_and_b32 v4, 15, v0
  v_lshlrev_b32 v7, 10, v4
  v_lshrrev_b32 v8, 4, v0
  v_lshl_add_u32 v7, v8, 4, v7
  v_lshlrev_b32 v4, 3, v4
  s_mul_i32 s92, s44, 4096
  s_add_u32 s92, s92, 131072
  v_add_u32 v5, s92, v1
  s_and_b32 s93, s44, 1
  s_lshl_b32 s94, s93, 11
  s_lshr_b32 s95, s44, 1
  s_lshl_b32 s95, s95, 3
  v_and_b32 v4, 7, v0
  v_add_u32 v4, s95, v4
  v_lshl_add_u32 v7, v8, 4, v4
  v_lshlrev_b32 v7, 4, v7
  v_bfe_u32 v8, v0, 3, 1
  v_lshl_add_u32 v9, v8, 10, v7
  v_lshl_add_u32 v7, v8, 3, v7
  v_lshlrev_b32 v4, 3, v4
  s_add_u32 s94, s94, 131072
  v_add_u32 v6, s94, v9
  s_lshl_b32 s66, s56, 1
  s_add_u32 s66, s66, s93
  s_mov_b32 s58, 0
  s_mov_b32 s59, 0
W_INIT:
  s_lshl_b32 s92, s55, 7
  s_add_u32 s92, s92, s58
  s_mul_i32 s92, s92, 36864
  s_lshl_b32 s93, s60, 4
  s_add_u32 s93, s93, s66
  s_lshl_b32 s93, s93, 10
  s_add_u32 s62, s92, s93
  s_add_u32 s62, s62, 0x400000
  s_add_u32 s63, s62, 2359296
  s_lshl_b32 s64, s66, 8
  s_lshl_b32 s93, s60, 7
  s_add_u32 s64, s64, s93
  s_add_u32 s64, s64, s92
  s_add_u32 s64, s64, 0x648000
  s_lshl_b32 s65, s66, 1
  s_add_u32 s65, s65, s60
  s_lshl_b32 s65, s65, 1
  s_lshr_b32 s93, s44, 1
  s_add_u32 s65, s65, s93
  s_lshl_b32 s65, s65, 7
  s_lshl_b32 s94, s55, 6
  s_add_u32 s94, s94, s58
  s_lshl_b32 s93, s94, 13
  s_add_u32 s65, s65, s93
  s_add_u32 s65, s65, 0xc200000
  s_lshl_b32 s61, s55, 6
  s_add_u32 s61, s61, s58
  s_mul_i32 s61, s61, 262144
  s_mul_i32 s93, s44, 32768
  s_add_u32 s61, s61, s93
  s_add_u32 s61, s61, 0x2000000
  s_lshl_b32 s93, s60, 17
  s_add_u32 s61, s61, s93
  s_lshl_b32 s67, s94, 12
  s_add_u32 s67, s67, 0xc100000
  s_lshl_b32 s70, s45, 7
  s_add_u32 s70, s70, 0x80000
W_WAIT:
  buffer_load_dword v8, v2, s[4:7], s67 offen sc1
  s_waitcnt vmcnt(0)
  v_cmp_eq_u32 vcc, 0, v8
  s_mov_b64 exec, 1
  buffer_store_dword v3, off, s[4:7], s70 sc1
  s_mov_b64 exec, -1
  s_cbranch_vccz polld_2332
  s_mov_b32 s101, 0
poll_2331:
  s_add_u32 s47, s47, 1
  s_mov_b32 s49, 3
  s_cmp_gt_u32 s47, 131072
  s_cbranch_scc1 TIMEOUT
  s_sleep 3
  buffer_load_dword v8, v2, s[4:7], s67 offen sc1
  s_waitcnt vmcnt(0)
  v_cmp_eq_u32 vcc, 0, v8
  s_nop 0
  s_cbranch_vccnz poll_2331
polld_2332:
  s_add_u32 s69, s61, s72
  buffer_load_dwordx4 v[64:67], v1, s[4:7], s69 offen offset:0 sc1
  buffer_load_dwordx4 v[68:71], v1, s[4:7], s69 offen offset:1024 sc1
  buffer_load_dwordx4 v[72:75], v1, s[4:7], s69 offen offset:2048 sc1
  buffer_load_dwordx4 v[76:79], v1, s[4:7], s69 offen offset:3072 sc1
  s_add_u32 s69, s61, s73
  buffer_load_dwordx4 v[80:83], v1, s[4:7], s69 offen offset:0 sc1
  buffer_load_dwordx4 v[84:87], v1, s[4:7], s69 offen offset:1024 sc1
  buffer_load_dwordx4 v[88:91], v1, s[4:7], s69 offen offset:2048 sc1
  buffer_load_dwordx4 v[92:95], v1, s[4:7], s69 offen offset:3072 sc1
  s_add_u32 s69, s61, s74
  buffer_load_dwordx4 v[96:99], v1, s[4:7], s69 offen offset:0 sc1
  buffer_load_dwordx4 v[100:103], v1, s[4:7], s69 offen offset:1024 sc1
  buffer_load_dwordx4 v[104:107], v1, s[4:7], s69 offen offset:2048 sc1
  buffer_load_dwordx4 v[108:111], v1, s[4:7], s69 offen offset:3072 sc1
  s_add_u32 s69, s61, s75
  buffer_load_dwordx4 v[112:115], v1, s[4:7], s69 offen offset:0 sc1
  buffer_load_dwordx4 v[116:119], v1, s[4:7], s69 offen offset:1024 sc1
  buffer_load_dwordx4 v[120:123], v1, s[4:7], s69 offen offset:2048 sc1
  buffer_load_dwordx4 v[124:127], v1, s[4:7], s69 offen offset:3072 sc1
  v_mov_b32 v10, 0
W_LOOP:
  buffer_load_dwordx2 v[12:13], v7, s[4:7], s62 offen sc1
  s_mul_i32 s93, s55, s58
  s_cmp_ge_u32 s93, 56
  s_cselect_b32 s52, 2, 1
  s_lshl_b32 s53, s52, 12
  s_add_u32 s53, s53, s67
  buffer_load_dword v10, v2, s[4:7], s53 offen sc1
  s_mul_i32 s89, s52, 262144
  s_add_u32 s89, s89, s61
  s_mul_i32 s92, s59, 16384
  v_add_u32 v8, s92, v5
  s_add_u32 s58, s58, s52
  s_mul_i32 s90, s52, 36864
  ds_read_b128 v[32:35], v11 offset:0
  ds_read_b128 v[36:39], v11 offset:1024
  ds_read_b128 v[40:43], v11 offset:2048
  ds_read_b128 v[44:47], v11 offset:3072
  ds_read_b128 v[48:51], v11 offset:4096
  ds_read_b128 v[52:55], v11 offset:5120
  ds_read_b128 v[56:59], v11 offset:6144
  ds_read_b128 v[60:63], v11 offset:7168
  s_waitcnt vmcnt(17)
  v_mfma_f32_16x16x32_bf16 v[16:19], a[0:3], v[64:67], 0
  v_mfma_f32_16x16x32_bf16 v[20:23], a[8:11], v[64:67], 0
  v_mfma_f32_16x16x32_bf16 v[24:27], a[16:19], v[64:67], 0
  v_mfma_f32_16x16x32_bf16 v[28:31], a[24:27], v[64:67], 0
  s_waitcnt vmcnt(16)
  v_mfma_f32_16x16x32_bf16 v[16:19], a[4:7], v[68:71], v[16:19]
  s_add_u32 s69, s61, s76
  buffer_load_dwordx4 v[64:67], v1, s[4:7], s69 offen offset:0 sc1
  v_mfma_f32_16x16x32_bf16 v[20:23], a[12:15], v[68:71], v[20:23]
  v_mfma_f32_16x16x32_bf16 v[24:27], a[20:23], v[68:71], v[24:27]
  v_mfma_f32_16x16x32_bf16 v[28:31], a[28:31], v[68:71], v[28:31]
  s_waitcnt vmcnt(16)
  v_mfma_f32_16x16x32_bf16 v[16:19], a[32:35], v[72:75], v[16:19]
  buffer_load_dwordx4 v[68:71], v1, s[4:7], s69 offen offset:1024 sc1
  v_mfma_f32_16x16x32_bf16 v[20:23], a[40:43], v[72:75], v[20:23]
  s_waitcnt lgkmcnt(7)
  v_mfma_f32_16x16x32_bf16 v[24:27], v[32:35], v[72:75], v[24:27]
  s_waitcnt lgkmcnt(5)
  v_mfma_f32_16x16x32_bf16 v[28:31], v[40:43], v[72:75], v[28:31]
  s_waitcnt vmcnt(16)
  v_mfma_f32_16x16x32_bf16 v[16:19], a[36:39], v[76:79], v[16:19]
  buffer_load_dwordx4 v[72:75], v1, s[4:7], s69 offen offset:2048 sc1
  v_mfma_f32_16x16x32_bf16 v[20:23], a[44:47], v[76:79], v[20:23]
  v_mfma_f32_16x16x32_bf16 v[24:27], v[36:39], v[76:79], v[24:27]
  s_waitcnt lgkmcnt(4)
  v_mfma_f32_16x16x32_bf16 v[28:31], v[44:47], v[76:79], v[28:31]
  s_waitcnt vmcnt(16)
  ds_read_b128 v[32:35], v11 offset:8192
  ds_read_b128 v[36:39], v11 offset:9216
  v_mfma_f32_16x16x32_bf16 v[16:19], a[48:51], v[80:83], v[16:19]
  ds_read_b128 v[40:43], v11 offset:10240
  buffer_load_dwordx4 v[76:79], v1, s[4:7], s69 offen offset:3072 sc1
  v_mfma_f32_16x16x32_bf16 v[20:23], a[56:59], v[80:83], v[20:23]
  ds_read_b128 v[44:47], v11 offset:11264
  v_mfma_f32_16x16x32_bf16 v[24:27], a[64:67], v[80:83], v[24:27]
  v_mfma_f32_16x16x32_bf16 v[28:31], a[72:75], v[80:83], v[28:31]
  s_waitcnt vmcnt(16)
  v_mfma_f32_16x16x32_bf16 v[16:19], a[52:55], v[84:87], v[16:19]
  s_add_u32 s69, s61, s77
  buffer_load_dwordx4 v[80:83], v1, s[4:7], s69 offen offset:0 sc1
  v_mfma_f32_16x16x32_bf16 v[20:23], a[60:63], v[84:87], v[20:23]
  v_mfma_f32_16x16x32_bf16 v[24:27], a[68:71], v[84:87], v[24:27]
  v_mfma_f32_16x16x32_bf16 v[28:31], a[76:79], v[84:87], v[28:31]
  s_waitcnt vmcnt(16)
  v_mfma_f32_16x16x32_bf16 v[16:19], a[80:83], v[88:91], v[16:19]
  buffer_load_dwordx4 v[84:87], v1, s[4:7], s69 offen offset:1024 sc1
  v_mfma_f32_16x16x32_bf16 v[20:23], a[88:91], v[88:91], v[20:23]
  s_waitcnt lgkmcnt(7)
  v_mfma_f32_16x16x32_bf16 v[24:27], v[48:51], v[88:91], v[24:27]
  s_waitcnt lgkmcnt(5)
  v_mfma_f32_16x16x32_bf16 v[28:31], v[56:59], v[88:91], v[28:31]
  s_waitcnt vmcnt(16)
  v_mfma_f32_16x16x32_bf16 v[16:19], a[84:87], v[92:95], v[16:19]
  buffer_load_dwordx4 v[88:91], v1, s[4:7], s69 offen offset:2048 sc1
  v_mfma_f32_16x16x32_bf16 v[20:23], a[92:95], v[92:95], v[20:23]
  v_mfma_f32_16x16x32_bf16 v[24:27], v[52:55], v[92:95], v[24:27]
  s_waitcnt lgkmcnt(4)
  v_mfma_f32_16x16x32_bf16 v[28:31], v[60:63], v[92:95], v[28:31]
  s_waitcnt vmcnt(16)
  ds_read_b128 v[48:51], v11 offset:12288
  ds_read_b128 v[52:55], v11 offset:13312
  v_mfma_f32_16x16x32_bf16 v[16:19], a[96:99], v[96:99], v[16:19]
  ds_read_b128 v[56:59], v11 offset:14336
  buffer_load_dwordx4 v[92:95], v1, s[4:7], s69 offen offset:3072 sc1
  v_mfma_f32_16x16x32_bf16 v[20:23], a[104:107], v[96:99], v[20:23]
  ds_read_b128 v[60:63], v11 offset:15360
  v_mfma_f32_16x16x32_bf16 v[24:27], a[112:115], v[96:99], v[24:27]
  v_mfma_f32_16x16x32_bf16 v[28:31], a[120:123], v[96:99], v[28:31]
  s_waitcnt vmcnt(16)
  v_mfma_f32_16x16x32_bf16 v[16:19], a[100:103], v[100:103], v[16:19]
  s_add_u32 s69, s61, s78
  buffer_load_dwordx4 v[96:99], v1, s[4:7], s69 offen offset:0 sc1
  v_mfma_f32_16x16x32_bf16 v[20:23], a[108:111], v[100:103], v[20:23]
  v_mfma_f32_16x16x32_bf16 v[24:27], a[116:119], v[100:103], v[24:27]
  v_mfma_f32_16x16x32_bf16 v[28:31], a[124:127], v[100:103], v[28:31]
  s_waitcnt vmcnt(16)
  v_mfma_f32_16x16x32_bf16 v[16:19], a[128:131], v[104:107], v[16:19]
  buffer_load_dwordx4 v[100:103], v1, s[4:7], s69 offen offset:1024 sc1
  v_mfma_f32_16x16x32_bf16 v[20:23], a[136:139], v[104:107], v[20:23]
  s_waitcnt lgkmcnt(7)
  v_mfma_f32_16x16x32_bf16 v[24:27], v[32:35], v[104:107], v[24:27]
  s_waitcnt lgkmcnt(5)
  v_mfma_f32_16x16x32_bf16 v[28:31], v[40:43], v[104:107], v[28:31]
  s_waitcnt vmcnt(16)
  v_mfma_f32_16x16x32_bf16 v[16:19], a[132:135], v[108:111], v[16:19]
  buffer_load_dwordx4 v[104:107], v1, s[4:7], s69 offen offset:2048 sc1
  v_mfma_f32_16x16x32_bf16 v[20:23], a[140:143], v[108:111], v[20:23]
  v_mfma_f32_16x16x32_bf16 v[24:27], v[36:39], v[108:111], v[24:27]
  s_waitcnt lgkmcnt(4)
  v_mfma_f32_16x16x32_bf16 v[28:31], v[44:47], v[108:111], v[28:31]
  s_waitcnt vmcnt(16)
  ds_read_b128 v[32:35], v11 offset:16384
  ds_read_b128 v[36:39], v11 offset:17408
  v_mfma_f32_16x16x32_bf16 v[16:19], a[144:147], v[112:115], v[16:19]
  ds_read_b128 v[40:43], v11 offset:18432
  buffer_load_dwordx4 v[108:111], v1, s[4:7], s69 offen offset:3072 sc1
  v_mfma_f32_16x16x32_bf16 v[20:23], a[152:155], v[112:115], v[20:23]
  ds_read_b128 v[44:47], v11 offset:19456
  v_mfma_f32_16x16x32_bf16 v[24:27], a[160:163], v[112:115], v[24:27]
  v_mfma_f32_16x16x32_bf16 v[28:31], a[168:171], v[112:115], v[28:31]
  s_waitcnt vmcnt(16)
  v_mfma_f32_16x16x32_bf16 v[16:19], a[148:151], v[116:119], v[16:19]
  s_add_u32 s69, s61, s79
  buffer_load_dwordx4 v[112:115], v1, s[4:7], s69 offen offset:0 sc1
  v_mfma_f32_16x16x32_bf16 v[20:23], a[156:159], v[116:119], v[20:23]
  v_mfma_f32_16x16x32_bf16 v[24:27], a[164:167], v[116:119], v[24:27]
  v_mfma_f32_16x16x32_bf16 v[28:31], a[172:175], v[116:119], v[28:31]
  s_waitcnt vmcnt(16)
  v_mfma_f32_16x16x32_bf16 v[16:19], a[176:179], v[120:123], v[16:19]
  buffer_load_dwordx4 v[116:119], v1, s[4:7], s69 offen offset:1024 sc1
  v_mfma_f32_16x16x32_bf16 v[20:23], a[184:187], v[120:123], v[20:23]
  s_waitcnt lgkmcnt(7)
  v_mfma_f32_16x16x32_bf16 v[24:27], v[48:51], v[120:123], v[24:27]
  s_waitcnt lgkmcnt(5)
  v_mfma_f32_16x16x32_bf16 v[28:31], v[56:59], v[120:123], v[28:31]
  s_waitcnt vmcnt(16)
  v_mfma_f32_16x16x32_bf16 v[16:19], a[180:183], v[124:127], v[16:19]
  buffer_load_dwordx4 v[120:123], v1, s[4:7], s69 offen offset:2048 sc1
  v_mfma_f32_16x16x32_bf16 v[20:23], a[188:191], v[124:127], v[20:23]
  v_mfma_f32_16x16x32_bf16 v[24:27], v[52:55], v[124:127], v[24:27]
  s_waitcnt lgkmcnt(4)
  v_mfma_f32_16x16x32_bf16 v[28:31], v[60:63], v[124:127], v[28:31]
  buffer_load_dwordx4 v[124:127], v1, s[4:7], s69 offen offset:3072 sc1
  s_waitcnt vmcnt(16)
  v_cmp_ne_u32 vcc, 0, v10
  s_nop 0
  s_cmp_eq_u64 vcc, -1
  s_cselect_b32 s68, 1, 0
  s_cmp_lt_u32 s58, 64
  s_cselect_b32 s68, s68, 0
  s_cmp_eq_u32 s68, 0
  s_cbranch_scc1 W_PLAIN
  s_waitcnt vmcnt(15)
  v_mfma_f32_16x16x32_bf16 v[16:19], a[192:195], v[64:67], v[16:19]
  ds_read_b128 v[48:51], v11 offset:20480
  ds_read_b128 v[52:55], v11 offset:21504
  v_mfma_f32_16x16x32_bf16 v[20:23], a[200:203], v[64:67], v[20:23]
  ds_read_b128 v[56:59], v11 offset:22528
  ds_read_b128 v[60:63], v11 offset:23552
  v_mfma_f32_16x16x32_bf16 v[24:27], a[208:211], v[64:67], v[24:27]
  v_mfma_f32_16x16x32_bf16 v[28:31], a[216:219], v[64:67], v[28:31]
  s_waitcnt vmcnt(14)
  v_mfma_f32_16x16x32_bf16 v[16:19], a[196:199], v[68:71], v[16:19]
  s_add_u32 s69, s89, s72
  buffer_load_dwordx4 v[64:67], v1, s[4:7], s69 offen offset:0 sc1
  v_mfma_f32_16x16x32_bf16 v[20:23], a[204:207], v[68:71], v[20:23]
  v_mfma_f32_16x16x32_bf16 v[24:27], a[212:215], v[68:71], v[24:27]
  v_mfma_f32_16x16x32_bf16 v[28:31], a[220:223], v[68:71], v[28:31]
  s_waitcnt vmcnt(14)
  v_mfma_f32_16x16x32_bf16 v[16:19], a[224:227], v[72:75], v[16:19]
  buffer_load_dwordx4 v[68:71], v1, s[4:7], s69 offen offset:1024 sc1
  v_mfma_f32_16x16x32_bf16 v[20:23], a[232:235], v[72:75], v[20:23]
  s_waitcnt lgkmcnt(7)
  v_mfma_f32_16x16x32_bf16 v[24:27], v[32:35], v[72:75], v[24:27]
  s_waitcnt lgkmcnt(5)
  v_mfma_f32_16x16x32_bf16 v[28:31], v[40:43], v[72:75], v[28:31]
  s_waitcnt vmcnt(14)
  v_mfma_f32_16x16x32_bf16 v[16:19], a[228:231], v[76:79], v[16:19]
  buffer_load_dwordx4 v[72:75], v1, s[4:7], s69 offen offset:2048 sc1
  v_mfma_f32_16x16x32_bf16 v[20:23], a[236:239], v[76:79], v[20:23]
  v_mfma_f32_16x16x32_bf16 v[24:27], v[36:39], v[76:79], v[24:27]
  s_waitcnt lgkmcnt(4)
  v_mfma_f32_16x16x32_bf16 v[28:31], v[44:47], v[76:79], v[28:31]
  s_waitcnt vmcnt(14)
  ds_read_b128 v[32:35], v11 offset:24576
  ds_read_b128 v[36:39], v11 offset:25600
  v_mfma_f32_16x16x32_bf16 v[16:19], a[240:243], v[80:83], v[16:19]
  ds_read_b128 v[40:43], v11 offset:26624
  buffer_load_dwordx4 v[76:79], v1, s[4:7], s69 offen offset:3072 sc1
  v_mfma_f32_16x16x32_bf16 v[20:23], a[248:251], v[80:83], v[20:23]
  ds_read_b128 v[44:47], v11 offset:27648
  v_mfma_f32_16x16x32_bf16 v[24:27], v[128:131], v[80:83], v[24:27]
  v_mfma_f32_16x16x32_bf16 v[28:31], v[136:139], v[80:83], v[28:31]
  s_waitcnt vmcnt(14)
  buffer_load_dword v9, v2, s[4:7], s53 offen sc1
  v_mfma_f32_16x16x32_bf16 v[16:19], a[244:247], v[84:87], v[16:19]
  s_add_u32 s69, s89, s73
  buffer_load_dwordx4 v[80:83], v1, s[4:7], s69 offen offset:0 sc1
  v_mfma_f32_16x16x32_bf16 v[20:23], a[252:255], v[84:87], v[20:23]
  v_mfma_f32_16x16x32_bf16 v[24:27], v[132:135], v[84:87], v[24:27]
  v_mfma_f32_16x16x32_bf16 v[28:31], v[140:143], v[84:87], v[28:31]
  s_waitcnt vmcnt(15)
  v_mfma_f32_16x16x32_bf16 v[16:19], v[144:147], v[88:91], v[16:19]
  buffer_load_dwordx4 v[84:87], v1, s[4:7], s69 offen offset:1024 sc1
  v_mfma_f32_16x16x32_bf16 v[20:23], v[152:155], v[88:91], v[20:23]
  s_mov_b64 exec, 1
  buffer_store_dword v3, off, s[4:7], s70 sc1
  s_mov_b64 exec, -1
  s_waitcnt lgkmcnt(7)
  v_mfma_f32_16x16x32_bf16 v[24:27], v[48:51], v[88:91], v[24:27]
  s_waitcnt lgkmcnt(5)
  v_mfma_f32_16x16x32_bf16 v[28:31], v[56:59], v[88:91], v[28:31]
  s_waitcnt vmcnt(16)
  v_mfma_f32_16x16x32_bf16 v[16:19], v[148:151], v[92:95], v[16:19]
  buffer_load_dwordx4 v[88:91], v1, s[4:7], s69 offen offset:2048 sc1
  v_mfma_f32_16x16x32_bf16 v[20:23], v[156:159], v[92:95], v[20:23]
  v_mfma_f32_16x16x32_bf16 v[24:27], v[52:55], v[92:95], v[24:27]
  s_waitcnt lgkmcnt(4)
  v_mfma_f32_16x16x32_bf16 v[28:31], v[60:63], v[92:95], v[28:31]
  s_waitcnt vmcnt(16)
  ds_read_b128 v[48:51], v11 offset:28672
  ds_read_b128 v[52:55], v11 offset:29696
  v_mfma_f32_16x16x32_bf16 v[16:19], v[160:163], v[96:99], v[16:19]
  ds_read_b128 v[56:59], v11 offset:30720
  buffer_load_dwordx4 v[92:95], v1, s[4:7], s69 offen offset:3072 sc1
  v_mfma_f32_16x16x32_bf16 v[20:23], v[168:171], v[96:99], v[20:23]
  ds_read_b128 v[60:63], v11 offset:31744
  v_mfma_f32_16x16x32_bf16 v[24:27], v[176:179], v[96:99], v[24:27]
  v_mfma_f32_16x16x32_bf16 v[28:31], v[184:187], v[96:99], v[28:31]
  s_waitcnt vmcnt(16)
  v_mfma_f32_16x16x32_bf16 v[16:19], v[164:167], v[100:103], v[16:19]
  s_add_u32 s69, s89, s74
  buffer_load_dwordx4 v[96:99], v1, s[4:7], s69 offen offset:0 sc1
  v_mfma_f32_16x16x32_bf16 v[20:23], v[172:175], v[100:103], v[20:23]
  v_mfma_f32_16x16x32_bf16 v[24:27], v[180:183], v[100:103], v[24:27]
  v_mfma_f32_16x16x32_bf16 v[28:31], v[188:191], v[100:103], v[28:31]
  s_waitcnt vmcnt(16)
  v_mfma_f32_16x16x32_bf16 v[16:19], v[192:195], v[104:107], v[16:19]
  buffer_load_dwordx4 v[100:103], v1, s[4:7], s69 offen offset:1024 sc1
  v_mfma_f32_16x16x32_bf16 v[20:23], v[200:203], v[104:107], v[20:23]
  s_waitcnt lgkmcnt(7)
  v_mfma_f32_16x16x32_bf16 v[24:27], v[32:35], v[104:107], v[24:27]
  s_waitcnt lgkmcnt(5)
  v_mfma_f32_16x16x32_bf16 v[28:31], v[40:43], v[104:107], v[28:31]
  s_waitcnt vmcnt(16)
  v_mfma_f32_16x16x32_bf16 v[16:19], v[196:199], v[108:111], v[16:19]
  buffer_load_dwordx4 v[104:107], v1, s[4:7], s69 offen offset:2048 sc1
  v_mfma_f32_16x16x32_bf16 v[20:23], v[204:207], v[108:111], v[20:23]
  v_mfma_f32_16x16x32_bf16 v[24:27], v[36:39], v[108:111], v[24:27]
  s_waitcnt lgkmcnt(4)
  v_mfma_f32_16x16x32_bf16 v[28:31], v[44:47], v[108:111], v[28:31]
  s_waitcnt vmcnt(16)
  v_mfma_f32_16x16x32_bf16 v[16:19], v[208:211], v[112:115], v[16:19]
  buffer_load_dwordx4 v[108:111], v1, s[4:7], s69 offen offset:3072 sc1
  v_mfma_f32_16x16x32_bf16 v[20:23], v[216:219], v[112:115], v[20:23]
  v_mfma_f32_16x16x32_bf16 v[24:27], v[224:227], v[112:115], v[24:27]
  v_mfma_f32_16x16x32_bf16 v[28:31], v[232:235], v[112:115], v[28:31]
  s_waitcnt vmcnt(16)
  v_mfma_f32_16x16x32_bf16 v[16:19], v[212:215], v[116:119], v[16:19]
  s_add_u32 s69, s89, s75
  buffer_load_dwordx4 v[112:115], v1, s[4:7], s69 offen offset:0 sc1
  v_mfma_f32_16x16x32_bf16 v[20:23], v[220:223], v[116:119], v[20:23]
  v_mfma_f32_16x16x32_bf16 v[24:27], v[228:231], v[116:119], v[24:27]
  v_mfma_f32_16x16x32_bf16 v[28:31], v[236:239], v[116:119], v[28:31]
  s_waitcnt vmcnt(16)
  v_mfma_f32_16x16x32_bf16 v[16:19], v[240:243], v[120:123], v[16:19]
  buffer_load_dwordx4 v[116:119], v1, s[4:7], s69 offen offset:1024 sc1
  v_mfma_f32_16x16x32_bf16 v[20:23], v[248:251], v[120:123], v[20:23]
  s_waitcnt lgkmcnt(3)
  v_mfma_f32_16x16x32_bf16 v[24:27], v[48:51], v[120:123], v[24:27]
  s_waitcnt lgkmcnt(1)
  v_mfma_f32_16x16x32_bf16 v[28:31], v[56:59], v[120:123], v[28:31]
  s_waitcnt vmcnt(16)
  v_mfma_f32_16x16x32_bf16 v[16:19], v[244:247], v[124:127], v[16:19]
  buffer_load_dwordx4 v[120:123], v1, s[4:7], s69 offen offset:2048 sc1
  v_mfma_f32_16x16x32_bf16 v[20:23], v[252:255], v[124:127], v[20:23]
  v_mfma_f32_16x16x32_bf16 v[24:27], v[52:55], v[124:127], v[24:27]
  s_waitcnt lgkmcnt(0)
  v_mfma_f32_16x16x32_bf16 v[28:31], v[60:63], v[124:127], v[28:31]
  buffer_load_dwordx4 v[124:127], v1, s[4:7], s69 offen offset:3072 sc1
  s_nop 1
  ds_write_b128 v8, v[16:19] offset:0
  s_nop 0
  ds_write_b128 v8, v[20:23] offset:1024
  ds_write_b128 v8, v[24:27] offset:2048
  s_nop 0
  ds_write_b128 v8, v[28:31] offset:3072
  v_add_u32 v8, s92, v6
  s_xor_b32 s59, s59, 1
  s_mov_b32 s61, s89
  s_mov_b32 s67, s53
  s_waitcnt lgkmcnt(0)
  s_barrier
  ds_read_b128 v[16:19], v8 offset:0
  ds_read_b128 v[20:23], v8 offset:4096
  ds_read_b128 v[24:27], v8 offset:8192
  ds_read_b128 v[28:31], v8 offset:12288
  v_lshlrev_b32 v48, 16, v12
  v_and_b32 v49, 0xffff0000, v12
  v_lshlrev_b32 v50, 16, v13
  v_and_b32 v51, 0xffff0000, v13
  s_waitcnt lgkmcnt(2)
  v_pk_add_f32 v[16:17], v[16:17], v[20:21]
  v_pk_add_f32 v[18:19], v[18:19], v[22:23]
  s_waitcnt lgkmcnt(0)
  v_pk_add_f32 v[24:25], v[24:25], v[28:29]
  v_pk_add_f32 v[26:27], v[26:27], v[30:31]
  v_pk_add_f32 v[16:17], v[16:17], v[24:25]
  v_pk_add_f32 v[18:19], v[18:19], v[26:27]
  v_cvt_pk_bf16_f32 v20, v16, v17
  v_cvt_pk_bf16_f32 v21, v18, v19
  v_lshlrev_b32 v16, 16, v20
  v_and_b32 v17, 0xffff0000, v20
  v_lshlrev_b32 v18, 16, v21
  v_and_b32 v19, 0xffff0000, v21
  v_pk_add_f32 v[48:49], v[48:49], v[16:17]
  v_pk_add_f32 v[50:51], v[50:51], v[18:19]
  v_cvt_pk_bf16_f32 v22, v48, v49
  v_cvt_pk_bf16_f32 v23, v50, v51
  buffer_store_dwordx2 v[22:23], v7, s[4:7], s63 offen sc1
  v_lshlrev_b32 v48, 16, v22
  v_and_b32 v49, 0xffff0000, v22
  v_lshlrev_b32 v50, 16, v23
  v_and_b32 v51, 0xffff0000, v23
  v_pk_add_f32 v[56:57], v[48:49], v[50:51]
  v_add_f32 v56, v56, v57
  s_nop 1
  v_add_f32_dpp v56, v56, v56 row_ror:8 row_mask:0xf bank_mask:0xf
  v_mov_b32 v58, v56
  s_nop 1
  v_permlane16_swap_b32 v56, v58
  v_add_f32 v56, v56, v58
  v_mov_b32 v58, v56
  s_nop 1
  v_permlane32_swap_b32 v56, v58
  v_add_f32 v56, v56, v58
  v_mul_f32 v56, 0x3d000000, v56
  v_pk_add_f32 v[48:49], v[48:49], v[56:57] op_sel_hi:[1,0] neg_lo:[0,1] neg_hi:[0,1]
  v_pk_add_f32 v[50:51], v[50:51], v[56:57] op_sel_hi:[1,0] neg_lo:[0,1] neg_hi:[0,1]
  v_pk_mul_f32 v[58:59], v[48:49], v[48:49]
  v_pk_fma_f32 v[58:59], v[50:51], v[50:51], v[58:59]
  v_add_f32 v57, v58, v59
  s_nop 1
  v_add_f32_dpp v57, v57, v57 row_ror:8 row_mask:0xf bank_mask:0xf
  v_mov_b32 v58, v57
  s_nop 1
  v_permlane16_swap_b32 v57, v58
  v_add_f32 v57, v57, v58
  v_mov_b32 v58, v57
  s_nop 1
  v_permlane32_swap_b32 v57, v58
  v_add_f32 v57, v57, v58
  s_mov_b64 exec, 0xff
  buffer_store_dwordx2 v[56:57], v4, s[4:7], s64 offen sc1
  s_mov_b64 exec, -1
  s_mov_b32 s70, s65
  s_lshl_b32 s93, s52, 13
  s_add_u32 s65, s65, s93
  s_add_u32 s62, s62, s90
  s_add_u32 s63, s63, s90
  s_add_u32 s64, s64, s90
  s_branch W_LOOP
W_PLAIN:
  s_waitcnt vmcnt(15)
  v_mfma_f32_16x16x32_bf16 v[16:19], a[192:195], v[64:67], v[16:19]
  ds_read_b128 v[48:51], v11 offset:20480
  ds_read_b128 v[52:55], v11 offset:21504
  v_mfma_f32_16x16x32_bf16 v[20:23], a[200:203], v[64:67], v[20:23]
  ds_read_b128 v[56:59], v11 offset:22528
  ds_read_b128 v[60:63], v11 offset:23552
  v_mfma_f32_16x16x32_bf16 v[24:27], a[208:211], v[64:67], v[24:27]
  v_mfma_f32_16x16x32_bf16 v[28:31], a[216:219], v[64:67], v[28:31]
  s_waitcnt vmcnt(14)
  v_mfma_f32_16x16x32_bf16 v[16:19], a[196:199], v[68:71], v[16:19]
  v_mfma_f32_16x16x32_bf16 v[20:23], a[204:207], v[68:71], v[20:23]
  v_mfma_f32_16x16x32_bf16 v[24:27], a[212:215], v[68:71], v[24:27]
  v_mfma_f32_16x16x32_bf16 v[28:31], a[220:223], v[68:71], v[28:31]
  s_waitcnt vmcnt(13)
  v_mfma_f32_16x16x32_bf16 v[16:19], a[224:227], v[72:75], v[16:19]
  v_mfma_f32_16x16x32_bf16 v[20:23], a[232:235], v[72:75], v[20:23]
  s_waitcnt lgkmcnt(7)
  v_mfma_f32_16x16x32_bf16 v[24:27], v[32:35], v[72:75], v[24:27]
  s_waitcnt lgkmcnt(5)
  v_mfma_f32_16x16x32_bf16 v[28:31], v[40:43], v[72:75], v[28:31]
  s_waitcnt vmcnt(12)
  v_mfma_f32_16x16x32_bf16 v[16:19], a[228:231], v[76:79], v[16:19]
  v_mfma_f32_16x16x32_bf16 v[20:23], a[236:239], v[76:79], v[20:23]
  v_mfma_f32_16x16x32_bf16 v[24:27], v[36:39], v[76:79], v[24:27]
  s_waitcnt lgkmcnt(4)
  v_mfma_f32_16x16x32_bf16 v[28:31], v[44:47], v[76:79], v[28:31]
  s_waitcnt vmcnt(11)
  ds_read_b128 v[32:35], v11 offset:24576
  ds_read_b128 v[36:39], v11 offset:25600
  v_mfma_f32_16x16x32_bf16 v[16:19], a[240:243], v[80:83], v[16:19]
  ds_read_b128 v[40:43], v11 offset:26624
  ds_read_b128 v[44:47], v11 offset:27648
  v_mfma_f32_16x16x32_bf16 v[20:23], a[248:251], v[80:83], v[20:23]
  v_mfma_f32_16x16x32_bf16 v[24:27], v[128:131], v[80:83], v[24:27]
  v_mfma_f32_16x16x32_bf16 v[28:31], v[136:139], v[80:83], v[28:31]
  s_waitcnt vmcnt(10)
  buffer_load_dword v9, v2, s[4:7], s53 offen sc1
  v_mfma_f32_16x16x32_bf16 v[16:19], a[244:247], v[84:87], v[16:19]
  v_mfma_f32_16x16x32_bf16 v[20:23], a[252:255], v[84:87], v[20:23]
  v_mfma_f32_16x16x32_bf16 v[24:27], v[132:135], v[84:87], v[24:27]
  v_mfma_f32_16x16x32_bf16 v[28:31], v[140:143], v[84:87], v[28:31]
  s_waitcnt vmcnt(10)
  v_mfma_f32_16x16x32_bf16 v[16:19], v[144:147], v[88:91], v[16:19]
  v_mfma_f32_16x16x32_bf16 v[20:23], v[152:155], v[88:91], v[20:23]
  s_mov_b64 exec, 1
  buffer_store_dword v3, off, s[4:7], s70 sc1
  s_mov_b64 exec, -1
  s_waitcnt lgkmcnt(7)
  v_mfma_f32_16x16x32_bf16 v[24:27], v[48:51], v[88:91], v[24:27]
  s_waitcnt lgkmcnt(5)
  v_mfma_f32_16x16x32_bf16 v[28:31], v[56:59], v[88:91], v[28:31]
  s_waitcnt vmcnt(10)
  v_mfma_f32_16x16x32_bf16 v[16:19], v[148:151], v[92:95], v[16:19]
  v_mfma_f32_16x16x32_bf16 v[20:23], v[156:159], v[92:95], v[20:23]
  v_mfma_f32_16x16x32_bf16 v[24:27], v[52:55], v[92:95], v[24:27]
  s_waitcnt lgkmcnt(4)
  v_mfma_f32_16x16x32_bf16 v[28:31], v[60:63], v[92:95], v[28:31]
  s_waitcnt vmcnt(9)
  ds_read_b128 v[48:51], v11 offset:28672
  ds_read_b128 v[52:55], v11 offset:29696
  v_mfma_f32_16x16x32_bf16 v[16:19], v[160:163], v[96:99], v[16:19]
  ds_read_b128 v[56:59], v11 offset:30720
  ds_read_b128 v[60:63], v11 offset:31744
  v_mfma_f32_16x16x32_bf16 v[20:23], v[168:171], v[96:99], v[20:23]
  v_mfma_f32_16x16x32_bf16 v[24:27], v[176:179], v[96:99], v[24:27]
  v_mfma_f32_16x16x32_bf16 v[28:31], v[184:187], v[96:99], v[28:31]
  s_waitcnt vmcnt(8)
  v_mfma_f32_16x16x32_bf16 v[16:19], v[164:167], v[100:103], v[16:19]
  v_mfma_f32_16x16x32_bf16 v[20:23], v[172:175], v[100:103], v[20:23]
  v_mfma_f32_16x16x32_bf16 v[24:27], v[180:183], v[100:103], v[24:27]
  v_mfma_f32_16x16x32_bf16 v[28:31], v[188:191], v[100:103], v[28:31]
  s_waitcnt vmcnt(7)
  v_mfma_f32_16x16x32_bf16 v[16:19], v[192:195], v[104:107], v[16:19]
  v_mfma_f32_16x16x32_bf16 v[20:23], v[200:203], v[104:107], v[20:23]
  s_waitcnt lgkmcnt(7)
  v_mfma_f32_16x16x32_bf16 v[24:27], v[32:35], v[104:107], v[24:27]
  s_waitcnt lgkmcnt(5)
  v_mfma_f32_16x16x32_bf16 v[28:31], v[40:43], v[104:107], v[28:31]
  s_waitcnt vmcnt(6)
  v_mfma_f32_16x16x32_bf16 v[16:19], v[196:199], v[108:111], v[16:19]
  v_mfma_f32_16x16x32_bf16 v[20:23], v[204:207], v[108:111], v[20:23]
  v_mfma_f32_16x16x32_bf16 v[24:27], v[36:39], v[108:111], v[24:27]
  s_waitcnt lgkmcnt(4)
  v_mfma_f32_16x16x32_bf16 v[28:31], v[44:47], v[108:111], v[28:31]
  s_waitcnt vmcnt(5)
  v_mfma_f32_16x16x32_bf16 v[16:19], v[208:211], v[112:115], v[16:19]
  v_mfma_f32_16x16x32_bf16 v[20:23], v[216:219], v[112:115], v[20:23]
  v_mfma_f32_16x16x32_bf16 v[24:27], v[224:227], v[112:115], v[24:27]
  v_mfma_f32_16x16x32_bf16 v[28:31], v[232:235], v[112:115], v[28:31]
  s_waitcnt vmcnt(4)
  v_mfma_f32_16x16x32_bf16 v[16:19], v[212:215], v[116:119], v[16:19]
  v_mfma_f32_16x16x32_bf16 v[20:23], v[220:223], v[116:119], v[20:23]
  v_mfma_f32_16x16x32_bf16 v[24:27], v[228:231], v[116:119], v[24:27]
  v_mfma_f32_16x16x32_bf16 v[28:31], v[236:239], v[116:119], v[28:31]
  s_waitcnt vmcnt(3)
  v_mfma_f32_16x16x32_bf16 v[16:19], v[240:243], v[120:123], v[16:19]
  v_mfma_f32_16x16x32_bf16 v[20:23], v[248:251], v[120:123], v[20:23]
  s_waitcnt lgkmcnt(3)
  v_mfma_f32_16x16x32_bf16 v[24:27], v[48:51], v[120:123], v[24:27]
  s_waitcnt lgkmcnt(1)
  v_mfma_f32_16x16x32_bf16 v[28:31], v[56:59], v[120:123], v[28:31]
  s_waitcnt vmcnt(2)
  v_mfma_f32_16x16x32_bf16 v[16:19], v[244:247], v[124:127], v[16:19]
  v_mfma_f32_16x16x32_bf16 v[20:23], v[252:255], v[124:127], v[20:23]
  v_mfma_f32_16x16x32_bf16 v[24:27], v[52:55], v[124:127], v[24:27]
  s_waitcnt lgkmcnt(0)
  v_mfma_f32_16x16x32_bf16 v[28:31], v[60:63], v[124:127], v[28:31]
  s_nop 3
  ds_write_b128 v8, v[16:19] offset:0
  ds_write_b128 v8, v[20:23] offset:1024
  ds_write_b128 v8, v[24:27] offset:2048
  s_nop 0
  ds_write_b128 v8, v[28:31] offset:3072
  v_add_u32 v8, s92, v6
  s_xor_b32 s59, s59, 1
  s_mov_b32 s61, s89
  s_mov_b32 s67, s53
  s_waitcnt vmcnt(1)
  v_cmp_ne_u32 vcc, 0, v9
  s_nop 0
  s_cmp_eq_u64 vcc, -1
  s_cselect_b32 s68, 1, 0
  s_cmp_lt_u32 s58, 64
  s_cselect_b32 s68, s68, 0
  s_cmp_eq_u32 s68, 0
  s_cbranch_scc1 W_DRAIN
  s_add_u32 s69, s61, s72
  buffer_load_dwordx4 v[64:67], v1, s[4:7], s69 offen offset:0 sc1
  buffer_load_dwordx4 v[68:71], v1, s[4:7], s69 offen offset:1024 sc1
  buffer_load_dwordx4 v[72:75], v1, s[4:7], s69 offen offset:2048 sc1
  buffer_load_dwordx4 v[76:79], v1, s[4:7], s69 offen offset:3072 sc1
  s_waitcnt lgkmcnt(0)
  s_barrier
  s_add_u32 s69, s61, s73
  buffer_load_dwordx4 v[80:83], v1, s[4:7], s69 offen offset:0 sc1
  ds_read_b128 v[16:19], v8 offset:0
  ds_read_b128 v[20:23], v8 offset:4096
  ds_read_b128 v[24:27], v8 offset:8192
  ds_read_b128 v[28:31], v8 offset:12288
  buffer_load_dwordx4 v[84:87], v1, s[4:7], s69 offen offset:1024 sc1
  v_lshlrev_b32 v48, 16, v12
  v_and_b32 v49, 0xffff0000, v12
  v_lshlrev_b32 v50, 16, v13
  v_and_b32 v51, 0xffff0000, v13
  buffer_load_dwordx4 v[88:91], v1, s[4:7], s69 offen offset:2048 sc1
  s_waitcnt lgkmcnt(2)
  v_pk_add_f32 v[16:17], v[16:17], v[20:21]
  v_pk_add_f32 v[18:19], v[18:19], v[22:23]
  s_waitcnt lgkmcnt(0)
  v_pk_add_f32 v[24:25], v[24:25], v[28:29]
  v_pk_add_f32 v[26:27], v[26:27], v[30:31]
  buffer_load_dwordx4 v[92:95], v1, s[4:7], s69 offen offset:3072 sc1
  v_pk_add_f32 v[16:17], v[16:17], v[24:25]
  v_pk_add_f32 v[18:19], v[18:19], v[26:27]
  v_cvt_pk_bf16_f32 v20, v16, v17
  v_cvt_pk_bf16_f32 v21, v18, v19
  s_add_u32 s69, s61, s74
  buffer_load_dwordx4 v[96:99], v1, s[4:7], s69 offen offset:0 sc1
  v_lshlrev_b32 v16, 16, v20
  v_and_b32 v17, 0xffff0000, v20
  v_lshlrev_b32 v18, 16, v21
  v_and_b32 v19, 0xffff0000, v21
  buffer_load_dwordx4 v[100:103], v1, s[4:7], s69 offen offset:1024 sc1
  v_pk_add_f32 v[48:49], v[48:49], v[16:17]
  v_pk_add_f32 v[50:51], v[50:51], v[18:19]
  v_cvt_pk_bf16_f32 v22, v48, v49
  v_cvt_pk_bf16_f32 v23, v50, v51
  buffer_load_dwordx4 v[104:107], v1, s[4:7], s69 offen offset:2048 sc1
  buffer_store_dwordx2 v[22:23], v7, s[4:7], s63 offen sc1
  v_lshlrev_b32 v48, 16, v22
  v_and_b32 v49, 0xffff0000, v22
  v_lshlrev_b32 v50, 16, v23
  buffer_load_dwordx4 v[108:111], v1, s[4:7], s69 offen offset:3072 sc1
  v_and_b32 v51, 0xffff0000, v23
  v_pk_add_f32 v[56:57], v[48:49], v[50:51]
  v_add_f32 v56, v56, v57
  s_nop 1
  v_add_f32_dpp v56, v56, v56 row_ror:8 row_mask:0xf bank_mask:0xf
  s_add_u32 s69, s61, s75
  buffer_load_dwordx4 v[112:115], v1, s[4:7], s69 offen offset:0 sc1
  v_mov_b32 v58, v56
  s_nop 1
  v_permlane16_swap_b32 v56, v58
  v_add_f32 v56, v56, v58
  v_mov_b32 v58, v56
  buffer_load_dwordx4 v[116:119], v1, s[4:7], s69 offen offset:1024 sc1
  s_nop 0
  v_permlane32_swap_b32 v56, v58
  v_add_f32 v56, v56, v58
  v_mul_f32 v56, 0x3d000000, v56
  v_pk_add_f32 v[48:49], v[48:49], v[56:57] op_sel_hi:[1,0] neg_lo:[0,1] neg_hi:[0,1]
  buffer_load_dwordx4 v[120:123], v1, s[4:7], s69 offen offset:2048 sc1
  v_pk_add_f32 v[50:51], v[50:51], v[56:57] op_sel_hi:[1,0] neg_lo:[0,1] neg_hi:[0,1]
  v_pk_mul_f32 v[58:59], v[48:49], v[48:49]
  v_pk_fma_f32 v[58:59], v[50:51], v[50:51], v[58:59]
  v_add_f32 v57, v58, v59
  buffer_load_dwordx4 v[124:127], v1, s[4:7], s69 offen offset:3072 sc1
  s_nop 0
  v_add_f32_dpp v57, v57, v57 row_ror:8 row_mask:0xf bank_mask:0xf
  v_mov_b32 v58, v57
  s_nop 1
  v_permlane16_swap_b32 v57, v58
  v_add_f32 v57, v57, v58
  v_mov_b32 v58, v57
  s_nop 1
  v_permlane32_swap_b32 v57, v58
  v_add_f32 v57, v57, v58
  s_mov_b64 exec, 0xff
  buffer_store_dwordx2 v[56:57], v4, s[4:7], s64 offen sc1
  s_mov_b64 exec, -1
  s_mov_b32 s70, s65
  s_lshl_b32 s93, s52, 13
  s_add_u32 s65, s65, s93
  s_add_u32 s62, s62, s90
  s_add_u32 s63, s63, s90
  s_add_u32 s64, s64, s90
  s_branch W_LOOP
W_DRAIN:
  s_waitcnt lgkmcnt(0)
  s_barrier
  ds_read_b128 v[16:19], v8 offset:0
  ds_read_b128 v[20:23], v8 offset:4096
  ds_read_b128 v[24:27], v8 offset:8192
  ds_read_b128 v[28:31], v8 offset:12288
  v_lshlrev_b32 v48, 16, v12
  v_and_b32 v49, 0xffff0000, v12
  v_lshlrev_b32 v50, 16, v13
  v_and_b32 v51, 0xffff0000, v13
  s_waitcnt lgkmcnt(2)
  v_pk_add_f32 v[16:17], v[16:17], v[20:21]
  v_pk_add_f32 v[18:19], v[18:19], v[22:23]
  s_waitcnt lgkmcnt(0)
  v_pk_add_f32 v[24:25], v[24:25], v[28:29]
  v_pk_add_f32 v[26:27], v[26:27], v[30:31]
  v_pk_add_f32 v[16:17], v[16:17], v[24:25]
  v_pk_add_f32 v[18:19], v[18:19], v[26:27]
  v_cvt_pk_bf16_f32 v20, v16, v17
  v_cvt_pk_bf16_f32 v21, v18, v19
  v_lshlrev_b32 v16, 16, v20
  v_and_b32 v17, 0xffff0000, v20
  v_lshlrev_b32 v18, 16, v21
  v_and_b32 v19, 0xffff0000, v21
  v_pk_add_f32 v[48:49], v[48:49], v[16:17]
  v_pk_add_f32 v[50:51], v[50:51], v[18:19]
  v_cvt_pk_bf16_f32 v22, v48, v49
  v_cvt_pk_bf16_f32 v23, v50, v51
  buffer_store_dwordx2 v[22:23], v7, s[4:7], s63 offen sc1
  v_lshlrev_b32 v48, 16, v22
  v_and_b32 v49, 0xffff0000, v22
  v_lshlrev_b32 v50, 16, v23
  v_and_b32 v51, 0xffff0000, v23
  v_pk_add_f32 v[56:57], v[48:49], v[50:51]
  v_add_f32 v56, v56, v57
  s_nop 1
  v_add_f32_dpp v56, v56, v56 row_ror:8 row_mask:0xf bank_mask:0xf
  v_mov_b32 v58, v56
  s_nop 1
  v_permlane16_swap_b32 v56, v58
  v_add_f32 v56, v56, v58
  v_mov_b32 v58, v56
  s_nop 1
  v_permlane32_swap_b32 v56, v58
  v_add_f32 v56, v56, v58
  v_mul_f32 v56, 0x3d000000, v56
  v_pk_add_f32 v[48:49], v[48:49], v[56:57] op_sel_hi:[1,0] neg_lo:[0,1] neg_hi:[0,1]
  v_pk_add_f32 v[50:51], v[50:51], v[56:57] op_sel_hi:[1,0] neg_lo:[0,1] neg_hi:[0,1]
  v_pk_mul_f32 v[58:59], v[48:49], v[48:49]
  v_pk_fma_f32 v[58:59], v[50:51], v[50:51], v[58:59]
  v_add_f32 v57, v58, v59
  s_nop 1
  v_add_f32_dpp v57, v57, v57 row_ror:8 row_mask:0xf bank_mask:0xf
  v_mov_b32 v58, v57
  s_nop 1
  v_permlane16_swap_b32 v57, v58
  v_add_f32 v57, v57, v58
  v_mov_b32 v58, v57
  s_nop 1
  v_permlane32_swap_b32 v57, v58
  v_add_f32 v57, v57, v58
  s_mov_b64 exec, 0xff
  buffer_store_dwordx2 v[56:57], v4, s[4:7], s64 offen sc1
  s_mov_b64 exec, -1
  s_mov_b32 s70, s65
  s_lshl_b32 s93, s52, 13
  s_add_u32 s65, s65, s93
  s_add_u32 s62, s62, s90
  s_add_u32 s63, s63, s90
  s_add_u32 s64, s64, s90
W_TAIL:
  s_cmp_lt_u32 s58, 64
  s_cbranch_scc1 W_WAIT
  s_waitcnt vmcnt(0)
  s_mov_b64 exec, 1
  buffer_store_dword v3, off, s[4:7], s70 sc1
  s_mov_b64 exec, -1
  s_cmp_lg_u32 s55, 0
  s_cbranch_scc1 END
  s_mov_b32 s55, 1
  s_mov_b32 s58, 57
  s_branch W_INIT
ROLE_F2:
  s_cmp_lg_u32 s46, 0
  s_cbranch_scc1 cen_2333
  v_mov_b32 v4, 163328
  s_cmp_lg_u32 s44, 0
  s_cbranch_scc1 cen_2334
  v_min_u32 v5, 9, v0
  v_lshlrev_b32 v5, 3, v5
  s_mov_b32 s92, 128
  v_writelane_b32 v5, s92, 0
cen_2335:
  buffer_load_dword v2, v5, s[12:15], 0 offen sc1
  s_mov_b32 s92, 0
  s_waitcnt vmcnt(0)
  v_readlane_b32 s93, v2, 0
  s_nop 0
  s_add_u32 s92, s92, s93
  v_readlane_b32 s93, v2, 1
  s_nop 0
  s_add_u32 s92, s92, s93
  v_readlane_b32 s93, v2, 2
  s_nop 0
  s_add_u32 s92, s92, s93
  v_readlane_b32 s93, v2, 3
  s_nop 0
  s_add_u32 s92, s92, s93
  v_readlane_b32 s93, v2, 4
  s_nop 0
  s_add_u32 s92, s92, s93
  v_readlane_b32 s93, v2, 5
  s_nop 0
  s_add_u32 s92, s92, s93
  v_readlane_b32 s93, v2, 6
  s_nop 0
  s_add_u32 s92, s92, s93
  v_readlane_b32 s93, v2, 7
  s_nop 0
  s_add_u32 s92, s92, s93
  v_readlane_b32 s93, v2, 8
  s_nop 0
  s_add_u32 s92, s92, s93
  s_cmp_eq_u32 s92, 256
  s_cbranch_scc1 cen_2336
  s_add_u32 s47, s47, 1
  s_mov_b32 s49, 1
  s_cmp_gt_u32 s47, 131072
  s_cbranch_scc1 TIMEOUT
  s_sleep 4
  s_branch cen_2335
cen_2336:
  v_cmp_ne_u32 vcc, 32, v2
  ds_read2_b32 v[6:7], v4 offset0:0 offset1:1
  s_and_b32 s94, vcc_lo, 0xff
  s_waitcnt lgkmcnt(0)
  v_readfirstlane_b32 s92, v6
  v_readfirstlane_b32 s95, v7
  v_readlane_b32 s93, v2, 0
  s_cmp_gt_u32 s95, 0
  s_cselect_b32 s93, s93, 0
  s_add_u32 s92, s92, s93
  v_readlane_b32 s93, v2, 1
  s_cmp_gt_u32 s95, 1
  s_cselect_b32 s93, s93, 0
  s_add_u32 s92, s92, s93
  v_readlane_b32 s93, v2, 2
  s_cmp_gt_u32 s95, 2
  s_cselect_b32 s93, s93, 0
  s_add_u32 s92, s92, s93
  v_readlane_b32 s93, v2, 3
  s_cmp_gt_u32 s95, 3
  s_cselect_b32 s93, s93, 0
  s_add_u32 s92, s92, s93
  v_readlane_b32 s93, v2, 4
  s_cmp_gt_u32 s95, 4
  s_cselect_b32 s93, s93, 0
  s_add_u32 s92, s92, s93
  v_readlane_b32 s93, v2, 5
  s_cmp_gt_u32 s95, 5
  s_cselect_b32 s93, s93, 0
  s_add_u32 s92, s92, s93
  v_readlane_b32 s93, v2, 6
  s_cmp_gt_u32 s95, 6
  s_cselect_b32 s93, s93, 0
  s_add_u32 s92, s92, s93
  v_readlane_b32 s93, v2, 7
  s_cmp_gt_u32 s95, 7
  s_cselect_b32 s93, s93, 0
  s_add_u32 s92, s92, s93
  v_mov_b32 v2, s92
  v_mov_b32 v3, s94
  ds_write2_b32 v4, v2, v3 offset0:2 offset1:3
cen_2334:
  s_waitcnt lgkmcnt(0)
  s_barrier
  ds_read2_b32 v[2:3], v4 offset0:2 offset1:3
  s_waitcnt lgkmcnt(0)
  v_readfirstlane_b32 s92, v2
  v_readfirstlane_b32 s93, v3
  s_nop 0
  s_cmp_eq_u32 s93, 0
  s_cbranch_scc1 cen_2333
  s_mov_b32 s46, 1
  s_mov_b32 s45, s92
  s_branch DISPATCH
cen_2333:
  s_sub_u32 s50, s45, 160
  s_mov_b32 s8, s16
  s_and_b32 s9, s17, 0xffff
  s_mov_b32 s10, 0x200000
  s_mov_b32 s11, 0x20000
  v_and_b32 v2, 15, v0
  v_lshlrev_b32 v3, 10, v2
  v_lshrrev_b32 v4, 4, v0
  v_lshl_add_u32 v3, v4, 4, v3
  v_lshlrev_b32 v5, 3, v2
  s_lshl_b32 s92, s50, 15
  s_lshr_b32 s93, s44, 1
  s_lshl_b32 s94, s93, 14
  s_add_u32 s92, s92, s94
  s_and_b32 s95, s44, 1
  s_lshl_b32 s94, s95, 9
  s_add_u32 s92, s92, s94
  buffer_load_dwordx4 v[16:19], v3, s[8:11], s92 offen offset:0
  buffer_load_dwordx4 v[20:23], v3, s[8:11], s92 offen offset:64
  buffer_load_dwordx4 v[24:27], v3, s[8:11], s92 offen offset:128
  buffer_load_dwordx4 v[28:31], v3, s[8:11], s92 offen offset:192
  buffer_load_dwordx4 v[32:35], v3, s[8:11], s92 offen offset:256
  buffer_load_dwordx4 v[36:39], v3, s[8:11], s92 offen offset:320
  buffer_load_dwordx4 v[40:43], v3, s[8:11], s92 offen offset:384
  buffer_load_dwordx4 v[44:47], v3, s[8:11], s92 offen offset:448
  s_mul_i32 s52, s50, 36864
  s_add_u32 s52, s52, 0x400000
  s_lshl_b32 s94, s44, 13
  s_add_u32 s53, s52, s94
  s_add_u32 s54, s53, 4096
  s_lshl_b32 s94, s95, 11
  s_add_u32 s52, s52, s94
  s_lshl_b32 s94, s93, 7
  s_add_u32 s52, s52, s94
  s_add_u32 s52, s52, 32768
  s_waitcnt vmcnt(7)
  buffer_store_dwordx4 v[16:19], v1, s[4:7], s53 offen offset:0 sc1
  v_lshlrev_b32 v48, 16, v16
  v_and_b32 v49, 0xffff0000, v16
  v_lshlrev_b32 v50, 16, v17
  v_and_b32 v51, 0xffff0000, v17
  v_lshlrev_b32 v52, 16, v18
  v_and_b32 v53, 0xffff0000, v18
  v_lshlrev_b32 v54, 16, v19
  v_and_b32 v55, 0xffff0000, v19
  v_pk_add_f32 v[56:57], v[48:49], v[50:51]
  v_pk_add_f32 v[58:59], v[52:53], v[54:55]
  v_pk_add_f32 v[56:57], v[56:57], v[58:59]
  v_add_f32 v56, v56, v57
  v_mov_b32 v58, v56
  s_nop 1
  v_permlane16_swap_b32 v56, v58
  v_add_f32 v56, v56, v58
  v_mov_b32 v58, v56
  s_nop 1
  v_permlane32_swap_b32 v56, v58
  v_add_f32 v56, v56, v58
  v_mul_f32 v56, 0x3d000000, v56
  v_pk_add_f32 v[48:49], v[48:49], v[56:57] op_sel_hi:[1,0] neg_lo:[0,1] neg_hi:[0,1]
  v_pk_add_f32 v[50:51], v[50:51], v[56:57] op_sel_hi:[1,0] neg_lo:[0,1] neg_hi:[0,1]
  v_pk_add_f32 v[52:53], v[52:53], v[56:57] op_sel_hi:[1,0] neg_lo:[0,1] neg_hi:[0,1]
  v_pk_add_f32 v[54:55], v[54:55], v[56:57] op_sel_hi:[1,0] neg_lo:[0,1] neg_hi:[0,1]
  v_pk_mul_f32 v[58:59], v[48:49], v[48:49]
  v_pk_fma_f32 v[58:59], v[50:51], v[50:51], v[58:59]
  v_pk_fma_f32 v[58:59], v[52:53], v[52:53], v[58:59]
  v_pk_fma_f32 v[58:59], v[54:55], v[54:55], v[58:59]
  v_add_f32 v57, v58, v59
  v_mov_b32 v58, v57
  s_nop 1
  v_permlane16_swap_b32 v57, v58
  v_add_f32 v57, v57, v58
  v_mov_b32 v58, v57
  s_nop 1
  v_permlane32_swap_b32 v57, v58
  v_add_f32 v57, v57, v58
  s_mov_b64 exec, 0xffff
  buffer_store_dwordx2 v[56:57], v5, s[4:7], s52 offen offset:0 sc1
  s_mov_b64 exec, -1
  s_waitcnt vmcnt(8)
  buffer_store_dwordx4 v[20:23], v1, s[4:7], s53 offen offset:1024 sc1
  v_lshlrev_b32 v48, 16, v20
  v_and_b32 v49, 0xffff0000, v20
  v_lshlrev_b32 v50, 16, v21
  v_and_b32 v51, 0xffff0000, v21
  v_lshlrev_b32 v52, 16, v22
  v_and_b32 v53, 0xffff0000, v22
  v_lshlrev_b32 v54, 16, v23
  v_and_b32 v55, 0xffff0000, v23
  v_pk_add_f32 v[56:57], v[48:49], v[50:51]
  v_pk_add_f32 v[58:59], v[52:53], v[54:55]
  v_pk_add_f32 v[56:57], v[56:57], v[58:59]
  v_add_f32 v56, v56, v57
  v_mov_b32 v58, v56
  s_nop 1
  v_permlane16_swap_b32 v56, v58
  v_add_f32 v56, v56, v58
  v_mov_b32 v58, v56
  s_nop 1
  v_permlane32_swap_b32 v56, v58
  v_add_f32 v56, v56, v58
  v_mul_f32 v56, 0x3d000000, v56
  v_pk_add_f32 v[48:49], v[48:49], v[56:57] op_sel_hi:[1,0] neg_lo:[0,1] neg_hi:[0,1]
  v_pk_add_f32 v[50:51], v[50:51], v[56:57] op_sel_hi:[1,0] neg_lo:[0,1] neg_hi:[0,1]
  v_pk_add_f32 v[52:53], v[52:53], v[56:57] op_sel_hi:[1,0] neg_lo:[0,1] neg_hi:[0,1]
  v_pk_add_f32 v[54:55], v[54:55], v[56:57] op_sel_hi:[1,0] neg_lo:[0,1] neg_hi:[0,1]
  v_pk_mul_f32 v[58:59], v[48:49], v[48:49]
  v_pk_fma_f32 v[58:59], v[50:51], v[50:51], v[58:59]
  v_pk_fma_f32 v[58:59], v[52:53], v[52:53], v[58:59]
  v_pk_fma_f32 v[58:59], v[54:55], v[54:55], v[58:59]
  v_add_f32 v57, v58, v59
  v_mov_b32 v58, v57
  s_nop 1
  v_permlane16_swap_b32 v57, v58
  v_add_f32 v57, v57, v58
  v_mov_b32 v58, v57
  s_nop 1
  v_permlane32_swap_b32 v57, v58
  v_add_f32 v57, v57, v58
  s_mov_b64 exec, 0xffff
  buffer_store_dwordx2 v[56:57], v5, s[4:7], s52 offen offset:256 sc1
  s_mov_b64 exec, -1
  s_waitcnt vmcnt(9)
  buffer_store_dwordx4 v[24:27], v1, s[4:7], s53 offen offset:2048 sc1
  v_lshlrev_b32 v48, 16, v24
  v_and_b32 v49, 0xffff0000, v24
  v_lshlrev_b32 v50, 16, v25
  v_and_b32 v51, 0xffff0000, v25
  v_lshlrev_b32 v52, 16, v26
  v_and_b32 v53, 0xffff0000, v26
  v_lshlrev_b32 v54, 16, v27
  v_and_b32 v55, 0xffff0000, v27
  v_pk_add_f32 v[56:57], v[48:49], v[50:51]
  v_pk_add_f32 v[58:59], v[52:53], v[54:55]
  v_pk_add_f32 v[56:57], v[56:57], v[58:59]
  v_add_f32 v56, v56, v57
  v_mov_b32 v58, v56
  s_nop 1
  v_permlane16_swap_b32 v56, v58
  v_add_f32 v56, v56, v58
  v_mov_b32 v58, v56
  s_nop 1
  v_permlane32_swap_b32 v56, v58
  v_add_f32 v56, v56, v58
  v_mul_f32 v56, 0x3d000000, v56
  v_pk_add_f32 v[48:49], v[48:49], v[56:57] op_sel_hi:[1,0] neg_lo:[0,1] neg_hi:[0,1]
  v_pk_add_f32 v[50:51], v[50:51], v[56:57] op_sel_hi:[1,0] neg_lo:[0,1] neg_hi:[0,1]
  v_pk_add_f32 v[52:53], v[52:53], v[56:57] op_sel_hi:[1,0] neg_lo:[0,1] neg_hi:[0,1]
  v_pk_add_f32 v[54:55], v[54:55], v[56:57] op_sel_hi:[1,0] neg_lo:[0,1] neg_hi:[0,1]
  v_pk_mul_f32 v[58:59], v[48:49], v[48:49]
  v_pk_fma_f32 v[58:59], v[50:51], v[50:51], v[58:59]
  v_pk_fma_f32 v[58:59], v[52:53], v[52:53], v[58:59]
  v_pk_fma_f32 v[58:59], v[54:55], v[54:55], v[58:59]
  v_add_f32 v57, v58, v59
  v_mov_b32 v58, v57
  s_nop 1
  v_permlane16_swap_b32 v57, v58
  v_add_f32 v57, v57, v58
  v_mov_b32 v58, v57
  s_nop 1
  v_permlane32_swap_b32 v57, v58
  v_add_f32 v57, v57, v58
  s_mov_b64 exec, 0xffff
  buffer_store_dwordx2 v[56:57], v5, s[4:7], s52 offen offset:512 sc1
  s_mov_b64 exec, -1
  s_waitcnt vmcnt(10)
  buffer_store_dwordx4 v[28:31], v1, s[4:7], s53 offen offset:3072 sc1
  v_lshlrev_b32 v48, 16, v28
  v_and_b32 v49, 0xffff0000, v28
  v_lshlrev_b32 v50, 16, v29
  v_and_b32 v51, 0xffff0000, v29
  v_lshlrev_b32 v52, 16, v30
  v_and_b32 v53, 0xffff0000, v30
  v_lshlrev_b32 v54, 16, v31
  v_and_b32 v55, 0xffff0000, v31
  v_pk_add_f32 v[56:57], v[48:49], v[50:51]
  v_pk_add_f32 v[58:59], v[52:53], v[54:55]
  v_pk_add_f32 v[56:57], v[56:57], v[58:59]
  v_add_f32 v56, v56, v57
  v_mov_b32 v58, v56
  s_nop 1
  v_permlane16_swap_b32 v56, v58
  v_add_f32 v56, v56, v58
  v_mov_b32 v58, v56
  s_nop 1
  v_permlane32_swap_b32 v56, v58
  v_add_f32 v56, v56, v58
  v_mul_f32 v56, 0x3d000000, v56
  v_pk_add_f32 v[48:49], v[48:49], v[56:57] op_sel_hi:[1,0] neg_lo:[0,1] neg_hi:[0,1]
  v_pk_add_f32 v[50:51], v[50:51], v[56:57] op_sel_hi:[1,0] neg_lo:[0,1] neg_hi:[0,1]
  v_pk_add_f32 v[52:53], v[52:53], v[56:57] op_sel_hi:[1,0] neg_lo:[0,1] neg_hi:[0,1]
  v_pk_add_f32 v[54:55], v[54:55], v[56:57] op_sel_hi:[1,0] neg_lo:[0,1] neg_hi:[0,1]
  v_pk_mul_f32 v[58:59], v[48:49], v[48:49]
  v_pk_fma_f32 v[58:59], v[50:51], v[50:51], v[58:59]
  v_pk_fma_f32 v[58:59], v[52:53], v[52:53], v[58:59]
  v_pk_fma_f32 v[58:59], v[54:55], v[54:55], v[58:59]
  v_add_f32 v57, v58, v59
  v_mov_b32 v58, v57
  s_nop 1
  v_permlane16_swap_b32 v57, v58
  v_add_f32 v57, v57, v58
  v_mov_b32 v58, v57
  s_nop 1
  v_permlane32_swap_b32 v57, v58
  v_add_f32 v57, v57, v58
  s_mov_b64 exec, 0xffff
  buffer_store_dwordx2 v[56:57], v5, s[4:7], s52 offen offset:768 sc1
  s_mov_b64 exec, -1
  s_waitcnt vmcnt(11)
  buffer_store_dwordx4 v[32:35], v1, s[4:7], s54 offen offset:0 sc1
  v_lshlrev_b32 v48, 16, v32
  v_and_b32 v49, 0xffff0000, v32
  v_lshlrev_b32 v50, 16, v33
  v_and_b32 v51, 0xffff0000, v33
  v_lshlrev_b32 v52, 16, v34
  v_and_b32 v53, 0xffff0000, v34
  v_lshlrev_b32 v54, 16, v35
  v_and_b32 v55, 0xffff0000, v35
  v_pk_add_f32 v[56:57], v[48:49], v[50:51]
  v_pk_add_f32 v[58:59], v[52:53], v[54:55]
  v_pk_add_f32 v[56:57], v[56:57], v[58:59]
  v_add_f32 v56, v56, v57
  v_mov_b32 v58, v56
  s_nop 1
  v_permlane16_swap_b32 v56, v58
  v_add_f32 v56, v56, v58
  v_mov_b32 v58, v56
  s_nop 1
  v_permlane32_swap_b32 v56, v58
  v_add_f32 v56, v56, v58
  v_mul_f32 v56, 0x3d000000, v56
  v_pk_add_f32 v[48:49], v[48:49], v[56:57] op_sel_hi:[1,0] neg_lo:[0,1] neg_hi:[0,1]
  v_pk_add_f32 v[50:51], v[50:51], v[56:57] op_sel_hi:[1,0] neg_lo:[0,1] neg_hi:[0,1]
  v_pk_add_f32 v[52:53], v[52:53], v[56:57] op_sel_hi:[1,0] neg_lo:[0,1] neg_hi:[0,1]
  v_pk_add_f32 v[54:55], v[54:55], v[56:57] op_sel_hi:[1,0] neg_lo:[0,1] neg_hi:[0,1]
  v_pk_mul_f32 v[58:59], v[48:49], v[48:49]
  v_pk_fma_f32 v[58:59], v[50:51], v[50:51], v[58:59]
  v_pk_fma_f32 v[58:59], v[52:53], v[52:53], v[58:59]
  v_pk_fma_f32 v[58:59], v[54:55], v[54:55], v[58:59]
  v_add_f32 v57, v58, v59
  v_mov_b32 v58, v57
  s_nop 1
  v_permlane16_swap_b32 v57, v58
  v_add_f32 v57, v57, v58
  v_mov_b32 v58, v57
  s_nop 1
  v_permlane32_swap_b32 v57, v58
  v_add_f32 v57, v57, v58
  s_mov_b64 exec, 0xffff
  buffer_store_dwordx2 v[56:57], v5, s[4:7], s52 offen offset:1024 sc1
  s_mov_b64 exec, -1
  s_waitcnt vmcnt(12)
  buffer_store_dwordx4 v[36:39], v1, s[4:7], s54 offen offset:1024 sc1
  v_lshlrev_b32 v48, 16, v36
  v_and_b32 v49, 0xffff0000, v36
  v_lshlrev_b32 v50, 16, v37
  v_and_b32 v51, 0xffff0000, v37
  v_lshlrev_b32 v52, 16, v38
  v_and_b32 v53, 0xffff0000, v38
  v_lshlrev_b32 v54, 16, v39
  v_and_b32 v55, 0xffff0000, v39
  v_pk_add_f32 v[56:57], v[48:49], v[50:51]
  v_pk_add_f32 v[58:59], v[52:53], v[54:55]
  v_pk_add_f32 v[56:57], v[56:57], v[58:59]
  v_add_f32 v56, v56, v57
  v_mov_b32 v58, v56
  s_nop 1
  v_permlane16_swap_b32 v56, v58
  v_add_f32 v56, v56, v58
  v_mov_b32 v58, v56
  s_nop 1
  v_permlane32_swap_b32 v56, v58
  v_add_f32 v56, v56, v58
  v_mul_f32 v56, 0x3d000000, v56
  v_pk_add_f32 v[48:49], v[48:49], v[56:57] op_sel_hi:[1,0] neg_lo:[0,1] neg_hi:[0,1]
  v_pk_add_f32 v[50:51], v[50:51], v[56:57] op_sel_hi:[1,0] neg_lo:[0,1] neg_hi:[0,1]
  v_pk_add_f32 v[52:53], v[52:53], v[56:57] op_sel_hi:[1,0] neg_lo:[0,1] neg_hi:[0,1]
  v_pk_add_f32 v[54:55], v[54:55], v[56:57] op_sel_hi:[1,0] neg_lo:[0,1] neg_hi:[0,1]
  v_pk_mul_f32 v[58:59], v[48:49], v[48:49]
  v_pk_fma_f32 v[58:59], v[50:51], v[50:51], v[58:59]
  v_pk_fma_f32 v[58:59], v[52:53], v[52:53], v[58:59]
  v_pk_fma_f32 v[58:59], v[54:55], v[54:55], v[58:59]
  v_add_f32 v57, v58, v59
  v_mov_b32 v58, v57
  s_nop 1
  v_permlane16_swap_b32 v57, v58
  v_add_f32 v57, v57, v58
  v_mov_b32 v58, v57
  s_nop 1
  v_permlane32_swap_b32 v57, v58
  v_add_f32 v57, v57, v58
  s_mov_b64 exec, 0xffff
  buffer_store_dwordx2 v[56:57], v5, s[4:7], s52 offen offset:1280 sc1
  s_mov_b64 exec, -1
  s_waitcnt vmcnt(13)
  buffer_store_dwordx4 v[40:43], v1, s[4:7], s54 offen offset:2048 sc1
  v_lshlrev_b32 v48, 16, v40
  v_and_b32 v49, 0xffff0000, v40
  v_lshlrev_b32 v50, 16, v41
  v_and_b32 v51, 0xffff0000, v41
  v_lshlrev_b32 v52, 16, v42
  v_and_b32 v53, 0xffff0000, v42
  v_lshlrev_b32 v54, 16, v43
  v_and_b32 v55, 0xffff0000, v43
  v_pk_add_f32 v[56:57], v[48:49], v[50:51]
  v_pk_add_f32 v[58:59], v[52:53], v[54:55]
  v_pk_add_f32 v[56:57], v[56:57], v[58:59]
  v_add_f32 v56, v56, v57
  v_mov_b32 v58, v56
  s_nop 1
  v_permlane16_swap_b32 v56, v58
  v_add_f32 v56, v56, v58
  v_mov_b32 v58, v56
  s_nop 1
  v_permlane32_swap_b32 v56, v58
  v_add_f32 v56, v56, v58
  v_mul_f32 v56, 0x3d000000, v56
  v_pk_add_f32 v[48:49], v[48:49], v[56:57] op_sel_hi:[1,0] neg_lo:[0,1] neg_hi:[0,1]
  v_pk_add_f32 v[50:51], v[50:51], v[56:57] op_sel_hi:[1,0] neg_lo:[0,1] neg_hi:[0,1]
  v_pk_add_f32 v[52:53], v[52:53], v[56:57] op_sel_hi:[1,0] neg_lo:[0,1] neg_hi:[0,1]
  v_pk_add_f32 v[54:55], v[54:55], v[56:57] op_sel_hi:[1,0] neg_lo:[0,1] neg_hi:[0,1]
  v_pk_mul_f32 v[58:59], v[48:49], v[48:49]
  v_pk_fma_f32 v[58:59], v[50:51], v[50:51], v[58:59]
  v_pk_fma_f32 v[58:59], v[52:53], v[52:53], v[58:59]
  v_pk_fma_f32 v[58:59], v[54:55], v[54:55], v[58:59]
  v_add_f32 v57, v58, v59
  v_mov_b32 v58, v57
  s_nop 1
  v_permlane16_swap_b32 v57, v58
  v_add_f32 v57, v57, v58
  v_mov_b32 v58, v57
  s_nop 1
  v_permlane32_swap_b32 v57, v58
  v_add_f32 v57, v57, v58
  s_mov_b64 exec, 0xffff
  buffer_store_dwordx2 v[56:57], v5, s[4:7], s52 offen offset:1536 sc1
  s_mov_b64 exec, -1
  s_waitcnt vmcnt(14)
  buffer_store_dwordx4 v[44:47], v1, s[4:7], s54 offen offset:3072 sc1
  v_lshlrev_b32 v48, 16, v44
  v_and_b32 v49, 0xffff0000, v44
  v_lshlrev_b32 v50, 16, v45
  v_and_b32 v51, 0xffff0000, v45
  v_lshlrev_b32 v52, 16, v46
  v_and_b32 v53, 0xffff0000, v46
  v_lshlrev_b32 v54, 16, v47
  v_and_b32 v55, 0xffff0000, v47
  v_pk_add_f32 v[56:57], v[48:49], v[50:51]
  v_pk_add_f32 v[58:59], v[52:53], v[54:55]
  v_pk_add_f32 v[56:57], v[56:57], v[58:59]
  v_add_f32 v56, v56, v57
  v_mov_b32 v58, v56
  s_nop 1
  v_permlane16_swap_b32 v56, v58
  v_add_f32 v56, v56, v58
  v_mov_b32 v58, v56
  s_nop 1
  v_permlane32_swap_b32 v56, v58
  v_add_f32 v56, v56, v58
  v_mul_f32 v56, 0x3d000000, v56
  v_pk_add_f32 v[48:49], v[48:49], v[56:57] op_sel_hi:[1,0] neg_lo:[0,1] neg_hi:[0,1]
  v_pk_add_f32 v[50:51], v[50:51], v[56:57] op_sel_hi:[1,0] neg_lo:[0,1] neg_hi:[0,1]
  v_pk_add_f32 v[52:53], v[52:53], v[56:57] op_sel_hi:[1,0] neg_lo:[0,1] neg_hi:[0,1]
  v_pk_add_f32 v[54:55], v[54:55], v[56:57] op_sel_hi:[1,0] neg_lo:[0,1] neg_hi:[0,1]
  v_pk_mul_f32 v[58:59], v[48:49], v[48:49]
  v_pk_fma_f32 v[58:59], v[50:51], v[50:51], v[58:59]
  v_pk_fma_f32 v[58:59], v[52:53], v[52:53], v[58:59]
  v_pk_fma_f32 v[58:59], v[54:55], v[54:55], v[58:59]
  v_add_f32 v57, v58, v59
  v_mov_b32 v58, v57
  s_nop 1
  v_permlane16_swap_b32 v57, v58
  v_add_f32 v57, v57, v58
  v_mov_b32 v58, v57
  s_nop 1
  v_permlane32_swap_b32 v57, v58
  v_add_f32 v57, v57, v58
  s_mov_b64 exec, 0xffff
  buffer_store_dwordx2 v[56:57], v5, s[4:7], s52 offen offset:1792 sc1
  s_mov_b64 exec, -1
  s_lshl_b32 s52, s50, 2
  s_lshl_b32 s94, s95, 12
  s_add_u32 s52, s52, s94
  s_lshl_b32 s94, s93, 8
  s_add_u32 s52, s52, s94
  s_add_u32 s52, s52, 0x0
  v_lshlrev_b32 v6, 9, v0
  v_mov_b32 v7, 1
  s_waitcnt vmcnt(0)
  s_mov_b64 exec, 0xff
  buffer_store_dword v7, v6, s[4:7], s52 offen sc1
  s_mov_b64 exec, -1
  s_sub_u32 s92, s45, 208
  s_lshr_b32 s55, s92, 3
  s_and_b32 s56, s92, 7
  s_and_b32 s60, s44, 1
  s_mul_i32 s57, s44, 458752
  s_lshl_b32 s92, s56, 7
  s_add_u32 s57, s57, s92
  s_add_u32 s92, s56, 0
  s_sub_u32 s93, s92, 7
  s_cmp_ge_u32 s92, 7
  s_cselect_b32 s92, s93, s92
  s_sub_u32 s93, s92, 7
  s_cmp_ge_u32 s92, 7
  s_cselect_b32 s92, s93, s92
  s_mul_i32 s72, s92, 2048
  s_mul_i32 s92, s92, 65536
  s_add_u32 s80, s57, s92
  s_add_u32 s92, s56, 1
  s_sub_u32 s93, s92, 7
  s_cmp_ge_u32 s92, 7
  s_cselect_b32 s92, s93, s92
  s_sub_u32 s93, s92, 7
  s_cmp_ge_u32 s92, 7
  s_cselect_b32 s92, s93, s92
  s_mul_i32 s73, s92, 2048
  s_mul_i32 s92, s92, 65536
  s_add_u32 s81, s57, s92
  s_add_u32 s92, s56, 2
  s_sub_u32 s93, s92, 7
  s_cmp_ge_u32 s92, 7
  s_cselect_b32 s92, s93, s92
  s_sub_u32 s93, s92, 7
  s_cmp_ge_u32 s92, 7
  s_cselect_b32 s92, s93, s92
  s_mul_i32 s74, s92, 2048
  s_mul_i32 s92, s92, 65536
  s_add_u32 s82, s57, s92
  s_add_u32 s92, s56, 3
  s_sub_u32 s93, s92, 7
  s_cmp_ge_u32 s92, 7
  s_cselect_b32 s92, s93, s92
  s_sub_u32 s93, s92, 7
  s_cmp_ge_u32 s92, 7
  s_cselect_b32 s92, s93, s92
  s_mul_i32 s75, s92, 2048
  s_mul_i32 s92, s92, 65536
  s_add_u32 s83, s57, s92
  s_add_u32 s92, s56, 4
  s_sub_u32 s93, s92, 7
  s_cmp_ge_u32 s92, 7
  s_cselect_b32 s92, s93, s92
  s_sub_u32 s93, s92, 7
  s_cmp_ge_u32 s92, 7
  s_cselect_b32 s92, s93, s92
  s_mul_i32 s76, s92, 2048
  s_mul_i32 s92, s92, 65536
  s_add_u32 s84, s57, s92
  s_add_u32 s92, s56, 5
  s_sub_u32 s93, s92, 7
  s_cmp_ge_u32 s92, 7
  s_cselect_b32 s92, s93, s92
  s_sub_u32 s93, s92, 7
  s_cmp_ge_u32 s92, 7
  s_cselect_b32 s92, s93, s92
  s_mul_i32 s77, s92, 2048
  s_mul_i32 s92, s92, 65536
  s_add_u32 s85, s57, s92
  s_add_u32 s92, s56, 6
  s_sub_u32 s93, s92, 7
  s_cmp_ge_u32 s92, 7
  s_cselect_b32 s92, s93, s92
  s_sub_u32 s93, s92, 7
  s_cmp_ge_u32 s92, 7
  s_cselect_b32 s92, s93, s92
  s_mul_i32 s78, s92, 2048
  s_mul_i32 s92, s92, 65536
  s_add_u32 s86, s57, s92
  v_lshrrev_b32 v21, 4, v0
  v_bfe_u32 v22, v0, 2, 2
  v_and_b32 v23, 3, v0
  v_lshl_add_u32 v17, v21, 3, v22
  v_lshlrev_b32 v17, 6, v17
  v_lshl_add_u32 v17, v23, 4, v17
  v_add_u32 v17, s48, v17
  v_add_u32 v21, s48, v1
  s_mov_b32 s8, s36
  s_and_b32 s9, s37, 0xffff
  s_mov_b32 s10, 0x1c0000
  s_mov_b32 s11, 0x20000
  s_mov_b32 s92, 1024
  v_lshrrev_b32 v16, 2, v0
  v_mul_lo_u32 v16, v16, s92
  v_lshl_add_u32 v16, v23, 4, v16
  s_add_u32 m0, s48, 0
  s_add_u32 s92, s80, 0x0
  buffer_load_dwordx4 v16, s[8:11], s92 offen offset:0 lds
  s_add_u32 s92, s80, 0x3c00
  buffer_load_dwordx4 v16, s[8:11], s92 offen offset:1024 lds
  s_add_u32 s92, s80, 0x7800
  buffer_load_dwordx4 v16, s[8:11], s92 offen offset:2048 lds
  s_add_u32 s92, s80, 0xb400
  buffer_load_dwordx4 v16, s[8:11], s92 offen offset:3072 lds
  s_add_u32 m0, s48, 4096
  s_add_u32 s92, s80, 0x40
  buffer_load_dwordx4 v16, s[8:11], s92 offen offset:0 lds
  s_add_u32 s92, s80, 0x3c40
  buffer_load_dwordx4 v16, s[8:11], s92 offen offset:1024 lds
  s_add_u32 s92, s80, 0x7840
  buffer_load_dwordx4 v16, s[8:11], s92 offen offset:2048 lds
  s_add_u32 s92, s80, 0xb440
  buffer_load_dwordx4 v16, s[8:11], s92 offen offset:3072 lds
  s_add_u32 m0, s48, 8192
  s_add_u32 s92, s81, 0x0
  buffer_load_dwordx4 v16, s[8:11], s92 offen offset:0 lds
  s_add_u32 s92, s81, 0x3c00
  buffer_load_dwordx4 v16, s[8:11], s92 offen offset:1024 lds
  s_add_u32 s92, s81, 0x7800
  buffer_load_dwordx4 v16, s[8:11], s92 offen offset:2048 lds
  s_add_u32 s92, s81, 0xb400
  buffer_load_dwordx4 v16, s[8:11], s92 offen offset:3072 lds
  s_add_u32 m0, s48, 12288
  s_add_u32 s92, s81, 0x40
  buffer_load_dwordx4 v16, s[8:11], s92 offen offset:0 lds
  s_add_u32 s92, s81, 0x3c40
  buffer_load_dwordx4 v16, s[8:11], s92 offen offset:1024 lds
  s_add_u32 s92, s81, 0x7840
  buffer_load_dwordx4 v16, s[8:11], s92 offen offset:2048 lds
  s_add_u32 s92, s81, 0xb440
  buffer_load_dwordx4 v16, s[8:11], s92 offen offset:3072 lds
  s_add_u32 m0, s48, 16384
  s_add_u32 s92, s82, 0x0
  buffer_load_dwordx4 v16, s[8:11], s92 offen offset:0 lds
  s_add_u32 s92, s82, 0x3c00
  buffer_load_dwordx4 v16, s[8:11], s92 offen offset:1024 lds
  s_add_u32 s92, s82, 0x7800
  buffer_load_dwordx4 v16, s[8:11], s92 offen offset:2048 lds
  s_add_u32 s92, s82, 0xb400
  buffer_load_dwordx4 v16, s[8:11], s92 offen offset:3072 lds
  s_add_u32 m0, s48, 20480
  s_add_u32 s92, s82, 0x40
  buffer_load_dwordx4 v16, s[8:11], s92 offen offset:0 lds
  s_add_u32 s92, s82, 0x3c40
  buffer_load_dwordx4 v16, s[8:11], s92 offen offset:1024 lds
  s_add_u32 s92, s82, 0x7840
  buffer_load_dwordx4 v16, s[8:11], s92 offen offset:2048 lds
  s_add_u32 s92, s82, 0xb440
  buffer_load_dwordx4 v16, s[8:11], s92 offen offset:3072 lds
  s_add_u32 m0, s48, 24576
  s_add_u32 s92, s83, 0x0
  buffer_load_dwordx4 v16, s[8:11], s92 offen offset:0 lds
  s_add_u32 s92, s83, 0x3c00
  buffer_load_dwordx4 v16, s[8:11], s92 offen offset:1024 lds
  s_add_u32 s92, s83, 0x7800
  buffer_load_dwordx4 v16, s[8:11], s92 offen offset:2048 lds
  s_add_u32 s92, s83, 0xb400
  buffer_load_dwordx4 v16, s[8:11], s92 offen offset:3072 lds
  s_add_u32 m0, s48, 28672
  s_add_u32 s92, s83, 0x40
  buffer_load_dwordx4 v16, s[8:11], s92 offen offset:0 lds
  s_add_u32 s92, s83, 0x3c40
  buffer_load_dwordx4 v16, s[8:11], s92 offen offset:1024 lds
  s_add_u32 s92, s83, 0x7840
  buffer_load_dwordx4 v16, s[8:11], s92 offen offset:2048 lds
  s_add_u32 s92, s83, 0xb440
  buffer_load_dwordx4 v16, s[8:11], s92 offen offset:3072 lds
  s_waitcnt vmcnt(28)
  ds_read_b64_tr_b16 a[0:1], v17 offset:0
  ds_read_b64_tr_b16 a[2:3], v17 offset:256
  ds_read_b64_tr_b16 a[8:9], v17 offset:8
  ds_read_b64_tr_b16 a[10:11], v17 offset:264
  ds_read_b64_tr_b16 a[4:5], v17 offset:2048
  ds_read_b64_tr_b16 a[6:7], v17 offset:2304
  ds_read_b64_tr_b16 a[12:13], v17 offset:2056
  ds_read_b64_tr_b16 a[14:15], v17 offset:2312
  s_waitcnt lgkmcnt(0)
  s_add_u32 m0, s48, 0
  s_add_u32 s92, s84, 0x0
  buffer_load_dwordx4 v16, s[8:11], s92 offen offset:0 lds
  s_add_u32 s92, s84, 0x3c00
  buffer_load_dwordx4 v16, s[8:11], s92 offen offset:1024 lds
  s_add_u32 s92, s84, 0x7800
  buffer_load_dwordx4 v16, s[8:11], s92 offen offset:2048 lds
  s_add_u32 s92, s84, 0xb400
  buffer_load_dwordx4 v16, s[8:11], s92 offen offset:3072 lds
  s_waitcnt vmcnt(28)
  ds_read_b64_tr_b16 a[16:17], v17 offset:4096
  ds_read_b64_tr_b16 a[18:19], v17 offset:4352
  ds_read_b64_tr_b16 a[24:25], v17 offset:4104
  ds_read_b64_tr_b16 a[26:27], v17 offset:4360
  ds_read_b64_tr_b16 a[20:21], v17 offset:6144
  ds_read_b64_tr_b16 a[22:23], v17 offset:6400
  ds_read_b64_tr_b16 a[28:29], v17 offset:6152
  ds_read_b64_tr_b16 a[30:31], v17 offset:6408
  s_waitcnt lgkmcnt(0)
  s_add_u32 m0, s48, 4096
  s_add_u32 s92, s84, 0x40
  buffer_load_dwordx4 v16, s[8:11], s92 offen offset:0 lds
  s_add_u32 s92, s84, 0x3c40
  buffer_load_dwordx4 v16, s[8:11], s92 offen offset:1024 lds
  s_add_u32 s92, s84, 0x7840
  buffer_load_dwordx4 v16, s[8:11], s92 offen offset:2048 lds
  s_add_u32 s92, s84, 0xb440
  buffer_load_dwordx4 v16, s[8:11], s92 offen offset:3072 lds
  s_waitcnt vmcnt(28)
  ds_read_b64_tr_b16 a[32:33], v17 offset:8192
  ds_read_b64_tr_b16 a[34:35], v17 offset:8448
  ds_read_b64_tr_b16 a[40:41], v17 offset:8200
  ds_read_b64_tr_b16 a[42:43], v17 offset:8456
  ds_read_b64_tr_b16 a[36:37], v17 offset:10240
  ds_read_b64_tr_b16 a[38:39], v17 offset:10496
  ds_read_b64_tr_b16 a[44:45], v17 offset:10248
  ds_read_b64_tr_b16 a[46:47], v17 offset:10504
  s_waitcnt lgkmcnt(0)
  s_add_u32 m0, s48, 8192
  s_add_u32 s92, s85, 0x0
  buffer_load_dwordx4 v16, s[8:11], s92 offen offset:0 lds
  s_add_u32 s92, s85, 0x3c00
  buffer_load_dwordx4 v16, s[8:11], s92 offen offset:1024 lds
  s_add_u32 s92, s85, 0x7800
  buffer_load_dwordx4 v16, s[8:11], s92 offen offset:2048 lds
  s_add_u32 s92, s85, 0xb400
  buffer_load_dwordx4 v16, s[8:11], s92 offen offset:3072 lds
  s_waitcnt vmcnt(28)
  ds_read_b64_tr_b16 a[48:49], v17 offset:12288
  ds_read_b64_tr_b16 a[50:51], v17 offset:12544
  ds_read_b64_tr_b16 a[56:57], v17 offset:12296
  ds_read_b64_tr_b16 a[58:59], v17 offset:12552
  ds_read_b64_tr_b16 a[52:53], v17 offset:14336
  ds_read_b64_tr_b16 a[54:55], v17 offset:14592
  ds_read_b64_tr_b16 a[60:61], v17 offset:14344
  ds_read_b64_tr_b16 a[62:63], v17 offset:14600
  s_waitcnt lgkmcnt(0)
  s_add_u32 m0, s48, 12288
  s_add_u32 s92, s85, 0x40
  buffer_load_dwordx4 v16, s[8:11], s92 offen offset:0 lds
  s_add_u32 s92, s85, 0x3c40
  buffer_load_dwordx4 v16, s[8:11], s92 offen offset:1024 lds
  s_add_u32 s92, s85, 0x7840
  buffer_load_dwordx4 v16, s[8:11], s92 offen offset:2048 lds
  s_add_u32 s92, s85, 0xb440
  buffer_load_dwordx4 v16, s[8:11], s92 offen offset:3072 lds
  s_waitcnt vmcnt(28)
  ds_read_b64_tr_b16 a[64:65], v17 offset:16384
  ds_read_b64_tr_b16 a[66:67], v17 offset:16640
  ds_read_b64_tr_b16 a[72:73], v17 offset:16392
  ds_read_b64_tr_b16 a[74:75], v17 offset:16648
  ds_read_b64_tr_b16 a[68:69], v17 offset:18432
  ds_read_b64_tr_b16 a[70:71], v17 offset:18688
  ds_read_b64_tr_b16 a[76:77], v17 offset:18440
  ds_read_b64_tr_b16 a[78:79], v17 offset:18696
  s_waitcnt lgkmcnt(0)
  s_add_u32 m0, s48, 16384
  s_add_u32 s92, s86, 0x0
  buffer_load_dwordx4 v16, s[8:11], s92 offen offset:0 lds
  s_add_u32 s92, s86, 0x3c00
  buffer_load_dwordx4 v16, s[8:11], s92 offen offset:1024 lds
  s_add_u32 s92, s86, 0x7800
  buffer_load_dwordx4 v16, s[8:11], s92 offen offset:2048 lds
  s_add_u32 s92, s86, 0xb400
  buffer_load_dwordx4 v16, s[8:11], s92 offen offset:3072 lds
  s_waitcnt vmcnt(28)
  ds_read_b64_tr_b16 a[80:81], v17 offset:20480
  ds_read_b64_tr_b16 a[82:83], v17 offset:20736
  ds_read_b64_tr_b16 a[88:89], v17 offset:20488
  ds_read_b64_tr_b16 a[90:91], v17 offset:20744
  ds_read_b64_tr_b16 a[84:85], v17 offset:22528
  ds_read_b64_tr_b16 a[86:87], v17 offset:22784
  ds_read_b64_tr_b16 a[92:93], v17 offset:22536
  ds_read_b64_tr_b16 a[94:95], v17 offset:22792
  s_waitcnt lgkmcnt(0)
  s_add_u32 m0, s48, 20480
  s_add_u32 s92, s86, 0x40
  buffer_load_dwordx4 v16, s[8:11], s92 offen offset:0 lds
  s_add_u32 s92, s86, 0x3c40
  buffer_load_dwordx4 v16, s[8:11], s92 offen offset:1024 lds
  s_add_u32 s92, s86, 0x7840
  buffer_load_dwordx4 v16, s[8:11], s92 offen offset:2048 lds
  s_add_u32 s92, s86, 0xb440
  buffer_load_dwordx4 v16, s[8:11], s92 offen offset:3072 lds
  s_waitcnt vmcnt(28)
  ds_read_b64_tr_b16 a[96:97], v17 offset:24576
  ds_read_b64_tr_b16 a[98:99], v17 offset:24832
  ds_read_b64_tr_b16 a[104:105], v17 offset:24584
  ds_read_b64_tr_b16 a[106:107], v17 offset:24840
  ds_read_b64_tr_b16 a[100:101], v17 offset:26624
  ds_read_b64_tr_b16 a[102:103], v17 offset:26880
  ds_read_b64_tr_b16 a[108:109], v17 offset:26632
  ds_read_b64_tr_b16 a[110:111], v17 offset:26888
  s_waitcnt lgkmcnt(0)
  s_waitcnt vmcnt(24)
  ds_read_b64_tr_b16 a[112:113], v17 offset:28672
  ds_read_b64_tr_b16 a[114:115], v17 offset:28928
  ds_read_b64_tr_b16 a[120:121], v17 offset:28680
  ds_read_b64_tr_b16 a[122:123], v17 offset:28936
  ds_read_b64_tr_b16 a[116:117], v17 offset:30720
  ds_read_b64_tr_b16 a[118:119], v17 offset:30976
  ds_read_b64_tr_b16 a[124:125], v17 offset:30728
  ds_read_b64_tr_b16 a[126:127], v17 offset:30984
  s_waitcnt lgkmcnt(0)
  s_waitcnt vmcnt(20)
  ds_read_b64_tr_b16 a[128:129], v17 offset:0
  ds_read_b64_tr_b16 a[130:131], v17 offset:256
  ds_read_b64_tr_b16 a[136:137], v17 offset:8
  ds_read_b64_tr_b16 a[138:139], v17 offset:264
  ds_read_b64_tr_b16 a[132:133], v17 offset:2048
  ds_read_b64_tr_b16 a[134:135], v17 offset:2304
  ds_read_b64_tr_b16 a[140:141], v17 offset:2056
  ds_read_b64_tr_b16 a[142:143], v17 offset:2312
  s_waitcnt lgkmcnt(0)
  s_waitcnt vmcnt(16)
  ds_read_b64_tr_b16 a[144:145], v17 offset:4096
  ds_read_b64_tr_b16 a[146:147], v17 offset:4352
  ds_read_b64_tr_b16 a[152:153], v17 offset:4104
  ds_read_b64_tr_b16 a[154:155], v17 offset:4360
  ds_read_b64_tr_b16 a[148:149], v17 offset:6144
  ds_read_b64_tr_b16 a[150:151], v17 offset:6400
  ds_read_b64_tr_b16 a[156:157], v17 offset:6152
  ds_read_b64_tr_b16 a[158:159], v17 offset:6408
  s_waitcnt lgkmcnt(0)
  s_waitcnt vmcnt(12)
  ds_read_b64_tr_b16 a[160:161], v17 offset:8192
  ds_read_b64_tr_b16 a[162:163], v17 offset:8448
  ds_read_b64_tr_b16 a[168:169], v17 offset:8200
  ds_read_b64_tr_b16 a[170:171], v17 offset:8456
  ds_read_b64_tr_b16 a[164:165], v17 offset:10240
  ds_read_b64_tr_b16 a[166:167], v17 offset:10496
  ds_read_b64_tr_b16 a[172:173], v17 offset:10248
  ds_read_b64_tr_b16 a[174:175], v17 offset:10504
  s_waitcnt lgkmcnt(0)
  s_waitcnt vmcnt(8)
  ds_read_b64_tr_b16 a[176:177], v17 offset:12288
  ds_read_b64_tr_b16 a[178:179], v17 offset:12544
  ds_read_b64_tr_b16 a[184:185], v17 offset:12296
  ds_read_b64_tr_b16 a[186:187], v17 offset:12552
  ds_read_b64_tr_b16 a[180:181], v17 offset:14336
  ds_read_b64_tr_b16 a[182:183], v17 offset:14592
  ds_read_b64_tr_b16 a[188:189], v17 offset:14344
  ds_read_b64_tr_b16 a[190:191], v17 offset:14600
  s_waitcnt lgkmcnt(0)
  s_waitcnt vmcnt(4)
  ds_read_b64_tr_b16 a[192:193], v17 offset:16384
  ds_read_b64_tr_b16 a[194:195], v17 offset:16640
  ds_read_b64_tr_b16 a[200:201], v17 offset:16392
  ds_read_b64_tr_b16 a[202:203], v17 offset:16648
  ds_read_b64_tr_b16 a[196:197], v17 offset:18432
  ds_read_b64_tr_b16 a[198:199], v17 offset:18688
  ds_read_b64_tr_b16 a[204:205], v17 offset:18440
  ds_read_b64_tr_b16 a[206:207], v17 offset:18696
  s_waitcnt lgkmcnt(0)
  s_waitcnt vmcnt(0)
  ds_read_b64_tr_b16 a[208:209], v17 offset:20480
  ds_read_b64_tr_b16 a[210:211], v17 offset:20736
  ds_read_b64_tr_b16 a[216:217], v17 offset:20488
  ds_read_b64_tr_b16 a[218:219], v17 offset:20744
  ds_read_b64_tr_b16 a[212:213], v17 offset:22528
  ds_read_b64_tr_b16 a[214:215], v17 offset:22784
  ds_read_b64_tr_b16 a[220:221], v17 offset:22536
  ds_read_b64_tr_b16 a[222:223], v17 offset:22792
  s_waitcnt lgkmcnt(0)
  s_waitcnt lgkmcnt(0)
  s_barrier
  v_min_u32 v2, 13, v0
  v_lshlrev_b32 v2, 7, v2
  s_mul_i32 s92, s44, 1792
  v_add_u32 v2, s92, v2
  v_mov_b32 v3, 1
  v_add_u32 v11, s48, v1
  v_and_b32 v4, 15, v0
  v_lshlrev_b32 v7, 10, v4
  v_lshrrev_b32 v8, 4, v0
  v_lshl_add_u32 v7, v8, 4, v7
  v_lshlrev_b32 v4, 3, v4
  s_mul_i32 s92, s44, 8192
  s_add_u32 s92, s92, 0
  v_add_u32 v5, s92, v1
  s_lshr_b32 s93, s44, 1
  s_lshl_b32 s94, s60, 1
  s_add_u32 s94, s94, s93
  s_lshl_b32 s94, s94, 11
  s_add_u32 s94, s94, 0
  v_add_u32 v6, s94, v1
  s_lshl_b32 s66, s56, 1
  s_add_u32 s66, s66, s93
  s_mov_b32 s8, s38
  s_and_b32 s9, s39, 0xffff
  s_mov_b32 s10, 0x200000
  s_mov_b32 s11, 0x20000
  s_mov_b32 s58, 0
  s_mov_b32 s59, 0
F2_INIT:
  s_lshl_b32 s92, s55, 7
  s_add_u32 s92, s92, s58
  s_mul_i32 s92, s92, 36864
  s_lshl_b32 s93, s60, 4
  s_add_u32 s93, s93, s66
  s_lshl_b32 s93, s93, 10
  s_add_u32 s62, s92, s93
  s_add_u32 s62, s62, 0x640000
  s_add_u32 s63, s62, 2359296
  s_lshl_b32 s64, s66, 8
  s_lshl_b32 s93, s60, 7
  s_add_u32 s64, s64, s93
  s_add_u32 s64, s64, s92
  s_add_u32 s64, s64, 0x888000
  s_lshl_b32 s65, s66, 1
  s_add_u32 s65, s65, s60
  s_lshl_b32 s65, s65, 7
  s_lshl_b32 s94, s55, 6
  s_add_u32 s94, s94, s58
  s_lshl_b32 s93, s94, 12
  s_add_u32 s65, s65, s93
  s_add_u32 s65, s65, 0xc180000
  s_lshl_b32 s61, s55, 6
  s_add_u32 s61, s61, s58
  s_mul_i32 s61, s61, 114688
  s_mul_i32 s93, s44, 14336
  s_add_u32 s61, s61, s93
  s_add_u32 s61, s61, 0xe00000
  s_lshl_b32 s67, s94, 13
  s_add_u32 s67, s67, 0xc300000
  s_add_u32 s88, s61, 57344
  s_cmp_lg_u32 s55, 0
  s_cbranch_scc1 F2B
  s_lshl_b32 s70, s45, 7
  s_add_u32 s70, s70, 0x80000
F2A_WAIT:
  buffer_load_dword v8, v2, s[4:7], s67 offen sc1
  s_waitcnt vmcnt(0)
  v_cmp_eq_u32 vcc, 0, v8
  s_mov_b64 exec, 1
  buffer_store_dword v3, off, s[4:7], s70 sc1
  s_mov_b64 exec, -1
  s_cbranch_vccz polld_2506
  s_mov_b32 s101, 0
poll_2505:
  s_add_u32 s47, s47, 1
  s_mov_b32 s49, 4
  s_cmp_gt_u32 s47, 131072
  s_cbranch_scc1 TIMEOUT
  s_sleep 3
  buffer_load_dword v8, v2, s[4:7], s67 offen sc1
  s_waitcnt vmcnt(0)
  v_cmp_eq_u32 vcc, 0, v8
  s_nop 0
  s_cbranch_vccnz poll_2505
polld_2506:
  s_add_u32 s69, s61, s72
  buffer_load_dwordx4 v[128:131], v1, s[4:7], s69 offen offset:0 sc1
  buffer_load_dwordx4 v[132:135], v1, s[4:7], s69 offen offset:1024 sc1
  s_add_u32 s69, s61, s73
  buffer_load_dwordx4 v[136:139], v1, s[4:7], s69 offen offset:0 sc1
  buffer_load_dwordx4 v[140:143], v1, s[4:7], s69 offen offset:1024 sc1
  s_add_u32 s69, s61, s74
  buffer_load_dwordx4 v[144:147], v1, s[4:7], s69 offen offset:0 sc1
  buffer_load_dwordx4 v[148:151], v1, s[4:7], s69 offen offset:1024 sc1
  s_add_u32 s69, s61, s75
  buffer_load_dwordx4 v[152:155], v1, s[4:7], s69 offen offset:0 sc1
  buffer_load_dwordx4 v[156:159], v1, s[4:7], s69 offen offset:1024 sc1
  s_add_u32 s69, s61, s76
  buffer_load_dwordx4 v[160:163], v1, s[4:7], s69 offen offset:0 sc1
  buffer_load_dwordx4 v[164:167], v1, s[4:7], s69 offen offset:1024 sc1
  s_add_u32 s69, s61, s77
  buffer_load_dwordx4 v[168:171], v1, s[4:7], s69 offen offset:0 sc1
  buffer_load_dwordx4 v[172:175], v1, s[4:7], s69 offen offset:1024 sc1
  s_add_u32 s69, s61, s78
  buffer_load_dwordx4 v[176:179], v1, s[4:7], s69 offen offset:0 sc1
  buffer_load_dwordx4 v[180:183], v1, s[4:7], s69 offen offset:1024 sc1
  v_mov_b32 v10, 0
F2A_LOOP:
  buffer_load_dwordx4 v[48:51], v1, s[4:7], s62 offen sc1
  s_mul_i32 s93, s55, s58
  s_cmp_ge_u32 s93, 56
  s_cselect_b32 s52, 2, 1
  s_lshl_b32 s53, s52, 13
  s_add_u32 s53, s53, s67
  buffer_load_dword v10, v2, s[4:7], s53 offen sc1
  s_mul_i32 s89, s52, 114688
  s_add_u32 s89, s89, s61
  s_mul_i32 s92, s59, 32768
  v_add_u32 v8, s92, v5
  s_add_u32 s58, s58, s52
  s_mul_i32 s90, s52, 36864
  s_waitcnt vmcnt(15)
  v_mfma_f32_16x16x32_bf16 v[16:19], a[0:3], v[128:131], 0
  v_mfma_f32_16x16x32_bf16 v[20:23], a[8:11], v[128:131], 0
  v_mfma_f32_16x16x32_bf16 v[24:27], a[16:19], v[128:131], 0
  v_mfma_f32_16x16x32_bf16 v[28:31], a[24:27], v[128:131], 0
  s_waitcnt vmcnt(14)
  v_mfma_f32_16x16x32_bf16 v[16:19], a[4:7], v[132:135], v[16:19]
  s_add_u32 s69, s88, s72
  buffer_load_dwordx4 v[128:131], v1, s[4:7], s69 offen offset:0 sc1
  v_mfma_f32_16x16x32_bf16 v[20:23], a[12:15], v[132:135], v[20:23]
  v_mfma_f32_16x16x32_bf16 v[24:27], a[20:23], v[132:135], v[24:27]
  v_mfma_f32_16x16x32_bf16 v[28:31], a[28:31], v[132:135], v[28:31]
  s_waitcnt vmcnt(14)
  v_mfma_f32_16x16x32_bf16 v[16:19], a[32:35], v[136:139], v[16:19]
  buffer_load_dwordx4 v[132:135], v1, s[4:7], s69 offen offset:1024 sc1
  v_mfma_f32_16x16x32_bf16 v[20:23], a[40:43], v[136:139], v[20:23]
  v_mfma_f32_16x16x32_bf16 v[24:27], a[48:51], v[136:139], v[24:27]
  v_mfma_f32_16x16x32_bf16 v[28:31], a[56:59], v[136:139], v[28:31]
  s_waitcnt vmcnt(14)
  v_mfma_f32_16x16x32_bf16 v[16:19], a[36:39], v[140:143], v[16:19]
  s_add_u32 s69, s88, s73
  buffer_load_dwordx4 v[136:139], v1, s[4:7], s69 offen offset:0 sc1
  v_mfma_f32_16x16x32_bf16 v[20:23], a[44:47], v[140:143], v[20:23]
  v_mfma_f32_16x16x32_bf16 v[24:27], a[52:55], v[140:143], v[24:27]
  v_mfma_f32_16x16x32_bf16 v[28:31], a[60:63], v[140:143], v[28:31]
  s_waitcnt vmcnt(14)
  v_mfma_f32_16x16x32_bf16 v[16:19], a[64:67], v[144:147], v[16:19]
  buffer_load_dwordx4 v[140:143], v1, s[4:7], s69 offen offset:1024 sc1
  v_mfma_f32_16x16x32_bf16 v[20:23], a[72:75], v[144:147], v[20:23]
  v_mfma_f32_16x16x32_bf16 v[24:27], a[80:83], v[144:147], v[24:27]
  v_mfma_f32_16x16x32_bf16 v[28:31], a[88:91], v[144:147], v[28:31]
  s_waitcnt vmcnt(14)
  v_mfma_f32_16x16x32_bf16 v[16:19], a[68:71], v[148:151], v[16:19]
  s_add_u32 s69, s88, s74
  buffer_load_dwordx4 v[144:147], v1, s[4:7], s69 offen offset:0 sc1
  v_mfma_f32_16x16x32_bf16 v[20:23], a[76:79], v[148:151], v[20:23]
  v_mfma_f32_16x16x32_bf16 v[24:27], a[84:87], v[148:151], v[24:27]
  v_mfma_f32_16x16x32_bf16 v[28:31], a[92:95], v[148:151], v[28:31]
  s_waitcnt vmcnt(14)
  v_mfma_f32_16x16x32_bf16 v[16:19], a[96:99], v[152:155], v[16:19]
  buffer_load_dwordx4 v[148:151], v1, s[4:7], s69 offen offset:1024 sc1
  v_mfma_f32_16x16x32_bf16 v[20:23], a[104:107], v[152:155], v[20:23]
  v_mfma_f32_16x16x32_bf16 v[24:27], a[112:115], v[152:155], v[24:27]
  v_mfma_f32_16x16x32_bf16 v[28:31], a[120:123], v[152:155], v[28:31]
  s_waitcnt vmcnt(14)
  v_mfma_f32_16x16x32_bf16 v[16:19], a[100:103], v[156:159], v[16:19]
  s_add_u32 s69, s88, s75
  buffer_load_dwordx4 v[152:155], v1, s[4:7], s69 offen offset:0 sc1
  v_mfma_f32_16x16x32_bf16 v[20:23], a[108:111], v[156:159], v[20:23]
  v_mfma_f32_16x16x32_bf16 v[24:27], a[116:119], v[156:159], v[24:27]
  v_mfma_f32_16x16x32_bf16 v[28:31], a[124:127], v[156:159], v[28:31]
  s_waitcnt vmcnt(14)
  v_mfma_f32_16x16x32_bf16 v[16:19], a[128:131], v[160:163], v[16:19]
  buffer_load_dwordx4 v[156:159], v1, s[4:7], s69 offen offset:1024 sc1
  v_mfma_f32_16x16x32_bf16 v[20:23], a[136:139], v[160:163], v[20:23]
  v_mfma_f32_16x16x32_bf16 v[24:27], a[144:147], v[160:163], v[24:27]
  v_mfma_f32_16x16x32_bf16 v[28:31], a[152:155], v[160:163], v[28:31]
  s_waitcnt vmcnt(14)
  v_mfma_f32_16x16x32_bf16 v[16:19], a[132:135], v[164:167], v[16:19]
  s_add_u32 s69, s88, s76
  buffer_load_dwordx4 v[160:163], v1, s[4:7], s69 offen offset:0 sc1
  v_mfma_f32_16x16x32_bf16 v[20:23], a[140:143], v[164:167], v[20:23]
  v_mfma_f32_16x16x32_bf16 v[24:27], a[148:151], v[164:167], v[24:27]
  v_mfma_f32_16x16x32_bf16 v[28:31], a[156:159], v[164:167], v[28:31]
  s_waitcnt vmcnt(14)
  v_mfma_f32_16x16x32_bf16 v[16:19], a[160:163], v[168:171], v[16:19]
  buffer_load_dwordx4 v[164:167], v1, s[4:7], s69 offen offset:1024 sc1
  v_mfma_f32_16x16x32_bf16 v[20:23], a[168:171], v[168:171], v[20:23]
  v_mfma_f32_16x16x32_bf16 v[24:27], a[176:179], v[168:171], v[24:27]
  v_mfma_f32_16x16x32_bf16 v[28:31], a[184:187], v[168:171], v[28:31]
  s_waitcnt vmcnt(14)
  v_mfma_f32_16x16x32_bf16 v[16:19], a[164:167], v[172:175], v[16:19]
  s_add_u32 s69, s88, s77
  buffer_load_dwordx4 v[168:171], v1, s[4:7], s69 offen offset:0 sc1
  v_mfma_f32_16x16x32_bf16 v[20:23], a[172:175], v[172:175], v[20:23]
  v_mfma_f32_16x16x32_bf16 v[24:27], a[180:183], v[172:175], v[24:27]
  v_mfma_f32_16x16x32_bf16 v[28:31], a[188:191], v[172:175], v[28:31]
  s_waitcnt vmcnt(14)
  v_mfma_f32_16x16x32_bf16 v[16:19], a[192:195], v[176:179], v[16:19]
  buffer_load_dwordx4 v[172:175], v1, s[4:7], s69 offen offset:1024 sc1
  v_mfma_f32_16x16x32_bf16 v[20:23], a[200:203], v[176:179], v[20:23]
  v_mfma_f32_16x16x32_bf16 v[24:27], a[208:211], v[176:179], v[24:27]
  v_mfma_f32_16x16x32_bf16 v[28:31], a[216:219], v[176:179], v[28:31]
  s_waitcnt vmcnt(14)
  v_mfma_f32_16x16x32_bf16 v[16:19], a[196:199], v[180:183], v[16:19]
  s_add_u32 s69, s88, s78
  buffer_load_dwordx4 v[176:179], v1, s[4:7], s69 offen offset:0 sc1
  v_mfma_f32_16x16x32_bf16 v[20:23], a[204:207], v[180:183], v[20:23]
  v_mfma_f32_16x16x32_bf16 v[24:27], a[212:215], v[180:183], v[24:27]
  v_mfma_f32_16x16x32_bf16 v[28:31], a[220:223], v[180:183], v[28:31]
  buffer_load_dwordx4 v[180:183], v1, s[4:7], s69 offen offset:1024 sc1
  s_waitcnt vmcnt(14)
  v_cmp_ne_u32 vcc, 0, v10
  s_nop 0
  s_cmp_eq_u64 vcc, -1
  s_cselect_b32 s68, 1, 0
  s_cmp_lt_u32 s58, 64
  s_cselect_b32 s68, s68, 0
  s_cmp_eq_u32 s68, 0
  s_cbranch_scc1 F2A_PLAIN
  s_waitcnt vmcnt(13)
  v_mfma_f32_16x16x32_bf16 v[32:35], a[0:3], v[128:131], 0
  v_mfma_f32_16x16x32_bf16 v[36:39], a[8:11], v[128:131], 0
  v_mfma_f32_16x16x32_bf16 v[40:43], a[16:19], v[128:131], 0
  v_mfma_f32_16x16x32_bf16 v[44:47], a[24:27], v[128:131], 0
  s_mov_b64 exec, 1
  buffer_store_dword v3, off, s[4:7], s70 sc1
  s_mov_b64 exec, -1
  s_waitcnt vmcnt(13)
  v_mfma_f32_16x16x32_bf16 v[32:35], a[4:7], v[132:135], v[32:35]
  ds_write_b128 v8, v[16:19] offset:0
  s_add_u32 s69, s89, s72
  buffer_load_dwordx4 v[128:131], v1, s[4:7], s69 offen offset:0 sc1
  v_mfma_f32_16x16x32_bf16 v[36:39], a[12:15], v[132:135], v[36:39]
  ds_write_b128 v8, v[20:23] offset:1024
  ds_write_b128 v8, v[24:27] offset:2048
  v_mfma_f32_16x16x32_bf16 v[40:43], a[20:23], v[132:135], v[40:43]
  ds_write_b128 v8, v[28:31] offset:3072
  v_mfma_f32_16x16x32_bf16 v[44:47], a[28:31], v[132:135], v[44:47]
  s_waitcnt vmcnt(13)
  v_mfma_f32_16x16x32_bf16 v[32:35], a[32:35], v[136:139], v[32:35]
  buffer_load_dwordx4 v[132:135], v1, s[4:7], s69 offen offset:1024 sc1
  v_mfma_f32_16x16x32_bf16 v[36:39], a[40:43], v[136:139], v[36:39]
  v_mfma_f32_16x16x32_bf16 v[40:43], a[48:51], v[136:139], v[40:43]
  v_mfma_f32_16x16x32_bf16 v[44:47], a[56:59], v[136:139], v[44:47]
  s_waitcnt vmcnt(13)
  buffer_load_dword v9, v2, s[4:7], s53 offen sc1
  v_mfma_f32_16x16x32_bf16 v[32:35], a[36:39], v[140:143], v[32:35]
  s_add_u32 s69, s89, s73
  buffer_load_dwordx4 v[136:139], v1, s[4:7], s69 offen offset:0 sc1
  v_mfma_f32_16x16x32_bf16 v[36:39], a[44:47], v[140:143], v[36:39]
  v_mfma_f32_16x16x32_bf16 v[40:43], a[52:55], v[140:143], v[40:43]
  v_mfma_f32_16x16x32_bf16 v[44:47], a[60:63], v[140:143], v[44:47]
  s_waitcnt vmcnt(14)
  v_mfma_f32_16x16x32_bf16 v[32:35], a[64:67], v[144:147], v[32:35]
  buffer_load_dwordx4 v[140:143], v1, s[4:7], s69 offen offset:1024 sc1
  v_mfma_f32_16x16x32_bf16 v[36:39], a[72:75], v[144:147], v[36:39]
  v_mfma_f32_16x16x32_bf16 v[40:43], a[80:83], v[144:147], v[40:43]
  v_mfma_f32_16x16x32_bf16 v[44:47], a[88:91], v[144:147], v[44:47]
  s_waitcnt vmcnt(14)
  v_mfma_f32_16x16x32_bf16 v[32:35], a[68:71], v[148:151], v[32:35]
  s_add_u32 s69, s89, s74
  buffer_load_dwordx4 v[144:147], v1, s[4:7], s69 offen offset:0 sc1
  v_mfma_f32_16x16x32_bf16 v[36:39], a[76:79], v[148:151], v[36:39]
  v_mfma_f32_16x16x32_bf16 v[40:43], a[84:87], v[148:151], v[40:43]
  v_mfma_f32_16x16x32_bf16 v[44:47], a[92:95], v[148:151], v[44:47]
  s_waitcnt vmcnt(14)
  v_mfma_f32_16x16x32_bf16 v[32:35], a[96:99], v[152:155], v[32:35]
  buffer_load_dwordx4 v[148:151], v1, s[4:7], s69 offen offset:1024 sc1
  v_mfma_f32_16x16x32_bf16 v[36:39], a[104:107], v[152:155], v[36:39]
  v_mfma_f32_16x16x32_bf16 v[40:43], a[112:115], v[152:155], v[40:43]
  v_mfma_f32_16x16x32_bf16 v[44:47], a[120:123], v[152:155], v[44:47]
  s_waitcnt vmcnt(14)
  v_mfma_f32_16x16x32_bf16 v[32:35], a[100:103], v[156:159], v[32:35]
  s_add_u32 s69, s89, s75
  buffer_load_dwordx4 v[152:155], v1, s[4:7], s69 offen offset:0 sc1
  v_mfma_f32_16x16x32_bf16 v[36:39], a[108:111], v[156:159], v[36:39]
  v_mfma_f32_16x16x32_bf16 v[40:43], a[116:119], v[156:159], v[40:43]
  v_mfma_f32_16x16x32_bf16 v[44:47], a[124:127], v[156:159], v[44:47]
  s_waitcnt vmcnt(14)
  v_mfma_f32_16x16x32_bf16 v[32:35], a[128:131], v[160:163], v[32:35]
  buffer_load_dwordx4 v[156:159], v1, s[4:7], s69 offen offset:1024 sc1
  v_mfma_f32_16x16x32_bf16 v[36:39], a[136:139], v[160:163], v[36:39]
  v_mfma_f32_16x16x32_bf16 v[40:43], a[144:147], v[160:163], v[40:43]
  v_mfma_f32_16x16x32_bf16 v[44:47], a[152:155], v[160:163], v[44:47]
  s_waitcnt vmcnt(14)
  v_mfma_f32_16x16x32_bf16 v[32:35], a[132:135], v[164:167], v[32:35]
  s_add_u32 s69, s89, s76
  buffer_load_dwordx4 v[160:163], v1, s[4:7], s69 offen offset:0 sc1
  v_mfma_f32_16x16x32_bf16 v[36:39], a[140:143], v[164:167], v[36:39]
  v_mfma_f32_16x16x32_bf16 v[40:43], a[148:151], v[164:167], v[40:43]
  v_mfma_f32_16x16x32_bf16 v[44:47], a[156:159], v[164:167], v[44:47]
  s_waitcnt vmcnt(14)
  v_mfma_f32_16x16x32_bf16 v[32:35], a[160:163], v[168:171], v[32:35]
  buffer_load_dwordx4 v[164:167], v1, s[4:7], s69 offen offset:1024 sc1
  v_mfma_f32_16x16x32_bf16 v[36:39], a[168:171], v[168:171], v[36:39]
  v_mfma_f32_16x16x32_bf16 v[40:43], a[176:179], v[168:171], v[40:43]
  v_mfma_f32_16x16x32_bf16 v[44:47], a[184:187], v[168:171], v[44:47]
  s_waitcnt vmcnt(14)
  v_mfma_f32_16x16x32_bf16 v[32:35], a[164:167], v[172:175], v[32:35]
  s_add_u32 s69, s89, s77
  buffer_load_dwordx4 v[168:171], v1, s[4:7], s69 offen offset:0 sc1
  v_mfma_f32_16x16x32_bf16 v[36:39], a[172:175], v[172:175], v[36:39]
  v_mfma_f32_16x16x32_bf16 v[40:43], a[180:183], v[172:175], v[40:43]
  v_mfma_f32_16x16x32_bf16 v[44:47], a[188:191], v[172:175], v[44:47]
  s_waitcnt vmcnt(14)
  v_mfma_f32_16x16x32_bf16 v[32:35], a[192:195], v[176:179], v[32:35]
  buffer_load_dwordx4 v[172:175], v1, s[4:7], s69 offen offset:1024 sc1
  v_mfma_f32_16x16x32_bf16 v[36:39], a[200:203], v[176:179], v[36:39]
  v_mfma_f32_16x16x32_bf16 v[40:43], a[208:211], v[176:179], v[40:43]
  v_mfma_f32_16x16x32_bf16 v[44:47], a[216:219], v[176:179], v[44:47]
  s_waitcnt vmcnt(14)
  v_mfma_f32_16x16x32_bf16 v[32:35], a[196:199], v[180:183], v[32:35]
  s_add_u32 s69, s89, s78
  buffer_load_dwordx4 v[176:179], v1, s[4:7], s69 offen offset:0 sc1
  v_mfma_f32_16x16x32_bf16 v[36:39], a[204:207], v[180:183], v[36:39]
  v_mfma_f32_16x16x32_bf16 v[40:43], a[212:215], v[180:183], v[40:43]
  v_mfma_f32_16x16x32_bf16 v[44:47], a[220:223], v[180:183], v[44:47]
  buffer_load_dwordx4 v[180:183], v1, s[4:7], s69 offen offset:1024 sc1
  s_nop 1
  ds_write_b128 v8, v[32:35] offset:4096
  s_nop 1
  ds_write_b128 v8, v[36:39] offset:5120
  ds_write_b128 v8, v[40:43] offset:6144
  ds_write_b128 v8, v[44:47] offset:7168
  v_add_u32 v8, s92, v6
  s_xor_b32 s59, s59, 1
  s_mov_b32 s61, s89
  s_add_u32 s88, s61, 57344
  s_mov_b32 s67, s53
  s_waitcnt lgkmcnt(0)
  s_barrier
  ds_read_b128 v[52:55], v8 offset:0
  ds_read_b128 v[56:59], v8 offset:1024
  ds_read_b128 v[60:63], v8 offset:8192
  ds_read_b128 v[64:67], v8 offset:9216
  ds_read_b128 v[68:71], v8 offset:16384
  ds_read_b128 v[72:75], v8 offset:17408
  ds_read_b128 v[76:79], v8 offset:24576
  ds_read_b128 v[80:83], v8 offset:25600
  v_lshlrev_b32 v84, 16, v48
  v_and_b32 v85, 0xffff0000, v48
  v_lshlrev_b32 v86, 16, v49
  v_and_b32 v87, 0xffff0000, v49
  v_lshlrev_b32 v88, 16, v50
  v_and_b32 v89, 0xffff0000, v50
  v_lshlrev_b32 v90, 16, v51
  v_and_b32 v91, 0xffff0000, v51
  s_waitcnt lgkmcnt(5)
  v_pk_add_f32 v[52:53], v[52:53], v[60:61]
  v_pk_add_f32 v[54:55], v[54:55], v[62:63]
  s_waitcnt lgkmcnt(4)
  v_pk_add_f32 v[56:57], v[56:57], v[64:65]
  v_pk_add_f32 v[58:59], v[58:59], v[66:67]
  s_waitcnt lgkmcnt(1)
  v_pk_add_f32 v[68:69], v[68:69], v[76:77]
  v_pk_add_f32 v[70:71], v[70:71], v[78:79]
  s_waitcnt lgkmcnt(0)
  v_pk_add_f32 v[72:73], v[72:73], v[80:81]
  v_pk_add_f32 v[74:75], v[74:75], v[82:83]
  v_pk_add_f32 v[52:53], v[52:53], v[68:69]
  v_pk_add_f32 v[54:55], v[54:55], v[70:71]
  v_pk_add_f32 v[56:57], v[56:57], v[72:73]
  v_pk_add_f32 v[58:59], v[58:59], v[74:75]
  v_cvt_pk_bf16_f32 v60, v52, v53
  v_cvt_pk_bf16_f32 v61, v54, v55
  v_cvt_pk_bf16_f32 v62, v56, v57
  v_cvt_pk_bf16_f32 v63, v58, v59
  v_lshlrev_b32 v52, 16, v60
  v_and_b32 v53, 0xffff0000, v60
  v_lshlrev_b32 v54, 16, v61
  v_and_b32 v55, 0xffff0000, v61
  v_lshlrev_b32 v56, 16, v62
  v_and_b32 v57, 0xffff0000, v62
  v_lshlrev_b32 v58, 16, v63
  v_and_b32 v59, 0xffff0000, v63
  v_pk_add_f32 v[84:85], v[84:85], v[52:53]
  v_pk_add_f32 v[86:87], v[86:87], v[54:55]
  v_pk_add_f32 v[88:89], v[88:89], v[56:57]
  v_pk_add_f32 v[90:91], v[90:91], v[58:59]
  v_cvt_pk_bf16_f32 v64, v84, v85
  v_cvt_pk_bf16_f32 v65, v86, v87
  v_cvt_pk_bf16_f32 v66, v88, v89
  v_cvt_pk_bf16_f32 v67, v90, v91
  buffer_store_dwordx4 v[64:67], v1, s[4:7], s63 offen sc1
  v_lshlrev_b32 v84, 16, v64
  v_and_b32 v85, 0xffff0000, v64
  v_lshlrev_b32 v86, 16, v65
  v_and_b32 v87, 0xffff0000, v65
  v_lshlrev_b32 v88, 16, v66
  v_and_b32 v89, 0xffff0000, v66
  v_lshlrev_b32 v90, 16, v67
  v_and_b32 v91, 0xffff0000, v67
  v_pk_add_f32 v[92:93], v[84:85], v[86:87]
  v_pk_add_f32 v[94:95], v[88:89], v[90:91]
  v_pk_add_f32 v[92:93], v[92:93], v[94:95]
  v_add_f32 v92, v92, v93
  v_mov_b32 v94, v92
  s_nop 1
  v_permlane16_swap_b32 v92, v94
  v_add_f32 v92, v92, v94
  v_mov_b32 v94, v92
  s_nop 1
  v_permlane32_swap_b32 v92, v94
  v_add_f32 v92, v92, v94
  v_mul_f32 v92, 0x3d000000, v92
  v_pk_add_f32 v[84:85], v[84:85], v[92:93] op_sel_hi:[1,0] neg_lo:[0,1] neg_hi:[0,1]
  v_pk_add_f32 v[86:87], v[86:87], v[92:93] op_sel_hi:[1,0] neg_lo:[0,1] neg_hi:[0,1]
  v_pk_add_f32 v[88:89], v[88:89], v[92:93] op_sel_hi:[1,0] neg_lo:[0,1] neg_hi:[0,1]
  v_pk_add_f32 v[90:91], v[90:91], v[92:93] op_sel_hi:[1,0] neg_lo:[0,1] neg_hi:[0,1]
  v_pk_mul_f32 v[94:95], v[84:85], v[84:85]
  v_pk_fma_f32 v[94:95], v[86:87], v[86:87], v[94:95]
  v_pk_fma_f32 v[94:95], v[88:89], v[88:89], v[94:95]
  v_pk_fma_f32 v[94:95], v[90:91], v[90:91], v[94:95]
  v_add_f32 v93, v94, v95
  v_mov_b32 v94, v93
  s_nop 1
  v_permlane16_swap_b32 v93, v94
  v_add_f32 v93, v93, v94
  v_mov_b32 v94, v93
  s_nop 1
  v_permlane32_swap_b32 v93, v94
  v_add_f32 v93, v93, v94
  s_mov_b64 exec, 0xffff
  buffer_store_dwordx2 v[92:93], v4, s[4:7], s64 offen sc1
  s_mov_b64 exec, -1
  s_mov_b32 s70, s65
  s_lshl_b32 s93, s52, 12
  s_add_u32 s65, s65, s93
  s_add_u32 s62, s62, s90
  s_add_u32 s63, s63, s90
  s_add_u32 s64, s64, s90
  s_branch F2A_LOOP
F2A_PLAIN:
  s_waitcnt vmcnt(13)
  v_mfma_f32_16x16x32_bf16 v[32:35], a[0:3], v[128:131], 0
  v_mfma_f32_16x16x32_bf16 v[36:39], a[8:11], v[128:131], 0
  v_mfma_f32_16x16x32_bf16 v[40:43], a[16:19], v[128:131], 0
  v_mfma_f32_16x16x32_bf16 v[44:47], a[24:27], v[128:131], 0
  s_mov_b64 exec, 1
  buffer_store_dword v3, off, s[4:7], s70 sc1
  s_mov_b64 exec, -1
  s_waitcnt vmcnt(13)
  v_mfma_f32_16x16x32_bf16 v[32:35], a[4:7], v[132:135], v[32:35]
  ds_write_b128 v8, v[16:19] offset:0
  ds_write_b128 v8, v[20:23] offset:1024
  v_mfma_f32_16x16x32_bf16 v[36:39], a[12:15], v[132:135], v[36:39]
  ds_write_b128 v8, v[24:27] offset:2048
  ds_write_b128 v8, v[28:31] offset:3072
  v_mfma_f32_16x16x32_bf16 v[40:43], a[20:23], v[132:135], v[40:43]
  v_mfma_f32_16x16x32_bf16 v[44:47], a[28:31], v[132:135], v[44:47]
  s_waitcnt vmcnt(12)
  v_mfma_f32_16x16x32_bf16 v[32:35], a[32:35], v[136:139], v[32:35]
  v_mfma_f32_16x16x32_bf16 v[36:39], a[40:43], v[136:139], v[36:39]
  v_mfma_f32_16x16x32_bf16 v[40:43], a[48:51], v[136:139], v[40:43]
  v_mfma_f32_16x16x32_bf16 v[44:47], a[56:59], v[136:139], v[44:47]
  s_waitcnt vmcnt(11)
  buffer_load_dword v9, v2, s[4:7], s53 offen sc1
  v_mfma_f32_16x16x32_bf16 v[32:35], a[36:39], v[140:143], v[32:35]
  v_mfma_f32_16x16x32_bf16 v[36:39], a[44:47], v[140:143], v[36:39]
  v_mfma_f32_16x16x32_bf16 v[40:43], a[52:55], v[140:143], v[40:43]
  v_mfma_f32_16x16x32_bf16 v[44:47], a[60:63], v[140:143], v[44:47]
  s_waitcnt vmcnt(11)
  v_mfma_f32_16x16x32_bf16 v[32:35], a[64:67], v[144:147], v[32:35]
  v_mfma_f32_16x16x32_bf16 v[36:39], a[72:75], v[144:147], v[36:39]
  v_mfma_f32_16x16x32_bf16 v[40:43], a[80:83], v[144:147], v[40:43]
  v_mfma_f32_16x16x32_bf16 v[44:47], a[88:91], v[144:147], v[44:47]
  s_waitcnt vmcnt(10)
  v_mfma_f32_16x16x32_bf16 v[32:35], a[68:71], v[148:151], v[32:35]
  v_mfma_f32_16x16x32_bf16 v[36:39], a[76:79], v[148:151], v[36:39]
  v_mfma_f32_16x16x32_bf16 v[40:43], a[84:87], v[148:151], v[40:43]
  v_mfma_f32_16x16x32_bf16 v[44:47], a[92:95], v[148:151], v[44:47]
  s_waitcnt vmcnt(9)
  v_mfma_f32_16x16x32_bf16 v[32:35], a[96:99], v[152:155], v[32:35]
  v_mfma_f32_16x16x32_bf16 v[36:39], a[104:107], v[152:155], v[36:39]
  v_mfma_f32_16x16x32_bf16 v[40:43], a[112:115], v[152:155], v[40:43]
  v_mfma_f32_16x16x32_bf16 v[44:47], a[120:123], v[152:155], v[44:47]
  s_waitcnt vmcnt(8)
  v_mfma_f32_16x16x32_bf16 v[32:35], a[100:103], v[156:159], v[32:35]
  v_mfma_f32_16x16x32_bf16 v[36:39], a[108:111], v[156:159], v[36:39]
  v_mfma_f32_16x16x32_bf16 v[40:43], a[116:119], v[156:159], v[40:43]
  v_mfma_f32_16x16x32_bf16 v[44:47], a[124:127], v[156:159], v[44:47]
  s_waitcnt vmcnt(7)
  v_mfma_f32_16x16x32_bf16 v[32:35], a[128:131], v[160:163], v[32:35]
  v_mfma_f32_16x16x32_bf16 v[36:39], a[136:139], v[160:163], v[36:39]
  v_mfma_f32_16x16x32_bf16 v[40:43], a[144:147], v[160:163], v[40:43]
  v_mfma_f32_16x16x32_bf16 v[44:47], a[152:155], v[160:163], v[44:47]
  s_waitcnt vmcnt(6)
  v_mfma_f32_16x16x32_bf16 v[32:35], a[132:135], v[164:167], v[32:35]
  v_mfma_f32_16x16x32_bf16 v[36:39], a[140:143], v[164:167], v[36:39]
  v_mfma_f32_16x16x32_bf16 v[40:43], a[148:151], v[164:167], v[40:43]
  v_mfma_f32_16x16x32_bf16 v[44:47], a[156:159], v[164:167], v[44:47]
  s_waitcnt vmcnt(5)
  v_mfma_f32_16x16x32_bf16 v[32:35], a[160:163], v[168:171], v[32:35]
  v_mfma_f32_16x16x32_bf16 v[36:39], a[168:171], v[168:171], v[36:39]
  v_mfma_f32_16x16x32_bf16 v[40:43], a[176:179], v[168:171], v[40:43]
  v_mfma_f32_16x16x32_bf16 v[44:47], a[184:187], v[168:171], v[44:47]
  s_waitcnt vmcnt(4)
  v_mfma_f32_16x16x32_bf16 v[32:35], a[164:167], v[172:175], v[32:35]
  v_mfma_f32_16x16x32_bf16 v[36:39], a[172:175], v[172:175], v[36:39]
  v_mfma_f32_16x16x32_bf16 v[40:43], a[180:183], v[172:175], v[40:43]
  v_mfma_f32_16x16x32_bf16 v[44:47], a[188:191], v[172:175], v[44:47]
  s_waitcnt vmcnt(3)
  v_mfma_f32_16x16x32_bf16 v[32:35], a[192:195], v[176:179], v[32:35]
  v_mfma_f32_16x16x32_bf16 v[36:39], a[200:203], v[176:179], v[36:39]
  v_mfma_f32_16x16x32_bf16 v[40:43], a[208:211], v[176:179], v[40:43]
  v_mfma_f32_16x16x32_bf16 v[44:47], a[216:219], v[176:179], v[44:47]
  s_waitcnt vmcnt(2)
  v_mfma_f32_16x16x32_bf16 v[32:35], a[196:199], v[180:183], v[32:35]
  v_mfma_f32_16x16x32_bf16 v[36:39], a[204:207], v[180:183], v[36:39]
  v_mfma_f32_16x16x32_bf16 v[40:43], a[212:215], v[180:183], v[40:43]
  v_mfma_f32_16x16x32_bf16 v[44:47], a[220:223], v[180:183], v[44:47]
  s_nop 4
  ds_write_b128 v8, v[32:35] offset:4096
  ds_write_b128 v8, v[36:39] offset:5120
  ds_write_b128 v8, v[40:43] offset:6144
  ds_write_b128 v8, v[44:47] offset:7168
  v_add_u32 v8, s92, v6
  s_xor_b32 s59, s59, 1
  s_mov_b32 s61, s89
  s_add_u32 s88, s61, 57344
  s_mov_b32 s67, s53
  s_waitcnt vmcnt(0)
  v_cmp_ne_u32 vcc, 0, v9
  s_nop 0
  s_cmp_eq_u64 vcc, -1
  s_cselect_b32 s68, 1, 0
  s_cmp_lt_u32 s58, 64
  s_cselect_b32 s68, s68, 0
  s_cmp_eq_u32 s68, 0
  s_cbranch_scc1 F2A_DRAIN
  s_add_u32 s69, s61, s72
  buffer_load_dwordx4 v[128:131], v1, s[4:7], s69 offen offset:0 sc1
  buffer_load_dwordx4 v[132:135], v1, s[4:7], s69 offen offset:1024 sc1
  s_add_u32 s69, s61, s73
  buffer_load_dwordx4 v[136:139], v1, s[4:7], s69 offen offset:0 sc1
  buffer_load_dwordx4 v[140:143], v1, s[4:7], s69 offen offset:1024 sc1
  s_waitcnt lgkmcnt(0)
  s_barrier
  s_add_u32 s69, s61, s74
  buffer_load_dwordx4 v[144:147], v1, s[4:7], s69 offen offset:0 sc1
  ds_read_b128 v[52:55], v8 offset:0
  ds_read_b128 v[56:59], v8 offset:1024
  ds_read_b128 v[60:63], v8 offset:8192
  ds_read_b128 v[64:67], v8 offset:9216
  ds_read_b128 v[68:71], v8 offset:16384
  ds_read_b128 v[72:75], v8 offset:17408
  ds_read_b128 v[76:79], v8 offset:24576
  ds_read_b128 v[80:83], v8 offset:25600
  buffer_load_dwordx4 v[148:151], v1, s[4:7], s69 offen offset:1024 sc1
  v_lshlrev_b32 v84, 16, v48
  v_and_b32 v85, 0xffff0000, v48
  v_lshlrev_b32 v86, 16, v49
  v_and_b32 v87, 0xffff0000, v49
  v_lshlrev_b32 v88, 16, v50
  v_and_b32 v89, 0xffff0000, v50
  v_lshlrev_b32 v90, 16, v51
  v_and_b32 v91, 0xffff0000, v51
  s_add_u32 s69, s61, s75
  buffer_load_dwordx4 v[152:155], v1, s[4:7], s69 offen offset:0 sc1
  s_waitcnt lgkmcnt(5)
  v_pk_add_f32 v[52:53], v[52:53], v[60:61]
  v_pk_add_f32 v[54:55], v[54:55], v[62:63]
  s_waitcnt lgkmcnt(4)
  v_pk_add_f32 v[56:57], v[56:57], v[64:65]
  v_pk_add_f32 v[58:59], v[58:59], v[66:67]
  s_waitcnt lgkmcnt(1)
  v_pk_add_f32 v[68:69], v[68:69], v[76:77]
  v_pk_add_f32 v[70:71], v[70:71], v[78:79]
  s_waitcnt lgkmcnt(0)
  v_pk_add_f32 v[72:73], v[72:73], v[80:81]
  v_pk_add_f32 v[74:75], v[74:75], v[82:83]
  buffer_load_dwordx4 v[156:159], v1, s[4:7], s69 offen offset:1024 sc1
  v_pk_add_f32 v[52:53], v[52:53], v[68:69]
  v_pk_add_f32 v[54:55], v[54:55], v[70:71]
  v_pk_add_f32 v[56:57], v[56:57], v[72:73]
  v_pk_add_f32 v[58:59], v[58:59], v[74:75]
  v_cvt_pk_bf16_f32 v60, v52, v53
  v_cvt_pk_bf16_f32 v61, v54, v55
  v_cvt_pk_bf16_f32 v62, v56, v57
  v_cvt_pk_bf16_f32 v63, v58, v59
  s_add_u32 s69, s61, s76
  buffer_load_dwordx4 v[160:163], v1, s[4:7], s69 offen offset:0 sc1
  v_lshlrev_b32 v52, 16, v60
  v_and_b32 v53, 0xffff0000, v60
  v_lshlrev_b32 v54, 16, v61
  v_and_b32 v55, 0xffff0000, v61
  v_lshlrev_b32 v56, 16, v62
  v_and_b32 v57, 0xffff0000, v62
  v_lshlrev_b32 v58, 16, v63
  v_and_b32 v59, 0xffff0000, v63
  buffer_load_dwordx4 v[164:167], v1, s[4:7], s69 offen offset:1024 sc1
  v_pk_add_f32 v[84:85], v[84:85], v[52:53]
  v_pk_add_f32 v[86:87], v[86:87], v[54:55]
  v_pk_add_f32 v[88:89], v[88:89], v[56:57]
  v_pk_add_f32 v[90:91], v[90:91], v[58:59]
  v_cvt_pk_bf16_f32 v64, v84, v85
  v_cvt_pk_bf16_f32 v65, v86, v87
  v_cvt_pk_bf16_f32 v66, v88, v89
  v_cvt_pk_bf16_f32 v67, v90, v91
  s_add_u32 s69, s61, s77
  buffer_load_dwordx4 v[168:171], v1, s[4:7], s69 offen offset:0 sc1
  buffer_store_dwordx4 v[64:67], v1, s[4:7], s63 offen sc1
  v_lshlrev_b32 v84, 16, v64
  v_and_b32 v85, 0xffff0000, v64
  v_lshlrev_b32 v86, 16, v65
  v_and_b32 v87, 0xffff0000, v65
  v_lshlrev_b32 v88, 16, v66
  v_and_b32 v89, 0xffff0000, v66
  v_lshlrev_b32 v90, 16, v67
  buffer_load_dwordx4 v[172:175], v1, s[4:7], s69 offen offset:1024 sc1
  v_and_b32 v91, 0xffff0000, v67
  v_pk_add_f32 v[92:93], v[84:85], v[86:87]
  v_pk_add_f32 v[94:95], v[88:89], v[90:91]
  v_pk_add_f32 v[92:93], v[92:93], v[94:95]
  v_add_f32 v92, v92, v93
  v_mov_b32 v94, v92
  s_nop 1
  v_permlane16_swap_b32 v92, v94
  v_add_f32 v92, v92, v94
  s_add_u32 s69, s61, s78
  buffer_load_dwordx4 v[176:179], v1, s[4:7], s69 offen offset:0 sc1
  v_mov_b32 v94, v92
  s_nop 1
  v_permlane32_swap_b32 v92, v94
  v_add_f32 v92, v92, v94
  v_mul_f32 v92, 0x3d000000, v92
  v_pk_add_f32 v[84:85], v[84:85], v[92:93] op_sel_hi:[1,0] neg_lo:[0,1] neg_hi:[0,1]
  v_pk_add_f32 v[86:87], v[86:87], v[92:93] op_sel_hi:[1,0] neg_lo:[0,1] neg_hi:[0,1]
  v_pk_add_f32 v[88:89], v[88:89], v[92:93] op_sel_hi:[1,0] neg_lo:[0,1] neg_hi:[0,1]
  v_pk_add_f32 v[90:91], v[90:91], v[92:93] op_sel_hi:[1,0] neg_lo:[0,1] neg_hi:[0,1]
  buffer_load_dwordx4 v[180:183], v1, s[4:7], s69 offen offset:1024 sc1
  v_pk_mul_f32 v[94:95], v[84:85], v[84:85]
  v_pk_fma_f32 v[94:95], v[86:87], v[86:87], v[94:95]
  v_pk_fma_f32 v[94:95], v[88:89], v[88:89], v[94:95]
  v_pk_fma_f32 v[94:95], v[90:91], v[90:91], v[94:95]
  v_add_f32 v93, v94, v95
  v_mov_b32 v94, v93
  s_nop 1
  v_permlane16_swap_b32 v93, v94
  v_add_f32 v93, v93, v94
  v_mov_b32 v94, v93
  s_nop 1
  v_permlane32_swap_b32 v93, v94
  v_add_f32 v93, v93, v94
  s_mov_b64 exec, 0xffff
  buffer_store_dwordx2 v[92:93], v4, s[4:7], s64 offen sc1
  s_mov_b64 exec, -1
  s_mov_b32 s70, s65
  s_lshl_b32 s93, s52, 12
  s_add_u32 s65, s65, s93
  s_add_u32 s62, s62, s90
  s_add_u32 s63, s63, s90
  s_add_u32 s64, s64, s90
  s_branch F2A_LOOP
F2A_DRAIN:
  s_waitcnt lgkmcnt(0)
  s_barrier
  ds_read_b128 v[52:55], v8 offset:0
  ds_read_b128 v[56:59], v8 offset:1024
  ds_read_b128 v[60:63], v8 offset:8192
  ds_read_b128 v[64:67], v8 offset:9216
  ds_read_b128 v[68:71], v8 offset:16384
  ds_read_b128 v[72:75], v8 offset:17408
  ds_read_b128 v[76:79], v8 offset:24576
  ds_read_b128 v[80:83], v8 offset:25600
  v_lshlrev_b32 v84, 16, v48
  v_and_b32 v85, 0xffff0000, v48
  v_lshlrev_b32 v86, 16, v49
  v_and_b32 v87, 0xffff0000, v49
  v_lshlrev_b32 v88, 16, v50
  v_and_b32 v89, 0xffff0000, v50
  v_lshlrev_b32 v90, 16, v51
  v_and_b32 v91, 0xffff0000, v51
  s_waitcnt lgkmcnt(5)
  v_pk_add_f32 v[52:53], v[52:53], v[60:61]
  v_pk_add_f32 v[54:55], v[54:55], v[62:63]
  s_waitcnt lgkmcnt(4)
  v_pk_add_f32 v[56:57], v[56:57], v[64:65]
  v_pk_add_f32 v[58:59], v[58:59], v[66:67]
  s_waitcnt lgkmcnt(1)
  v_pk_add_f32 v[68:69], v[68:69], v[76:77]
  v_pk_add_f32 v[70:71], v[70:71], v[78:79]
  s_waitcnt lgkmcnt(0)
  v_pk_add_f32 v[72:73], v[72:73], v[80:81]
  v_pk_add_f32 v[74:75], v[74:75], v[82:83]
  v_pk_add_f32 v[52:53], v[52:53], v[68:69]
  v_pk_add_f32 v[54:55], v[54:55], v[70:71]
  v_pk_add_f32 v[56:57], v[56:57], v[72:73]
  v_pk_add_f32 v[58:59], v[58:59], v[74:75]
  v_cvt_pk_bf16_f32 v60, v52, v53
  v_cvt_pk_bf16_f32 v61, v54, v55
  v_cvt_pk_bf16_f32 v62, v56, v57
  v_cvt_pk_bf16_f32 v63, v58, v59
  v_lshlrev_b32 v52, 16, v60
  v_and_b32 v53, 0xffff0000, v60
  v_lshlrev_b32 v54, 16, v61
  v_and_b32 v55, 0xffff0000, v61
  v_lshlrev_b32 v56, 16, v62
  v_and_b32 v57, 0xffff0000, v62
  v_lshlrev_b32 v58, 16, v63
  v_and_b32 v59, 0xffff0000, v63
  v_pk_add_f32 v[84:85], v[84:85], v[52:53]
  v_pk_add_f32 v[86:87], v[86:87], v[54:55]
  v_pk_add_f32 v[88:89], v[88:89], v[56:57]
  v_pk_add_f32 v[90:91], v[90:91], v[58:59]
  v_cvt_pk_bf16_f32 v64, v84, v85
  v_cvt_pk_bf16_f32 v65, v86, v87
  v_cvt_pk_bf16_f32 v66, v88, v89
  v_cvt_pk_bf16_f32 v67, v90, v91
  buffer_store_dwordx4 v[64:67], v1, s[4:7], s63 offen sc1
  v_lshlrev_b32 v84, 16, v64
  v_and_b32 v85, 0xffff0000, v64
  v_lshlrev_b32 v86, 16, v65
  v_and_b32 v87, 0xffff0000, v65
  v_lshlrev_b32 v88, 16, v66
  v_and_b32 v89, 0xffff0000, v66
  v_lshlrev_b32 v90, 16, v67
  v_and_b32 v91, 0xffff0000, v67
  v_pk_add_f32 v[92:93], v[84:85], v[86:87]
  v_pk_add_f32 v[94:95], v[88:89], v[90:91]
  v_pk_add_f32 v[92:93], v[92:93], v[94:95]
  v_add_f32 v92, v92, v93
  v_mov_b32 v94, v92
  s_nop 1
  v_permlane16_swap_b32 v92, v94
  v_add_f32 v92, v92, v94
  v_mov_b32 v94, v92
  s_nop 1
  v_permlane32_swap_b32 v92, v94
  v_add_f32 v92, v92, v94
  v_mul_f32 v92, 0x3d000000, v92
  v_pk_add_f32 v[84:85], v[84:85], v[92:93] op_sel_hi:[1,0] neg_lo:[0,1] neg_hi:[0,1]
  v_pk_add_f32 v[86:87], v[86:87], v[92:93] op_sel_hi:[1,0] neg_lo:[0,1] neg_hi:[0,1]
  v_pk_add_f32 v[88:89], v[88:89], v[92:93] op_sel_hi:[1,0] neg_lo:[0,1] neg_hi:[0,1]
  v_pk_add_f32 v[90:91], v[90:91], v[92:93] op_sel_hi:[1,0] neg_lo:[0,1] neg_hi:[0,1]
  v_pk_mul_f32 v[94:95], v[84:85], v[84:85]
  v_pk_fma_f32 v[94:95], v[86:87], v[86:87], v[94:95]
  v_pk_fma_f32 v[94:95], v[88:89], v[88:89], v[94:95]
  v_pk_fma_f32 v[94:95], v[90:91], v[90:91], v[94:95]
  v_add_f32 v93, v94, v95
  v_mov_b32 v94, v93
  s_nop 1
  v_permlane16_swap_b32 v93, v94
  v_add_f32 v93, v93, v94
  v_mov_b32 v94, v93
  s_nop 1
  v_permlane32_swap_b32 v93, v94
  v_add_f32 v93, v93, v94
  s_mov_b64 exec, 0xffff
  buffer_store_dwordx2 v[92:93], v4, s[4:7], s64 offen sc1
  s_mov_b64 exec, -1
  s_mov_b32 s70, s65
  s_lshl_b32 s93, s52, 12
  s_add_u32 s65, s65, s93
  s_add_u32 s62, s62, s90
  s_add_u32 s63, s63, s90
  s_add_u32 s64, s64, s90
F2A_TAIL:
  s_cmp_lt_u32 s58, 64
  s_cbranch_scc1 F2A_WAIT
  s_waitcnt vmcnt(0)
  s_mov_b64 exec, 1
  buffer_store_dword v3, off, s[4:7], s70 sc1
  s_mov_b64 exec, -1
  s_cmp_lg_u32 s55, 0
  s_cbranch_scc1 END
  s_mov_b32 s55, 1
  s_mov_b32 s58, 57
  s_branch F2_INIT
F2B:
  s_lshl_b32 s63, s60, 14
  s_lshl_b32 s93, s66, 6
  s_add_u32 s63, s63, s93
  s_lshl_b32 s93, s58, 15
  s_add_u32 s63, s63, s93
  s_lshl_b32 s70, s45, 7
  s_add_u32 s70, s70, 0x80000
F2B_WAIT:
  s_mov_b32 s101, 0
poll_2507:
  buffer_load_dword v8, v2, s[4:7], s67 offen sc1
  s_waitcnt vmcnt(0)
  v_cmp_eq_u32 vcc, 0, v8
  s_nop 0
  s_cbranch_vccz polld_2508
  s_add_u32 s47, s47, 1
  s_mov_b32 s49, 4
  s_cmp_gt_u32 s47, 131072
  s_cbranch_scc1 TIMEOUT
  s_sleep 3
  s_branch poll_2507
polld_2508:
  s_add_u32 s69, s61, s72
  buffer_load_dwordx4 v[128:131], v1, s[4:7], s69 offen offset:0 sc1
  buffer_load_dwordx4 v[132:135], v1, s[4:7], s69 offen offset:1024 sc1
  s_add_u32 s69, s61, s73
  buffer_load_dwordx4 v[136:139], v1, s[4:7], s69 offen offset:0 sc1
  buffer_load_dwordx4 v[140:143], v1, s[4:7], s69 offen offset:1024 sc1
  s_add_u32 s69, s61, s74
  buffer_load_dwordx4 v[144:147], v1, s[4:7], s69 offen offset:0 sc1
  buffer_load_dwordx4 v[148:151], v1, s[4:7], s69 offen offset:1024 sc1
  s_add_u32 s69, s61, s75
  buffer_load_dwordx4 v[152:155], v1, s[4:7], s69 offen offset:0 sc1
  buffer_load_dwordx4 v[156:159], v1, s[4:7], s69 offen offset:1024 sc1
  s_add_u32 s69, s61, s76
  buffer_load_dwordx4 v[160:163], v1, s[4:7], s69 offen offset:0 sc1
  buffer_load_dwordx4 v[164:167], v1, s[4:7], s69 offen offset:1024 sc1
  s_add_u32 s69, s61, s77
  buffer_load_dwordx4 v[168:171], v1, s[4:7], s69 offen offset:0 sc1
  buffer_load_dwordx4 v[172:175], v1, s[4:7], s69 offen offset:1024 sc1
  s_add_u32 s69, s61, s78
  buffer_load_dwordx4 v[176:179], v1, s[4:7], s69 offen offset:0 sc1
  buffer_load_dwordx4 v[180:183], v1, s[4:7], s69 offen offset:1024 sc1
  v_mov_b32 v10, 0
F2B_LOOP:
  buffer_load_dwordx4 v[48:51], v1, s[4:7], s62 offen sc1
  s_mul_i32 s93, s55, s58
  s_cmp_ge_u32 s93, 56
  s_cselect_b32 s52, 2, 1
  s_lshl_b32 s53, s52, 13
  s_add_u32 s53, s53, s67
  buffer_load_dword v10, v2, s[4:7], s53 offen sc1
  s_mul_i32 s89, s52, 114688
  s_add_u32 s89, s89, s61
  s_mul_i32 s92, s59, 32768
  v_add_u32 v8, s92, v5
  s_add_u32 s58, s58, s52
  s_mul_i32 s90, s52, 36864
  s_waitcnt vmcnt(15)
  v_mfma_f32_16x16x32_bf16 v[16:19], a[0:3], v[128:131], 0
  v_mfma_f32_16x16x32_bf16 v[20:23], a[8:11], v[128:131], 0
  v_mfma_f32_16x16x32_bf16 v[24:27], a[16:19], v[128:131], 0
  v_mfma_f32_16x16x32_bf16 v[28:31], a[24:27], v[128:131], 0
  s_waitcnt vmcnt(14)
  v_mfma_f32_16x16x32_bf16 v[16:19], a[4:7], v[132:135], v[16:19]
  s_add_u32 s69, s88, s72
  buffer_load_dwordx4 v[128:131], v1, s[4:7], s69 offen offset:0 sc1
  v_mfma_f32_16x16x32_bf16 v[20:23], a[12:15], v[132:135], v[20:23]
  v_mfma_f32_16x16x32_bf16 v[24:27], a[20:23], v[132:135], v[24:27]
  v_mfma_f32_16x16x32_bf16 v[28:31], a[28:31], v[132:135], v[28:31]
  s_waitcnt vmcnt(14)
  v_mfma_f32_16x16x32_bf16 v[16:19], a[32:35], v[136:139], v[16:19]
  buffer_load_dwordx4 v[132:135], v1, s[4:7], s69 offen offset:1024 sc1
  v_mfma_f32_16x16x32_bf16 v[20:23], a[40:43], v[136:139], v[20:23]
  v_mfma_f32_16x16x32_bf16 v[24:27], a[48:51], v[136:139], v[24:27]
  v_mfma_f32_16x16x32_bf16 v[28:31], a[56:59], v[136:139], v[28:31]
  s_waitcnt vmcnt(14)
  v_mfma_f32_16x16x32_bf16 v[16:19], a[36:39], v[140:143], v[16:19]
  s_add_u32 s69, s88, s73
  buffer_load_dwordx4 v[136:139], v1, s[4:7], s69 offen offset:0 sc1
  v_mfma_f32_16x16x32_bf16 v[20:23], a[44:47], v[140:143], v[20:23]
  v_mfma_f32_16x16x32_bf16 v[24:27], a[52:55], v[140:143], v[24:27]
  v_mfma_f32_16x16x32_bf16 v[28:31], a[60:63], v[140:143], v[28:31]
  s_waitcnt vmcnt(14)
  v_mfma_f32_16x16x32_bf16 v[16:19], a[64:67], v[144:147], v[16:19]
  buffer_load_dwordx4 v[140:143], v1, s[4:7], s69 offen offset:1024 sc1
  v_mfma_f32_16x16x32_bf16 v[20:23], a[72:75], v[144:147], v[20:23]
  v_mfma_f32_16x16x32_bf16 v[24:27], a[80:83], v[144:147], v[24:27]
  v_mfma_f32_16x16x32_bf16 v[28:31], a[88:91], v[144:147], v[28:31]
  s_waitcnt vmcnt(14)
  v_mfma_f32_16x16x32_bf16 v[16:19], a[68:71], v[148:151], v[16:19]
  s_add_u32 s69, s88, s74
  buffer_load_dwordx4 v[144:147], v1, s[4:7], s69 offen offset:0 sc1
  v_mfma_f32_16x16x32_bf16 v[20:23], a[76:79], v[148:151], v[20:23]
  v_mfma_f32_16x16x32_bf16 v[24:27], a[84:87], v[148:151], v[24:27]
  v_mfma_f32_16x16x32_bf16 v[28:31], a[92:95], v[148:151], v[28:31]
  s_waitcnt vmcnt(14)
  v_mfma_f32_16x16x32_bf16 v[16:19], a[96:99], v[152:155], v[16:19]
  buffer_load_dwordx4 v[148:151], v1, s[4:7], s69 offen offset:1024 sc1
  v_mfma_f32_16x16x32_bf16 v[20:23], a[104:107], v[152:155], v[20:23]
  v_mfma_f32_16x16x32_bf16 v[24:27], a[112:115], v[152:155], v[24:27]
  v_mfma_f32_16x16x32_bf16 v[28:31], a[120:123], v[152:155], v[28:31]
  s_waitcnt vmcnt(14)
  v_mfma_f32_16x16x32_bf16 v[16:19], a[100:103], v[156:159], v[16:19]
  s_add_u32 s69, s88, s75
  buffer_load_dwordx4 v[152:155], v1, s[4:7], s69 offen offset:0 sc1
  v_mfma_f32_16x16x32_bf16 v[20:23], a[108:111], v[156:159], v[20:23]
  v_mfma_f32_16x16x32_bf16 v[24:27], a[116:119], v[156:159], v[24:27]
  v_mfma_f32_16x16x32_bf16 v[28:31], a[124:127], v[156:159], v[28:31]
  s_waitcnt vmcnt(14)
  v_mfma_f32_16x16x32_bf16 v[16:19], a[128:131], v[160:163], v[16:19]
  buffer_load_dwordx4 v[156:159], v1, s[4:7], s69 offen offset:1024 sc1
  v_mfma_f32_16x16x32_bf16 v[20:23], a[136:139], v[160:163], v[20:23]
  v_mfma_f32_16x16x32_bf16 v[24:27], a[144:147], v[160:163], v[24:27]
  v_mfma_f32_16x16x32_bf16 v[28:31], a[152:155], v[160:163], v[28:31]
  s_waitcnt vmcnt(14)
  v_mfma_f32_16x16x32_bf16 v[16:19], a[132:135], v[164:167], v[16:19]
  s_add_u32 s69, s88, s76
  buffer_load_dwordx4 v[160:163], v1, s[4:7], s69 offen offset:0 sc1
  v_mfma_f32_16x16x32_bf16 v[20:23], a[140:143], v[164:167], v[20:23]
  v_mfma_f32_16x16x32_bf16 v[24:27], a[148:151], v[164:167], v[24:27]
  v_mfma_f32_16x16x32_bf16 v[28:31], a[156:159], v[164:167], v[28:31]
  s_waitcnt vmcnt(14)
  v_mfma_f32_16x16x32_bf16 v[16:19], a[160:163], v[168:171], v[16:19]
  buffer_load_dwordx4 v[164:167], v1, s[4:7], s69 offen offset:1024 sc1
  v_mfma_f32_16x16x32_bf16 v[20:23], a[168:171], v[168:171], v[20:23]
  v_mfma_f32_16x16x32_bf16 v[24:27], a[176:179], v[168:171], v[24:27]
  v_mfma_f32_16x16x32_bf16 v[28:31], a[184:187], v[168:171], v[28:31]
  s_waitcnt vmcnt(14)
  v_mfma_f32_16x16x32_bf16 v[16:19], a[164:167], v[172:175], v[16:19]
  s_add_u32 s69, s88, s77
  buffer_load_dwordx4 v[168:171], v1, s[4:7], s69 offen offset:0 sc1
  v_mfma_f32_16x16x32_bf16 v[20:23], a[172:175], v[172:175], v[20:23]
  v_mfma_f32_16x16x32_bf16 v[24:27], a[180:183], v[172:175], v[24:27]
  v_mfma_f32_16x16x32_bf16 v[28:31], a[188:191], v[172:175], v[28:31]
  s_waitcnt vmcnt(14)
  v_mfma_f32_16x16x32_bf16 v[16:19], a[192:195], v[176:179], v[16:19]
  buffer_load_dwordx4 v[172:175], v1, s[4:7], s69 offen offset:1024 sc1
  v_mfma_f32_16x16x32_bf16 v[20:23], a[200:203], v[176:179], v[20:23]
  v_mfma_f32_16x16x32_bf16 v[24:27], a[208:211], v[176:179], v[24:27]
  v_mfma_f32_16x16x32_bf16 v[28:31], a[216:219], v[176:179], v[28:31]
  s_waitcnt vmcnt(14)
  v_mfma_f32_16x16x32_bf16 v[16:19], a[196:199], v[180:183], v[16:19]
  s_add_u32 s69, s88, s78
  buffer_load_dwordx4 v[176:179], v1, s[4:7], s69 offen offset:0 sc1
  v_mfma_f32_16x16x32_bf16 v[20:23], a[204:207], v[180:183], v[20:23]
  v_mfma_f32_16x16x32_bf16 v[24:27], a[212:215], v[180:183], v[24:27]
  v_mfma_f32_16x16x32_bf16 v[28:31], a[220:223], v[180:183], v[28:31]
  buffer_load_dwordx4 v[180:183], v1, s[4:7], s69 offen offset:1024 sc1
  s_waitcnt vmcnt(14)
  v_cmp_ne_u32 vcc, 0, v10
  s_nop 0
  s_cmp_eq_u64 vcc, -1
  s_cselect_b32 s68, 1, 0
  s_cmp_lt_u32 s58, 64
  s_cselect_b32 s68, s68, 0
  s_cmp_eq_u32 s68, 0
  s_cbranch_scc1 F2B_PLAIN
  s_waitcnt vmcnt(13)
  v_mfma_f32_16x16x32_bf16 v[32:35], a[0:3], v[128:131], 0
  v_mfma_f32_16x16x32_bf16 v[36:39], a[8:11], v[128:131], 0
  v_mfma_f32_16x16x32_bf16 v[40:43], a[16:19], v[128:131], 0
  v_mfma_f32_16x16x32_bf16 v[44:47], a[24:27], v[128:131], 0
  s_waitcnt vmcnt(12)
  ds_write_b128 v8, v[16:19] offset:0
  ds_write_b128 v8, v[20:23] offset:1024
  v_mfma_f32_16x16x32_bf16 v[32:35], a[4:7], v[132:135], v[32:35]
  ds_write_b128 v8, v[24:27] offset:2048
  s_add_u32 s69, s89, s72
  buffer_load_dwordx4 v[128:131], v1, s[4:7], s69 offen offset:0 sc1
  v_mfma_f32_16x16x32_bf16 v[36:39], a[12:15], v[132:135], v[36:39]
  ds_write_b128 v8, v[28:31] offset:3072
  v_mfma_f32_16x16x32_bf16 v[40:43], a[20:23], v[132:135], v[40:43]
  v_mfma_f32_16x16x32_bf16 v[44:47], a[28:31], v[132:135], v[44:47]
  s_waitcnt vmcnt(12)
  v_mfma_f32_16x16x32_bf16 v[32:35], a[32:35], v[136:139], v[32:35]
  buffer_load_dwordx4 v[132:135], v1, s[4:7], s69 offen offset:1024 sc1
  v_mfma_f32_16x16x32_bf16 v[36:39], a[40:43], v[136:139], v[36:39]
  v_mfma_f32_16x16x32_bf16 v[40:43], a[48:51], v[136:139], v[40:43]
  v_mfma_f32_16x16x32_bf16 v[44:47], a[56:59], v[136:139], v[44:47]
  s_waitcnt vmcnt(12)
  buffer_load_dword v9, v2, s[4:7], s53 offen sc1
  v_mfma_f32_16x16x32_bf16 v[32:35], a[36:39], v[140:143], v[32:35]
  s_add_u32 s69, s89, s73
  buffer_load_dwordx4 v[136:139], v1, s[4:7], s69 offen offset:0 sc1
  v_mfma_f32_16x16x32_bf16 v[36:39], a[44:47], v[140:143], v[36:39]
  v_mfma_f32_16x16x32_bf16 v[40:43], a[52:55], v[140:143], v[40:43]
  v_mfma_f32_16x16x32_bf16 v[44:47], a[60:63], v[140:143], v[44:47]
  s_waitcnt vmcnt(13)
  v_mfma_f32_16x16x32_bf16 v[32:35], a[64:67], v[144:147], v[32:35]
  buffer_load_dwordx4 v[140:143], v1, s[4:7], s69 offen offset:1024 sc1
  v_mfma_f32_16x16x32_bf16 v[36:39], a[72:75], v[144:147], v[36:39]
  v_mfma_f32_16x16x32_bf16 v[40:43], a[80:83], v[144:147], v[40:43]
  v_mfma_f32_16x16x32_bf16 v[44:47], a[88:91], v[144:147], v[44:47]
  s_waitcnt vmcnt(13)
  v_mfma_f32_16x16x32_bf16 v[32:35], a[68:71], v[148:151], v[32:35]
  s_add_u32 s69, s89, s74
  buffer_load_dwordx4 v[144:147], v1, s[4:7], s69 offen offset:0 sc1
  v_mfma_f32_16x16x32_bf16 v[36:39], a[76:79], v[148:151], v[36:39]
  v_mfma_f32_16x16x32_bf16 v[40:43], a[84:87], v[148:151], v[40:43]
  v_mfma_f32_16x16x32_bf16 v[44:47], a[92:95], v[148:151], v[44:47]
  s_waitcnt vmcnt(13)
  v_mfma_f32_16x16x32_bf16 v[32:35], a[96:99], v[152:155], v[32:35]
  buffer_load_dwordx4 v[148:151], v1, s[4:7], s69 offen offset:1024 sc1
  v_mfma_f32_16x16x32_bf16 v[36:39], a[104:107], v[152:155], v[36:39]
  v_mfma_f32_16x16x32_bf16 v[40:43], a[112:115], v[152:155], v[40:43]
  v_mfma_f32_16x16x32_bf16 v[44:47], a[120:123], v[152:155], v[44:47]
  s_waitcnt vmcnt(13)
  v_mfma_f32_16x16x32_bf16 v[32:35], a[100:103], v[156:159], v[32:35]
  s_add_u32 s69, s89, s75
  buffer_load_dwordx4 v[152:155], v1, s[4:7], s69 offen offset:0 sc1
  v_mfma_f32_16x16x32_bf16 v[36:39], a[108:111], v[156:159], v[36:39]
  v_mfma_f32_16x16x32_bf16 v[40:43], a[116:119], v[156:159], v[40:43]
  v_mfma_f32_16x16x32_bf16 v[44:47], a[124:127], v[156:159], v[44:47]
  s_waitcnt vmcnt(13)
  v_mfma_f32_16x16x32_bf16 v[32:35], a[128:131], v[160:163], v[32:35]
  buffer_load_dwordx4 v[156:159], v1, s[4:7], s69 offen offset:1024 sc1
  v_mfma_f32_16x16x32_bf16 v[36:39], a[136:139], v[160:163], v[36:39]
  v_mfma_f32_16x16x32_bf16 v[40:43], a[144:147], v[160:163], v[40:43]
  v_mfma_f32_16x16x32_bf16 v[44:47], a[152:155], v[160:163], v[44:47]
  s_waitcnt vmcnt(13)
  v_mfma_f32_16x16x32_bf16 v[32:35], a[132:135], v[164:167], v[32:35]
  s_add_u32 s69, s89, s76
  buffer_load_dwordx4 v[160:163], v1, s[4:7], s69 offen offset:0 sc1
  v_mfma_f32_16x16x32_bf16 v[36:39], a[140:143], v[164:167], v[36:39]
  v_mfma_f32_16x16x32_bf16 v[40:43], a[148:151], v[164:167], v[40:43]
  v_mfma_f32_16x16x32_bf16 v[44:47], a[156:159], v[164:167], v[44:47]
  s_waitcnt vmcnt(13)
  v_mfma_f32_16x16x32_bf16 v[32:35], a[160:163], v[168:171], v[32:35]
  buffer_load_dwordx4 v[164:167], v1, s[4:7], s69 offen offset:1024 sc1
  v_mfma_f32_16x16x32_bf16 v[36:39], a[168:171], v[168:171], v[36:39]
  v_mfma_f32_16x16x32_bf16 v[40:43], a[176:179], v[168:171], v[40:43]
  v_mfma_f32_16x16x32_bf16 v[44:47], a[184:187], v[168:171], v[44:47]
  s_waitcnt vmcnt(13)
  v_mfma_f32_16x16x32_bf16 v[32:35], a[164:167], v[172:175], v[32:35]
  s_add_u32 s69, s89, s77
  buffer_load_dwordx4 v[168:171], v1, s[4:7], s69 offen offset:0 sc1
  v_mfma_f32_16x16x32_bf16 v[36:39], a[172:175], v[172:175], v[36:39]
  v_mfma_f32_16x16x32_bf16 v[40:43], a[180:183], v[172:175], v[40:43]
  v_mfma_f32_16x16x32_bf16 v[44:47], a[188:191], v[172:175], v[44:47]
  s_waitcnt vmcnt(13)
  v_mfma_f32_16x16x32_bf16 v[32:35], a[192:195], v[176:179], v[32:35]
  buffer_load_dwordx4 v[172:175], v1, s[4:7], s69 offen offset:1024 sc1
  v_mfma_f32_16x16x32_bf16 v[36:39], a[200:203], v[176:179], v[36:39]
  v_mfma_f32_16x16x32_bf16 v[40:43], a[208:211], v[176:179], v[40:43]
  v_mfma_f32_16x16x32_bf16 v[44:47], a[216:219], v[176:179], v[44:47]
  s_waitcnt vmcnt(13)
  v_mfma_f32_16x16x32_bf16 v[32:35], a[196:199], v[180:183], v[32:35]
  s_add_u32 s69, s89, s78
  buffer_load_dwordx4 v[176:179], v1, s[4:7], s69 offen offset:0 sc1
  v_mfma_f32_16x16x32_bf16 v[36:39], a[204:207], v[180:183], v[36:39]
  v_mfma_f32_16x16x32_bf16 v[40:43], a[212:215], v[180:183], v[40:43]
  v_mfma_f32_16x16x32_bf16 v[44:47], a[220:223], v[180:183], v[44:47]
  buffer_load_dwordx4 v[180:183], v1, s[4:7], s69 offen offset:1024 sc1
  s_nop 1
  ds_write_b128 v8, v[32:35] offset:4096
  s_nop 1
  ds_write_b128 v8, v[36:39] offset:5120
  ds_write_b128 v8, v[40:43] offset:6144
  ds_write_b128 v8, v[44:47] offset:7168
  v_add_u32 v8, s92, v6
  s_xor_b32 s59, s59, 1
  s_mov_b32 s61, s89
  s_add_u32 s88, s61, 57344
  s_mov_b32 s67, s53
  s_waitcnt lgkmcnt(0)
  s_barrier
  ds_read_b128 v[52:55], v8 offset:0
  ds_read_b128 v[56:59], v8 offset:1024
  ds_read_b128 v[60:63], v8 offset:8192
  ds_read_b128 v[64:67], v8 offset:9216
  ds_read_b128 v[68:71], v8 offset:16384
  ds_read_b128 v[72:75], v8 offset:17408
  ds_read_b128 v[76:79], v8 offset:24576
  ds_read_b128 v[80:83], v8 offset:25600
  v_lshlrev_b32 v84, 16, v48
  v_and_b32 v85, 0xffff0000, v48
  v_lshlrev_b32 v86, 16, v49
  v_and_b32 v87, 0xffff0000, v49
  v_lshlrev_b32 v88, 16, v50
  v_and_b32 v89, 0xffff0000, v50
  v_lshlrev_b32 v90, 16, v51
  v_and_b32 v91, 0xffff0000, v51
  s_waitcnt lgkmcnt(5)
  v_pk_add_f32 v[52:53], v[52:53], v[60:61]
  v_pk_add_f32 v[54:55], v[54:55], v[62:63]
  s_waitcnt lgkmcnt(4)
  v_pk_add_f32 v[56:57], v[56:57], v[64:65]
  v_pk_add_f32 v[58:59], v[58:59], v[66:67]
  s_waitcnt lgkmcnt(1)
  v_pk_add_f32 v[68:69], v[68:69], v[76:77]
  v_pk_add_f32 v[70:71], v[70:71], v[78:79]
  s_waitcnt lgkmcnt(0)
  v_pk_add_f32 v[72:73], v[72:73], v[80:81]
  v_pk_add_f32 v[74:75], v[74:75], v[82:83]
  v_pk_add_f32 v[52:53], v[52:53], v[68:69]
  v_pk_add_f32 v[54:55], v[54:55], v[70:71]
  v_pk_add_f32 v[56:57], v[56:57], v[72:73]
  v_pk_add_f32 v[58:59], v[58:59], v[74:75]
  v_cvt_pk_bf16_f32 v60, v52, v53
  v_cvt_pk_bf16_f32 v61, v54, v55
  v_cvt_pk_bf16_f32 v62, v56, v57
  v_cvt_pk_bf16_f32 v63, v58, v59
  v_lshlrev_b32 v52, 16, v60
  v_and_b32 v53, 0xffff0000, v60
  v_lshlrev_b32 v54, 16, v61
  v_and_b32 v55, 0xffff0000, v61
  v_lshlrev_b32 v56, 16, v62
  v_and_b32 v57, 0xffff0000, v62
  v_lshlrev_b32 v58, 16, v63
  v_and_b32 v59, 0xffff0000, v63
  v_pk_add_f32 v[84:85], v[84:85], v[52:53]
  v_pk_add_f32 v[86:87], v[86:87], v[54:55]
  v_pk_add_f32 v[88:89], v[88:89], v[56:57]
  v_pk_add_f32 v[90:91], v[90:91], v[58:59]
  v_cvt_pk_bf16_f32 v64, v84, v85
  v_cvt_pk_bf16_f32 v65, v86, v87
  v_cvt_pk_bf16_f32 v66, v88, v89
  v_cvt_pk_bf16_f32 v67, v90, v91
  buffer_store_dwordx4 v[64:67], v7, s[8:11], s63 offen sc1
  s_mov_b32 s70, s65
  s_lshl_b32 s93, s52, 12
  s_add_u32 s65, s65, s93
  s_add_u32 s62, s62, s90
  s_lshl_b32 s93, s52, 15
  s_add_u32 s63, s63, s93
  s_branch F2B_LOOP
F2B_PLAIN:
  s_waitcnt vmcnt(13)
  v_mfma_f32_16x16x32_bf16 v[32:35], a[0:3], v[128:131], 0
  v_mfma_f32_16x16x32_bf16 v[36:39], a[8:11], v[128:131], 0
  v_mfma_f32_16x16x32_bf16 v[40:43], a[16:19], v[128:131], 0
  v_mfma_f32_16x16x32_bf16 v[44:47], a[24:27], v[128:131], 0
  s_waitcnt vmcnt(12)
  ds_write_b128 v8, v[16:19] offset:0
  ds_write_b128 v8, v[20:23] offset:1024
  v_mfma_f32_16x16x32_bf16 v[32:35], a[4:7], v[132:135], v[32:35]
  ds_write_b128 v8, v[24:27] offset:2048
  ds_write_b128 v8, v[28:31] offset:3072
  v_mfma_f32_16x16x32_bf16 v[36:39], a[12:15], v[132:135], v[36:39]
  v_mfma_f32_16x16x32_bf16 v[40:43], a[20:23], v[132:135], v[40:43]
  v_mfma_f32_16x16x32_bf16 v[44:47], a[28:31], v[132:135], v[44:47]
  s_waitcnt vmcnt(11)
  v_mfma_f32_16x16x32_bf16 v[32:35], a[32:35], v[136:139], v[32:35]
  v_mfma_f32_16x16x32_bf16 v[36:39], a[40:43], v[136:139], v[36:39]
  v_mfma_f32_16x16x32_bf16 v[40:43], a[48:51], v[136:139], v[40:43]
  v_mfma_f32_16x16x32_bf16 v[44:47], a[56:59], v[136:139], v[44:47]
  s_waitcnt vmcnt(10)
  buffer_load_dword v9, v2, s[4:7], s53 offen sc1
  v_mfma_f32_16x16x32_bf16 v[32:35], a[36:39], v[140:143], v[32:35]
  v_mfma_f32_16x16x32_bf16 v[36:39], a[44:47], v[140:143], v[36:39]
  v_mfma_f32_16x16x32_bf16 v[40:43], a[52:55], v[140:143], v[40:43]
  v_mfma_f32_16x16x32_bf16 v[44:47], a[60:63], v[140:143], v[44:47]
  s_waitcnt vmcnt(10)
  v_mfma_f32_16x16x32_bf16 v[32:35], a[64:67], v[144:147], v[32:35]
  v_mfma_f32_16x16x32_bf16 v[36:39], a[72:75], v[144:147], v[36:39]
  v_mfma_f32_16x16x32_bf16 v[40:43], a[80:83], v[144:147], v[40:43]
  v_mfma_f32_16x16x32_bf16 v[44:47], a[88:91], v[144:147], v[44:47]
  s_waitcnt vmcnt(9)
  v_mfma_f32_16x16x32_bf16 v[32:35], a[68:71], v[148:151], v[32:35]
  v_mfma_f32_16x16x32_bf16 v[36:39], a[76:79], v[148:151], v[36:39]
  v_mfma_f32_16x16x32_bf16 v[40:43], a[84:87], v[148:151], v[40:43]
  v_mfma_f32_16x16x32_bf16 v[44:47], a[92:95], v[148:151], v[44:47]
  s_waitcnt vmcnt(8)
  v_mfma_f32_16x16x32_bf16 v[32:35], a[96:99], v[152:155], v[32:35]
  v_mfma_f32_16x16x32_bf16 v[36:39], a[104:107], v[152:155], v[36:39]
  v_mfma_f32_16x16x32_bf16 v[40:43], a[112:115], v[152:155], v[40:43]
  v_mfma_f32_16x16x32_bf16 v[44:47], a[120:123], v[152:155], v[44:47]
  s_waitcnt vmcnt(7)
  v_mfma_f32_16x16x32_bf16 v[32:35], a[100:103], v[156:159], v[32:35]
  v_mfma_f32_16x16x32_bf16 v[36:39], a[108:111], v[156:159], v[36:39]
  v_mfma_f32_16x16x32_bf16 v[40:43], a[116:119], v[156:159], v[40:43]
  v_mfma_f32_16x16x32_bf16 v[44:47], a[124:127], v[156:159], v[44:47]
  s_waitcnt vmcnt(6)
  v_mfma_f32_16x16x32_bf16 v[32:35], a[128:131], v[160:163], v[32:35]
  v_mfma_f32_16x16x32_bf16 v[36:39], a[136:139], v[160:163], v[36:39]
  v_mfma_f32_16x16x32_bf16 v[40:43], a[144:147], v[160:163], v[40:43]
  v_mfma_f32_16x16x32_bf16 v[44:47], a[152:155], v[160:163], v[44:47]
  s_waitcnt vmcnt(5)
  v_mfma_f32_16x16x32_bf16 v[32:35], a[132:135], v[164:167], v[32:35]
  v_mfma_f32_16x16x32_bf16 v[36:39], a[140:143], v[164:167], v[36:39]
  v_mfma_f32_16x16x32_bf16 v[40:43], a[148:151], v[164:167], v[40:43]
  v_mfma_f32_16x16x32_bf16 v[44:47], a[156:159], v[164:167], v[44:47]
  s_waitcnt vmcnt(4)
  v_mfma_f32_16x16x32_bf16 v[32:35], a[160:163], v[168:171], v[32:35]
  v_mfma_f32_16x16x32_bf16 v[36:39], a[168:171], v[168:171], v[36:39]
  v_mfma_f32_16x16x32_bf16 v[40:43], a[176:179], v[168:171], v[40:43]
  v_mfma_f32_16x16x32_bf16 v[44:47], a[184:187], v[168:171], v[44:47]
  s_waitcnt vmcnt(3)
  v_mfma_f32_16x16x32_bf16 v[32:35], a[164:167], v[172:175], v[32:35]
  v_mfma_f32_16x16x32_bf16 v[36:39], a[172:175], v[172:175], v[36:39]
  v_mfma_f32_16x16x32_bf16 v[40:43], a[180:183], v[172:175], v[40:43]
  v_mfma_f32_16x16x32_bf16 v[44:47], a[188:191], v[172:175], v[44:47]
  s_waitcnt vmcnt(2)
  v_mfma_f32_16x16x32_bf16 v[32:35], a[192:195], v[176:179], v[32:35]
  v_mfma_f32_16x16x32_bf16 v[36:39], a[200:203], v[176:179], v[36:39]
  v_mfma_f32_16x16x32_bf16 v[40:43], a[208:211], v[176:179], v[40:43]
  v_mfma_f32_16x16x32_bf16 v[44:47], a[216:219], v[176:179], v[44:47]
  s_waitcnt vmcnt(1)
  v_mfma_f32_16x16x32_bf16 v[32:35], a[196:199], v[180:183], v[32:35]
  v_mfma_f32_16x16x32_bf16 v[36:39], a[204:207], v[180:183], v[36:39]
  v_mfma_f32_16x16x32_bf16 v[40:43], a[212:215], v[180:183], v[40:43]
  v_mfma_f32_16x16x32_bf16 v[44:47], a[220:223], v[180:183], v[44:47]
  s_nop 4
  ds_write_b128 v8, v[32:35] offset:4096
  ds_write_b128 v8, v[36:39] offset:5120
  ds_write_b128 v8, v[40:43] offset:6144
  ds_write_b128 v8, v[44:47] offset:7168
  v_add_u32 v8, s92, v6
  s_xor_b32 s59, s59, 1
  s_mov_b32 s61, s89
  s_add_u32 s88, s61, 57344
  s_mov_b32 s67, s53
  s_waitcnt vmcnt(0)
  v_cmp_ne_u32 vcc, 0, v9
  s_nop 0
  s_cmp_eq_u64 vcc, -1
  s_cselect_b32 s68, 1, 0
  s_cmp_lt_u32 s58, 64
  s_cselect_b32 s68, s68, 0
  s_cmp_eq_u32 s68, 0
  s_cbranch_scc1 F2B_DRAIN
  s_add_u32 s69, s61, s72
  buffer_load_dwordx4 v[128:131], v1, s[4:7], s69 offen offset:0 sc1
  buffer_load_dwordx4 v[132:135], v1, s[4:7], s69 offen offset:1024 sc1
  s_add_u32 s69, s61, s73
  buffer_load_dwordx4 v[136:139], v1, s[4:7], s69 offen offset:0 sc1
  buffer_load_dwordx4 v[140:143], v1, s[4:7], s69 offen offset:1024 sc1
  s_waitcnt lgkmcnt(0)
  s_barrier
  s_add_u32 s69, s61, s74
  buffer_load_dwordx4 v[144:147], v1, s[4:7], s69 offen offset:0 sc1
  ds_read_b128 v[52:55], v8 offset:0
  ds_read_b128 v[56:59], v8 offset:1024
  ds_read_b128 v[60:63], v8 offset:8192
  ds_read_b128 v[64:67], v8 offset:9216
  buffer_load_dwordx4 v[148:151], v1, s[4:7], s69 offen offset:1024 sc1
  ds_read_b128 v[68:71], v8 offset:16384
  ds_read_b128 v[72:75], v8 offset:17408
  ds_read_b128 v[76:79], v8 offset:24576
  ds_read_b128 v[80:83], v8 offset:25600
  s_add_u32 s69, s61, s75
  buffer_load_dwordx4 v[152:155], v1, s[4:7], s69 offen offset:0 sc1
  v_lshlrev_b32 v84, 16, v48
  v_and_b32 v85, 0xffff0000, v48
  v_lshlrev_b32 v86, 16, v49
  v_and_b32 v87, 0xffff0000, v49
  buffer_load_dwordx4 v[156:159], v1, s[4:7], s69 offen offset:1024 sc1
  v_lshlrev_b32 v88, 16, v50
  v_and_b32 v89, 0xffff0000, v50
  v_lshlrev_b32 v90, 16, v51
  v_and_b32 v91, 0xffff0000, v51
  s_add_u32 s69, s61, s76
  buffer_load_dwordx4 v[160:163], v1, s[4:7], s69 offen offset:0 sc1
  s_waitcnt lgkmcnt(5)
  v_pk_add_f32 v[52:53], v[52:53], v[60:61]
  v_pk_add_f32 v[54:55], v[54:55], v[62:63]
  s_waitcnt lgkmcnt(4)
  v_pk_add_f32 v[56:57], v[56:57], v[64:65]
  v_pk_add_f32 v[58:59], v[58:59], v[66:67]
  buffer_load_dwordx4 v[164:167], v1, s[4:7], s69 offen offset:1024 sc1
  s_waitcnt lgkmcnt(1)
  v_pk_add_f32 v[68:69], v[68:69], v[76:77]
  v_pk_add_f32 v[70:71], v[70:71], v[78:79]
  s_waitcnt lgkmcnt(0)
  v_pk_add_f32 v[72:73], v[72:73], v[80:81]
  v_pk_add_f32 v[74:75], v[74:75], v[82:83]
  s_add_u32 s69, s61, s77
  buffer_load_dwordx4 v[168:171], v1, s[4:7], s69 offen offset:0 sc1
  v_pk_add_f32 v[52:53], v[52:53], v[68:69]
  v_pk_add_f32 v[54:55], v[54:55], v[70:71]
  v_pk_add_f32 v[56:57], v[56:57], v[72:73]
  v_pk_add_f32 v[58:59], v[58:59], v[74:75]
  buffer_load_dwordx4 v[172:175], v1, s[4:7], s69 offen offset:1024 sc1
  v_cvt_pk_bf16_f32 v60, v52, v53
  v_cvt_pk_bf16_f32 v61, v54, v55
  v_cvt_pk_bf16_f32 v62, v56, v57
  v_cvt_pk_bf16_f32 v63, v58, v59
  s_add_u32 s69, s61, s78
  buffer_load_dwordx4 v[176:179], v1, s[4:7], s69 offen offset:0 sc1
  v_lshlrev_b32 v52, 16, v60
  v_and_b32 v53, 0xffff0000, v60
  v_lshlrev_b32 v54, 16, v61
  v_and_b32 v55, 0xffff0000, v61
  buffer_load_dwordx4 v[180:183], v1, s[4:7], s69 offen offset:1024 sc1
  v_lshlrev_b32 v56, 16, v62
  v_and_b32 v57, 0xffff0000, v62
  v_lshlrev_b32 v58, 16, v63
  v_and_b32 v59, 0xffff0000, v63
  v_pk_add_f32 v[84:85], v[84:85], v[52:53]
  v_pk_add_f32 v[86:87], v[86:87], v[54:55]
  v_pk_add_f32 v[88:89], v[88:89], v[56:57]
  v_pk_add_f32 v[90:91], v[90:91], v[58:59]
  v_cvt_pk_bf16_f32 v64, v84, v85
  v_cvt_pk_bf16_f32 v65, v86, v87
  v_cvt_pk_bf16_f32 v66, v88, v89
  v_cvt_pk_bf16_f32 v67, v90, v91
  buffer_store_dwordx4 v[64:67], v7, s[8:11], s63 offen sc1
  s_mov_b32 s70, s65
  s_lshl_b32 s93, s52, 12
  s_add_u32 s65, s65, s93
  s_add_u32 s62, s62, s90
  s_lshl_b32 s93, s52, 15
  s_add_u32 s63, s63, s93
  s_branch F2B_LOOP
F2B_DRAIN:
  s_waitcnt lgkmcnt(0)
  s_barrier
  ds_read_b128 v[52:55], v8 offset:0
  ds_read_b128 v[56:59], v8 offset:1024
  ds_read_b128 v[60:63], v8 offset:8192
  ds_read_b128 v[64:67], v8 offset:9216
  ds_read_b128 v[68:71], v8 offset:16384
  ds_read_b128 v[72:75], v8 offset:17408
  ds_read_b128 v[76:79], v8 offset:24576
  ds_read_b128 v[80:83], v8 offset:25600
  v_lshlrev_b32 v84, 16, v48
  v_and_b32 v85, 0xffff0000, v48
  v_lshlrev_b32 v86, 16, v49
  v_and_b32 v87, 0xffff0000, v49
  v_lshlrev_b32 v88, 16, v50
  v_and_b32 v89, 0xffff0000, v50
  v_lshlrev_b32 v90, 16, v51
  v_and_b32 v91, 0xffff0000, v51
  s_waitcnt lgkmcnt(5)
  v_pk_add_f32 v[52:53], v[52:53], v[60:61]
  v_pk_add_f32 v[54:55], v[54:55], v[62:63]
  s_waitcnt lgkmcnt(4)
  v_pk_add_f32 v[56:57], v[56:57], v[64:65]
  v_pk_add_f32 v[58:59], v[58:59], v[66:67]
  s_waitcnt lgkmcnt(1)
  v_pk_add_f32 v[68:69], v[68:69], v[76:77]
  v_pk_add_f32 v[70:71], v[70:71], v[78:79]
  s_waitcnt lgkmcnt(0)
  v_pk_add_f32 v[72:73], v[72:73], v[80:81]
  v_pk_add_f32 v[74:75], v[74:75], v[82:83]
  v_pk_add_f32 v[52:53], v[52:53], v[68:69]
  v_pk_add_f32 v[54:55], v[54:55], v[70:71]
  v_pk_add_f32 v[56:57], v[56:57], v[72:73]
  v_pk_add_f32 v[58:59], v[58:59], v[74:75]
  v_cvt_pk_bf16_f32 v60, v52, v53
  v_cvt_pk_bf16_f32 v61, v54, v55
  v_cvt_pk_bf16_f32 v62, v56, v57
  v_cvt_pk_bf16_f32 v63, v58, v59
  v_lshlrev_b32 v52, 16, v60
  v_and_b32 v53, 0xffff0000, v60
  v_lshlrev_b32 v54, 16, v61
  v_and_b32 v55, 0xffff0000, v61
  v_lshlrev_b32 v56, 16, v62
  v_and_b32 v57, 0xffff0000, v62
  v_lshlrev_b32 v58, 16, v63
  v_and_b32 v59, 0xffff0000, v63
  v_pk_add_f32 v[84:85], v[84:85], v[52:53]
  v_pk_add_f32 v[86:87], v[86:87], v[54:55]
  v_pk_add_f32 v[88:89], v[88:89], v[56:57]
  v_pk_add_f32 v[90:91], v[90:91], v[58:59]
  v_cvt_pk_bf16_f32 v64, v84, v85
  v_cvt_pk_bf16_f32 v65, v86, v87
  v_cvt_pk_bf16_f32 v66, v88, v89
  v_cvt_pk_bf16_f32 v67, v90, v91
  buffer_store_dwordx4 v[64:67], v7, s[8:11], s63 offen sc1
  s_mov_b32 s70, s65
  s_lshl_b32 s93, s52, 12
  s_add_u32 s65, s65, s93
  s_add_u32 s62, s62, s90
  s_lshl_b32 s93, s52, 15
  s_add_u32 s63, s63, s93
F2B_TAIL:
  s_cmp_lt_u32 s58, 64
  s_cbranch_scc1 F2B_WAIT
  s_cmp_lg_u32 s55, 0
  s_cbranch_scc1 END
  s_mov_b32 s55, 1
  s_mov_b32 s58, 57
  s_branch F2_INIT
ROLE_F1:
  s_cmp_lg_u32 s46, 0
  s_cbranch_scc1 cen_2509
  v_mov_b32 v4, 163328
  s_cmp_lg_u32 s44, 0
  s_cbranch_scc1 cen_2510
  v_min_u32 v5, 9, v0
  v_lshlrev_b32 v5, 3, v5
  s_mov_b32 s92, 128
  v_writelane_b32 v5, s92, 0
cen_2511:
  buffer_load_dword v2, v5, s[12:15], 0 offen sc1
  s_mov_b32 s92, 0
  s_waitcnt vmcnt(0)
  v_readlane_b32 s93, v2, 0
  s_nop 0
  s_add_u32 s92, s92, s93
  v_readlane_b32 s93, v2, 1
  s_nop 0
  s_add_u32 s92, s92, s93
  v_readlane_b32 s93, v2, 2
  s_nop 0
  s_add_u32 s92, s92, s93
  v_readlane_b32 s93, v2, 3
  s_nop 0
  s_add_u32 s92, s92, s93
  v_readlane_b32 s93, v2, 4
  s_nop 0
  s_add_u32 s92, s92, s93
  v_readlane_b32 s93, v2, 5
  s_nop 0
  s_add_u32 s92, s92, s93
  v_readlane_b32 s93, v2, 6
  s_nop 0
  s_add_u32 s92, s92, s93
  v_readlane_b32 s93, v2, 7
  s_nop 0
  s_add_u32 s92, s92, s93
  v_readlane_b32 s93, v2, 8
  s_nop 0
  s_add_u32 s92, s92, s93
  s_cmp_eq_u32 s92, 256
  s_cbranch_scc1 cen_2512
  s_add_u32 s47, s47, 1
  s_mov_b32 s49, 1
  s_cmp_gt_u32 s47, 131072
  s_cbranch_scc1 TIMEOUT
  s_sleep 4
  s_branch cen_2511
cen_2512:
  v_cmp_ne_u32 vcc, 32, v2
  ds_read2_b32 v[6:7], v4 offset0:0 offset1:1
  s_and_b32 s94, vcc_lo, 0xff
  s_waitcnt lgkmcnt(0)
  v_readfirstlane_b32 s92, v6
  v_readfirstlane_b32 s95, v7
  v_readlane_b32 s93, v2, 0
  s_cmp_gt_u32 s95, 0
  s_cselect_b32 s93, s93, 0
  s_add_u32 s92, s92, s93
  v_readlane_b32 s93, v2, 1
  s_cmp_gt_u32 s95, 1
  s_cselect_b32 s93, s93, 0
  s_add_u32 s92, s92, s93
  v_readlane_b32 s93, v2, 2
  s_cmp_gt_u32 s95, 2
  s_cselect_b32 s93, s93, 0
  s_add_u32 s92, s92, s93
  v_readlane_b32 s93, v2, 3
  s_cmp_gt_u32 s95, 3
  s_cselect_b32 s93, s93, 0
  s_add_u32 s92, s92, s93
  v_readlane_b32 s93, v2, 4
  s_cmp_gt_u32 s95, 4
  s_cselect_b32 s93, s93, 0
  s_add_u32 s92, s92, s93
  v_readlane_b32 s93, v2, 5
  s_cmp_gt_u32 s95, 5
  s_cselect_b32 s93, s93, 0
  s_add_u32 s92, s92, s93
  v_readlane_b32 s93, v2, 6
  s_cmp_gt_u32 s95, 6
  s_cselect_b32 s93, s93, 0
  s_add_u32 s92, s92, s93
  v_readlane_b32 s93, v2, 7
  s_cmp_gt_u32 s95, 7
  s_cselect_b32 s93, s93, 0
  s_add_u32 s92, s92, s93
  v_mov_b32 v2, s92
  v_mov_b32 v3, s94
  ds_write2_b32 v4, v2, v3 offset0:2 offset1:3
cen_2510:
  s_waitcnt lgkmcnt(0)
  s_barrier
  ds_read2_b32 v[2:3], v4 offset0:2 offset1:3
  s_waitcnt lgkmcnt(0)
  v_readfirstlane_b32 s92, v2
  v_readfirstlane_b32 s93, v3
  s_nop 0
  s_cmp_eq_u32 s93, 0
  s_cbranch_scc1 cen_2509
  s_mov_b32 s46, 1
  s_mov_b32 s45, s92
  s_branch DISPATCH
cen_2509:
  s_sub_u32 s92, s45, 224
  s_cmp_ge_u32 s92, 14
  s_cselect_b32 s50, 1, 0
  s_mul_i32 s93, s50, 14
  s_sub_u32 s51, s92, s93
  s_lshl_b32 s57, s51, 2
  s_add_u32 s57, s57, s44
  s_lshl_b32 s52, s57, 6
  v_lshrrev_b32 v15, 4, v0
  v_bfe_u32 v16, v0, 2, 2
  v_and_b32 v17, 3, v0
  v_lshl_add_u32 v11, v15, 3, v16
  v_lshlrev_b32 v11, 6, v11
  v_lshl_add_u32 v11, v17, 4, v11
  v_add_u32 v11, s48, v11
  v_add_u32 v15, s48, v1
  s_mov_b32 s8, s32
  s_and_b32 s9, s33, 0xffff
  s_mov_b32 s10, 0x1c0000
  s_mov_b32 s11, 0x20000
  s_mov_b32 s92, 3584
  v_lshrrev_b32 v10, 2, v0
  v_mul_lo_u32 v10, v10, s92
  v_lshl_add_u32 v10, v17, 4, v10
  s_add_u32 m0, s48, 0
  s_add_u32 s92, s52, 0x0
  buffer_load_dwordx4 v10, s[8:11], s92 offen offset:0 lds
  s_add_u32 s92, s52, 0xdc00
  buffer_load_dwordx4 v10, s[8:11], s92 offen offset:1024 lds
  s_add_u32 s92, s52, 0x1b800
  buffer_load_dwordx4 v10, s[8:11], s92 offen offset:2048 lds
  s_add_u32 s92, s52, 0x29400
  buffer_load_dwordx4 v10, s[8:11], s92 offen offset:3072 lds
  s_add_u32 m0, s48, 4096
  s_add_u32 s92, s52, 0x38000
  buffer_load_dwordx4 v10, s[8:11], s92 offen offset:0 lds
  s_add_u32 s92, s52, 0x45c00
  buffer_load_dwordx4 v10, s[8:11], s92 offen offset:1024 lds
  s_add_u32 s92, s52, 0x53800
  buffer_load_dwordx4 v10, s[8:11], s92 offen offset:2048 lds
  s_add_u32 s92, s52, 0x61400
  buffer_load_dwordx4 v10, s[8:11], s92 offen offset:3072 lds
  s_add_u32 m0, s48, 8192
  s_add_u32 s92, s52, 0x70000
  buffer_load_dwordx4 v10, s[8:11], s92 offen offset:0 lds
  s_add_u32 s92, s52, 0x7dc00
  buffer_load_dwordx4 v10, s[8:11], s92 offen offset:1024 lds
  s_add_u32 s92, s52, 0x8b800
  buffer_load_dwordx4 v10, s[8:11], s92 offen offset:2048 lds
  s_add_u32 s92, s52, 0x99400
  buffer_load_dwordx4 v10, s[8:11], s92 offen offset:3072 lds
  s_add_u32 m0, s48, 12288
  s_add_u32 s92, s52, 0xa8000
  buffer_load_dwordx4 v10, s[8:11], s92 offen offset:0 lds
  s_add_u32 s92, s52, 0xb5c00
  buffer_load_dwordx4 v10, s[8:11], s92 offen offset:1024 lds
  s_add_u32 s92, s52, 0xc3800
  buffer_load_dwordx4 v10, s[8:11], s92 offen offset:2048 lds
  s_add_u32 s92, s52, 0xd1400
  buffer_load_dwordx4 v10, s[8:11], s92 offen offset:3072 lds
  s_add_u32 m0, s48, 16384
  s_add_u32 s92, s52, 0xe0000
  buffer_load_dwordx4 v10, s[8:11], s92 offen offset:0 lds
  s_add_u32 s92, s52, 0xedc00
  buffer_load_dwordx4 v10, s[8:11], s92 offen offset:1024 lds
  s_add_u32 s92, s52, 0xfb800
  buffer_load_dwordx4 v10, s[8:11], s92 offen offset:2048 lds
  s_add_u32 s92, s52, 0x109400
  buffer_load_dwordx4 v10, s[8:11], s92 offen offset:3072 lds
  s_add_u32 m0, s48, 20480
  s_add_u32 s92, s52, 0x118000
  buffer_load_dwordx4 v10, s[8:11], s92 offen offset:0 lds
  s_add_u32 s92, s52, 0x125c00
  buffer_load_dwordx4 v10, s[8:11], s92 offen offset:1024 lds
  s_add_u32 s92, s52, 0x133800
  buffer_load_dwordx4 v10, s[8:11], s92 offen offset:2048 lds
  s_add_u32 s92, s52, 0x141400
  buffer_load_dwordx4 v10, s[8:11], s92 offen offset:3072 lds
  s_add_u32 m0, s48, 24576
  s_add_u32 s92, s52, 0x150000
  buffer_load_dwordx4 v10, s[8:11], s92 offen offset:0 lds
  s_add_u32 s92, s52, 0x15dc00
  buffer_load_dwordx4 v10, s[8:11], s92 offen offset:1024 lds
  s_add_u32 s92, s52, 0x16b800
  buffer_load_dwordx4 v10, s[8:11], s92 offen offset:2048 lds
  s_add_u32 s92, s52, 0x179400
  buffer_load_dwordx4 v10, s[8:11], s92 offen offset:3072 lds
  s_add_u32 m0, s48, 28672
  s_add_u32 s92, s52, 0x188000
  buffer_load_dwordx4 v10, s[8:11], s92 offen offset:0 lds
  s_add_u32 s92, s52, 0x195c00
  buffer_load_dwordx4 v10, s[8:11], s92 offen offset:1024 lds
  s_add_u32 s92, s52, 0x1a3800
  buffer_load_dwordx4 v10, s[8:11], s92 offen offset:2048 lds
  s_add_u32 s92, s52, 0x1b1400
  buffer_load_dwordx4 v10, s[8:11], s92 offen offset:3072 lds
  s_waitcnt vmcnt(28)
  ds_read_b64_tr_b16 a[0:1], v11 offset:0
  ds_read_b64_tr_b16 a[2:3], v11 offset:256
  ds_read_b64_tr_b16 a[64:65], v11 offset:8
  ds_read_b64_tr_b16 a[66:67], v11 offset:264
  ds_read_b64_tr_b16 a[4:5], v11 offset:2048
  ds_read_b64_tr_b16 a[6:7], v11 offset:2304
  ds_read_b64_tr_b16 a[68:69], v11 offset:2056
  ds_read_b64_tr_b16 a[70:71], v11 offset:2312
  s_waitcnt lgkmcnt(0)
  s_mov_b32 s8, s34
  s_and_b32 s9, s35, 0xffff
  s_mov_b32 s10, 0x1c0000
  s_mov_b32 s11, 0x20000
  s_add_u32 m0, s48, 0
  s_add_u32 s92, s52, 0x0
  buffer_load_dwordx4 v10, s[8:11], s92 offen offset:0 lds
  s_add_u32 s92, s52, 0xdc00
  buffer_load_dwordx4 v10, s[8:11], s92 offen offset:1024 lds
  s_add_u32 s92, s52, 0x1b800
  buffer_load_dwordx4 v10, s[8:11], s92 offen offset:2048 lds
  s_add_u32 s92, s52, 0x29400
  buffer_load_dwordx4 v10, s[8:11], s92 offen offset:3072 lds
  s_waitcnt vmcnt(28)
  ds_read_b64_tr_b16 a[8:9], v11 offset:4096
  ds_read_b64_tr_b16 a[10:11], v11 offset:4352
  ds_read_b64_tr_b16 a[72:73], v11 offset:4104
  ds_read_b64_tr_b16 a[74:75], v11 offset:4360
  ds_read_b64_tr_b16 a[12:13], v11 offset:6144
  ds_read_b64_tr_b16 a[14:15], v11 offset:6400
  ds_read_b64_tr_b16 a[76:77], v11 offset:6152
  ds_read_b64_tr_b16 a[78:79], v11 offset:6408
  s_waitcnt lgkmcnt(0)
  s_add_u32 m0, s48, 4096
  s_add_u32 s92, s52, 0x38000
  buffer_load_dwordx4 v10, s[8:11], s92 offen offset:0 lds
  s_add_u32 s92, s52, 0x45c00
  buffer_load_dwordx4 v10, s[8:11], s92 offen offset:1024 lds
  s_add_u32 s92, s52, 0x53800
  buffer_load_dwordx4 v10, s[8:11], s92 offen offset:2048 lds
  s_add_u32 s92, s52, 0x61400
  buffer_load_dwordx4 v10, s[8:11], s92 offen offset:3072 lds
  s_waitcnt vmcnt(28)
  ds_read_b64_tr_b16 a[16:17], v11 offset:8192
  ds_read_b64_tr_b16 a[18:19], v11 offset:8448
  ds_read_b64_tr_b16 a[80:81], v11 offset:8200
  ds_read_b64_tr_b16 a[82:83], v11 offset:8456
  ds_read_b64_tr_b16 a[20:21], v11 offset:10240
  ds_read_b64_tr_b16 a[22:23], v11 offset:10496
  ds_read_b64_tr_b16 a[84:85], v11 offset:10248
  ds_read_b64_tr_b16 a[86:87], v11 offset:10504
  s_waitcnt lgkmcnt(0)
  s_add_u32 m0, s48, 8192
  s_add_u32 s92, s52, 0x70000
  buffer_load_dwordx4 v10, s[8:11], s92 offen offset:0 lds
  s_add_u32 s92, s52, 0x7dc00
  buffer_load_dwordx4 v10, s[8:11], s92 offen offset:1024 lds
  s_add_u32 s92, s52, 0x8b800
  buffer_load_dwordx4 v10, s[8:11], s92 offen offset:2048 lds
  s_add_u32 s92, s52, 0x99400
  buffer_load_dwordx4 v10, s[8:11], s92 offen offset:3072 lds
  s_waitcnt vmcnt(28)
  ds_read_b64_tr_b16 a[24:25], v11 offset:12288
  ds_read_b64_tr_b16 a[26:27], v11 offset:12544
  ds_read_b64_tr_b16 a[88:89], v11 offset:12296
  ds_read_b64_tr_b16 a[90:91], v11 offset:12552
  ds_read_b64_tr_b16 a[28:29], v11 offset:14336
  ds_read_b64_tr_b16 a[30:31], v11 offset:14592
  ds_read_b64_tr_b16 a[92:93], v11 offset:14344
  ds_read_b64_tr_b16 a[94:95], v11 offset:14600
  s_waitcnt lgkmcnt(0)
  s_add_u32 m0, s48, 12288
  s_add_u32 s92, s52, 0xa8000
  buffer_load_dwordx4 v10, s[8:11], s92 offen offset:0 lds
  s_add_u32 s92, s52, 0xb5c00
  buffer_load_dwordx4 v10, s[8:11], s92 offen offset:1024 lds
  s_add_u32 s92, s52, 0xc3800
  buffer_load_dwordx4 v10, s[8:11], s92 offen offset:2048 lds
  s_add_u32 s92, s52, 0xd1400
  buffer_load_dwordx4 v10, s[8:11], s92 offen offset:3072 lds
  s_waitcnt vmcnt(28)
  ds_read_b64_tr_b16 a[32:33], v11 offset:16384
  ds_read_b64_tr_b16 a[34:35], v11 offset:16640
  ds_read_b64_tr_b16 a[96:97], v11 offset:16392
  ds_read_b64_tr_b16 a[98:99], v11 offset:16648
  ds_read_b64_tr_b16 a[36:37], v11 offset:18432
  ds_read_b64_tr_b16 a[38:39], v11 offset:18688
  ds_read_b64_tr_b16 a[100:101], v11 offset:18440
  ds_read_b64_tr_b16 a[102:103], v11 offset:18696
  s_waitcnt lgkmcnt(0)
  s_add_u32 m0, s48, 16384
  s_add_u32 s92, s52, 0xe0000
  buffer_load_dwordx4 v10, s[8:11], s92 offen offset:0 lds
  s_add_u32 s92, s52, 0xedc00
  buffer_load_dwordx4 v10, s[8:11], s92 offen offset:1024 lds
  s_add_u32 s92, s52, 0xfb800
  buffer_load_dwordx4 v10, s[8:11], s92 offen offset:2048 lds
  s_add_u32 s92, s52, 0x109400
  buffer_load_dwordx4 v10, s[8:11], s92 offen offset:3072 lds
  s_waitcnt vmcnt(28)
  ds_read_b64_tr_b16 a[40:41], v11 offset:20480
  ds_read_b64_tr_b16 a[42:43], v11 offset:20736
  ds_read_b64_tr_b16 a[104:105], v11 offset:20488
  ds_read_b64_tr_b16 a[106:107], v11 offset:20744
  ds_read_b64_tr_b16 a[44:45], v11 offset:22528
  ds_read_b64_tr_b16 a[46:47], v11 offset:22784
  ds_read_b64_tr_b16 a[108:109], v11 offset:22536
  ds_read_b64_tr_b16 a[110:111], v11 offset:22792
  s_waitcnt lgkmcnt(0)
  s_add_u32 m0, s48, 20480
  s_add_u32 s92, s52, 0x118000
  buffer_load_dwordx4 v10, s[8:11], s92 offen offset:0 lds
  s_add_u32 s92, s52, 0x125c00
  buffer_load_dwordx4 v10, s[8:11], s92 offen offset:1024 lds
  s_add_u32 s92, s52, 0x133800
  buffer_load_dwordx4 v10, s[8:11], s92 offen offset:2048 lds
  s_add_u32 s92, s52, 0x141400
  buffer_load_dwordx4 v10, s[8:11], s92 offen offset:3072 lds
  s_waitcnt vmcnt(28)
  ds_read_b64_tr_b16 a[48:49], v11 offset:24576
  ds_read_b64_tr_b16 a[50:51], v11 offset:24832
  ds_read_b64_tr_b16 a[112:113], v11 offset:24584
  ds_read_b64_tr_b16 a[114:115], v11 offset:24840
  ds_read_b64_tr_b16 a[52:53], v11 offset:26624
  ds_read_b64_tr_b16 a[54:55], v11 offset:26880
  ds_read_b64_tr_b16 a[116:117], v11 offset:26632
  ds_read_b64_tr_b16 a[118:119], v11 offset:26888
  s_waitcnt lgkmcnt(0)
  s_add_u32 m0, s48, 24576
  s_add_u32 s92, s52, 0x150000
  buffer_load_dwordx4 v10, s[8:11], s92 offen offset:0 lds
  s_add_u32 s92, s52, 0x15dc00
  buffer_load_dwordx4 v10, s[8:11], s92 offen offset:1024 lds
  s_add_u32 s92, s52, 0x16b800
  buffer_load_dwordx4 v10, s[8:11], s92 offen offset:2048 lds
  s_add_u32 s92, s52, 0x179400
  buffer_load_dwordx4 v10, s[8:11], s92 offen offset:3072 lds
  s_waitcnt vmcnt(28)
  ds_read_b64_tr_b16 a[56:57], v11 offset:28672
  ds_read_b64_tr_b16 a[58:59], v11 offset:28928
  ds_read_b64_tr_b16 a[120:121], v11 offset:28680
  ds_read_b64_tr_b16 a[122:123], v11 offset:28936
  ds_read_b64_tr_b16 a[60:61], v11 offset:30720
  ds_read_b64_tr_b16 a[62:63], v11 offset:30976
  ds_read_b64_tr_b16 a[124:125], v11 offset:30728
  ds_read_b64_tr_b16 a[126:127], v11 offset:30984
  s_waitcnt lgkmcnt(0)
  s_add_u32 m0, s48, 28672
  s_add_u32 s92, s52, 0x188000
  buffer_load_dwordx4 v10, s[8:11], s92 offen offset:0 lds
  s_add_u32 s92, s52, 0x195c00
  buffer_load_dwordx4 v10, s[8:11], s92 offen offset:1024 lds
  s_add_u32 s92, s52, 0x1a3800
  buffer_load_dwordx4 v10, s[8:11], s92 offen offset:2048 lds
  s_add_u32 s92, s52, 0x1b1400
  buffer_load_dwordx4 v10, s[8:11], s92 offen offset:3072 lds
  s_waitcnt vmcnt(28)
  ds_read_b64_tr_b16 a[128:129], v11 offset:0
  ds_read_b64_tr_b16 a[130:131], v11 offset:256
  ds_read_b64_tr_b16 a[192:193], v11 offset:8
  ds_read_b64_tr_b16 a[194:195], v11 offset:264
  ds_read_b64_tr_b16 a[132:133], v11 offset:2048
  ds_read_b64_tr_b16 a[134:135], v11 offset:2304
  ds_read_b64_tr_b16 a[196:197], v11 offset:2056
  ds_read_b64_tr_b16 a[198:199], v11 offset:2312
  s_waitcnt lgkmcnt(0)
  s_waitcnt vmcnt(24)
  ds_read_b64_tr_b16 a[136:137], v11 offset:4096
  ds_read_b64_tr_b16 a[138:139], v11 offset:4352
  ds_read_b64_tr_b16 a[200:201], v11 offset:4104
  ds_read_b64_tr_b16 a[202:203], v11 offset:4360
  ds_read_b64_tr_b16 a[140:141], v11 offset:6144
  ds_read_b64_tr_b16 a[142:143], v11 offset:6400
  ds_read_b64_tr_b16 a[204:205], v11 offset:6152
  ds_read_b64_tr_b16 a[206:207], v11 offset:6408
  s_waitcnt lgkmcnt(0)
  s_waitcnt vmcnt(20)
  ds_read_b64_tr_b16 a[144:145], v11 offset:8192
  ds_read_b64_tr_b16 a[146:147], v11 offset:8448
  ds_read_b64_tr_b16 a[208:209], v11 offset:8200
  ds_read_b64_tr_b16 a[210:211], v11 offset:8456
  ds_read_b64_tr_b16 a[148:149], v11 offset:10240
  ds_read_b64_tr_b16 a[150:151], v11 offset:10496
  ds_read_b64_tr_b16 a[212:213], v11 offset:10248
  ds_read_b64_tr_b16 a[214:215], v11 offset:10504
  s_waitcnt lgkmcnt(0)
  s_waitcnt vmcnt(16)
  ds_read_b64_tr_b16 a[152:153], v11 offset:12288
  ds_read_b64_tr_b16 a[154:155], v11 offset:12544
  ds_read_b64_tr_b16 a[216:217], v11 offset:12296
  ds_read_b64_tr_b16 a[218:219], v11 offset:12552
  ds_read_b64_tr_b16 a[156:157], v11 offset:14336
  ds_read_b64_tr_b16 a[158:159], v11 offset:14592
  ds_read_b64_tr_b16 a[220:221], v11 offset:14344
  ds_read_b64_tr_b16 a[222:223], v11 offset:14600
  s_waitcnt lgkmcnt(0)
  s_waitcnt vmcnt(12)
  ds_read_b64_tr_b16 a[160:161], v11 offset:16384
  ds_read_b64_tr_b16 a[162:163], v11 offset:16640
  ds_read_b64_tr_b16 a[224:225], v11 offset:16392
  ds_read_b64_tr_b16 a[226:227], v11 offset:16648
  ds_read_b64_tr_b16 a[164:165], v11 offset:18432
  ds_read_b64_tr_b16 a[166:167], v11 offset:18688
  ds_read_b64_tr_b16 a[228:229], v11 offset:18440
  ds_read_b64_tr_b16 a[230:231], v11 offset:18696
  s_waitcnt lgkmcnt(0)
  s_waitcnt vmcnt(8)
  ds_read_b64_tr_b16 a[168:169], v11 offset:20480
  ds_read_b64_tr_b16 a[170:171], v11 offset:20736
  ds_read_b64_tr_b16 a[232:233], v11 offset:20488
  ds_read_b64_tr_b16 a[234:235], v11 offset:20744
  ds_read_b64_tr_b16 a[172:173], v11 offset:22528
  ds_read_b64_tr_b16 a[174:175], v11 offset:22784
  ds_read_b64_tr_b16 a[236:237], v11 offset:22536
  ds_read_b64_tr_b16 a[238:239], v11 offset:22792
  s_waitcnt lgkmcnt(0)
  s_waitcnt vmcnt(4)
  ds_read_b64_tr_b16 a[176:177], v11 offset:24576
  ds_read_b64_tr_b16 a[178:179], v11 offset:24832
  ds_read_b64_tr_b16 a[240:241], v11 offset:24584
  ds_read_b64_tr_b16 a[242:243], v11 offset:24840
  ds_read_b64_tr_b16 a[180:181], v11 offset:26624
  ds_read_b64_tr_b16 a[182:183], v11 offset:26880
  ds_read_b64_tr_b16 a[244:245], v11 offset:26632
  ds_read_b64_tr_b16 a[246:247], v11 offset:26888
  s_waitcnt lgkmcnt(0)
  s_waitcnt vmcnt(0)
  ds_read_b64_tr_b16 a[184:185], v11 offset:28672
  ds_read_b64_tr_b16 a[186:187], v11 offset:28928
  ds_read_b64_tr_b16 a[248:249], v11 offset:28680
  ds_read_b64_tr_b16 a[250:251], v11 offset:28936
  ds_read_b64_tr_b16 a[188:189], v11 offset:30720
  ds_read_b64_tr_b16 a[190:191], v11 offset:30976
  ds_read_b64_tr_b16 a[252:253], v11 offset:30728
  ds_read_b64_tr_b16 a[254:255], v11 offset:30984
  s_waitcnt lgkmcnt(0)
  s_waitcnt lgkmcnt(0)
  v_mov_b32 v48, 0x3f803f80
  v_mov_b32 v49, 0x3f803f80
  v_mov_b32 v50, 0x3f803f80
  v_mov_b32 v51, 0x3f803f80
  s_nop 1
  v_mfma_f32_16x16x32_bf16 v[68:71], a[0:3], v[48:51], 0
  v_mfma_f32_16x16x32_bf16 v[68:71], a[4:7], v[48:51], v[68:71]
  v_mfma_f32_16x16x32_bf16 v[68:71], a[8:11], v[48:51], v[68:71]
  v_mfma_f32_16x16x32_bf16 v[68:71], a[12:15], v[48:51], v[68:71]
  v_mfma_f32_16x16x32_bf16 v[68:71], a[16:19], v[48:51], v[68:71]
  v_mfma_f32_16x16x32_bf16 v[68:71], a[20:23], v[48:51], v[68:71]
  v_mfma_f32_16x16x32_bf16 v[68:71], a[24:27], v[48:51], v[68:71]
  v_mfma_f32_16x16x32_bf16 v[68:71], a[28:31], v[48:51], v[68:71]
  v_mfma_f32_16x16x32_bf16 v[68:71], a[32:35], v[48:51], v[68:71]
  v_mfma_f32_16x16x32_bf16 v[68:71], a[36:39], v[48:51], v[68:71]
  v_mfma_f32_16x16x32_bf16 v[68:71], a[40:43], v[48:51], v[68:71]
  v_mfma_f32_16x16x32_bf16 v[68:71], a[44:47], v[48:51], v[68:71]
  v_mfma_f32_16x16x32_bf16 v[68:71], a[48:51], v[48:51], v[68:71]
  v_mfma_f32_16x16x32_bf16 v[68:71], a[52:55], v[48:51], v[68:71]
  v_mfma_f32_16x16x32_bf16 v[68:71], a[56:59], v[48:51], v[68:71]
  v_mfma_f32_16x16x32_bf16 v[68:71], a[60:63], v[48:51], v[68:71]
  v_mfma_f32_16x16x32_bf16 v[72:75], a[64:67], v[48:51], 0
  v_mfma_f32_16x16x32_bf16 v[72:75], a[68:71], v[48:51], v[72:75]
  v_mfma_f32_16x16x32_bf16 v[72:75], a[72:75], v[48:51], v[72:75]
  v_mfma_f32_16x16x32_bf16 v[72:75], a[76:79], v[48:51], v[72:75]
  v_mfma_f32_16x16x32_bf16 v[72:75], a[80:83], v[48:51], v[72:75]
  v_mfma_f32_16x16x32_bf16 v[72:75], a[84:87], v[48:51], v[72:75]
  v_mfma_f32_16x16x32_bf16 v[72:75], a[88:91], v[48:51], v[72:75]
  v_mfma_f32_16x16x32_bf16 v[72:75], a[92:95], v[48:51], v[72:75]
  v_mfma_f32_16x16x32_bf16 v[72:75], a[96:99], v[48:51], v[72:75]
  v_mfma_f32_16x16x32_bf16 v[72:75], a[100:103], v[48:51], v[72:75]
  v_mfma_f32_16x16x32_bf16 v[72:75], a[104:107], v[48:51], v[72:75]
  v_mfma_f32_16x16x32_bf16 v[72:75], a[108:111], v[48:51], v[72:75]
  v_mfma_f32_16x16x32_bf16 v[72:75], a[112:115], v[48:51], v[72:75]
  v_mfma_f32_16x16x32_bf16 v[72:75], a[116:119], v[48:51], v[72:75]
  v_mfma_f32_16x16x32_bf16 v[72:75], a[120:123], v[48:51], v[72:75]
  v_mfma_f32_16x16x32_bf16 v[72:75], a[124:127], v[48:51], v[72:75]
  v_mfma_f32_16x16x32_bf16 v[76:79], a[128:131], v[48:51], 0
  v_mfma_f32_16x16x32_bf16 v[76:79], a[132:135], v[48:51], v[76:79]
  v_mfma_f32_16x16x32_bf16 v[76:79], a[136:139], v[48:51], v[76:79]
  v_mfma_f32_16x16x32_bf16 v[76:79], a[140:143], v[48:51], v[76:79]
  v_mfma_f32_16x16x32_bf16 v[76:79], a[144:147], v[48:51], v[76:79]
  v_mfma_f32_16x16x32_bf16 v[76:79], a[148:151], v[48:51], v[76:79]
  v_mfma_f32_16x16x32_bf16 v[76:79], a[152:155], v[48:51], v[76:79]
  v_mfma_f32_16x16x32_bf16 v[76:79], a[156:159], v[48:51], v[76:79]
  v_mfma_f32_16x16x32_bf16 v[76:79], a[160:163], v[48:51], v[76:79]
  v_mfma_f32_16x16x32_bf16 v[76:79], a[164:167], v[48:51], v[76:79]
  v_mfma_f32_16x16x32_bf16 v[76:79], a[168:171], v[48:51], v[76:79]
  v_mfma_f32_16x16x32_bf16 v[76:79], a[172:175], v[48:51], v[76:79]
  v_mfma_f32_16x16x32_bf16 v[76:79], a[176:179], v[48:51], v[76:79]
  v_mfma_f32_16x16x32_bf16 v[76:79], a[180:183], v[48:51], v[76:79]
  v_mfma_f32_16x16x32_bf16 v[76:79], a[184:187], v[48:51], v[76:79]
  v_mfma_f32_16x16x32_bf16 v[76:79], a[188:191], v[48:51], v[76:79]
  v_mfma_f32_16x16x32_bf16 v[80:83], a[192:195], v[48:51], 0
  v_mfma_f32_16x16x32_bf16 v[80:83], a[196:199], v[48:51], v[80:83]
  v_mfma_f32_16x16x32_bf16 v[80:83], a[200:203], v[48:51], v[80:83]
  v_mfma_f32_16x16x32_bf16 v[80:83], a[204:207], v[48:51], v[80:83]
  v_mfma_f32_16x16x32_bf16 v[80:83], a[208:211], v[48:51], v[80:83]
  v_mfma_f32_16x16x32_bf16 v[80:83], a[212:215], v[48:51], v[80:83]
  v_mfma_f32_16x16x32_bf16 v[80:83], a[216:219], v[48:51], v[80:83]
  v_mfma_f32_16x16x32_bf16 v[80:83], a[220:223], v[48:51], v[80:83]
  v_mfma_f32_16x16x32_bf16 v[80:83], a[224:227], v[48:51], v[80:83]
  v_mfma_f32_16x16x32_bf16 v[80:83], a[228:231], v[48:51], v[80:83]
  v_mfma_f32_16x16x32_bf16 v[80:83], a[232:235], v[48:51], v[80:83]
  v_mfma_f32_16x16x32_bf16 v[80:83], a[236:239], v[48:51], v[80:83]
  v_mfma_f32_16x16x32_bf16 v[80:83], a[240:243], v[48:51], v[80:83]
  v_mfma_f32_16x16x32_bf16 v[80:83], a[244:247], v[48:51], v[80:83]
  v_mfma_f32_16x16x32_bf16 v[80:83], a[248:251], v[48:51], v[80:83]
  v_mfma_f32_16x16x32_bf16 v[80:83], a[252:255], v[48:51], v[80:83]
  v_and_b32 v3, 31, v0
  v_lshrrev_b32 v7, 5, v0
  v_lshlrev_b32 v2, 3, v3
  v_lshl_add_u32 v2, v7, 11, v2
  s_lshl_b32 s92, s44, 8
  s_add_u32 s92, s92, 81920
  v_lshlrev_b32 v7, 7, v0
  v_lshl_add_u32 v3, v3, 2, s92
  v_and_b32 v10, 15, v0
  v_lshl_add_u32 v4, v10, 2, s92
  v_mov_b32 v5, 1
  v_mov_b32 v6, 0
  v_mov_b32 v8, 0xc0135761
  v_mov_b32 v9, 0xbdd2d3e8
  v_add_u32 v11, 36864, v1
  v_add_u32 v14, 36864, v2
  s_mul_i32 s64, s44, 9216
  s_mov_b32 s53, 0
F1_INIT:
  s_lshl_b32 s94, s50, 7
  s_add_u32 s94, s94, s53
  s_add_u32 s94, s94, 64
  s_mul_i32 s54, s94, 36864
  s_add_u32 s54, s54, 0x400000
  s_add_u32 s54, s54, s64
  s_lshl_b32 s95, s50, 6
  s_add_u32 s95, s95, s53
  s_lshl_b32 s95, s95, 13
  s_add_u32 s58, s95, 0xc200000
  s_add_u32 s56, s95, 0xc300000
  s_lshl_b32 s92, s57, 7
  s_add_u32 s56, s56, s92
  s_lshl_b32 s55, s50, 6
  s_add_u32 s55, s55, s53
  s_mul_i32 s55, s55, 114688
  s_add_u32 s55, s55, 0xe00000
  s_lshl_b32 s92, s57, 10
  s_add_u32 s55, s55, s92
  s_lshl_b32 s62, s45, 7
  s_add_u32 s62, s62, 0x80000
  s_mov_b32 s61, s62
  s_barrier
  s_mov_b32 s101, 0
poll_2705:
  buffer_load_dword v10, v7, s[4:7], s58 offen sc1
  s_waitcnt vmcnt(0)
  v_cmp_eq_u32 vcc, 0, v10
  s_nop 0
  s_cbranch_vccz polld_2706
  s_add_u32 s47, s47, 1
  s_mov_b32 s49, 5
  s_cmp_gt_u32 s47, 131072
  s_cbranch_scc1 TIMEOUT
  s_sleep 3
  s_branch poll_2705
polld_2706:
  s_mov_b32 s59, s54
  s_add_u32 s63, s64, 0
  s_add_u32 m0, s63, 0
  s_nop 0
  buffer_load_dwordx4 v1, s[4:7], s59 offen offset:0 sc1 lds
  buffer_load_dwordx4 v1, s[4:7], s59 offen offset:1024 sc1 lds
  buffer_load_dwordx4 v1, s[4:7], s59 offen offset:2048 sc1 lds
  buffer_load_dwordx4 v1, s[4:7], s59 offen offset:3072 sc1 lds
  s_add_u32 m0, s63, 4096
  s_add_u32 s59, s59, 4096
  buffer_load_dwordx4 v1, s[4:7], s59 offen offset:0 sc1 lds
  buffer_load_dwordx4 v1, s[4:7], s59 offen offset:1024 sc1 lds
  buffer_load_dwordx4 v1, s[4:7], s59 offen offset:2048 sc1 lds
  buffer_load_dwordx4 v1, s[4:7], s59 offen offset:3072 sc1 lds
  s_add_u32 m0, s63, 8192
  s_add_u32 s59, s59, 4096
  buffer_load_dwordx4 v1, s[4:7], s59 offen offset:0 sc1 lds
  s_waitcnt vmcnt(0)
F1_LOOP:
  s_mul_i32 s93, s50, s53
  s_cmp_ge_u32 s93, 56
  s_cselect_b32 s65, 2, 1
  s_add_u32 s53, s53, s65
  s_lshl_b32 s92, s65, 13
  s_add_u32 s58, s58, s92
  s_waitcnt vmcnt(1)
  s_barrier
  ds_read_b128 v[48:51], v1 offset:0
  ds_read_b128 v[52:55], v1 offset:1024
  ds_read_b128 v[56:59], v1 offset:2048
  ds_read_b128 v[60:63], v1 offset:3072
  s_waitcnt lgkmcnt(3)
  v_mfma_f32_16x16x32_bf16 v[16:19], a[0:3], v[48:51], 0
  ds_read_b64 v[100:101], v2 offset:32768
  ds_read_b64 v[102:103], v2 offset:33024
  v_mfma_f32_16x16x32_bf16 v[20:23], a[64:67], v[48:51], 0
  ds_read_b64 v[104:105], v2 offset:33280
  ds_read_b64 v[106:107], v2 offset:33536
  v_mfma_f32_16x16x32_bf16 v[24:27], a[128:131], v[48:51], 0
  ds_read_b64 v[108:109], v2 offset:33792
  ds_read_b64 v[110:111], v2 offset:34048
  v_mfma_f32_16x16x32_bf16 v[28:31], a[192:195], v[48:51], 0
  s_waitcnt lgkmcnt(8)
  ds_read_b64 v[112:113], v2 offset:34304
  ds_read_b128 v[48:51], v1 offset:4096
  v_mfma_f32_16x16x32_bf16 v[16:19], a[4:7], v[52:55], v[16:19]
  ds_read_b64 v[114:115], v2 offset:34560
  v_mfma_f32_16x16x32_bf16 v[20:23], a[68:71], v[52:55], v[20:23]
  v_mfma_f32_16x16x32_bf16 v[24:27], a[132:135], v[52:55], v[24:27]
  v_mfma_f32_16x16x32_bf16 v[28:31], a[196:199], v[52:55], v[28:31]
  s_waitcnt lgkmcnt(10)
  ds_read_b128 v[52:55], v1 offset:5120
  v_mfma_f32_16x16x32_bf16 v[16:19], a[8:11], v[56:59], v[16:19]
  v_mfma_f32_16x16x32_bf16 v[20:23], a[72:75], v[56:59], v[20:23]
  v_mfma_f32_16x16x32_bf16 v[24:27], a[136:139], v[56:59], v[24:27]
  s_waitcnt lgkmcnt(8)
  v_add_f32 v116, v100, v102
  s_waitcnt lgkmcnt(7)
  v_add_f32 v116, v116, v104
  v_mfma_f32_16x16x32_bf16 v[28:31], a[200:203], v[56:59], v[28:31]
  s_waitcnt lgkmcnt(6)
  v_add_f32 v116, v116, v106
  ds_read_b128 v[56:59], v1 offset:6144
  v_mfma_f32_16x16x32_bf16 v[16:19], a[12:15], v[60:63], v[16:19]
  s_waitcnt lgkmcnt(6)
  v_add_f32 v116, v116, v108
  s_waitcnt lgkmcnt(5)
  v_add_f32 v116, v116, v110
  v_mfma_f32_16x16x32_bf16 v[20:23], a[76:79], v[60:63], v[20:23]
  s_waitcnt lgkmcnt(4)
  v_add_f32 v116, v116, v112
  s_waitcnt lgkmcnt(2)
  v_add_f32 v116, v116, v114
  v_mfma_f32_16x16x32_bf16 v[24:27], a[140:143], v[60:63], v[24:27]
  v_mov_b32 v118, v116
  v_mfma_f32_16x16x32_bf16 v[28:31], a[204:207], v[60:63], v[28:31]
  ds_read_b128 v[60:63], v1 offset:7168
  v_mfma_f32_16x16x32_bf16 v[16:19], a[16:19], v[48:51], v[16:19]
  v_permlane32_swap_b32 v116, v118
  v_mfma_f32_16x16x32_bf16 v[20:23], a[80:83], v[48:51], v[20:23]
  v_add_f32 v116, v116, v118
  v_mul_f32 v116, 0x3d800000, v116
  v_mfma_f32_16x16x32_bf16 v[24:27], a[144:147], v[48:51], v[24:27]
  v_add_f32 v117, v101, v103
  v_add_f32 v117, v117, v105
  v_mfma_f32_16x16x32_bf16 v[28:31], a[208:211], v[48:51], v[28:31]
  s_waitcnt lgkmcnt(2)
  v_add_f32 v117, v117, v107
  ds_read_b128 v[48:51], v1 offset:8192
  v_mfma_f32_16x16x32_bf16 v[16:19], a[20:23], v[52:55], v[16:19]
  v_add_f32 v117, v117, v109
  v_add_f32 v117, v117, v111
  v_mfma_f32_16x16x32_bf16 v[20:23], a[84:87], v[52:55], v[20:23]
  buffer_load_dword v10, v7, s[4:7], s58 offen sc1
  v_mfma_f32_16x16x32_bf16 v[24:27], a[148:151], v[52:55], v[24:27]
  v_add_f32 v117, v117, v113
  v_add_f32 v117, v117, v115
  v_mfma_f32_16x16x32_bf16 v[28:31], a[212:215], v[52:55], v[28:31]
  s_waitcnt lgkmcnt(2)
  v_sub_f32 v100, v100, v116
  ds_read_b128 v[52:55], v1 offset:9216
  v_mfma_f32_16x16x32_bf16 v[16:19], a[24:27], v[56:59], v[16:19]
  v_sub_f32 v102, v102, v116
  v_sub_f32 v104, v104, v116
  v_mfma_f32_16x16x32_bf16 v[20:23], a[88:91], v[56:59], v[20:23]
  v_sub_f32 v106, v106, v116
  v_sub_f32 v108, v108, v116
  v_mfma_f32_16x16x32_bf16 v[24:27], a[152:155], v[56:59], v[24:27]
  v_sub_f32 v110, v110, v116
  v_sub_f32 v112, v112, v116
  v_mfma_f32_16x16x32_bf16 v[28:31], a[216:219], v[56:59], v[28:31]
  s_waitcnt lgkmcnt(2)
  v_sub_f32 v114, v114, v116
  ds_read_b128 v[56:59], v1 offset:10240
  v_mfma_f32_16x16x32_bf16 v[16:19], a[28:31], v[60:63], v[16:19]
  v_mul_f32 v118, v100, v100
  v_fmac_f32 v118, v102, v102
  v_mfma_f32_16x16x32_bf16 v[20:23], a[92:95], v[60:63], v[20:23]
  v_fmac_f32 v118, v104, v104
  v_fmac_f32 v118, v106, v106
  v_mfma_f32_16x16x32_bf16 v[24:27], a[156:159], v[60:63], v[24:27]
  v_fmac_f32 v118, v108, v108
  v_fmac_f32 v118, v110, v110
  v_mfma_f32_16x16x32_bf16 v[28:31], a[220:223], v[60:63], v[28:31]
  s_waitcnt lgkmcnt(2)
  v_fmac_f32 v118, v112, v112
  ds_read_b128 v[60:63], v1 offset:11264
  v_mfma_f32_16x16x32_bf16 v[16:19], a[32:35], v[48:51], v[16:19]
  v_fmac_f32 v118, v114, v114
  v_fmac_f32 v117, 0x42000000, v118
  v_mfma_f32_16x16x32_bf16 v[20:23], a[96:99], v[48:51], v[20:23]
  v_mov_b32 v118, v117
  v_mfma_f32_16x16x32_bf16 v[24:27], a[160:163], v[48:51], v[24:27]
  s_nop 0
  v_permlane32_swap_b32 v117, v118
  v_mfma_f32_16x16x32_bf16 v[28:31], a[224:227], v[48:51], v[28:31]
  s_waitcnt lgkmcnt(2)
  v_add_f32 v117, v117, v118
  ds_read_b128 v[48:51], v1 offset:12288
  v_mfma_f32_16x16x32_bf16 v[16:19], a[36:39], v[52:55], v[16:19]
  v_mul_f32 v117, 0x3b000000, v117
  v_cvt_pk_bf16_f32 v116, v116, v116
  v_mfma_f32_16x16x32_bf16 v[20:23], a[100:103], v[52:55], v[20:23]
  v_lshlrev_b32 v116, 16, v116
  v_cvt_pk_bf16_f32 v117, v117, v117
  v_mfma_f32_16x16x32_bf16 v[24:27], a[164:167], v[52:55], v[24:27]
  v_lshlrev_b32 v117, 16, v117
  v_add_f32 v117, 0x3727c5ac, v117
  v_mfma_f32_16x16x32_bf16 v[28:31], a[228:231], v[52:55], v[28:31]
  s_waitcnt lgkmcnt(2)
  v_cvt_pk_bf16_f32 v117, v117, v117
  ds_read_b128 v[52:55], v1 offset:13312
  v_mfma_f32_16x16x32_bf16 v[16:19], a[40:43], v[56:59], v[16:19]
  v_lshlrev_b32 v117, 16, v117
  v_mfma_f32_16x16x32_bf16 v[20:23], a[104:107], v[56:59], v[20:23]
  v_sqrt_f32 v117, v117
  v_mfma_f32_16x16x32_bf16 v[24:27], a[168:171], v[56:59], v[24:27]
  v_cvt_pk_bf16_f32 v117, v117, v117
  v_lshlrev_b32 v117, 16, v117
  v_mfma_f32_16x16x32_bf16 v[28:31], a[232:235], v[56:59], v[28:31]
  s_waitcnt lgkmcnt(2)
  ds_read_b128 v[56:59], v1 offset:14336
  v_mfma_f32_16x16x32_bf16 v[16:19], a[44:47], v[60:63], v[16:19]
  v_rcp_f32 v117, v117
  v_mfma_f32_16x16x32_bf16 v[20:23], a[108:111], v[60:63], v[20:23]
  v_sub_f32 v116, 0, v116
  ds_write_b32 v3, v117
  v_mfma_f32_16x16x32_bf16 v[24:27], a[172:175], v[60:63], v[24:27]
  ds_write_b32 v3, v116 offset:128
  ds_read_b32 v64, v4 offset:0
  v_mfma_f32_16x16x32_bf16 v[28:31], a[236:239], v[60:63], v[28:31]
  s_waitcnt lgkmcnt(5)
  ds_read_b32 v65, v4 offset:128
  ds_read_b128 v[60:63], v1 offset:15360
  v_mfma_f32_16x16x32_bf16 v[16:19], a[48:51], v[48:51], v[16:19]
  ds_read_b32 v66, v4 offset:64
  ds_read_b32 v67, v4 offset:192
  v_mfma_f32_16x16x32_bf16 v[20:23], a[112:115], v[48:51], v[20:23]
  v_mfma_f32_16x16x32_bf16 v[24:27], a[176:179], v[48:51], v[24:27]
  v_mfma_f32_16x16x32_bf16 v[28:31], a[240:243], v[48:51], v[28:31]
  s_waitcnt lgkmcnt(8)
  ds_read_b128 v[48:51], v1 offset:16384
  v_mfma_f32_16x16x32_bf16 v[16:19], a[52:55], v[52:55], v[16:19]
  v_mfma_f32_16x16x32_bf16 v[20:23], a[116:119], v[52:55], v[20:23]
  v_mfma_f32_16x16x32_bf16 v[24:27], a[180:183], v[52:55], v[24:27]
  v_mfma_f32_16x16x32_bf16 v[28:31], a[244:247], v[52:55], v[28:31]
  s_waitcnt lgkmcnt(8)
  ds_read_b128 v[52:55], v1 offset:17408
  v_mfma_f32_16x16x32_bf16 v[16:19], a[56:59], v[56:59], v[16:19]
  v_mfma_f32_16x16x32_bf16 v[20:23], a[120:123], v[56:59], v[20:23]
  v_mfma_f32_16x16x32_bf16 v[24:27], a[184:187], v[56:59], v[24:27]
  v_mfma_f32_16x16x32_bf16 v[28:31], a[248:251], v[56:59], v[28:31]
  s_waitcnt vmcnt(1)
  s_mov_b64 exec, 1
  buffer_store_dword v5, off, s[4:7], s61 sc1
  s_mov_b64 exec, -1
  ds_read_b128 v[56:59], v1 offset:18432
  s_waitcnt lgkmcnt(5)
  v_mfma_f32_16x16x32_bf16 v[16:19], a[60:63], v[60:63], v[16:19]
  v_rcp_f32 v120, v64
  v_mfma_f32_16x16x32_bf16 v[20:23], a[124:127], v[60:63], v[20:23]
  s_waitcnt lgkmcnt(4)
  v_rcp_f32 v121, v66
  v_mfma_f32_16x16x32_bf16 v[24:27], a[188:191], v[60:63], v[24:27]
  v_mfma_f32_16x16x32_bf16 v[28:31], a[252:255], v[60:63], v[28:31]
  s_waitcnt lgkmcnt(2)
  ds_read_b128 v[60:63], v1 offset:19456
  v_mfma_f32_16x16x32_bf16 v[32:35], a[0:3], v[48:51], 0
  v_mfma_f32_16x16x32_bf16 v[36:39], a[64:67], v[48:51], 0
  v_mfma_f32_16x16x32_bf16 v[40:43], a[128:131], v[48:51], 0
  v_mfma_f32_16x16x32_bf16 v[44:47], a[192:195], v[48:51], 0
  s_waitcnt vmcnt(1)
  v_cmp_ne_u32 vcc, 0, v10
  ds_read_b128 v[48:51], v1 offset:20480
  s_waitcnt lgkmcnt(3)
  v_mfma_f32_16x16x32_bf16 v[32:35], a[4:7], v[52:55], v[32:35]
  s_add_u32 s63, s64, 36864
  s_mul_i32 s59, s65, 36864
  s_add_u32 s59, s59, s54
  v_mfma_f32_16x16x32_bf16 v[36:39], a[68:71], v[52:55], v[36:39]
  s_cmp_eq_u64 vcc, -1
  s_cselect_b32 s60, 1, 0
  s_cmp_lt_u32 s53, 64
  v_mfma_f32_16x16x32_bf16 v[40:43], a[132:135], v[52:55], v[40:43]
  s_cselect_b32 s60, s60, 0
  v_mfma_f32_16x16x32_bf16 v[44:47], a[196:199], v[52:55], v[44:47]
  ds_read_b128 v[52:55], v1 offset:21504
  s_cmp_eq_u32 s60, 0
  s_cbranch_scc1 fpl_2707
  s_waitcnt lgkmcnt(3)
  v_mfma_f32_16x16x32_bf16 v[32:35], a[8:11], v[56:59], v[32:35]
  s_add_u32 m0, s63, 0
  s_nop 0
  v_mfma_f32_16x16x32_bf16 v[36:39], a[72:75], v[56:59], v[36:39]
  buffer_load_dwordx4 v1, s[4:7], s59 offen offset:0 sc1 lds
  v_mfma_f32_16x16x32_bf16 v[40:43], a[136:139], v[56:59], v[40:43]
  v_fmac_f32 v16, v65, v68
  v_fmac_f32 v24, v65, v76
  v_mfma_f32_16x16x32_bf16 v[44:47], a[200:203], v[56:59], v[44:47]
  s_waitcnt lgkmcnt(2)
  v_mul_f32 v16, v64, v16
  ds_read_b128 v[56:59], v1 offset:22528
  v_mfma_f32_16x16x32_bf16 v[32:35], a[12:15], v[60:63], v[32:35]
  v_mul_f32 v92, v16, v16
  v_mfma_f32_16x16x32_bf16 v[36:39], a[76:79], v[60:63], v[36:39]
  buffer_load_dwordx4 v1, s[4:7], s59 offen offset:1024 sc1 lds
  v_mfma_f32_16x16x32_bf16 v[40:43], a[140:143], v[60:63], v[40:43]
  v_fma_f32 v92, v92, v9, v8
  v_mul_f32 v92, v92, v16
  v_mfma_f32_16x16x32_bf16 v[44:47], a[204:207], v[60:63], v[44:47]
  s_waitcnt lgkmcnt(2)
  ds_read_b128 v[60:63], v1 offset:23552
  v_mfma_f32_16x16x32_bf16 v[32:35], a[16:19], v[48:51], v[32:35]
  v_exp_f32 v92, v92
  v_mfma_f32_16x16x32_bf16 v[36:39], a[80:83], v[48:51], v[36:39]
  v_mul_f32 v24, v24, v16
  v_mfma_f32_16x16x32_bf16 v[40:43], a[144:147], v[48:51], v[40:43]
  buffer_load_dwordx4 v1, s[4:7], s59 offen offset:2048 sc1 lds
  v_mfma_f32_16x16x32_bf16 v[44:47], a[208:211], v[48:51], v[44:47]
  s_waitcnt lgkmcnt(2)
  v_fma_f32 v92, v92, v120, v120
  ds_read_b128 v[48:51], v1 offset:24576
  v_mfma_f32_16x16x32_bf16 v[32:35], a[20:23], v[52:55], v[32:35]
  v_rcp_f32 v92, v92
  v_mfma_f32_16x16x32_bf16 v[36:39], a[84:87], v[52:55], v[36:39]
  v_fmac_f32 v17, v65, v69
  v_fmac_f32 v25, v65, v77
  v_mfma_f32_16x16x32_bf16 v[40:43], a[148:151], v[52:55], v[40:43]
  buffer_load_dwordx4 v1, s[4:7], s59 offen offset:3072 sc1 lds
  v_mfma_f32_16x16x32_bf16 v[44:47], a[212:215], v[52:55], v[44:47]
  s_waitcnt lgkmcnt(2)
  v_mul_f32 v17, v64, v17
  ds_read_b128 v[52:55], v1 offset:25600
  v_mfma_f32_16x16x32_bf16 v[32:35], a[24:27], v[56:59], v[32:35]
  v_mul_f32 v93, v17, v17
  v_fma_f32 v93, v93, v9, v8
  v_mfma_f32_16x16x32_bf16 v[36:39], a[88:91], v[56:59], v[36:39]
  v_mul_f32 v93, v93, v17
  s_add_u32 m0, s63, 4096
  v_mfma_f32_16x16x32_bf16 v[40:43], a[152:155], v[56:59], v[40:43]
  s_add_u32 s59, s59, 4096
  buffer_load_dwordx4 v1, s[4:7], s59 offen offset:0 sc1 lds
  v_mfma_f32_16x16x32_bf16 v[44:47], a[216:219], v[56:59], v[44:47]
  s_waitcnt lgkmcnt(2)
  ds_read_b128 v[56:59], v1 offset:26624
  v_mfma_f32_16x16x32_bf16 v[32:35], a[28:31], v[60:63], v[32:35]
  v_exp_f32 v93, v93
  v_mfma_f32_16x16x32_bf16 v[36:39], a[92:95], v[60:63], v[36:39]
  v_mul_f32 v25, v25, v17
  v_fma_f32 v93, v93, v120, v120
  v_mfma_f32_16x16x32_bf16 v[40:43], a[156:159], v[60:63], v[40:43]
  v_rcp_f32 v93, v93
  v_mfma_f32_16x16x32_bf16 v[44:47], a[220:223], v[60:63], v[44:47]
  s_waitcnt lgkmcnt(2)
  ds_read_b128 v[60:63], v1 offset:27648
  v_mfma_f32_16x16x32_bf16 v[32:35], a[32:35], v[48:51], v[32:35]
  buffer_load_dwordx4 v1, s[4:7], s59 offen offset:1024 sc1 lds
  v_mfma_f32_16x16x32_bf16 v[36:39], a[96:99], v[48:51], v[36:39]
  v_mul_f32 v24, v24, v92
  v_fmac_f32 v18, v65, v70
  v_mfma_f32_16x16x32_bf16 v[40:43], a[160:163], v[48:51], v[40:43]
  v_fmac_f32 v26, v65, v78
  v_mul_f32 v18, v64, v18
  v_mfma_f32_16x16x32_bf16 v[44:47], a[224:227], v[48:51], v[44:47]
  s_waitcnt lgkmcnt(2)
  ds_read_b128 v[48:51], v1 offset:28672
  v_mfma_f32_16x16x32_bf16 v[32:35], a[36:39], v[52:55], v[32:35]
  buffer_load_dwordx4 v1, s[4:7], s59 offen offset:2048 sc1 lds
  v_mfma_f32_16x16x32_bf16 v[36:39], a[100:103], v[52:55], v[36:39]
  v_mul_f32 v94, v18, v18
  v_fma_f32 v94, v94, v9, v8
  v_mfma_f32_16x16x32_bf16 v[40:43], a[164:167], v[52:55], v[40:43]
  v_mul_f32 v94, v94, v18
  v_mfma_f32_16x16x32_bf16 v[44:47], a[228:231], v[52:55], v[44:47]
  s_waitcnt lgkmcnt(2)
  ds_read_b128 v[52:55], v1 offset:29696
  v_mfma_f32_16x16x32_bf16 v[32:35], a[40:43], v[56:59], v[32:35]
  v_exp_f32 v94, v94
  v_mfma_f32_16x16x32_bf16 v[36:39], a[104:107], v[56:59], v[36:39]
  buffer_load_dwordx4 v1, s[4:7], s59 offen offset:3072 sc1 lds
  v_mfma_f32_16x16x32_bf16 v[40:43], a[168:171], v[56:59], v[40:43]
  v_mul_f32 v26, v26, v18
  v_fma_f32 v94, v94, v120, v120
  v_mfma_f32_16x16x32_bf16 v[44:47], a[232:235], v[56:59], v[44:47]
  s_waitcnt lgkmcnt(2)
  ds_read_b128 v[56:59], v1 offset:30720
  v_mfma_f32_16x16x32_bf16 v[32:35], a[44:47], v[60:63], v[32:35]
  v_rcp_f32 v94, v94
  v_mfma_f32_16x16x32_bf16 v[36:39], a[108:111], v[60:63], v[36:39]
  v_mul_f32 v25, v25, v93
  s_add_u32 m0, s63, 8192
  v_mfma_f32_16x16x32_bf16 v[40:43], a[172:175], v[60:63], v[40:43]
  s_add_u32 s59, s59, 4096
  buffer_load_dwordx4 v1, s[4:7], s59 offen offset:0 sc1 lds
  v_mfma_f32_16x16x32_bf16 v[44:47], a[236:239], v[60:63], v[44:47]
  s_waitcnt lgkmcnt(2)
  v_fmac_f32 v19, v65, v71
  ds_read_b128 v[60:63], v1 offset:31744
  v_mfma_f32_16x16x32_bf16 v[32:35], a[48:51], v[48:51], v[32:35]
  v_fmac_f32 v27, v65, v79
  v_mul_f32 v19, v64, v19
  v_mfma_f32_16x16x32_bf16 v[36:39], a[112:115], v[48:51], v[36:39]
  v_mul_f32 v95, v19, v19
  v_fma_f32 v95, v95, v9, v8
  v_mfma_f32_16x16x32_bf16 v[40:43], a[176:179], v[48:51], v[40:43]
  v_mul_f32 v95, v95, v19
  v_mfma_f32_16x16x32_bf16 v[44:47], a[240:243], v[48:51], v[44:47]
  s_waitcnt lgkmcnt(2)
  v_exp_f32 v95, v95
  v_mfma_f32_16x16x32_bf16 v[32:35], a[52:55], v[52:55], v[32:35]
  v_mul_f32 v27, v27, v19
  v_fma_f32 v95, v95, v120, v120
  v_mfma_f32_16x16x32_bf16 v[36:39], a[116:119], v[52:55], v[36:39]
  v_rcp_f32 v95, v95
  v_mfma_f32_16x16x32_bf16 v[40:43], a[180:183], v[52:55], v[40:43]
  v_mul_f32 v26, v26, v94
  v_fmac_f32 v20, v65, v72
  v_mfma_f32_16x16x32_bf16 v[44:47], a[244:247], v[52:55], v[44:47]
  s_waitcnt lgkmcnt(1)
  v_fmac_f32 v28, v65, v80
  v_mul_f32 v20, v64, v20
  v_mfma_f32_16x16x32_bf16 v[32:35], a[56:59], v[56:59], v[32:35]
  v_mul_f32 v96, v20, v20
  v_fma_f32 v96, v96, v9, v8
  v_mfma_f32_16x16x32_bf16 v[36:39], a[120:123], v[56:59], v[36:39]
  v_mul_f32 v96, v96, v20
  v_mfma_f32_16x16x32_bf16 v[40:43], a[184:187], v[56:59], v[40:43]
  v_exp_f32 v96, v96
  v_mfma_f32_16x16x32_bf16 v[44:47], a[248:251], v[56:59], v[44:47]
  s_waitcnt lgkmcnt(0)
  v_mul_f32 v28, v28, v20
  v_fma_f32 v96, v96, v120, v120
  v_mfma_f32_16x16x32_bf16 v[32:35], a[60:63], v[60:63], v[32:35]
  v_rcp_f32 v96, v96
  v_mfma_f32_16x16x32_bf16 v[36:39], a[124:127], v[60:63], v[36:39]
  v_mul_f32 v27, v27, v95
  v_fmac_f32 v21, v65, v73
  v_mfma_f32_16x16x32_bf16 v[40:43], a[188:191], v[60:63], v[40:43]
  v_fmac_f32 v29, v65, v81
  v_mul_f32 v21, v64, v21
  v_mfma_f32_16x16x32_bf16 v[44:47], a[252:255], v[60:63], v[44:47]
  v_mul_f32 v97, v21, v21
  v_fma_f32 v97, v97, v9, v8
  v_mul_f32 v97, v97, v21
  v_exp_f32 v97, v97
  v_mul_f32 v29, v29, v21
  v_fma_f32 v97, v97, v120, v120
  v_rcp_f32 v97, v97
  v_mul_f32 v28, v28, v96
  v_fmac_f32 v22, v65, v74
  v_fmac_f32 v30, v65, v82
  v_mul_f32 v22, v64, v22
  v_mul_f32 v98, v22, v22
  v_fma_f32 v98, v98, v9, v8
  v_mul_f32 v98, v98, v22
  v_exp_f32 v98, v98
  v_mul_f32 v30, v30, v22
  v_fma_f32 v98, v98, v120, v120
  v_rcp_f32 v98, v98
  v_mul_f32 v29, v29, v97
  v_fmac_f32 v23, v65, v75
  v_fmac_f32 v31, v65, v83
  v_mul_f32 v23, v64, v23
  v_mul_f32 v99, v23, v23
  v_fma_f32 v99, v99, v9, v8
  v_mul_f32 v99, v99, v23
  v_exp_f32 v99, v99
  v_mul_f32 v31, v31, v23
  v_fma_f32 v99, v99, v120, v120
  v_rcp_f32 v99, v99
  v_mul_f32 v30, v30, v98
  v_mul_f32 v31, v31, v99
  v_cvt_pk_bf16_f32 v84, v24, v25
  v_cvt_pk_bf16_f32 v85, v26, v27
  v_cvt_pk_bf16_f32 v86, v28, v29
  v_cvt_pk_bf16_f32 v87, v30, v31
  s_add_u32 s3, s55, 0
  buffer_store_dwordx4 v[84:87], v1, s[4:7], s3 offen sc1
  s_branch fsc_2708
fpl_2707:
  s_waitcnt lgkmcnt(3)
  v_mfma_f32_16x16x32_bf16 v[32:35], a[8:11], v[56:59], v[32:35]
  buffer_load_dword v10, v7, s[4:7], s58 offen sc1
  v_mfma_f32_16x16x32_bf16 v[36:39], a[72:75], v[56:59], v[36:39]
  v_fmac_f32 v16, v65, v68
  v_fmac_f32 v24, v65, v76
  v_mfma_f32_16x16x32_bf16 v[40:43], a[136:139], v[56:59], v[40:43]
  v_mul_f32 v16, v64, v16
  v_mul_f32 v92, v16, v16
  v_mfma_f32_16x16x32_bf16 v[44:47], a[200:203], v[56:59], v[44:47]
  s_waitcnt lgkmcnt(2)
  v_fma_f32 v92, v92, v9, v8
  ds_read_b128 v[56:59], v1 offset:22528
  v_mfma_f32_16x16x32_bf16 v[32:35], a[12:15], v[60:63], v[32:35]
  v_mul_f32 v92, v92, v16
  v_mfma_f32_16x16x32_bf16 v[36:39], a[76:79], v[60:63], v[36:39]
  v_exp_f32 v92, v92
  v_mfma_f32_16x16x32_bf16 v[40:43], a[140:143], v[60:63], v[40:43]
  v_mul_f32 v24, v24, v16
  v_fma_f32 v92, v92, v120, v120
  v_mfma_f32_16x16x32_bf16 v[44:47], a[204:207], v[60:63], v[44:47]
  s_waitcnt lgkmcnt(2)
  ds_read_b128 v[60:63], v1 offset:23552
  v_mfma_f32_16x16x32_bf16 v[32:35], a[16:19], v[48:51], v[32:35]
  v_rcp_f32 v92, v92
  v_mfma_f32_16x16x32_bf16 v[36:39], a[80:83], v[48:51], v[36:39]
  v_fmac_f32 v17, v65, v69
  v_fmac_f32 v25, v65, v77
  v_mfma_f32_16x16x32_bf16 v[40:43], a[144:147], v[48:51], v[40:43]
  v_mul_f32 v17, v64, v17
  v_mul_f32 v93, v17, v17
  v_mfma_f32_16x16x32_bf16 v[44:47], a[208:211], v[48:51], v[44:47]
  s_waitcnt lgkmcnt(2)
  v_fma_f32 v93, v93, v9, v8
  ds_read_b128 v[48:51], v1 offset:24576
  v_mfma_f32_16x16x32_bf16 v[32:35], a[20:23], v[52:55], v[32:35]
  v_mul_f32 v93, v93, v17
  v_mfma_f32_16x16x32_bf16 v[36:39], a[84:87], v[52:55], v[36:39]
  v_exp_f32 v93, v93
  v_mfma_f32_16x16x32_bf16 v[40:43], a[148:151], v[52:55], v[40:43]
  v_mul_f32 v25, v25, v17
  v_fma_f32 v93, v93, v120, v120
  v_mfma_f32_16x16x32_bf16 v[44:47], a[212:215], v[52:55], v[44:47]
  s_waitcnt lgkmcnt(2)
  ds_read_b128 v[52:55], v1 offset:25600
  v_mfma_f32_16x16x32_bf16 v[32:35], a[24:27], v[56:59], v[32:35]
  v_rcp_f32 v93, v93
  v_mfma_f32_16x16x32_bf16 v[36:39], a[88:91], v[56:59], v[36:39]
  v_mul_f32 v24, v24, v92
  v_fmac_f32 v18, v65, v70
  v_mfma_f32_16x16x32_bf16 v[40:43], a[152:155], v[56:59], v[40:43]
  v_fmac_f32 v26, v65, v78
  v_mul_f32 v18, v64, v18
  v_mfma_f32_16x16x32_bf16 v[44:47], a[216:219], v[56:59], v[44:47]
  s_waitcnt lgkmcnt(2)
  v_mul_f32 v94, v18, v18
  ds_read_b128 v[56:59], v1 offset:26624
  v_mfma_f32_16x16x32_bf16 v[32:35], a[28:31], v[60:63], v[32:35]
  v_fma_f32 v94, v94, v9, v8
  v_mul_f32 v94, v94, v18
  v_mfma_f32_16x16x32_bf16 v[36:39], a[92:95], v[60:63], v[36:39]
  v_exp_f32 v94, v94
  v_mfma_f32_16x16x32_bf16 v[40:43], a[156:159], v[60:63], v[40:43]
  v_mul_f32 v26, v26, v18
  v_fma_f32 v94, v94, v120, v120
  v_mfma_f32_16x16x32_bf16 v[44:47], a[220:223], v[60:63], v[44:47]
  s_waitcnt lgkmcnt(2)
  ds_read_b128 v[60:63], v1 offset:27648
  v_mfma_f32_16x16x32_bf16 v[32:35], a[32:35], v[48:51], v[32:35]
  v_rcp_f32 v94, v94
  v_mfma_f32_16x16x32_bf16 v[36:39], a[96:99], v[48:51], v[36:39]
  v_mul_f32 v25, v25, v93
  v_fmac_f32 v19, v65, v71
  v_mfma_f32_16x16x32_bf16 v[40:43], a[160:163], v[48:51], v[40:43]
  v_fmac_f32 v27, v65, v79
  v_mul_f32 v19, v64, v19
  v_mfma_f32_16x16x32_bf16 v[44:47], a[224:227], v[48:51], v[44:47]
  s_waitcnt lgkmcnt(2)
  v_mul_f32 v95, v19, v19
  ds_read_b128 v[48:51], v1 offset:28672
  v_mfma_f32_16x16x32_bf16 v[32:35], a[36:39], v[52:55], v[32:35]
  v_fma_f32 v95, v95, v9, v8
  v_mul_f32 v95, v95, v19
  v_mfma_f32_16x16x32_bf16 v[36:39], a[100:103], v[52:55], v[36:39]
  v_exp_f32 v95, v95
  v_mfma_f32_16x16x32_bf16 v[40:43], a[164:167], v[52:55], v[40:43]
  v_mul_f32 v27, v27, v19
  v_fma_f32 v95, v95, v120, v120
  v_mfma_f32_16x16x32_bf16 v[44:47], a[228:231], v[52:55], v[44:47]
  s_waitcnt lgkmcnt(2)
  ds_read_b128 v[52:55], v1 offset:29696
  v_mfma_f32_16x16x32_bf16 v[32:35], a[40:43], v[56:59], v[32:35]
  v_rcp_f32 v95, v95
  v_mfma_f32_16x16x32_bf16 v[36:39], a[104:107], v[56:59], v[36:39]
  v_mul_f32 v26, v26, v94
  v_fmac_f32 v20, v65, v72
  v_mfma_f32_16x16x32_bf16 v[40:43], a[168:171], v[56:59], v[40:43]
  v_fmac_f32 v28, v65, v80
  v_mul_f32 v20, v64, v20
  v_mfma_f32_16x16x32_bf16 v[44:47], a[232:235], v[56:59], v[44:47]
  s_waitcnt lgkmcnt(2)
  v_mul_f32 v96, v20, v20
  ds_read_b128 v[56:59], v1 offset:30720
  v_mfma_f32_16x16x32_bf16 v[32:35], a[44:47], v[60:63], v[32:35]
  v_fma_f32 v96, v96, v9, v8
  v_mul_f32 v96, v96, v20
  v_mfma_f32_16x16x32_bf16 v[36:39], a[108:111], v[60:63], v[36:39]
  v_exp_f32 v96, v96
  v_mfma_f32_16x16x32_bf16 v[40:43], a[172:175], v[60:63], v[40:43]
  v_mul_f32 v28, v28, v20
  v_fma_f32 v96, v96, v120, v120
  v_mfma_f32_16x16x32_bf16 v[44:47], a[236:239], v[60:63], v[44:47]
  s_waitcnt lgkmcnt(2)
  ds_read_b128 v[60:63], v1 offset:31744
  v_mfma_f32_16x16x32_bf16 v[32:35], a[48:51], v[48:51], v[32:35]
  v_rcp_f32 v96, v96
  v_mfma_f32_16x16x32_bf16 v[36:39], a[112:115], v[48:51], v[36:39]
  v_mul_f32 v27, v27, v95
  v_fmac_f32 v21, v65, v73
  v_mfma_f32_16x16x32_bf16 v[40:43], a[176:179], v[48:51], v[40:43]
  v_fmac_f32 v29, v65, v81
  v_mul_f32 v21, v64, v21
  v_mfma_f32_16x16x32_bf16 v[44:47], a[240:243], v[48:51], v[44:47]
  s_waitcnt lgkmcnt(2)
  v_mul_f32 v97, v21, v21
  v_fma_f32 v97, v97, v9, v8
  v_mfma_f32_16x16x32_bf16 v[32:35], a[52:55], v[52:55], v[32:35]
  v_mul_f32 v97, v97, v21
  v_mfma_f32_16x16x32_bf16 v[36:39], a[116:119], v[52:55], v[36:39]
  v_exp_f32 v97, v97
  v_mfma_f32_16x16x32_bf16 v[40:43], a[180:183], v[52:55], v[40:43]
  v_mul_f32 v29, v29, v21
  v_fma_f32 v97, v97, v120, v120
  v_mfma_f32_16x16x32_bf16 v[44:47], a[244:247], v[52:55], v[44:47]
  s_waitcnt lgkmcnt(1)
  v_rcp_f32 v97, v97
  v_mfma_f32_16x16x32_bf16 v[32:35], a[56:59], v[56:59], v[32:35]
  v_mul_f32 v28, v28, v96
  v_fmac_f32 v22, v65, v74
  v_mfma_f32_16x16x32_bf16 v[36:39], a[120:123], v[56:59], v[36:39]
  v_fmac_f32 v30, v65, v82
  v_mul_f32 v22, v64, v22
  v_mfma_f32_16x16x32_bf16 v[40:43], a[184:187], v[56:59], v[40:43]
  v_mul_f32 v98, v22, v22
  v_fma_f32 v98, v98, v9, v8
  v_mfma_f32_16x16x32_bf16 v[44:47], a[248:251], v[56:59], v[44:47]
  s_waitcnt lgkmcnt(0)
  v_mul_f32 v98, v98, v22
  v_mfma_f32_16x16x32_bf16 v[32:35], a[60:63], v[60:63], v[32:35]
  v_exp_f32 v98, v98
  v_mfma_f32_16x16x32_bf16 v[36:39], a[124:127], v[60:63], v[36:39]
  v_mul_f32 v30, v30, v22
  v_fma_f32 v98, v98, v120, v120
  v_mfma_f32_16x16x32_bf16 v[40:43], a[188:191], v[60:63], v[40:43]
  v_rcp_f32 v98, v98
  v_mfma_f32_16x16x32_bf16 v[44:47], a[252:255], v[60:63], v[44:47]
  v_mul_f32 v29, v29, v97
  v_fmac_f32 v23, v65, v75
  v_fmac_f32 v31, v65, v83
  v_mul_f32 v23, v64, v23
  v_mul_f32 v99, v23, v23
  v_fma_f32 v99, v99, v9, v8
  v_mul_f32 v99, v99, v23
  v_exp_f32 v99, v99
  v_mul_f32 v31, v31, v23
  v_fma_f32 v99, v99, v120, v120
  v_rcp_f32 v99, v99
  v_mul_f32 v30, v30, v98
  v_mul_f32 v31, v31, v99
  v_cvt_pk_bf16_f32 v84, v24, v25
  v_cvt_pk_bf16_f32 v85, v26, v27
  v_cvt_pk_bf16_f32 v86, v28, v29
  v_cvt_pk_bf16_f32 v87, v30, v31
  s_add_u32 s3, s55, 0
  buffer_store_dwordx4 v[84:87], v1, s[4:7], s3 offen sc1
  s_waitcnt vmcnt(1)
  v_cmp_ne_u32 vcc, 0, v10
  s_add_u32 s63, s64, 36864
  s_mul_i32 s59, s65, 36864
  s_add_u32 s59, s59, s54
  s_cmp_eq_u64 vcc, -1
  s_cselect_b32 s60, 1, 0
  s_cmp_lt_u32 s53, 64
  s_cselect_b32 s60, s60, 0
  s_cmp_eq_u32 s60, 0
  s_cbranch_scc1 fsc_2708
  s_add_u32 m0, s63, 0
  s_nop 0
  buffer_load_dwordx4 v1, s[4:7], s59 offen offset:0 sc1 lds
  buffer_load_dwordx4 v1, s[4:7], s59 offen offset:1024 sc1 lds
  v_pk_fma_f32 v[32:33], v[66:67], v[68:69], v[32:33] op_sel:[1,0,0] op_sel_hi:[1,1,1]
  v_pk_fma_f32 v[40:41], v[66:67], v[76:77], v[40:41] op_sel:[1,0,0] op_sel_hi:[1,1,1]
  v_pk_mul_f32 v[32:33], v[66:67], v[32:33] op_sel_hi:[0,1]
  v_pk_mul_f32 v[92:93], v[32:33], v[32:33]
  v_pk_fma_f32 v[92:93], v[92:93], v[8:9], v[8:9] op_sel:[0,1,0] op_sel_hi:[1,1,0]
  v_pk_mul_f32 v[92:93], v[92:93], v[32:33]
  v_exp_f32 v92, v92
  buffer_load_dwordx4 v1, s[4:7], s59 offen offset:2048 sc1 lds
  v_exp_f32 v93, v93
  v_pk_mul_f32 v[40:41], v[40:41], v[32:33]
  v_fma_f32 v92, v92, v121, v121
  v_fma_f32 v93, v93, v121, v121
  v_rcp_f32 v92, v92
  v_rcp_f32 v93, v93
  v_pk_fma_f32 v[34:35], v[66:67], v[70:71], v[34:35] op_sel:[1,0,0] op_sel_hi:[1,1,1]
  buffer_load_dwordx4 v1, s[4:7], s59 offen offset:3072 sc1 lds
  v_pk_fma_f32 v[42:43], v[66:67], v[78:79], v[42:43] op_sel:[1,0,0] op_sel_hi:[1,1,1]
  v_pk_mul_f32 v[34:35], v[66:67], v[34:35] op_sel_hi:[0,1]
  v_pk_mul_f32 v[94:95], v[34:35], v[34:35]
  v_pk_fma_f32 v[94:95], v[94:95], v[8:9], v[8:9] op_sel:[0,1,0] op_sel_hi:[1,1,0]
  v_pk_mul_f32 v[94:95], v[94:95], v[34:35]
  v_exp_f32 v94, v94
  v_exp_f32 v95, v95
  s_add_u32 m0, s63, 4096
  s_add_u32 s59, s59, 4096
  buffer_load_dwordx4 v1, s[4:7], s59 offen offset:0 sc1 lds
  v_pk_mul_f32 v[42:43], v[42:43], v[34:35]
  v_fma_f32 v94, v94, v121, v121
  v_fma_f32 v95, v95, v121, v121
  v_rcp_f32 v94, v94
  v_rcp_f32 v95, v95
  v_pk_fma_f32 v[36:37], v[66:67], v[72:73], v[36:37] op_sel:[1,0,0] op_sel_hi:[1,1,1]
  v_pk_fma_f32 v[44:45], v[66:67], v[80:81], v[44:45] op_sel:[1,0,0] op_sel_hi:[1,1,1]
  buffer_load_dwordx4 v1, s[4:7], s59 offen offset:1024 sc1 lds
  v_pk_mul_f32 v[36:37], v[66:67], v[36:37] op_sel_hi:[0,1]
  v_pk_mul_f32 v[96:97], v[36:37], v[36:37]
  v_pk_fma_f32 v[96:97], v[96:97], v[8:9], v[8:9] op_sel:[0,1,0] op_sel_hi:[1,1,0]
  v_pk_mul_f32 v[96:97], v[96:97], v[36:37]
  v_exp_f32 v96, v96
  v_exp_f32 v97, v97
  v_pk_mul_f32 v[44:45], v[44:45], v[36:37]
  buffer_load_dwordx4 v1, s[4:7], s59 offen offset:2048 sc1 lds
  v_fma_f32 v96, v96, v121, v121
  v_fma_f32 v97, v97, v121, v121
  v_rcp_f32 v96, v96
  v_rcp_f32 v97, v97
  v_pk_fma_f32 v[38:39], v[66:67], v[74:75], v[38:39] op_sel:[1,0,0] op_sel_hi:[1,1,1]
  v_pk_fma_f32 v[46:47], v[66:67], v[82:83], v[46:47] op_sel:[1,0,0] op_sel_hi:[1,1,1]
  v_pk_mul_f32 v[38:39], v[66:67], v[38:39] op_sel_hi:[0,1]
  buffer_load_dwordx4 v1, s[4:7], s59 offen offset:3072 sc1 lds
  v_pk_mul_f32 v[98:99], v[38:39], v[38:39]
  v_pk_fma_f32 v[98:99], v[98:99], v[8:9], v[8:9] op_sel:[0,1,0] op_sel_hi:[1,1,0]
  v_pk_mul_f32 v[98:99], v[98:99], v[38:39]
  v_exp_f32 v98, v98
  v_exp_f32 v99, v99
  v_pk_mul_f32 v[46:47], v[46:47], v[38:39]
  v_fma_f32 v98, v98, v121, v121
  s_add_u32 m0, s63, 8192
  s_add_u32 s59, s59, 4096
  buffer_load_dwordx4 v1, s[4:7], s59 offen offset:0 sc1 lds
  v_fma_f32 v99, v99, v121, v121
  v_rcp_f32 v98, v98
  v_rcp_f32 v99, v99
  v_pk_mul_f32 v[40:41], v[40:41], v[92:93]
  v_pk_mul_f32 v[42:43], v[42:43], v[94:95]
  v_pk_mul_f32 v[44:45], v[44:45], v[96:97]
  v_pk_mul_f32 v[46:47], v[46:47], v[98:99]
  v_cvt_pk_bf16_f32 v88, v40, v41
  v_cvt_pk_bf16_f32 v89, v42, v43
  v_cvt_pk_bf16_f32 v90, v44, v45
  v_cvt_pk_bf16_f32 v91, v46, v47
  s_add_u32 s3, s55, 57344
  buffer_store_dwordx4 v[88:91], v1, s[4:7], s3 offen sc1
  s_branch fsc_2709
fsc_2708:
  v_pk_fma_f32 v[32:33], v[66:67], v[68:69], v[32:33] op_sel:[1,0,0] op_sel_hi:[1,1,1]
  v_pk_fma_f32 v[40:41], v[66:67], v[76:77], v[40:41] op_sel:[1,0,0] op_sel_hi:[1,1,1]
  v_pk_mul_f32 v[32:33], v[66:67], v[32:33] op_sel_hi:[0,1]
  v_pk_mul_f32 v[92:93], v[32:33], v[32:33]
  v_pk_fma_f32 v[92:93], v[92:93], v[8:9], v[8:9] op_sel:[0,1,0] op_sel_hi:[1,1,0]
  v_pk_mul_f32 v[92:93], v[92:93], v[32:33]
  v_exp_f32 v92, v92
  v_exp_f32 v93, v93
  v_pk_mul_f32 v[40:41], v[40:41], v[32:33]
  v_fma_f32 v92, v92, v121, v121
  v_fma_f32 v93, v93, v121, v121
  v_rcp_f32 v92, v92
  v_rcp_f32 v93, v93
  v_pk_fma_f32 v[34:35], v[66:67], v[70:71], v[34:35] op_sel:[1,0,0] op_sel_hi:[1,1,1]
  v_pk_fma_f32 v[42:43], v[66:67], v[78:79], v[42:43] op_sel:[1,0,0] op_sel_hi:[1,1,1]
  v_pk_mul_f32 v[34:35], v[66:67], v[34:35] op_sel_hi:[0,1]
  v_pk_mul_f32 v[94:95], v[34:35], v[34:35]
  v_pk_fma_f32 v[94:95], v[94:95], v[8:9], v[8:9] op_sel:[0,1,0] op_sel_hi:[1,1,0]
  v_pk_mul_f32 v[94:95], v[94:95], v[34:35]
  v_exp_f32 v94, v94
  v_exp_f32 v95, v95
  v_pk_mul_f32 v[42:43], v[42:43], v[34:35]
  v_fma_f32 v94, v94, v121, v121
  v_fma_f32 v95, v95, v121, v121
  v_rcp_f32 v94, v94
  v_rcp_f32 v95, v95
  v_pk_fma_f32 v[36:37], v[66:67], v[72:73], v[36:37] op_sel:[1,0,0] op_sel_hi:[1,1,1]
  v_pk_fma_f32 v[44:45], v[66:67], v[80:81], v[44:45] op_sel:[1,0,0] op_sel_hi:[1,1,1]
  v_pk_mul_f32 v[36:37], v[66:67], v[36:37] op_sel_hi:[0,1]
  v_pk_mul_f32 v[96:97], v[36:37], v[36:37]
  v_pk_fma_f32 v[96:97], v[96:97], v[8:9], v[8:9] op_sel:[0,1,0] op_sel_hi:[1,1,0]
  v_pk_mul_f32 v[96:97], v[96:97], v[36:37]
  v_exp_f32 v96, v96
  v_exp_f32 v97, v97
  v_pk_mul_f32 v[44:45], v[44:45], v[36:37]
  v_fma_f32 v96, v96, v121, v121
  v_fma_f32 v97, v97, v121, v121
  v_rcp_f32 v96, v96
  v_rcp_f32 v97, v97
  v_pk_fma_f32 v[38:39], v[66:67], v[74:75], v[38:39] op_sel:[1,0,0] op_sel_hi:[1,1,1]
  v_pk_fma_f32 v[46:47], v[66:67], v[82:83], v[46:47] op_sel:[1,0,0] op_sel_hi:[1,1,1]
  v_pk_mul_f32 v[38:39], v[66:67], v[38:39] op_sel_hi:[0,1]
  v_pk_mul_f32 v[98:99], v[38:39], v[38:39]
  v_pk_fma_f32 v[98:99], v[98:99], v[8:9], v[8:9] op_sel:[0,1,0] op_sel_hi:[1,1,0]
  v_pk_mul_f32 v[98:99], v[98:99], v[38:39]
  v_exp_f32 v98, v98
  v_exp_f32 v99, v99
  v_pk_mul_f32 v[46:47], v[46:47], v[38:39]
  v_fma_f32 v98, v98, v121, v121
  v_fma_f32 v99, v99, v121, v121
  v_rcp_f32 v98, v98
  v_rcp_f32 v99, v99
  v_pk_mul_f32 v[40:41], v[40:41], v[92:93]
  v_pk_mul_f32 v[42:43], v[42:43], v[94:95]
  v_pk_mul_f32 v[44:45], v[44:45], v[96:97]
  v_pk_mul_f32 v[46:47], v[46:47], v[98:99]
  v_cvt_pk_bf16_f32 v88, v40, v41
  v_cvt_pk_bf16_f32 v89, v42, v43
  v_cvt_pk_bf16_f32 v90, v44, v45
  v_cvt_pk_bf16_f32 v91, v46, v47
  s_add_u32 s3, s55, 57344
  buffer_store_dwordx4 v[88:91], v1, s[4:7], s3 offen sc1
fsc_2709:
  s_mov_b32 s61, s56
  s_lshl_b32 s92, s65, 13
  s_add_u32 s56, s56, s92
  s_mul_i32 s92, s65, 114688
  s_add_u32 s55, s55, s92
  s_mul_i32 s92, s65, 36864
  s_add_u32 s54, s54, s92
  s_cmp_lg_u32 s60, 0
  s_cbranch_scc1 f1n_2710
  s_cmp_ge_u32 s53, 64
  s_cbranch_scc1 F1_END
  buffer_load_dword v10, v7, s[4:7], s58 offen sc1
  s_waitcnt vmcnt(0)
  v_cmp_eq_u32 vcc, 0, v10
  s_mov_b64 exec, 1
  buffer_store_dword v5, off, s[4:7], s61 sc1
  s_mov_b64 exec, -1
  s_cbranch_vccz polld_2712
  s_mov_b32 s101, 0
poll_2711:
  s_add_u32 s47, s47, 1
  s_mov_b32 s49, 5
  s_cmp_gt_u32 s47, 131072
  s_cbranch_scc1 TIMEOUT
  s_sleep 3
  buffer_load_dword v10, v7, s[4:7], s58 offen sc1
  s_waitcnt vmcnt(0)
  v_cmp_eq_u32 vcc, 0, v10
  s_nop 0
  s_cbranch_vccnz poll_2711
polld_2712:
  s_mov_b32 s59, s54
  s_add_u32 m0, s63, 0
  s_nop 0
  buffer_load_dwordx4 v1, s[4:7], s59 offen offset:0 sc1 lds
  buffer_load_dwordx4 v1, s[4:7], s59 offen offset:1024 sc1 lds
  buffer_load_dwordx4 v1, s[4:7], s59 offen offset:2048 sc1 lds
  buffer_load_dwordx4 v1, s[4:7], s59 offen offset:3072 sc1 lds
  s_add_u32 m0, s63, 4096
  s_add_u32 s59, s59, 4096
  buffer_load_dwordx4 v1, s[4:7], s59 offen offset:0 sc1 lds
  buffer_load_dwordx4 v1, s[4:7], s59 offen offset:1024 sc1 lds
  buffer_load_dwordx4 v1, s[4:7], s59 offen offset:2048 sc1 lds
  buffer_load_dwordx4 v1, s[4:7], s59 offen offset:3072 sc1 lds
  s_add_u32 m0, s63, 8192
  s_add_u32 s59, s59, 4096
  buffer_load_dwordx4 v1, s[4:7], s59 offen offset:0 sc1 lds
  s_waitcnt vmcnt(0)
f1n_2710:
  s_mul_i32 s93, s50, s53
  s_cmp_ge_u32 s93, 56
  s_cselect_b32 s65, 2, 1
  s_add_u32 s53, s53, s65
  s_lshl_b32 s92, s65, 13
  s_add_u32 s58, s58, s92
  s_waitcnt vmcnt(1)
  s_barrier
  ds_read_b128 v[48:51], v11 offset:0
  ds_read_b128 v[52:55], v11 offset:1024
  ds_read_b128 v[56:59], v11 offset:2048
  ds_read_b128 v[60:63], v11 offset:3072
  s_waitcnt lgkmcnt(3)
  v_mfma_f32_16x16x32_bf16 v[16:19], a[0:3], v[48:51], 0
  ds_read_b64 v[100:101], v14 offset:32768
  ds_read_b64 v[102:103], v14 offset:33024
  v_mfma_f32_16x16x32_bf16 v[20:23], a[64:67], v[48:51], 0
  ds_read_b64 v[104:105], v14 offset:33280
  ds_read_b64 v[106:107], v14 offset:33536
  v_mfma_f32_16x16x32_bf16 v[24:27], a[128:131], v[48:51], 0
  ds_read_b64 v[108:109], v14 offset:33792
  ds_read_b64 v[110:111], v14 offset:34048
  v_mfma_f32_16x16x32_bf16 v[28:31], a[192:195], v[48:51], 0
  s_waitcnt lgkmcnt(8)
  ds_read_b64 v[112:113], v14 offset:34304
  ds_read_b128 v[48:51], v11 offset:4096
  v_mfma_f32_16x16x32_bf16 v[16:19], a[4:7], v[52:55], v[16:19]
  ds_read_b64 v[114:115], v14 offset:34560
  v_mfma_f32_16x16x32_bf16 v[20:23], a[68:71], v[52:55], v[20:23]
  v_mfma_f32_16x16x32_bf16 v[24:27], a[132:135], v[52:55], v[24:27]
  v_mfma_f32_16x16x32_bf16 v[28:31], a[196:199], v[52:55], v[28:31]
  s_waitcnt lgkmcnt(10)
  ds_read_b128 v[52:55], v11 offset:5120
  v_mfma_f32_16x16x32_bf16 v[16:19], a[8:11], v[56:59], v[16:19]
  v_mfma_f32_16x16x32_bf16 v[20:23], a[72:75], v[56:59], v[20:23]
  v_mfma_f32_16x16x32_bf16 v[24:27], a[136:139], v[56:59], v[24:27]
  s_waitcnt lgkmcnt(8)
  v_add_f32 v116, v100, v102
  s_waitcnt lgkmcnt(7)
  v_add_f32 v116, v116, v104
  v_mfma_f32_16x16x32_bf16 v[28:31], a[200:203], v[56:59], v[28:31]
  s_waitcnt lgkmcnt(6)
  v_add_f32 v116, v116, v106
  ds_read_b128 v[56:59], v11 offset:6144
  v_mfma_f32_16x16x32_bf16 v[16:19], a[12:15], v[60:63], v[16:19]
  s_waitcnt lgkmcnt(6)
  v_add_f32 v116, v116, v108
  s_waitcnt lgkmcnt(5)
  v_add_f32 v116, v116, v110
  v_mfma_f32_16x16x32_bf16 v[20:23], a[76:79], v[60:63], v[20:23]
  s_waitcnt lgkmcnt(4)
  v_add_f32 v116, v116, v112
  s_waitcnt lgkmcnt(2)
  v_add_f32 v116, v116, v114
  v_mfma_f32_16x16x32_bf16 v[24:27], a[140:143], v[60:63], v[24:27]
  v_mov_b32 v118, v116
  v_mfma_f32_16x16x32_bf16 v[28:31], a[204:207], v[60:63], v[28:31]
  ds_read_b128 v[60:63], v11 offset:7168
  v_mfma_f32_16x16x32_bf16 v[16:19], a[16:19], v[48:51], v[16:19]
  v_permlane32_swap_b32 v116, v118
  v_mfma_f32_16x16x32_bf16 v[20:23], a[80:83], v[48:51], v[20:23]
  v_add_f32 v116, v116, v118
  v_mul_f32 v116, 0x3d800000, v116
  v_mfma_f32_16x16x32_bf16 v[24:27], a[144:147], v[48:51], v[24:27]
  v_add_f32 v117, v101, v103
  v_add_f32 v117, v117, v105
  v_mfma_f32_16x16x32_bf16 v[28:31], a[208:211], v[48:51], v[28:31]
  s_waitcnt lgkmcnt(2)
  v_add_f32 v117, v117, v107
  ds_read_b128 v[48:51], v11 offset:8192
  v_mfma_f32_16x16x32_bf16 v[16:19], a[20:23], v[52:55], v[16:19]
  v_add_f32 v117, v117, v109
  v_add_f32 v117, v117, v111
  v_mfma_f32_16x16x32_bf16 v[20:23], a[84:87], v[52:55], v[20:23]
  buffer_load_dword v10, v7, s[4:7], s58 offen sc1
  v_mfma_f32_16x16x32_bf16 v[24:27], a[148:151], v[52:55], v[24:27]
  v_add_f32 v117, v117, v113
  v_add_f32 v117, v117, v115
  v_mfma_f32_16x16x32_bf16 v[28:31], a[212:215], v[52:55], v[28:31]
  s_waitcnt lgkmcnt(2)
  v_sub_f32 v100, v100, v116
  ds_read_b128 v[52:55], v11 offset:9216
  v_mfma_f32_16x16x32_bf16 v[16:19], a[24:27], v[56:59], v[16:19]
  v_sub_f32 v102, v102, v116
  v_sub_f32 v104, v104, v116
  v_mfma_f32_16x16x32_bf16 v[20:23], a[88:91], v[56:59], v[20:23]
  v_sub_f32 v106, v106, v116
  v_sub_f32 v108, v108, v116
  v_mfma_f32_16x16x32_bf16 v[24:27], a[152:155], v[56:59], v[24:27]
  v_sub_f32 v110, v110, v116
  v_sub_f32 v112, v112, v116
  v_mfma_f32_16x16x32_bf16 v[28:31], a[216:219], v[56:59], v[28:31]
  s_waitcnt lgkmcnt(2)
  v_sub_f32 v114, v114, v116
  ds_read_b128 v[56:59], v11 offset:10240
  v_mfma_f32_16x16x32_bf16 v[16:19], a[28:31], v[60:63], v[16:19]
  v_mul_f32 v118, v100, v100
  v_fmac_f32 v118, v102, v102
  v_mfma_f32_16x16x32_bf16 v[20:23], a[92:95], v[60:63], v[20:23]
  v_fmac_f32 v118, v104, v104
  v_fmac_f32 v118, v106, v106
  v_mfma_f32_16x16x32_bf16 v[24:27], a[156:159], v[60:63], v[24:27]
  v_fmac_f32 v118, v108, v108
  v_fmac_f32 v118, v110, v110
  v_mfma_f32_16x16x32_bf16 v[28:31], a[220:223], v[60:63], v[28:31]
  s_waitcnt lgkmcnt(2)
  v_fmac_f32 v118, v112, v112
  ds_read_b128 v[60:63], v11 offset:11264
  v_mfma_f32_16x16x32_bf16 v[16:19], a[32:35], v[48:51], v[16:19]
  v_fmac_f32 v118, v114, v114
  v_fmac_f32 v117, 0x42000000, v118
  v_mfma_f32_16x16x32_bf16 v[20:23], a[96:99], v[48:51], v[20:23]
  v_mov_b32 v118, v117
  v_mfma_f32_16x16x32_bf16 v[24:27], a[160:163], v[48:51], v[24:27]
  s_nop 0
  v_permlane32_swap_b32 v117, v118
  v_mfma_f32_16x16x32_bf16 v[28:31], a[224:227], v[48:51], v[28:31]
  s_waitcnt lgkmcnt(2)
  v_add_f32 v117, v117, v118
  ds_read_b128 v[48:51], v11 offset:12288
  v_mfma_f32_16x16x32_bf16 v[16:19], a[36:39], v[52:55], v[16:19]
  v_mul_f32 v117, 0x3b000000, v117
  v_cvt_pk_bf16_f32 v116, v116, v116
  v_mfma_f32_16x16x32_bf16 v[20:23], a[100:103], v[52:55], v[20:23]
  v_lshlrev_b32 v116, 16, v116
  v_cvt_pk_bf16_f32 v117, v117, v117
  v_mfma_f32_16x16x32_bf16 v[24:27], a[164:167], v[52:55], v[24:27]
  v_lshlrev_b32 v117, 16, v117
  v_add_f32 v117, 0x3727c5ac, v117
  v_mfma_f32_16x16x32_bf16 v[28:31], a[228:231], v[52:55], v[28:31]
  s_waitcnt lgkmcnt(2)
  v_cvt_pk_bf16_f32 v117, v117, v117
  ds_read_b128 v[52:55], v11 offset:13312
  v_mfma_f32_16x16x32_bf16 v[16:19], a[40:43], v[56:59], v[16:19]
  v_lshlrev_b32 v117, 16, v117
  v_mfma_f32_16x16x32_bf16 v[20:23], a[104:107], v[56:59], v[20:23]
  v_sqrt_f32 v117, v117
  v_mfma_f32_16x16x32_bf16 v[24:27], a[168:171], v[56:59], v[24:27]
  v_cvt_pk_bf16_f32 v117, v117, v117
  v_lshlrev_b32 v117, 16, v117
  v_mfma_f32_16x16x32_bf16 v[28:31], a[232:235], v[56:59], v[28:31]
  s_waitcnt lgkmcnt(2)
  ds_read_b128 v[56:59], v11 offset:14336
  v_mfma_f32_16x16x32_bf16 v[16:19], a[44:47], v[60:63], v[16:19]
  v_rcp_f32 v117, v117
  v_mfma_f32_16x16x32_bf16 v[20:23], a[108:111], v[60:63], v[20:23]
  v_sub_f32 v116, 0, v116
  ds_write_b32 v3, v117
  v_mfma_f32_16x16x32_bf16 v[24:27], a[172:175], v[60:63], v[24:27]
  ds_write_b32 v3, v116 offset:128
  ds_read_b32 v64, v4 offset:0
  v_mfma_f32_16x16x32_bf16 v[28:31], a[236:239], v[60:63], v[28:31]
  s_waitcnt lgkmcnt(5)
  ds_read_b32 v65, v4 offset:128
  ds_read_b128 v[60:63], v11 offset:15360
  v_mfma_f32_16x16x32_bf16 v[16:19], a[48:51], v[48:51], v[16:19]
  ds_read_b32 v66, v4 offset:64
  ds_read_b32 v67, v4 offset:192
  v_mfma_f32_16x16x32_bf16 v[20:23], a[112:115], v[48:51], v[20:23]
  v_mfma_f32_16x16x32_bf16 v[24:27], a[176:179], v[48:51], v[24:27]
  v_mfma_f32_16x16x32_bf16 v[28:31], a[240:243], v[48:51], v[28:31]
  s_waitcnt lgkmcnt(8)
  ds_read_b128 v[48:51], v11 offset:16384
  v_mfma_f32_16x16x32_bf16 v[16:19], a[52:55], v[52:55], v[16:19]
  v_mfma_f32_16x16x32_bf16 v[20:23], a[116:119], v[52:55], v[20:23]
  v_mfma_f32_16x16x32_bf16 v[24:27], a[180:183], v[52:55], v[24:27]
  v_mfma_f32_16x16x32_bf16 v[28:31], a[244:247], v[52:55], v[28:31]
  s_waitcnt lgkmcnt(8)
  ds_read_b128 v[52:55], v11 offset:17408
  v_mfma_f32_16x16x32_bf16 v[16:19], a[56:59], v[56:59], v[16:19]
  v_mfma_f32_16x16x32_bf16 v[20:23], a[120:123], v[56:59], v[20:23]
  v_mfma_f32_16x16x32_bf16 v[24:27], a[184:187], v[56:59], v[24:27]
  v_mfma_f32_16x16x32_bf16 v[28:31], a[248:251], v[56:59], v[28:31]
  s_waitcnt vmcnt(1)
  s_mov_b64 exec, 1
  buffer_store_dword v5, off, s[4:7], s61 sc1
  s_mov_b64 exec, -1
  ds_read_b128 v[56:59], v11 offset:18432
  s_waitcnt lgkmcnt(5)
  v_mfma_f32_16x16x32_bf16 v[16:19], a[60:63], v[60:63], v[16:19]
  v_rcp_f32 v120, v64
  v_mfma_f32_16x16x32_bf16 v[20:23], a[124:127], v[60:63], v[20:23]
  s_waitcnt lgkmcnt(4)
  v_rcp_f32 v121, v66
  v_mfma_f32_16x16x32_bf16 v[24:27], a[188:191], v[60:63], v[24:27]
  v_mfma_f32_16x16x32_bf16 v[28:31], a[252:255], v[60:63], v[28:31]
  s_waitcnt lgkmcnt(2)
  ds_read_b128 v[60:63], v11 offset:19456
  v_mfma_f32_16x16x32_bf16 v[32:35], a[0:3], v[48:51], 0
  v_mfma_f32_16x16x32_bf16 v[36:39], a[64:67], v[48:51], 0
  v_mfma_f32_16x16x32_bf16 v[40:43], a[128:131], v[48:51], 0
  v_mfma_f32_16x16x32_bf16 v[44:47], a[192:195], v[48:51], 0
  s_waitcnt vmcnt(1)
  v_cmp_ne_u32 vcc, 0, v10
  ds_read_b128 v[48:51], v11 offset:20480
  s_waitcnt lgkmcnt(3)
  v_mfma_f32_16x16x32_bf16 v[32:35], a[4:7], v[52:55], v[32:35]
  s_add_u32 s63, s64, 0
  s_mul_i32 s59, s65, 36864
  s_add_u32 s59, s59, s54
  v_mfma_f32_16x16x32_bf16 v[36:39], a[68:71], v[52:55], v[36:39]
  s_cmp_eq_u64 vcc, -1
  s_cselect_b32 s60, 1, 0
  s_cmp_lt_u32 s53, 64
  v_mfma_f32_16x16x32_bf16 v[40:43], a[132:135], v[52:55], v[40:43]
  s_cselect_b32 s60, s60, 0
  v_mfma_f32_16x16x32_bf16 v[44:47], a[196:199], v[52:55], v[44:47]
  ds_read_b128 v[52:55], v11 offset:21504
  s_cmp_eq_u32 s60, 0
  s_cbranch_scc1 fpl_2713
  s_waitcnt lgkmcnt(3)
  v_mfma_f32_16x16x32_bf16 v[32:35], a[8:11], v[56:59], v[32:35]
  s_add_u32 m0, s63, 0
  s_nop 0
  v_mfma_f32_16x16x32_bf16 v[36:39], a[72:75], v[56:59], v[36:39]
  buffer_load_dwordx4 v1, s[4:7], s59 offen offset:0 sc1 lds
  v_mfma_f32_16x16x32_bf16 v[40:43], a[136:139], v[56:59], v[40:43]
  v_fmac_f32 v16, v65, v68
  v_fmac_f32 v24, v65, v76
  v_mfma_f32_16x16x32_bf16 v[44:47], a[200:203], v[56:59], v[44:47]
  s_waitcnt lgkmcnt(2)
  v_mul_f32 v16, v64, v16
  ds_read_b128 v[56:59], v11 offset:22528
  v_mfma_f32_16x16x32_bf16 v[32:35], a[12:15], v[60:63], v[32:35]
  v_mul_f32 v92, v16, v16
  v_mfma_f32_16x16x32_bf16 v[36:39], a[76:79], v[60:63], v[36:39]
  buffer_load_dwordx4 v1, s[4:7], s59 offen offset:1024 sc1 lds
  v_mfma_f32_16x16x32_bf16 v[40:43], a[140:143], v[60:63], v[40:43]
  v_fma_f32 v92, v92, v9, v8
  v_mul_f32 v92, v92, v16
  v_mfma_f32_16x16x32_bf16 v[44:47], a[204:207], v[60:63], v[44:47]
  s_waitcnt lgkmcnt(2)
  ds_read_b128 v[60:63], v11 offset:23552
  v_mfma_f32_16x16x32_bf16 v[32:35], a[16:19], v[48:51], v[32:35]
  v_exp_f32 v92, v92
  v_mfma_f32_16x16x32_bf16 v[36:39], a[80:83], v[48:51], v[36:39]
  v_mul_f32 v24, v24, v16
  v_mfma_f32_16x16x32_bf16 v[40:43], a[144:147], v[48:51], v[40:43]
  buffer_load_dwordx4 v1, s[4:7], s59 offen offset:2048 sc1 lds
  v_mfma_f32_16x16x32_bf16 v[44:47], a[208:211], v[48:51], v[44:47]
  s_waitcnt lgkmcnt(2)
  v_fma_f32 v92, v92, v120, v120
  ds_read_b128 v[48:51], v11 offset:24576
  v_mfma_f32_16x16x32_bf16 v[32:35], a[20:23], v[52:55], v[32:35]
  v_rcp_f32 v92, v92
  v_mfma_f32_16x16x32_bf16 v[36:39], a[84:87], v[52:55], v[36:39]
  v_fmac_f32 v17, v65, v69
  v_fmac_f32 v25, v65, v77
  v_mfma_f32_16x16x32_bf16 v[40:43], a[148:151], v[52:55], v[40:43]
  buffer_load_dwordx4 v1, s[4:7], s59 offen offset:3072 sc1 lds
  v_mfma_f32_16x16x32_bf16 v[44:47], a[212:215], v[52:55], v[44:47]
  s_waitcnt lgkmcnt(2)
  v_mul_f32 v17, v64, v17
  ds_read_b128 v[52:55], v11 offset:25600
  v_mfma_f32_16x16x32_bf16 v[32:35], a[24:27], v[56:59], v[32:35]
  v_mul_f32 v93, v17, v17
  v_fma_f32 v93, v93, v9, v8
  v_mfma_f32_16x16x32_bf16 v[36:39], a[88:91], v[56:59], v[36:39]
  v_mul_f32 v93, v93, v17
  s_add_u32 m0, s63, 4096
  v_mfma_f32_16x16x32_bf16 v[40:43], a[152:155], v[56:59], v[40:43]
  s_add_u32 s59, s59, 4096
  buffer_load_dwordx4 v1, s[4:7], s59 offen offset:0 sc1 lds
  v_mfma_f32_16x16x32_bf16 v[44:47], a[216:219], v[56:59], v[44:47]
  s_waitcnt lgkmcnt(2)
  ds_read_b128 v[56:59], v11 offset:26624
  v_mfma_f32_16x16x32_bf16 v[32:35], a[28:31], v[60:63], v[32:35]
  v_exp_f32 v93, v93
  v_mfma_f32_16x16x32_bf16 v[36:39], a[92:95], v[60:63], v[36:39]
  v_mul_f32 v25, v25, v17
  v_fma_f32 v93, v93, v120, v120
  v_mfma_f32_16x16x32_bf16 v[40:43], a[156:159], v[60:63], v[40:43]
  v_rcp_f32 v93, v93
  v_mfma_f32_16x16x32_bf16 v[44:47], a[220:223], v[60:63], v[44:47]
  s_waitcnt lgkmcnt(2)
  ds_read_b128 v[60:63], v11 offset:27648
  v_mfma_f32_16x16x32_bf16 v[32:35], a[32:35], v[48:51], v[32:35]
  buffer_load_dwordx4 v1, s[4:7], s59 offen offset:1024 sc1 lds
  v_mfma_f32_16x16x32_bf16 v[36:39], a[96:99], v[48:51], v[36:39]
  v_mul_f32 v24, v24, v92
  v_fmac_f32 v18, v65, v70
  v_mfma_f32_16x16x32_bf16 v[40:43], a[160:163], v[48:51], v[40:43]
  v_fmac_f32 v26, v65, v78
  v_mul_f32 v18, v64, v18
  v_mfma_f32_16x16x32_bf16 v[44:47], a[224:227], v[48:51], v[44:47]
  s_waitcnt lgkmcnt(2)
  ds_read_b128 v[48:51], v11 offset:28672
  v_mfma_f32_16x16x32_bf16 v[32:35], a[36:39], v[52:55], v[32:35]
  buffer_load_dwordx4 v1, s[4:7], s59 offen offset:2048 sc1 lds
  v_mfma_f32_16x16x32_bf16 v[36:39], a[100:103], v[52:55], v[36:39]
  v_mul_f32 v94, v18, v18
  v_fma_f32 v94, v94, v9, v8
  v_mfma_f32_16x16x32_bf16 v[40:43], a[164:167], v[52:55], v[40:43]
  v_mul_f32 v94, v94, v18
  v_mfma_f32_16x16x32_bf16 v[44:47], a[228:231], v[52:55], v[44:47]
  s_waitcnt lgkmcnt(2)
  ds_read_b128 v[52:55], v11 offset:29696
  v_mfma_f32_16x16x32_bf16 v[32:35], a[40:43], v[56:59], v[32:35]
  v_exp_f32 v94, v94
  v_mfma_f32_16x16x32_bf16 v[36:39], a[104:107], v[56:59], v[36:39]
  buffer_load_dwordx4 v1, s[4:7], s59 offen offset:3072 sc1 lds
  v_mfma_f32_16x16x32_bf16 v[40:43], a[168:171], v[56:59], v[40:43]
  v_mul_f32 v26, v26, v18
  v_fma_f32 v94, v94, v120, v120
  v_mfma_f32_16x16x32_bf16 v[44:47], a[232:235], v[56:59], v[44:47]
  s_waitcnt lgkmcnt(2)
  ds_read_b128 v[56:59], v11 offset:30720
  v_mfma_f32_16x16x32_bf16 v[32:35], a[44:47], v[60:63], v[32:35]
  v_rcp_f32 v94, v94
  v_mfma_f32_16x16x32_bf16 v[36:39], a[108:111], v[60:63], v[36:39]
  v_mul_f32 v25, v25, v93
  s_add_u32 m0, s63, 8192
  v_mfma_f32_16x16x32_bf16 v[40:43], a[172:175], v[60:63], v[40:43]
  s_add_u32 s59, s59, 4096
  buffer_load_dwordx4 v1, s[4:7], s59 offen offset:0 sc1 lds
  v_mfma_f32_16x16x32_bf16 v[44:47], a[236:239], v[60:63], v[44:47]
  s_waitcnt lgkmcnt(2)
  v_fmac_f32 v19, v65, v71
  ds_read_b128 v[60:63], v11 offset:31744
  v_mfma_f32_16x16x32_bf16 v[32:35], a[48:51], v[48:51], v[32:35]
  v_fmac_f32 v27, v65, v79
  v_mul_f32 v19, v64, v19
  v_mfma_f32_16x16x32_bf16 v[36:39], a[112:115], v[48:51], v[36:39]
  v_mul_f32 v95, v19, v19
  v_fma_f32 v95, v95, v9, v8
  v_mfma_f32_16x16x32_bf16 v[40:43], a[176:179], v[48:51], v[40:43]
  v_mul_f32 v95, v95, v19
  v_mfma_f32_16x16x32_bf16 v[44:47], a[240:243], v[48:51], v[44:47]
  s_waitcnt lgkmcnt(2)
  v_exp_f32 v95, v95
  v_mfma_f32_16x16x32_bf16 v[32:35], a[52:55], v[52:55], v[32:35]
  v_mul_f32 v27, v27, v19
  v_fma_f32 v95, v95, v120, v120
  v_mfma_f32_16x16x32_bf16 v[36:39], a[116:119], v[52:55], v[36:39]
  v_rcp_f32 v95, v95
  v_mfma_f32_16x16x32_bf16 v[40:43], a[180:183], v[52:55], v[40:43]
  v_mul_f32 v26, v26, v94
  v_fmac_f32 v20, v65, v72
  v_mfma_f32_16x16x32_bf16 v[44:47], a[244:247], v[52:55], v[44:47]
  s_waitcnt lgkmcnt(1)
  v_fmac_f32 v28, v65, v80
  v_mul_f32 v20, v64, v20
  v_mfma_f32_16x16x32_bf16 v[32:35], a[56:59], v[56:59], v[32:35]
  v_mul_f32 v96, v20, v20
  v_fma_f32 v96, v96, v9, v8
  v_mfma_f32_16x16x32_bf16 v[36:39], a[120:123], v[56:59], v[36:39]
  v_mul_f32 v96, v96, v20
  v_mfma_f32_16x16x32_bf16 v[40:43], a[184:187], v[56:59], v[40:43]
  v_exp_f32 v96, v96
  v_mfma_f32_16x16x32_bf16 v[44:47], a[248:251], v[56:59], v[44:47]
  s_waitcnt lgkmcnt(0)
  v_mul_f32 v28, v28, v20
  v_fma_f32 v96, v96, v120, v120
  v_mfma_f32_16x16x32_bf16 v[32:35], a[60:63], v[60:63], v[32:35]
  v_rcp_f32 v96, v96
  v_mfma_f32_16x16x32_bf16 v[36:39], a[124:127], v[60:63], v[36:39]
  v_mul_f32 v27, v27, v95
  v_fmac_f32 v21, v65, v73
  v_mfma_f32_16x16x32_bf16 v[40:43], a[188:191], v[60:63], v[40:43]
  v_fmac_f32 v29, v65, v81
  v_mul_f32 v21, v64, v21
  v_mfma_f32_16x16x32_bf16 v[44:47], a[252:255], v[60:63], v[44:47]
  v_mul_f32 v97, v21, v21
  v_fma_f32 v97, v97, v9, v8
  v_mul_f32 v97, v97, v21
  v_exp_f32 v97, v97
  v_mul_f32 v29, v29, v21
  v_fma_f32 v97, v97, v120, v120
  v_rcp_f32 v97, v97
  v_mul_f32 v28, v28, v96
  v_fmac_f32 v22, v65, v74
  v_fmac_f32 v30, v65, v82
  v_mul_f32 v22, v64, v22
  v_mul_f32 v98, v22, v22
  v_fma_f32 v98, v98, v9, v8
  v_mul_f32 v98, v98, v22
  v_exp_f32 v98, v98
  v_mul_f32 v30, v30, v22
  v_fma_f32 v98, v98, v120, v120
  v_rcp_f32 v98, v98
  v_mul_f32 v29, v29, v97
  v_fmac_f32 v23, v65, v75
  v_fmac_f32 v31, v65, v83
  v_mul_f32 v23, v64, v23
  v_mul_f32 v99, v23, v23
  v_fma_f32 v99, v99, v9, v8
  v_mul_f32 v99, v99, v23
  v_exp_f32 v99, v99
  v_mul_f32 v31, v31, v23
  v_fma_f32 v99, v99, v120, v120
  v_rcp_f32 v99, v99
  v_mul_f32 v30, v30, v98
  v_mul_f32 v31, v31, v99
  v_cvt_pk_bf16_f32 v84, v24, v25
  v_cvt_pk_bf16_f32 v85, v26, v27
  v_cvt_pk_bf16_f32 v86, v28, v29
  v_cvt_pk_bf16_f32 v87, v30, v31
  s_add_u32 s3, s55, 0
  buffer_store_dwordx4 v[84:87], v1, s[4:7], s3 offen sc1
  s_branch fsc_2714
fpl_2713:
  s_waitcnt lgkmcnt(3)
  v_mfma_f32_16x16x32_bf16 v[32:35], a[8:11], v[56:59], v[32:35]
  buffer_load_dword v10, v7, s[4:7], s58 offen sc1
  v_mfma_f32_16x16x32_bf16 v[36:39], a[72:75], v[56:59], v[36:39]
  v_fmac_f32 v16, v65, v68
  v_fmac_f32 v24, v65, v76
  v_mfma_f32_16x16x32_bf16 v[40:43], a[136:139], v[56:59], v[40:43]
  v_mul_f32 v16, v64, v16
  v_mul_f32 v92, v16, v16
  v_mfma_f32_16x16x32_bf16 v[44:47], a[200:203], v[56:59], v[44:47]
  s_waitcnt lgkmcnt(2)
  v_fma_f32 v92, v92, v9, v8
  ds_read_b128 v[56:59], v11 offset:22528
  v_mfma_f32_16x16x32_bf16 v[32:35], a[12:15], v[60:63], v[32:35]
  v_mul_f32 v92, v92, v16
  v_mfma_f32_16x16x32_bf16 v[36:39], a[76:79], v[60:63], v[36:39]
  v_exp_f32 v92, v92
  v_mfma_f32_16x16x32_bf16 v[40:43], a[140:143], v[60:63], v[40:43]
  v_mul_f32 v24, v24, v16
  v_fma_f32 v92, v92, v120, v120
  v_mfma_f32_16x16x32_bf16 v[44:47], a[204:207], v[60:63], v[44:47]
  s_waitcnt lgkmcnt(2)
  ds_read_b128 v[60:63], v11 offset:23552
  v_mfma_f32_16x16x32_bf16 v[32:35], a[16:19], v[48:51], v[32:35]
  v_rcp_f32 v92, v92
  v_mfma_f32_16x16x32_bf16 v[36:39], a[80:83], v[48:51], v[36:39]
  v_fmac_f32 v17, v65, v69
  v_fmac_f32 v25, v65, v77
  v_mfma_f32_16x16x32_bf16 v[40:43], a[144:147], v[48:51], v[40:43]
  v_mul_f32 v17, v64, v17
  v_mul_f32 v93, v17, v17
  v_mfma_f32_16x16x32_bf16 v[44:47], a[208:211], v[48:51], v[44:47]
  s_waitcnt lgkmcnt(2)
  v_fma_f32 v93, v93, v9, v8
  ds_read_b128 v[48:51], v11 offset:24576
  v_mfma_f32_16x16x32_bf16 v[32:35], a[20:23], v[52:55], v[32:35]
  v_mul_f32 v93, v93, v17
  v_mfma_f32_16x16x32_bf16 v[36:39], a[84:87], v[52:55], v[36:39]
  v_exp_f32 v93, v93
  v_mfma_f32_16x16x32_bf16 v[40:43], a[148:151], v[52:55], v[40:43]
  v_mul_f32 v25, v25, v17
  v_fma_f32 v93, v93, v120, v120
  v_mfma_f32_16x16x32_bf16 v[44:47], a[212:215], v[52:55], v[44:47]
  s_waitcnt lgkmcnt(2)
  ds_read_b128 v[52:55], v11 offset:25600
  v_mfma_f32_16x16x32_bf16 v[32:35], a[24:27], v[56:59], v[32:35]
  v_rcp_f32 v93, v93
  v_mfma_f32_16x16x32_bf16 v[36:39], a[88:91], v[56:59], v[36:39]
  v_mul_f32 v24, v24, v92
  v_fmac_f32 v18, v65, v70
  v_mfma_f32_16x16x32_bf16 v[40:43], a[152:155], v[56:59], v[40:43]
  v_fmac_f32 v26, v65, v78
  v_mul_f32 v18, v64, v18
  v_mfma_f32_16x16x32_bf16 v[44:47], a[216:219], v[56:59], v[44:47]
  s_waitcnt lgkmcnt(2)
  v_mul_f32 v94, v18, v18
  ds_read_b128 v[56:59], v11 offset:26624
  v_mfma_f32_16x16x32_bf16 v[32:35], a[28:31], v[60:63], v[32:35]
  v_fma_f32 v94, v94, v9, v8
  v_mul_f32 v94, v94, v18
  v_mfma_f32_16x16x32_bf16 v[36:39], a[92:95], v[60:63], v[36:39]
  v_exp_f32 v94, v94
  v_mfma_f32_16x16x32_bf16 v[40:43], a[156:159], v[60:63], v[40:43]
  v_mul_f32 v26, v26, v18
  v_fma_f32 v94, v94, v120, v120
  v_mfma_f32_16x16x32_bf16 v[44:47], a[220:223], v[60:63], v[44:47]
  s_waitcnt lgkmcnt(2)
  ds_read_b128 v[60:63], v11 offset:27648
  v_mfma_f32_16x16x32_bf16 v[32:35], a[32:35], v[48:51], v[32:35]
  v_rcp_f32 v94, v94
  v_mfma_f32_16x16x32_bf16 v[36:39], a[96:99], v[48:51], v[36:39]
  v_mul_f32 v25, v25, v93
  v_fmac_f32 v19, v65, v71
  v_mfma_f32_16x16x32_bf16 v[40:43], a[160:163], v[48:51], v[40:43]
  v_fmac_f32 v27, v65, v79
  v_mul_f32 v19, v64, v19
  v_mfma_f32_16x16x32_bf16 v[44:47], a[224:227], v[48:51], v[44:47]
  s_waitcnt lgkmcnt(2)
  v_mul_f32 v95, v19, v19
  ds_read_b128 v[48:51], v11 offset:28672
  v_mfma_f32_16x16x32_bf16 v[32:35], a[36:39], v[52:55], v[32:35]
  v_fma_f32 v95, v95, v9, v8
  v_mul_f32 v95, v95, v19
  v_mfma_f32_16x16x32_bf16 v[36:39], a[100:103], v[52:55], v[36:39]
  v_exp_f32 v95, v95
  v_mfma_f32_16x16x32_bf16 v[40:43], a[164:167], v[52:55], v[40:43]
  v_mul_f32 v27, v27, v19
  v_fma_f32 v95, v95, v120, v120
  v_mfma_f32_16x16x32_bf16 v[44:47], a[228:231], v[52:55], v[44:47]
  s_waitcnt lgkmcnt(2)
  ds_read_b128 v[52:55], v11 offset:29696
  v_mfma_f32_16x16x32_bf16 v[32:35], a[40:43], v[56:59], v[32:35]
  v_rcp_f32 v95, v95
  v_mfma_f32_16x16x32_bf16 v[36:39], a[104:107], v[56:59], v[36:39]
  v_mul_f32 v26, v26, v94
  v_fmac_f32 v20, v65, v72
  v_mfma_f32_16x16x32_bf16 v[40:43], a[168:171], v[56:59], v[40:43]
  v_fmac_f32 v28, v65, v80
  v_mul_f32 v20, v64, v20
  v_mfma_f32_16x16x32_bf16 v[44:47], a[232:235], v[56:59], v[44:47]
  s_waitcnt lgkmcnt(2)
  v_mul_f32 v96, v20, v20
  ds_read_b128 v[56:59], v11 offset:30720
  v_mfma_f32_16x16x32_bf16 v[32:35], a[44:47], v[60:63], v[32:35]
  v_fma_f32 v96, v96, v9, v8
  v_mul_f32 v96, v96, v20
  v_mfma_f32_16x16x32_bf16 v[36:39], a[108:111], v[60:63], v[36:39]
  v_exp_f32 v96, v96
  v_mfma_f32_16x16x32_bf16 v[40:43], a[172:175], v[60:63], v[40:43]
  v_mul_f32 v28, v28, v20
  v_fma_f32 v96, v96, v120, v120
  v_mfma_f32_16x16x32_bf16 v[44:47], a[236:239], v[60:63], v[44:47]
  s_waitcnt lgkmcnt(2)
  ds_read_b128 v[60:63], v11 offset:31744
  v_mfma_f32_16x16x32_bf16 v[32:35], a[48:51], v[48:51], v[32:35]
  v_rcp_f32 v96, v96
  v_mfma_f32_16x16x32_bf16 v[36:39], a[112:115], v[48:51], v[36:39]
  v_mul_f32 v27, v27, v95
  v_fmac_f32 v21, v65, v73
  v_mfma_f32_16x16x32_bf16 v[40:43], a[176:179], v[48:51], v[40:43]
  v_fmac_f32 v29, v65, v81
  v_mul_f32 v21, v64, v21
  v_mfma_f32_16x16x32_bf16 v[44:47], a[240:243], v[48:51], v[44:47]
  s_waitcnt lgkmcnt(2)
  v_mul_f32 v97, v21, v21
  v_fma_f32 v97, v97, v9, v8
  v_mfma_f32_16x16x32_bf16 v[32:35], a[52:55], v[52:55], v[32:35]
  v_mul_f32 v97, v97, v21
  v_mfma_f32_16x16x32_bf16 v[36:39], a[116:119], v[52:55], v[36:39]
  v_exp_f32 v97, v97
  v_mfma_f32_16x16x32_bf16 v[40:43], a[180:183], v[52:55], v[40:43]
  v_mul_f32 v29, v29, v21
  v_fma_f32 v97, v97, v120, v120
  v_mfma_f32_16x16x32_bf16 v[44:47], a[244:247], v[52:55], v[44:47]
  s_waitcnt lgkmcnt(1)
  v_rcp_f32 v97, v97
  v_mfma_f32_16x16x32_bf16 v[32:35], a[56:59], v[56:59], v[32:35]
  v_mul_f32 v28, v28, v96
  v_fmac_f32 v22, v65, v74
  v_mfma_f32_16x16x32_bf16 v[36:39], a[120:123], v[56:59], v[36:39]
  v_fmac_f32 v30, v65, v82
  v_mul_f32 v22, v64, v22
  v_mfma_f32_16x16x32_bf16 v[40:43], a[184:187], v[56:59], v[40:43]
  v_mul_f32 v98, v22, v22
  v_fma_f32 v98, v98, v9, v8
  v_mfma_f32_16x16x32_bf16 v[44:47], a[248:251], v[56:59], v[44:47]
  s_waitcnt lgkmcnt(0)
  v_mul_f32 v98, v98, v22
  v_mfma_f32_16x16x32_bf16 v[32:35], a[60:63], v[60:63], v[32:35]
  v_exp_f32 v98, v98
  v_mfma_f32_16x16x32_bf16 v[36:39], a[124:127], v[60:63], v[36:39]
  v_mul_f32 v30, v30, v22
  v_fma_f32 v98, v98, v120, v120
  v_mfma_f32_16x16x32_bf16 v[40:43], a[188:191], v[60:63], v[40:43]
  v_rcp_f32 v98, v98
  v_mfma_f32_16x16x32_bf16 v[44:47], a[252:255], v[60:63], v[44:47]
  v_mul_f32 v29, v29, v97
  v_fmac_f32 v23, v65, v75
  v_fmac_f32 v31, v65, v83
  v_mul_f32 v23, v64, v23
  v_mul_f32 v99, v23, v23
  v_fma_f32 v99, v99, v9, v8
  v_mul_f32 v99, v99, v23
  v_exp_f32 v99, v99
  v_mul_f32 v31, v31, v23
  v_fma_f32 v99, v99, v120, v120
  v_rcp_f32 v99, v99
  v_mul_f32 v30, v30, v98
  v_mul_f32 v31, v31, v99
  v_cvt_pk_bf16_f32 v84, v24, v25
  v_cvt_pk_bf16_f32 v85, v26, v27
  v_cvt_pk_bf16_f32 v86, v28, v29
  v_cvt_pk_bf16_f32 v87, v30, v31
  s_add_u32 s3, s55, 0
  buffer_store_dwordx4 v[84:87], v1, s[4:7], s3 offen sc1
  s_waitcnt vmcnt(1)
  v_cmp_ne_u32 vcc, 0, v10
  s_add_u32 s63, s64, 0
  s_mul_i32 s59, s65, 36864
  s_add_u32 s59, s59, s54
  s_cmp_eq_u64 vcc, -1
  s_cselect_b32 s60, 1, 0
  s_cmp_lt_u32 s53, 64
  s_cselect_b32 s60, s60, 0
  s_cmp_eq_u32 s60, 0
  s_cbranch_scc1 fsc_2714
  s_add_u32 m0, s63, 0
  s_nop 0
  buffer_load_dwordx4 v1, s[4:7], s59 offen offset:0 sc1 lds
  buffer_load_dwordx4 v1, s[4:7], s59 offen offset:1024 sc1 lds
  v_pk_fma_f32 v[32:33], v[66:67], v[68:69], v[32:33] op_sel:[1,0,0] op_sel_hi:[1,1,1]
  v_pk_fma_f32 v[40:41], v[66:67], v[76:77], v[40:41] op_sel:[1,0,0] op_sel_hi:[1,1,1]
  v_pk_mul_f32 v[32:33], v[66:67], v[32:33] op_sel_hi:[0,1]
  v_pk_mul_f32 v[92:93], v[32:33], v[32:33]
  v_pk_fma_f32 v[92:93], v[92:93], v[8:9], v[8:9] op_sel:[0,1,0] op_sel_hi:[1,1,0]
  v_pk_mul_f32 v[92:93], v[92:93], v[32:33]
  v_exp_f32 v92, v92
  buffer_load_dwordx4 v1, s[4:7], s59 offen offset:2048 sc1 lds
  v_exp_f32 v93, v93
  v_pk_mul_f32 v[40:41], v[40:41], v[32:33]
  v_fma_f32 v92, v92, v121, v121
  v_fma_f32 v93, v93, v121, v121
  v_rcp_f32 v92, v92
  v_rcp_f32 v93, v93
  v_pk_fma_f32 v[34:35], v[66:67], v[70:71], v[34:35] op_sel:[1,0,0] op_sel_hi:[1,1,1]
  buffer_load_dwordx4 v1, s[4:7], s59 offen offset:3072 sc1 lds
  v_pk_fma_f32 v[42:43], v[66:67], v[78:79], v[42:43] op_sel:[1,0,0] op_sel_hi:[1,1,1]
  v_pk_mul_f32 v[34:35], v[66:67], v[34:35] op_sel_hi:[0,1]
  v_pk_mul_f32 v[94:95], v[34:35], v[34:35]
  v_pk_fma_f32 v[94:95], v[94:95], v[8:9], v[8:9] op_sel:[0,1,0] op_sel_hi:[1,1,0]
  v_pk_mul_f32 v[94:95], v[94:95], v[34:35]
  v_exp_f32 v94, v94
  v_exp_f32 v95, v95
  s_add_u32 m0, s63, 4096
  s_add_u32 s59, s59, 4096
  buffer_load_dwordx4 v1, s[4:7], s59 offen offset:0 sc1 lds
  v_pk_mul_f32 v[42:43], v[42:43], v[34:35]
  v_fma_f32 v94, v94, v121, v121
  v_fma_f32 v95, v95, v121, v121
  v_rcp_f32 v94, v94
  v_rcp_f32 v95, v95
  v_pk_fma_f32 v[36:37], v[66:67], v[72:73], v[36:37] op_sel:[1,0,0] op_sel_hi:[1,1,1]
  v_pk_fma_f32 v[44:45], v[66:67], v[80:81], v[44:45] op_sel:[1,0,0] op_sel_hi:[1,1,1]
  buffer_load_dwordx4 v1, s[4:7], s59 offen offset:1024 sc1 lds
  v_pk_mul_f32 v[36:37], v[66:67], v[36:37] op_sel_hi:[0,1]
  v_pk_mul_f32 v[96:97], v[36:37], v[36:37]
  v_pk_fma_f32 v[96:97], v[96:97], v[8:9], v[8:9] op_sel:[0,1,0] op_sel_hi:[1,1,0]
  v_pk_mul_f32 v[96:97], v[96:97], v[36:37]
  v_exp_f32 v96, v96
  v_exp_f32 v97, v97
  v_pk_mul_f32 v[44:45], v[44:45], v[36:37]
  buffer_load_dwordx4 v1, s[4:7], s59 offen offset:2048 sc1 lds
  v_fma_f32 v96, v96, v121, v121
  v_fma_f32 v97, v97, v121, v121
  v_rcp_f32 v96, v96
  v_rcp_f32 v97, v97
  v_pk_fma_f32 v[38:39], v[66:67], v[74:75], v[38:39] op_sel:[1,0,0] op_sel_hi:[1,1,1]
  v_pk_fma_f32 v[46:47], v[66:67], v[82:83], v[46:47] op_sel:[1,0,0] op_sel_hi:[1,1,1]
  v_pk_mul_f32 v[38:39], v[66:67], v[38:39] op_sel_hi:[0,1]
  buffer_load_dwordx4 v1, s[4:7], s59 offen offset:3072 sc1 lds
  v_pk_mul_f32 v[98:99], v[38:39], v[38:39]
  v_pk_fma_f32 v[98:99], v[98:99], v[8:9], v[8:9] op_sel:[0,1,0] op_sel_hi:[1,1,0]
  v_pk_mul_f32 v[98:99], v[98:99], v[38:39]
  v_exp_f32 v98, v98
  v_exp_f32 v99, v99
  v_pk_mul_f32 v[46:47], v[46:47], v[38:39]
  v_fma_f32 v98, v98, v121, v121
  s_add_u32 m0, s63, 8192
  s_add_u32 s59, s59, 4096
  buffer_load_dwordx4 v1, s[4:7], s59 offen offset:0 sc1 lds
  v_fma_f32 v99, v99, v121, v121
  v_rcp_f32 v98, v98
  v_rcp_f32 v99, v99
  v_pk_mul_f32 v[40:41], v[40:41], v[92:93]
  v_pk_mul_f32 v[42:43], v[42:43], v[94:95]
  v_pk_mul_f32 v[44:45], v[44:45], v[96:97]
  v_pk_mul_f32 v[46:47], v[46:47], v[98:99]
  v_cvt_pk_bf16_f32 v88, v40, v41
  v_cvt_pk_bf16_f32 v89, v42, v43
  v_cvt_pk_bf16_f32 v90, v44, v45
  v_cvt_pk_bf16_f32 v91, v46, v47
  s_add_u32 s3, s55, 57344
  buffer_store_dwordx4 v[88:91], v1, s[4:7], s3 offen sc1
  s_branch fsc_2715
fsc_2714:
  v_pk_fma_f32 v[32:33], v[66:67], v[68:69], v[32:33] op_sel:[1,0,0] op_sel_hi:[1,1,1]
  v_pk_fma_f32 v[40:41], v[66:67], v[76:77], v[40:41] op_sel:[1,0,0] op_sel_hi:[1,1,1]
  v_pk_mul_f32 v[32:33], v[66:67], v[32:33] op_sel_hi:[0,1]
  v_pk_mul_f32 v[92:93], v[32:33], v[32:33]
  v_pk_fma_f32 v[92:93], v[92:93], v[8:9], v[8:9] op_sel:[0,1,0] op_sel_hi:[1,1,0]
  v_pk_mul_f32 v[92:93], v[92:93], v[32:33]
  v_exp_f32 v92, v92
  v_exp_f32 v93, v93
  v_pk_mul_f32 v[40:41], v[40:41], v[32:33]
  v_fma_f32 v92, v92, v121, v121
  v_fma_f32 v93, v93, v121, v121
  v_rcp_f32 v92, v92
  v_rcp_f32 v93, v93
  v_pk_fma_f32 v[34:35], v[66:67], v[70:71], v[34:35] op_sel:[1,0,0] op_sel_hi:[1,1,1]
  v_pk_fma_f32 v[42:43], v[66:67], v[78:79], v[42:43] op_sel:[1,0,0] op_sel_hi:[1,1,1]
  v_pk_mul_f32 v[34:35], v[66:67], v[34:35] op_sel_hi:[0,1]
  v_pk_mul_f32 v[94:95], v[34:35], v[34:35]
  v_pk_fma_f32 v[94:95], v[94:95], v[8:9], v[8:9] op_sel:[0,1,0] op_sel_hi:[1,1,0]
  v_pk_mul_f32 v[94:95], v[94:95], v[34:35]
  v_exp_f32 v94, v94
  v_exp_f32 v95, v95
  v_pk_mul_f32 v[42:43], v[42:43], v[34:35]
  v_fma_f32 v94, v94, v121, v121
  v_fma_f32 v95, v95, v121, v121
  v_rcp_f32 v94, v94
  v_rcp_f32 v95, v95
  v_pk_fma_f32 v[36:37], v[66:67], v[72:73], v[36:37] op_sel:[1,0,0] op_sel_hi:[1,1,1]
  v_pk_fma_f32 v[44:45], v[66:67], v[80:81], v[44:45] op_sel:[1,0,0] op_sel_hi:[1,1,1]
  v_pk_mul_f32 v[36:37], v[66:67], v[36:37] op_sel_hi:[0,1]
  v_pk_mul_f32 v[96:97], v[36:37], v[36:37]
  v_pk_fma_f32 v[96:97], v[96:97], v[8:9], v[8:9] op_sel:[0,1,0] op_sel_hi:[1,1,0]
  v_pk_mul_f32 v[96:97], v[96:97], v[36:37]
  v_exp_f32 v96, v96
  v_exp_f32 v97, v97
  v_pk_mul_f32 v[44:45], v[44:45], v[36:37]
  v_fma_f32 v96, v96, v121, v121
  v_fma_f32 v97, v97, v121, v121
  v_rcp_f32 v96, v96
  v_rcp_f32 v97, v97
  v_pk_fma_f32 v[38:39], v[66:67], v[74:75], v[38:39] op_sel:[1,0,0] op_sel_hi:[1,1,1]
  v_pk_fma_f32 v[46:47], v[66:67], v[82:83], v[46:47] op_sel:[1,0,0] op_sel_hi:[1,1,1]
  v_pk_mul_f32 v[38:39], v[66:67], v[38:39] op_sel_hi:[0,1]
  v_pk_mul_f32 v[98:99], v[38:39], v[38:39]
  v_pk_fma_f32 v[98:99], v[98:99], v[8:9], v[8:9] op_sel:[0,1,0] op_sel_hi:[1,1,0]
  v_pk_mul_f32 v[98:99], v[98:99], v[38:39]
  v_exp_f32 v98, v98
  v_exp_f32 v99, v99
  v_pk_mul_f32 v[46:47], v[46:47], v[38:39]
  v_fma_f32 v98, v98, v121, v121
  v_fma_f32 v99, v99, v121, v121
  v_rcp_f32 v98, v98
  v_rcp_f32 v99, v99
  v_pk_mul_f32 v[40:41], v[40:41], v[92:93]
  v_pk_mul_f32 v[42:43], v[42:43], v[94:95]
  v_pk_mul_f32 v[44:45], v[44:45], v[96:97]
  v_pk_mul_f32 v[46:47], v[46:47], v[98:99]
  v_cvt_pk_bf16_f32 v88, v40, v41
  v_cvt_pk_bf16_f32 v89, v42, v43
  v_cvt_pk_bf16_f32 v90, v44, v45
  v_cvt_pk_bf16_f32 v91, v46, v47
  s_add_u32 s3, s55, 57344
  buffer_store_dwordx4 v[88:91], v1, s[4:7], s3 offen sc1
fsc_2715:
  s_mov_b32 s61, s56
  s_lshl_b32 s92, s65, 13
  s_add_u32 s56, s56, s92
  s_mul_i32 s92, s65, 114688
  s_add_u32 s55, s55, s92
  s_mul_i32 s92, s65, 36864
  s_add_u32 s54, s54, s92
  s_cmp_lg_u32 s60, 0
  s_cbranch_scc1 f1n_2716
  s_cmp_ge_u32 s53, 64
  s_cbranch_scc1 F1_END
  buffer_load_dword v10, v7, s[4:7], s58 offen sc1
  s_waitcnt vmcnt(0)
  v_cmp_eq_u32 vcc, 0, v10
  s_mov_b64 exec, 1
  buffer_store_dword v5, off, s[4:7], s61 sc1
  s_mov_b64 exec, -1
  s_cbranch_vccz polld_2718
  s_mov_b32 s101, 0
poll_2717:
  s_add_u32 s47, s47, 1
  s_mov_b32 s49, 5
  s_cmp_gt_u32 s47, 131072
  s_cbranch_scc1 TIMEOUT
  s_sleep 3
  buffer_load_dword v10, v7, s[4:7], s58 offen sc1
  s_waitcnt vmcnt(0)
  v_cmp_eq_u32 vcc, 0, v10
  s_nop 0
  s_cbranch_vccnz poll_2717
polld_2718:
  s_mov_b32 s59, s54
  s_add_u32 m0, s63, 0
  s_nop 0
  buffer_load_dwordx4 v1, s[4:7], s59 offen offset:0 sc1 lds
  buffer_load_dwordx4 v1, s[4:7], s59 offen offset:1024 sc1 lds
  buffer_load_dwordx4 v1, s[4:7], s59 offen offset:2048 sc1 lds
  buffer_load_dwordx4 v1, s[4:7], s59 offen offset:3072 sc1 lds
  s_add_u32 m0, s63, 4096
  s_add_u32 s59, s59, 4096
  buffer_load_dwordx4 v1, s[4:7], s59 offen offset:0 sc1 lds
  buffer_load_dwordx4 v1, s[4:7], s59 offen offset:1024 sc1 lds
  buffer_load_dwordx4 v1, s[4:7], s59 offen offset:2048 sc1 lds
  buffer_load_dwordx4 v1, s[4:7], s59 offen offset:3072 sc1 lds
  s_add_u32 m0, s63, 8192
  s_add_u32 s59, s59, 4096
  buffer_load_dwordx4 v1, s[4:7], s59 offen offset:0 sc1 lds
  s_waitcnt vmcnt(0)
f1n_2716:
  s_branch F1_LOOP
F1_END:
  s_waitcnt vmcnt(0)
  s_mov_b64 exec, 1
  buffer_store_dword v5, off, s[4:7], s61 sc1
  s_mov_b64 exec, -1
  s_cmp_lg_u32 s50, 0
  s_cbranch_scc1 END
  s_mov_b32 s50, 1
  s_mov_b32 s53, 57
  s_branch F1_INIT
TIMEOUT:
  s_lshl_b32 s92, s49, 16
  s_lshl_b32 s93, s44, 8
  s_or_b32 s92, s92, s93
  s_or_b32 s92, s92, s45
  s_or_b32 s92, s92, 0x40000000
  s_mov_b64 exec, 1
  v_mov_b32 v2, s92
  s_lshl_b32 s93, s49, 2
  s_add_u32 s93, s93, 192
  v_mov_b32 v3, s93
  buffer_store_dword v2, v3, s[12:15], 0 offen sc1
END:
  s_endpgm
.section .rodata,"a"
.p2align 6
.amdhsa_kernel interleave_layers__memory_aug_recurrent_mem_tr__glu_gated_geglu__prompt_kernel
  .amdhsa_next_free_vgpr 512
  .amdhsa_next_free_sgpr 102
  .amdhsa_accum_offset 256
  .amdhsa_group_segment_fixed_size 0
  .amdhsa_kernarg_size 112
  .amdhsa_user_sgpr_count 2
  .amdhsa_user_sgpr_kernarg_segment_ptr 1
  .amdhsa_system_sgpr_workgroup_id_x 1
  .amdhsa_float_denorm_mode_32 3
.end_amdhsa_kernel
```
